```python
import torch

def _softmax(x, axis=-1):
    return torch.softmax(x, dim=axis)

def _gelu(x):
    return torch.nn.functional.gelu(x, approximate='tanh')

def _silu(x):
    return torch.nn.functional.silu(x)

def _sigmoid(x):
    return torch.sigmoid(x)

def _layernorm(x, axis=-1, eps=1e-05):
    m = x.mean(dim=axis, keepdim=True)
    v = x.var(dim=axis, keepdim=True, unbiased=False)
    return (x - m) / torch.sqrt(v + eps)

def _scatter_add(tgt, idx, src, axis=0):
    return tgt.clone().index_add_(axis, idx, src)

def _segment_sum(src, seg, n):
    out = torch.zeros((n,) + src.shape[1:], dtype=src.dtype)
    return out.index_add_(0, seg, src)

def _pad(x, pw):
    flat = tuple((v for pair in reversed(pw) for v in pair))
    return torch.nn.functional.pad(x, flat)
kernel_name = 'gated_mix__memory_aug_recurrent_mem_tr__softmax_full_mha__prompt'

def setup_inputs():

    _w = lambda a: (lambda t: t.to(torch.bfloat16) if t.is_floating_point() else t)(torch.as_tensor(a))

    def _A_setup():
        B, S, Dm = (1, 2048, 512)
        H, Dh = (32, 128)
        M, seg = (8, 32)
        seg = min(seg, S)
        S = S // seg * seg
        return {'x': _w((lambda *s: torch.randn(*s, dtype=torch.bfloat16) * 0.05)(B, S, Dm)), 'mem0': _w((lambda *s: torch.randn(*s, dtype=torch.bfloat16) * 0.8)(B, M, Dm)), 'Wq': _w((lambda *s: torch.randn(*s, dtype=torch.bfloat16) * 1.6)(Dm, H, Dh) * Dm ** (-0.5)), 'Wk': _w((lambda *s: torch.randn(*s, dtype=torch.bfloat16) * 1.6)(Dm, H, Dh) * Dm ** (-0.5)), 'Wv': _w((lambda *s: torch.randn(*s, dtype=torch.bfloat16) * 0.8)(Dm, H, Dh) * Dm ** (-0.5)), 'Wo': _w((lambda *s: torch.randn(*s, dtype=torch.bfloat16) * 0.8)(H, Dh, Dm) * (H * Dh) ** (-0.5)), 'seg_len': seg}
    _A_in = _A_setup()

    def _B_setup():
        B, S, D = (1, 2048, 512)
        return {'x': _w((lambda *s: torch.randn(*s, dtype=torch.bfloat16) * 0.05)(B, S, D)), 'wqkv': _w((lambda *s: torch.randn(*s, dtype=torch.bfloat16) * 0.8)(D, 3 * D)), 'wo': _w((lambda *s: torch.randn(*s, dtype=torch.bfloat16) * 0.05)(D, D))}
    _B_in = _B_setup()
    return {'A_x': _A_in['x'], 'A_mem0': _A_in['mem0'], 'A_Wq': _A_in['Wq'], 'A_Wk': _A_in['Wk'], 'A_Wv': _A_in['Wv'], 'A_Wo': _A_in['Wo'], 'A_seg_len': _A_in['seg_len'], 'B_x': _B_in['x'], 'B_wqkv': _B_in['wqkv'], 'B_wo': _B_in['wo'], 'gate_w': _w((lambda *s: torch.randn(*s, dtype=torch.bfloat16) * 0.05)(512) * 16.0)}

def reference(A_x, A_mem0, A_Wq, A_Wk, A_Wv, A_Wo, A_seg_len, B_x, B_wqkv, B_wo, gate_w):

    def _A_ref(x, mem0, Wq, Wk, Wv, Wo, seg_len):
        B, S, Dm = x.shape
        H, Dh = (Wq.shape[1], Wq.shape[2])
        M = mem0.shape[1]
        scale = Dh ** (-0.5)
        n_seg = S // seg_len
        L = M + seg_len
        idx = torch.arange(L)
        mask = (idx[:, None] < M) | (idx[:, None] >= idx[None, :])
        mem = mem0
        outs = []
        for s in range(n_seg):
            xs = x[:, s * seg_len:(s + 1) * seg_len, :].clone()
            h = torch.concatenate([mem, xs], axis=1)
            q = torch.einsum('btd,dhe->bhte', h, Wq)
            k = torch.einsum('btd,dhe->bhte', h, Wk)
            v = torch.einsum('btd,dhe->bhte', h, Wv)
            scores = torch.einsum('bhqe,bhke->bhqk', q, k) * scale
            scores = torch.where(mask[None, None], scores, -1000000000.0)
            p = _softmax(scores, axis=-1)
            o = torch.einsum('bhqk,bhke->bhqe', p, v)
            o = torch.einsum('bhte,hed->btd', o, Wo)
            mem = o[:, :M, :].clone()
            outs.append(o[:, M:, :])
        return torch.concatenate(outs, axis=1)

    def _B_ref(x, wqkv, wo):
        B, S, D = x.shape
        H = 32
        Dh = D // H
        qkv = (lambda x, *d: x.permute(*d))((x @ wqkv).reshape(B, S, 3, H, Dh), 2, 0, 3, 1, 4)
        q, k, v = (qkv[0], qkv[1], qkv[2])
        scale = Dh ** (-0.5)
        scores = torch.einsum('bhqd,bhkd->bhqk', q, k) * scale
        p = _softmax(scores, axis=-1)
        o = torch.einsum('bhqk,bhkd->bhqd', p, v)
        return (lambda x, *d: x.permute(*d))(o, 0, 2, 1, 3).reshape(B, S, D) @ wo
    x = A_x
    g = _sigmoid((x * gate_w).sum(-1, keepdims=True))
    a = _A_ref(x, A_mem0, A_Wq, A_Wk, A_Wv, A_Wo, A_seg_len)
    b = _B_ref(x, B_wqkv, B_wo)
    return g * a + (1 - g) * b
```

```asm
; @launch grid=(256,1,1) block=(256,1,1) lds=163840
.amdgcn_target "amdgcn-amd-amdhsa--gfx950"
.text
.globl gated_mix__memory_aug_recurrent_mem_tr__softmax_full_mha__prompt_kernel
.p2align 8
.type gated_mix__memory_aug_recurrent_mem_tr__softmax_full_mha__prompt_kernel,@function
gated_mix__memory_aug_recurrent_mem_tr__softmax_full_mha__prompt_kernel:
    s_getpc_b64 s[28:29]
    s_cmp_ge_u32 s2, 256
    s_cbranch_scc1 L_end
    s_load_dwordx4 s[64:67], s[0:1], 96
    s_load_dwordx8 s[16:23], s[0:1], 16
    s_lshr_b32 s56, s2, 3
    s_lshl_b32 s56, s56, 8
    v_add_u32 v1, s56, v0
    v_mul_u32_u24 v1, 12, v1
    v_min_u32 v1, L_end-gated_mix__memory_aug_recurrent_mem_tr__softmax_full_mha__prompt_kernel-16, v1
    global_load_dword v239, v1, s[28:29]
    s_load_dwordx2 s[24:25], s[0:1], 0
    s_load_dwordx2 s[26:27], s[0:1], 64
    v_lshrrev_b32 v1, 6, v0
    s_getreg_b32 s63, hwreg(HW_REG_XCC_ID)
    v_readfirstlane_b32 s62, v1
    v_and_b32 v0, 63, v0
    s_xor_b32 s63, s63, 2
    s_and_b32 s63, s63, 7
    s_mov_b32 s60, s63
    s_bfe_u32 s61, s2, 0x50003
    s_cmp_eq_u32 s62, 0
    s_cbranch_scc0 L_nc
    s_lshl_b32 s58, s60, 2
    s_cmp_eq_u32 s60, 0
    s_cselect_b32 s58, 128, s58
    s_lshl_b32 s57, 1, s61
    v_mov_b32 v1, s58
    v_mov_b32 v2, s57
    s_mov_b64 exec, 1
    s_waitcnt lgkmcnt(0)
    global_atomic_or v3, v1, v2, s[64:65] sc0
    s_mov_b64 exec, -1
L_nc:
    s_waitcnt lgkmcnt(0)
    s_mov_b32 s4, s66
    s_mov_b32 s5, s67
    s_mov_b32 s6, 268435456
    s_mov_b32 s7, 0x20000
    s_barrier
    s_mov_b32 s59, 1
    s_mov_b32 s8, s61
    s_cmp_eq_u32 s63, 0
    s_cbranch_scc0 L_nrec
L_rec:
    s_mov_b32 s44, s22
    s_mov_b32 s45, s23
    s_mov_b32 s46, 4194304
    s_mov_b32 s47, 0x20000
    v_lshrrev_b32 v33, 3, v0
    v_lshlrev_b32 v33, 10, v33
    v_and_b32 v22, 7, v0
    v_lshl_add_u32 v33, v22, 4, v33
    s_mul_i32 s56, s62, 34816
    s_add_u32 m0, s56, 43008
    s_lshl_b32 s49, s8, 17
    s_lshl_b32 s56, s62, 8
    s_add_u32 s49, s49, s56
    s_mov_b32 s56, s49
    s_add_u32 s57, s49, 131072
L_wo0:
    buffer_load_dwordx4 v33, s[44:47], s56 offen lds
    s_add_u32 m0, m0, 1024
    s_add_u32 s56, s56, 8192
    s_cmp_lt_u32 s56, s57
    s_cbranch_scc1 L_wo0
    s_branch L_rec2
L_nrec:
    s_cmp_eq_u32 s62, 0
    s_cbranch_scc0 L_oth
L_try1:
    s_waitcnt vmcnt(0)
    v_readfirstlane_b32 s56, v3
    s_bitcmp1_b32 s56, s61
    s_cbranch_scc1 L_next
L_got:
    s_lshl_b32 s60, s60, 5
    s_add_u32 s60, s60, s61
    v_mov_b32 v3, s60
    v_mov_b32 v1, 0
    ds_write_b32 v1, v3
    s_waitcnt lgkmcnt(0)
L_tk:
    s_barrier
    v_mov_b32 v1, 0
    ds_read_b32 v3, v1
    s_waitcnt lgkmcnt(0)
    v_readfirstlane_b32 s60, v3
    s_barrier
    s_mov_b32 s59, 0
    s_mov_b32 s8, s60
    s_cmp_lt_u32 s60, 32
    s_cbranch_scc1 L_rec
    s_branch L_work
L_next:
    s_ff0_i32_b32 s61, s56
    s_cmp_lg_u32 s56, -1
    s_cbranch_scc1 L_again
    s_mov_b32 s61, 0
    s_add_u32 s60, s60, 1
    s_and_b32 s60, s60, 7
    s_cmp_lg_u32 s60, s63
    s_cselect_b32 s60, s60, 8
    s_cbranch_scc0 L_got
    s_cmp_lg_u32 s60, 0
    s_cbranch_scc1 L_again
    v_mov_b32 v1, 136
    v_mov_b32 v2, 1
    s_mov_b64 exec, 1
    global_atomic_or v3, v1, v2, s[64:65] sc0
    s_mov_b64 exec, -1
    s_waitcnt vmcnt(0)
L_again:
    s_lshl_b32 s58, s60, 2
    s_cmp_eq_u32 s60, 0
    s_cselect_b32 s58, 128, s58
    s_lshl_b32 s57, 1, s61
    v_mov_b32 v1, s58
    v_mov_b32 v2, s57
    s_mov_b64 exec, 1
    global_atomic_or v3, v1, v2, s[64:65] sc0
    s_mov_b64 exec, -1
    s_branch L_try1
L_lost2:
    s_mov_b32 s60, s63
L_lost:
    s_load_dwordx2 s[24:25], s[0:1], 0
    s_load_dwordx2 s[26:27], s[0:1], 64
    s_load_dwordx8 s[16:23], s[0:1], 16
    s_waitcnt vmcnt(0) lgkmcnt(0)
    s_barrier
    s_cmp_eq_u32 s62, 0
    s_cbranch_scc1 L_try1
    s_branch L_tk
L_oth:
    s_lshr_b32 s56, s2, 3
    s_mul_i32 s56, s56, 7
    s_add_u32 s56, s56, s63
    s_mul_i32 s56, s56, 3
    s_add_u32 s56, s56, s62
    s_sub_u32 s56, s56, 4
    s_mul_i32 s57, s56, 49
    v_min_u32 v1, 48, v0
    v_add_u32 v1, s57, v1
    v_lshlrev_b32 v1, 7, v1
    s_mul_i32 s57, s56, 25
    v_min_u32 v2, 24, v0
    v_add_u32 v2, s57, v2
    v_lshlrev_b32 v2, 7, v2
    s_mov_b32 s32, s18
    s_mov_b32 s33, s19
    s_mov_b32 s34, 4194304
    s_mov_b32 s35, 0x20000
    buffer_load_dword v240, v1, s[32:35], 0 offen
    s_mov_b32 s36, s20
    s_mov_b32 s37, s21
    s_mov_b32 s38, 4194304
    s_mov_b32 s39, 0x20000
    buffer_load_dword v241, v1, s[36:39], 0 offen
    s_branch L_tk
L_work:
    s_mov_b32 s55, s59
    s_cmp_ge_u32 s60, 256
    s_cbranch_scc1 L_end
    s_sub_u32 s60, s60, 32
    s_mov_b32 s70, 1048576
    s_cmp_lt_u32 s60, 128
    s_cbranch_scc1 L_g2
    s_cmp_ge_u32 s60, 216
    s_cbranch_scc1 L_g2
    s_sub_u32 s56, s60, 128
    s_lshl_b32 s56, s56, 2
    s_add_u32 s56, s56, s62
    s_mul_i32 s57, s56, 94
    v_add_u32 v1, s57, v0
    v_lshlrev_b32 v1, 7, v1
    v_min_u32 v2, 29, v0
    v_add_u32 v2, 64, v2
    v_add_u32 v2, s57, v2
    v_lshlrev_b32 v2, 7, v2
    s_mul_i32 s57, s56, 47
    v_min_u32 v3, 46, v0
    v_add_u32 v3, s57, v3
    v_lshlrev_b32 v3, 7, v3
    s_mov_b32 s32, s16
    s_mov_b32 s33, s17
    s_mov_b32 s34, 4194304
    s_mov_b32 s35, 0x20000
    buffer_load_dword v240, v1, s[32:35], 0 offen
    buffer_load_dword v240, v2, s[32:35], 0 offen
    s_mov_b32 s36, s22
    s_mov_b32 s37, s23
    s_mov_b32 s38, 4194304
    s_mov_b32 s39, 0x20000
    buffer_load_dword v241, v1, s[36:39], 0 offen
    buffer_load_dword v241, v2, s[36:39], 0 offen
    s_mov_b32 s40, s26
    s_mov_b32 s41, s27
    s_mov_b32 s42, 1572864
    s_mov_b32 s43, 0x20000
    buffer_load_dword v242, v3, s[40:43], 0 offen
    s_waitcnt vmcnt(0)
L_g2:
    s_cmp_ge_u32 s60, 216
    s_cbranch_scc0 L_proj
    s_sub_u32 s59, s60, 216
    s_lshl_b32 s56, s59, 2
    s_add_u32 s56, s56, s62
    s_mul_i32 s57, s56, 33792
    s_add_u32 s57, s57, 50331648
    s_lshl_b32 s56, s56, 9
    s_add_u32 s56, s56, 95420416
    v_lshlrev_b32 v1, 4, v0
    v_lshlrev_b32 v2, 3, v0
    v_mov_b64 v[4:5], -1
    v_mov_b64 v[6:7], -1
    v_mov_b64 v[8:9], 0
    buffer_store_dwordx2 v[8:9], v2, s[4:7], s56 offen sc1
    s_waitcnt vmcnt(0)
    v_mov_b32 v2, 140
    v_mov_b32 v3, 1
    s_mov_b64 exec, 1
    global_atomic_add v2, v3, s[64:65]
    s_mov_b64 exec, -1
    buffer_store_dwordx4 v[4:7], v1, s[4:7], s57 offen offset:0 sc1
    buffer_store_dwordx4 v[4:7], v1, s[4:7], s57 offen offset:1024 sc1
    buffer_store_dwordx4 v[4:7], v1, s[4:7], s57 offen offset:2048 sc1
    buffer_store_dwordx4 v[4:7], v1, s[4:7], s57 offen offset:3072 sc1
    s_add_u32 s57, s57, 4096
    buffer_store_dwordx4 v[4:7], v1, s[4:7], s57 offen offset:0 sc1
    buffer_store_dwordx4 v[4:7], v1, s[4:7], s57 offen offset:1024 sc1
    buffer_store_dwordx4 v[4:7], v1, s[4:7], s57 offen offset:2048 sc1
    buffer_store_dwordx4 v[4:7], v1, s[4:7], s57 offen offset:3072 sc1
    s_add_u32 s57, s57, 4096
    buffer_store_dwordx4 v[4:7], v1, s[4:7], s57 offen offset:0 sc1
    buffer_store_dwordx4 v[4:7], v1, s[4:7], s57 offen offset:1024 sc1
    buffer_store_dwordx4 v[4:7], v1, s[4:7], s57 offen offset:2048 sc1
    buffer_store_dwordx4 v[4:7], v1, s[4:7], s57 offen offset:3072 sc1
    s_add_u32 s57, s57, 4096
    buffer_store_dwordx4 v[4:7], v1, s[4:7], s57 offen offset:0 sc1
    buffer_store_dwordx4 v[4:7], v1, s[4:7], s57 offen offset:1024 sc1
    buffer_store_dwordx4 v[4:7], v1, s[4:7], s57 offen offset:2048 sc1
    buffer_store_dwordx4 v[4:7], v1, s[4:7], s57 offen offset:3072 sc1
    s_add_u32 s57, s57, 4096
    buffer_store_dwordx4 v[4:7], v1, s[4:7], s57 offen offset:0 sc1
    buffer_store_dwordx4 v[4:7], v1, s[4:7], s57 offen offset:1024 sc1
    buffer_store_dwordx4 v[4:7], v1, s[4:7], s57 offen offset:2048 sc1
    buffer_store_dwordx4 v[4:7], v1, s[4:7], s57 offen offset:3072 sc1
    s_add_u32 s57, s57, 4096
    buffer_store_dwordx4 v[4:7], v1, s[4:7], s57 offen offset:0 sc1
    buffer_store_dwordx4 v[4:7], v1, s[4:7], s57 offen offset:1024 sc1
    buffer_store_dwordx4 v[4:7], v1, s[4:7], s57 offen offset:2048 sc1
    buffer_store_dwordx4 v[4:7], v1, s[4:7], s57 offen offset:3072 sc1
    s_add_u32 s57, s57, 4096
    buffer_store_dwordx4 v[4:7], v1, s[4:7], s57 offen offset:0 sc1
    buffer_store_dwordx4 v[4:7], v1, s[4:7], s57 offen offset:1024 sc1
    buffer_store_dwordx4 v[4:7], v1, s[4:7], s57 offen offset:2048 sc1
    buffer_store_dwordx4 v[4:7], v1, s[4:7], s57 offen offset:3072 sc1
    s_add_u32 s57, s57, 4096
    buffer_store_dwordx4 v[4:7], v1, s[4:7], s57 offen offset:0 sc1
    buffer_store_dwordx4 v[4:7], v1, s[4:7], s57 offen offset:1024 sc1
    buffer_store_dwordx4 v[4:7], v1, s[4:7], s57 offen offset:2048 sc1
    buffer_store_dwordx4 v[4:7], v1, s[4:7], s57 offen offset:3072 sc1
    s_add_u32 s57, s57, 4096
    buffer_store_dwordx4 v[4:7], v1, s[4:7], s57 offen offset:0 sc1
    s_waitcnt vmcnt(0)
    s_barrier
    s_cmp_eq_u32 s62, 0
    s_cbranch_scc0 L_clrd
    v_mov_b32 v1, 132
    v_mov_b32 v2, 1
    s_mov_b64 exec, 1
    global_atomic_add v1, v2, s[64:65]
    s_mov_b64 exec, -1
L_clrd:
    s_load_dwordx2 s[8:9], s[0:1], 0
    s_load_dwordx2 s[12:13], s[0:1], 80
    s_mov_b32 s10, 2097152
    s_mov_b32 s11, 0x20000
    v_lshlrev_b32 v1, 4, v0
    s_lshl_b32 s16, s59, 2
    s_add_u32 s16, s16, s62
    s_lshl_b32 s18, s16, 9
    s_lshl_b32 s16, s16, 16
    s_waitcnt lgkmcnt(0)
    global_load_dwordx4 v[4:7], v1, s[12:13]
    s_waitcnt vmcnt(0)
    v_lshlrev_b32 v8, 16, v4
    v_and_b32 v9, 0xffff0000, v4
    v_lshlrev_b32 v10, 16, v5
    v_and_b32 v11, 0xffff0000, v5
    v_lshlrev_b32 v12, 16, v6
    v_and_b32 v13, 0xffff0000, v6
    v_lshlrev_b32 v14, 16, v7
    v_and_b32 v15, 0xffff0000, v7
    v_mov_b32 v2, 0
    s_mov_b32 s17, 0
GT_1_loop:
    buffer_load_dwordx4 v[32:35], v1, s[8:11], s16 offen offset:0
    buffer_load_dwordx4 v[36:39], v1, s[8:11], s16 offen offset:1024
    buffer_load_dwordx4 v[40:43], v1, s[8:11], s16 offen offset:2048
    buffer_load_dwordx4 v[44:47], v1, s[8:11], s16 offen offset:3072
    s_waitcnt vmcnt(3)
    v_lshlrev_b32 v16, 16, v32
    v_and_b32 v17, 0xffff0000, v32
    v_mul_f32 v16, v16, v8
    v_mul_f32 v17, v17, v9
    v_cvt_pk_bf16_f32 v18, v16, v17
    v_lshlrev_b32 v16, 16, v18
    v_and_b32 v17, 0xffff0000, v18
    v_add_f32 v19, v16, v17
    v_lshlrev_b32 v16, 16, v33
    v_and_b32 v17, 0xffff0000, v33
    v_mul_f32 v16, v16, v10
    v_mul_f32 v17, v17, v11
    v_cvt_pk_bf16_f32 v18, v16, v17
    v_lshlrev_b32 v16, 16, v18
    v_and_b32 v17, 0xffff0000, v18
    v_add_f32 v19, v19, v16
    v_add_f32 v19, v19, v17
    v_lshlrev_b32 v16, 16, v34
    v_and_b32 v17, 0xffff0000, v34
    v_mul_f32 v16, v16, v12
    v_mul_f32 v17, v17, v13
    v_cvt_pk_bf16_f32 v18, v16, v17
    v_lshlrev_b32 v16, 16, v18
    v_and_b32 v17, 0xffff0000, v18
    v_add_f32 v19, v19, v16
    v_add_f32 v19, v19, v17
    v_lshlrev_b32 v16, 16, v35
    v_and_b32 v17, 0xffff0000, v35
    v_mul_f32 v16, v16, v14
    v_mul_f32 v17, v17, v15
    v_cvt_pk_bf16_f32 v18, v16, v17
    v_lshlrev_b32 v16, 16, v18
    v_and_b32 v17, 0xffff0000, v18
    v_add_f32 v19, v19, v16
    v_add_f32 v19, v19, v17
    s_nop 1
    v_add_f32_dpp v19, v19, v19 row_ror:1 row_mask:0xf bank_mask:0xf
    s_nop 1
    v_add_f32_dpp v19, v19, v19 row_ror:2 row_mask:0xf bank_mask:0xf
    s_nop 1
    v_add_f32_dpp v19, v19, v19 row_ror:4 row_mask:0xf bank_mask:0xf
    s_nop 1
    v_add_f32_dpp v19, v19, v19 row_ror:8 row_mask:0xf bank_mask:0xf
    v_mov_b32 v20, v19
    s_nop 1
    v_permlane16_swap_b32 v19, v20
    v_add_f32 v19, v19, v20
    v_mov_b32 v20, v19
    s_nop 1
    v_permlane32_swap_b32 v19, v20
    v_add_f32 v19, v19, v20
    v_cmp_eq_u32 vcc, s17, v0
    s_nop 1
    v_cndmask_b32 v2, v2, v19, vcc
    s_add_u32 s17, s17, 1
    s_waitcnt vmcnt(2)
    v_lshlrev_b32 v16, 16, v36
    v_and_b32 v17, 0xffff0000, v36
    v_mul_f32 v16, v16, v8
    v_mul_f32 v17, v17, v9
    v_cvt_pk_bf16_f32 v18, v16, v17
    v_lshlrev_b32 v16, 16, v18
    v_and_b32 v17, 0xffff0000, v18
    v_add_f32 v19, v16, v17
    v_lshlrev_b32 v16, 16, v37
    v_and_b32 v17, 0xffff0000, v37
    v_mul_f32 v16, v16, v10
    v_mul_f32 v17, v17, v11
    v_cvt_pk_bf16_f32 v18, v16, v17
    v_lshlrev_b32 v16, 16, v18
    v_and_b32 v17, 0xffff0000, v18
    v_add_f32 v19, v19, v16
    v_add_f32 v19, v19, v17
    v_lshlrev_b32 v16, 16, v38
    v_and_b32 v17, 0xffff0000, v38
    v_mul_f32 v16, v16, v12
    v_mul_f32 v17, v17, v13
    v_cvt_pk_bf16_f32 v18, v16, v17
    v_lshlrev_b32 v16, 16, v18
    v_and_b32 v17, 0xffff0000, v18
    v_add_f32 v19, v19, v16
    v_add_f32 v19, v19, v17
    v_lshlrev_b32 v16, 16, v39
    v_and_b32 v17, 0xffff0000, v39
    v_mul_f32 v16, v16, v14
    v_mul_f32 v17, v17, v15
    v_cvt_pk_bf16_f32 v18, v16, v17
    v_lshlrev_b32 v16, 16, v18
    v_and_b32 v17, 0xffff0000, v18
    v_add_f32 v19, v19, v16
    v_add_f32 v19, v19, v17
    s_nop 1
    v_add_f32_dpp v19, v19, v19 row_ror:1 row_mask:0xf bank_mask:0xf
    s_nop 1
    v_add_f32_dpp v19, v19, v19 row_ror:2 row_mask:0xf bank_mask:0xf
    s_nop 1
    v_add_f32_dpp v19, v19, v19 row_ror:4 row_mask:0xf bank_mask:0xf
    s_nop 1
    v_add_f32_dpp v19, v19, v19 row_ror:8 row_mask:0xf bank_mask:0xf
    v_mov_b32 v20, v19
    s_nop 1
    v_permlane16_swap_b32 v19, v20
    v_add_f32 v19, v19, v20
    v_mov_b32 v20, v19
    s_nop 1
    v_permlane32_swap_b32 v19, v20
    v_add_f32 v19, v19, v20
    v_cmp_eq_u32 vcc, s17, v0
    s_nop 1
    v_cndmask_b32 v2, v2, v19, vcc
    s_add_u32 s17, s17, 1
    s_waitcnt vmcnt(1)
    v_lshlrev_b32 v16, 16, v40
    v_and_b32 v17, 0xffff0000, v40
    v_mul_f32 v16, v16, v8
    v_mul_f32 v17, v17, v9
    v_cvt_pk_bf16_f32 v18, v16, v17
    v_lshlrev_b32 v16, 16, v18
    v_and_b32 v17, 0xffff0000, v18
    v_add_f32 v19, v16, v17
    v_lshlrev_b32 v16, 16, v41
    v_and_b32 v17, 0xffff0000, v41
    v_mul_f32 v16, v16, v10
    v_mul_f32 v17, v17, v11
    v_cvt_pk_bf16_f32 v18, v16, v17
    v_lshlrev_b32 v16, 16, v18
    v_and_b32 v17, 0xffff0000, v18
    v_add_f32 v19, v19, v16
    v_add_f32 v19, v19, v17
    v_lshlrev_b32 v16, 16, v42
    v_and_b32 v17, 0xffff0000, v42
    v_mul_f32 v16, v16, v12
    v_mul_f32 v17, v17, v13
    v_cvt_pk_bf16_f32 v18, v16, v17
    v_lshlrev_b32 v16, 16, v18
    v_and_b32 v17, 0xffff0000, v18
    v_add_f32 v19, v19, v16
    v_add_f32 v19, v19, v17
    v_lshlrev_b32 v16, 16, v43
    v_and_b32 v17, 0xffff0000, v43
    v_mul_f32 v16, v16, v14
    v_mul_f32 v17, v17, v15
    v_cvt_pk_bf16_f32 v18, v16, v17
    v_lshlrev_b32 v16, 16, v18
    v_and_b32 v17, 0xffff0000, v18
    v_add_f32 v19, v19, v16
    v_add_f32 v19, v19, v17
    s_nop 1
    v_add_f32_dpp v19, v19, v19 row_ror:1 row_mask:0xf bank_mask:0xf
    s_nop 1
    v_add_f32_dpp v19, v19, v19 row_ror:2 row_mask:0xf bank_mask:0xf
    s_nop 1
    v_add_f32_dpp v19, v19, v19 row_ror:4 row_mask:0xf bank_mask:0xf
    s_nop 1
    v_add_f32_dpp v19, v19, v19 row_ror:8 row_mask:0xf bank_mask:0xf
    v_mov_b32 v20, v19
    s_nop 1
    v_permlane16_swap_b32 v19, v20
    v_add_f32 v19, v19, v20
    v_mov_b32 v20, v19
    s_nop 1
    v_permlane32_swap_b32 v19, v20
    v_add_f32 v19, v19, v20
    v_cmp_eq_u32 vcc, s17, v0
    s_nop 1
    v_cndmask_b32 v2, v2, v19, vcc
    s_add_u32 s17, s17, 1
    s_waitcnt vmcnt(0)
    v_lshlrev_b32 v16, 16, v44
    v_and_b32 v17, 0xffff0000, v44
    v_mul_f32 v16, v16, v8
    v_mul_f32 v17, v17, v9
    v_cvt_pk_bf16_f32 v18, v16, v17
    v_lshlrev_b32 v16, 16, v18
    v_and_b32 v17, 0xffff0000, v18
    v_add_f32 v19, v16, v17
    v_lshlrev_b32 v16, 16, v45
    v_and_b32 v17, 0xffff0000, v45
    v_mul_f32 v16, v16, v10
    v_mul_f32 v17, v17, v11
    v_cvt_pk_bf16_f32 v18, v16, v17
    v_lshlrev_b32 v16, 16, v18
    v_and_b32 v17, 0xffff0000, v18
    v_add_f32 v19, v19, v16
    v_add_f32 v19, v19, v17
    v_lshlrev_b32 v16, 16, v46
    v_and_b32 v17, 0xffff0000, v46
    v_mul_f32 v16, v16, v12
    v_mul_f32 v17, v17, v13
    v_cvt_pk_bf16_f32 v18, v16, v17
    v_lshlrev_b32 v16, 16, v18
    v_and_b32 v17, 0xffff0000, v18
    v_add_f32 v19, v19, v16
    v_add_f32 v19, v19, v17
    v_lshlrev_b32 v16, 16, v47
    v_and_b32 v17, 0xffff0000, v47
    v_mul_f32 v16, v16, v14
    v_mul_f32 v17, v17, v15
    v_cvt_pk_bf16_f32 v18, v16, v17
    v_lshlrev_b32 v16, 16, v18
    v_and_b32 v17, 0xffff0000, v18
    v_add_f32 v19, v19, v16
    v_add_f32 v19, v19, v17
    s_nop 1
    v_add_f32_dpp v19, v19, v19 row_ror:1 row_mask:0xf bank_mask:0xf
    s_nop 1
    v_add_f32_dpp v19, v19, v19 row_ror:2 row_mask:0xf bank_mask:0xf
    s_nop 1
    v_add_f32_dpp v19, v19, v19 row_ror:4 row_mask:0xf bank_mask:0xf
    s_nop 1
    v_add_f32_dpp v19, v19, v19 row_ror:8 row_mask:0xf bank_mask:0xf
    v_mov_b32 v20, v19
    s_nop 1
    v_permlane16_swap_b32 v19, v20
    v_add_f32 v19, v19, v20
    v_mov_b32 v20, v19
    s_nop 1
    v_permlane32_swap_b32 v19, v20
    v_add_f32 v19, v19, v20
    v_cmp_eq_u32 vcc, s17, v0
    s_nop 1
    v_cndmask_b32 v2, v2, v19, vcc
    s_add_u32 s17, s17, 1
    s_add_u32 s16, s16, 4096
    s_cmp_lt_u32 s17, 64
    s_cbranch_scc1 GT_1_loop
    v_cvt_pk_bf16_f32 v2, v2, v2
    v_lshlrev_b32 v2, 16, v2
    v_mul_f32 v2, 0xbfb8aa3b, v2
    v_exp_f32 v2, v2
    s_nop 0
    v_add_f32 v2, 1.0, v2
    v_rcp_f32 v2, v2
    s_nop 0
    v_cvt_pk_bf16_f32 v2, v2, v2
    v_lshlrev_b32 v2, 16, v2
    v_sub_f32 v3, 1.0, v2
    v_cvt_pk_bf16_f32 v3, v3, v3
    v_lshlrev_b32 v3, 16, v3
    v_lshlrev_b32 v1, 3, v0
    s_add_u32 s18, s18, 71303168
    buffer_store_dwordx2 v[2:3], v1, s[4:7], s18 offen sc1
    s_waitcnt vmcnt(0)
    s_cmp_eq_u32 s62, 0
    s_cbranch_scc0 WW_2_ok
WW_2:
    v_mov_b32 v254, 140
    global_load_dword v255, v254, s[64:65] sc1
    s_sub_u32 s70, s70, 1
    s_cbranch_scc1 WW_2_to
    s_waitcnt vmcnt(0)
    v_readfirstlane_b32 s71, v255
    s_cmp_ge_u32 s71, 32
    s_cbranch_scc1 WW_2_ok
    s_sleep 8
    s_branch WW_2
WW_2_to:
    s_mov_b32 s70, 0
    s_waitcnt vmcnt(0)
WW_2_ok:
    s_barrier
    s_branch L_p1done
L_proj:
    s_lshr_b32 s16, s60, 2
    s_and_b32 s17, s60, 3
    s_mov_b32 s18, s62
    s_cmp_lt_u32 s60, 128
    s_cselect_b32 s58, 1, 0
    s_cmp_eq_u32 s62, 0
    s_cselect_b32 s58, s58, 0
    s_lshl_b32 s57, s16, 7
    s_lshl_b32 s56, s17, 2
    s_add_u32 s57, s57, s56
    s_add_u32 s57, s57, 95420416
    s_load_dwordx2 s[8:9], s[0:1], 0
    s_mov_b32 s10, 2097152
    s_mov_b32 s11, 0x20000
    s_mov_b32 s15, 0x20000
    s_mov_b32 s25, 1.0
    s_and_b32 s29, s18, 1
    s_lshr_b32 s30, s18, 1
    s_cmp_ge_u32 s16, 48
    s_cbranch_scc1 PJ_4_B
    s_mov_b32 s19, 8192
    s_mov_b32 s14, 4194304
    s_mov_b32 s22, 1048576
    s_mov_b32 s23, 512
    s_cmp_ge_u32 s16, 32
    s_cbranch_scc1 PJ_4_Q
    s_mov_b32 s26, s16
    s_cmp_eq_u32 s30, 0
    s_cbranch_scc0 PJ_4_V
    s_load_dwordx2 s[12:13], s[0:1], 24
    s_mov_b32 s21, 16777216
    s_branch PJ_4_KQ
PJ_4_Q:
    s_load_dwordx2 s[12:13], s[0:1], 16
    s_sub_u32 s26, s16, 32
    s_lshl_b32 s26, s26, 1
    s_add_u32 s26, s26, s30
    s_mov_b32 s21, 0
PJ_4_KQ:
    s_mov_b32 s31, 0
    s_mov_b32 s24, 1024
    s_lshl_b32 s27, s29, 11
    s_branch PJ_4_A
PJ_4_V:
    s_load_dwordx2 s[12:13], s[0:1], 32
    s_mov_b32 s21, 33554432
    s_mov_b32 s31, 1
    s_mov_b32 s24, 2048
    s_lshl_b32 s27, s29, 12
PJ_4_A:
    s_add_u32 s21, s21, s27
    s_lshl_b32 s27, s26, 13
    s_add_u32 s21, s21, s27
    s_lshl_b32 s27, s17, 18
    s_add_u32 s21, s21, s27
    s_lshl_b32 s20, s26, 8
    s_lshl_b32 s29, s29, 7
    s_add_u32 s20, s20, s29
    s_branch PJ_4_done
PJ_4_B:
    s_load_dwordx2 s[12:13], s[0:1], 64
    s_mov_b32 s19, 3072
    s_mov_b32 s14, 1572864
    s_mov_b32 s22, 4096
    s_mov_b32 s24, 131072
    s_sub_u32 s26, s16, 48
    s_lshl_b32 s26, s26, 2
    s_add_u32 s26, s26, s18
    s_lshl_b32 s20, s26, 7
    s_lshl_b32 s21, s26, 18
    s_add_u32 s21, s21, 65011712
    s_lshl_b32 s27, s17, 10
    s_add_u32 s21, s21, s27
    s_mov_b32 s31, 2
    s_mov_b32 s23, 65536
    s_cmp_lt_u32 s26, 8
    s_cselect_b32 s25, 0x3eb8aa3b, 1.0
    s_cmp_lt_u32 s26, 16
    s_cbranch_scc1 PJ_4_done
    s_mov_b32 s31, 3
    s_mov_b32 s23, 512
PJ_4_done:
    s_waitcnt lgkmcnt(0)
    v_lshrrev_b32 v4, 3, v0
    v_mul_lo_u32 v4, v4, s19
    v_and_b32 v5, 7, v0
    v_lshl_add_u32 v4, v5, 4, v4
    v_add_u32 v4, s20, v4
    s_mul_i32 s27, s18, 40960
    v_lshrrev_b32 v5, 5, v0
    v_lshlrev_b32 v5, 10, v5
    v_bfe_u32 v6, v0, 2, 2
    v_lshl_add_u32 v5, v6, 7, v5
    v_bfe_u32 v6, v0, 4, 1
    v_lshl_add_u32 v5, v6, 5, v5
    v_and_b32 v6, 3, v0
    v_lshl_add_u32 v5, v6, 3, v5
    v_add_u32 v5, s27, v5
    s_lshl_b32 s30, s19, 3
    s_mov_b32 s29, 0
    v_lshlrev_b32 v6, 7, v0
    s_lshl_b32 s28, s17, 15
    s_lshl_b32 s26, s18, 13
    s_add_u32 s28, s28, s26
    buffer_load_dword v246, v6, s[8:11], s28 offen
    s_add_u32 s28, s28, 131072
    buffer_load_dword v247, v6, s[8:11], s28 offen
    s_add_u32 m0, s27, 0
    s_nop 0
    buffer_load_dwordx4 v4, s[12:15], s29 offen lds
    s_add_u32 s29, s29, s30
    s_add_u32 m0, s27, 1024
    s_nop 0
    buffer_load_dwordx4 v4, s[12:15], s29 offen lds
    s_add_u32 s29, s29, s30
    s_add_u32 m0, s27, 2048
    s_nop 0
    buffer_load_dwordx4 v4, s[12:15], s29 offen lds
    s_add_u32 s29, s29, s30
    s_add_u32 m0, s27, 3072
    s_nop 0
    buffer_load_dwordx4 v4, s[12:15], s29 offen lds
    s_add_u32 s29, s29, s30
    s_add_u32 m0, s27, 4096
    s_nop 0
    buffer_load_dwordx4 v4, s[12:15], s29 offen lds
    s_add_u32 s29, s29, s30
    s_add_u32 m0, s27, 5120
    s_nop 0
    buffer_load_dwordx4 v4, s[12:15], s29 offen lds
    s_add_u32 s29, s29, s30
    s_add_u32 m0, s27, 6144
    s_nop 0
    buffer_load_dwordx4 v4, s[12:15], s29 offen lds
    s_add_u32 s29, s29, s30
    s_add_u32 m0, s27, 7168
    s_nop 0
    buffer_load_dwordx4 v4, s[12:15], s29 offen lds
    s_add_u32 s29, s29, s30
    s_add_u32 m0, s27, 8192
    s_nop 0
    buffer_load_dwordx4 v4, s[12:15], s29 offen lds
    s_add_u32 s29, s29, s30
    s_add_u32 m0, s27, 9216
    s_nop 0
    buffer_load_dwordx4 v4, s[12:15], s29 offen lds
    s_add_u32 s29, s29, s30
    s_add_u32 m0, s27, 10240
    s_nop 0
    buffer_load_dwordx4 v4, s[12:15], s29 offen lds
    s_add_u32 s29, s29, s30
    s_add_u32 m0, s27, 11264
    s_nop 0
    buffer_load_dwordx4 v4, s[12:15], s29 offen lds
    s_add_u32 s29, s29, s30
    s_add_u32 m0, s27, 12288
    s_nop 0
    buffer_load_dwordx4 v4, s[12:15], s29 offen lds
    s_add_u32 s29, s29, s30
    s_add_u32 m0, s27, 13312
    s_nop 0
    buffer_load_dwordx4 v4, s[12:15], s29 offen lds
    s_add_u32 s29, s29, s30
    s_add_u32 m0, s27, 14336
    s_nop 0
    buffer_load_dwordx4 v4, s[12:15], s29 offen lds
    s_add_u32 s29, s29, s30
    s_add_u32 m0, s27, 15360
    s_nop 0
    buffer_load_dwordx4 v4, s[12:15], s29 offen lds
    s_add_u32 s29, s29, s30
    s_add_u32 m0, s27, 16384
    s_nop 0
    buffer_load_dwordx4 v4, s[12:15], s29 offen lds
    s_add_u32 s29, s29, s30
    s_add_u32 m0, s27, 17408
    s_nop 0
    buffer_load_dwordx4 v4, s[12:15], s29 offen lds
    s_add_u32 s29, s29, s30
    s_add_u32 m0, s27, 18432
    s_nop 0
    buffer_load_dwordx4 v4, s[12:15], s29 offen lds
    s_add_u32 s29, s29, s30
    s_add_u32 m0, s27, 19456
    s_nop 0
    buffer_load_dwordx4 v4, s[12:15], s29 offen lds
    s_add_u32 s29, s29, s30
    s_add_u32 m0, s27, 20480
    s_nop 0
    buffer_load_dwordx4 v4, s[12:15], s29 offen lds
    s_add_u32 s29, s29, s30
    s_add_u32 m0, s27, 21504
    s_nop 0
    buffer_load_dwordx4 v4, s[12:15], s29 offen lds
    s_add_u32 s29, s29, s30
    s_add_u32 m0, s27, 22528
    s_nop 0
    buffer_load_dwordx4 v4, s[12:15], s29 offen lds
    s_add_u32 s29, s29, s30
    s_add_u32 m0, s27, 23552
    s_nop 0
    buffer_load_dwordx4 v4, s[12:15], s29 offen lds
    s_add_u32 s29, s29, s30
    s_add_u32 m0, s27, 24576
    s_nop 0
    buffer_load_dwordx4 v4, s[12:15], s29 offen lds
    s_add_u32 s29, s29, s30
    s_add_u32 m0, s27, 25600
    s_nop 0
    buffer_load_dwordx4 v4, s[12:15], s29 offen lds
    s_add_u32 s29, s29, s30
    s_add_u32 m0, s27, 26624
    s_nop 0
    buffer_load_dwordx4 v4, s[12:15], s29 offen lds
    s_add_u32 s29, s29, s30
    s_add_u32 m0, s27, 27648
    s_nop 0
    buffer_load_dwordx4 v4, s[12:15], s29 offen lds
    s_add_u32 s29, s29, s30
    s_add_u32 m0, s27, 28672
    s_nop 0
    buffer_load_dwordx4 v4, s[12:15], s29 offen lds
    s_add_u32 s29, s29, s30
    s_add_u32 m0, s27, 29696
    s_nop 0
    buffer_load_dwordx4 v4, s[12:15], s29 offen lds
    s_add_u32 s29, s29, s30
    s_add_u32 m0, s27, 30720
    s_nop 0
    buffer_load_dwordx4 v4, s[12:15], s29 offen lds
    s_add_u32 s29, s29, s30
    s_add_u32 m0, s27, 31744
    s_nop 0
    buffer_load_dwordx4 v4, s[12:15], s29 offen lds
    s_add_u32 s29, s29, s30
    s_waitcnt vmcnt(16)
    ds_read_b64_tr_b16 a[0:1], v5 offset:0
    ds_read_b64_tr_b16 a[2:3], v5 offset:512
    ds_read_b64_tr_b16 a[128:129], v5 offset:64
    ds_read_b64_tr_b16 a[130:131], v5 offset:576
    ds_read_b64_tr_b16 a[4:5], v5 offset:2048
    ds_read_b64_tr_b16 a[6:7], v5 offset:2560
    ds_read_b64_tr_b16 a[132:133], v5 offset:2112
    ds_read_b64_tr_b16 a[134:135], v5 offset:2624
    ds_read_b64_tr_b16 a[8:9], v5 offset:4096
    ds_read_b64_tr_b16 a[10:11], v5 offset:4608
    ds_read_b64_tr_b16 a[136:137], v5 offset:4160
    ds_read_b64_tr_b16 a[138:139], v5 offset:4672
    ds_read_b64_tr_b16 a[12:13], v5 offset:6144
    ds_read_b64_tr_b16 a[14:15], v5 offset:6656
    ds_read_b64_tr_b16 a[140:141], v5 offset:6208
    ds_read_b64_tr_b16 a[142:143], v5 offset:6720
    ds_read_b64_tr_b16 a[16:17], v5 offset:8192
    ds_read_b64_tr_b16 a[18:19], v5 offset:8704
    ds_read_b64_tr_b16 a[144:145], v5 offset:8256
    ds_read_b64_tr_b16 a[146:147], v5 offset:8768
    ds_read_b64_tr_b16 a[20:21], v5 offset:10240
    ds_read_b64_tr_b16 a[22:23], v5 offset:10752
    ds_read_b64_tr_b16 a[148:149], v5 offset:10304
    ds_read_b64_tr_b16 a[150:151], v5 offset:10816
    ds_read_b64_tr_b16 a[24:25], v5 offset:12288
    ds_read_b64_tr_b16 a[26:27], v5 offset:12800
    ds_read_b64_tr_b16 a[152:153], v5 offset:12352
    ds_read_b64_tr_b16 a[154:155], v5 offset:12864
    ds_read_b64_tr_b16 a[28:29], v5 offset:14336
    ds_read_b64_tr_b16 a[30:31], v5 offset:14848
    ds_read_b64_tr_b16 a[156:157], v5 offset:14400
    ds_read_b64_tr_b16 a[158:159], v5 offset:14912
    s_waitcnt lgkmcnt(0)
    s_add_u32 m0, s27, 0
    s_nop 0
    buffer_load_dwordx4 v4, s[12:15], s29 offen lds
    s_add_u32 s29, s29, s30
    s_add_u32 m0, s27, 1024
    s_nop 0
    buffer_load_dwordx4 v4, s[12:15], s29 offen lds
    s_add_u32 s29, s29, s30
    s_add_u32 m0, s27, 2048
    s_nop 0
    buffer_load_dwordx4 v4, s[12:15], s29 offen lds
    s_add_u32 s29, s29, s30
    s_add_u32 m0, s27, 3072
    s_nop 0
    buffer_load_dwordx4 v4, s[12:15], s29 offen lds
    s_add_u32 s29, s29, s30
    s_add_u32 m0, s27, 4096
    s_nop 0
    buffer_load_dwordx4 v4, s[12:15], s29 offen lds
    s_add_u32 s29, s29, s30
    s_add_u32 m0, s27, 5120
    s_nop 0
    buffer_load_dwordx4 v4, s[12:15], s29 offen lds
    s_add_u32 s29, s29, s30
    s_add_u32 m0, s27, 6144
    s_nop 0
    buffer_load_dwordx4 v4, s[12:15], s29 offen lds
    s_add_u32 s29, s29, s30
    s_add_u32 m0, s27, 7168
    s_nop 0
    buffer_load_dwordx4 v4, s[12:15], s29 offen lds
    s_add_u32 s29, s29, s30
    s_add_u32 m0, s27, 8192
    s_nop 0
    buffer_load_dwordx4 v4, s[12:15], s29 offen lds
    s_add_u32 s29, s29, s30
    s_add_u32 m0, s27, 9216
    s_nop 0
    buffer_load_dwordx4 v4, s[12:15], s29 offen lds
    s_add_u32 s29, s29, s30
    s_add_u32 m0, s27, 10240
    s_nop 0
    buffer_load_dwordx4 v4, s[12:15], s29 offen lds
    s_add_u32 s29, s29, s30
    s_add_u32 m0, s27, 11264
    s_nop 0
    buffer_load_dwordx4 v4, s[12:15], s29 offen lds
    s_add_u32 s29, s29, s30
    s_add_u32 m0, s27, 12288
    s_nop 0
    buffer_load_dwordx4 v4, s[12:15], s29 offen lds
    s_add_u32 s29, s29, s30
    s_add_u32 m0, s27, 13312
    s_nop 0
    buffer_load_dwordx4 v4, s[12:15], s29 offen lds
    s_add_u32 s29, s29, s30
    s_add_u32 m0, s27, 14336
    s_nop 0
    buffer_load_dwordx4 v4, s[12:15], s29 offen lds
    s_add_u32 s29, s29, s30
    s_add_u32 m0, s27, 15360
    s_nop 0
    buffer_load_dwordx4 v4, s[12:15], s29 offen lds
    s_add_u32 s29, s29, s30
    s_waitcnt vmcnt(16)
    ds_read_b64_tr_b16 a[32:33], v5 offset:16384
    ds_read_b64_tr_b16 a[34:35], v5 offset:16896
    ds_read_b64_tr_b16 a[160:161], v5 offset:16448
    ds_read_b64_tr_b16 a[162:163], v5 offset:16960
    ds_read_b64_tr_b16 a[36:37], v5 offset:18432
    ds_read_b64_tr_b16 a[38:39], v5 offset:18944
    ds_read_b64_tr_b16 a[164:165], v5 offset:18496
    ds_read_b64_tr_b16 a[166:167], v5 offset:19008
    ds_read_b64_tr_b16 a[40:41], v5 offset:20480
    ds_read_b64_tr_b16 a[42:43], v5 offset:20992
    ds_read_b64_tr_b16 a[168:169], v5 offset:20544
    ds_read_b64_tr_b16 a[170:171], v5 offset:21056
    ds_read_b64_tr_b16 a[44:45], v5 offset:22528
    ds_read_b64_tr_b16 a[46:47], v5 offset:23040
    ds_read_b64_tr_b16 a[172:173], v5 offset:22592
    ds_read_b64_tr_b16 a[174:175], v5 offset:23104
    ds_read_b64_tr_b16 a[48:49], v5 offset:24576
    ds_read_b64_tr_b16 a[50:51], v5 offset:25088
    ds_read_b64_tr_b16 a[176:177], v5 offset:24640
    ds_read_b64_tr_b16 a[178:179], v5 offset:25152
    ds_read_b64_tr_b16 a[52:53], v5 offset:26624
    ds_read_b64_tr_b16 a[54:55], v5 offset:27136
    ds_read_b64_tr_b16 a[180:181], v5 offset:26688
    ds_read_b64_tr_b16 a[182:183], v5 offset:27200
    ds_read_b64_tr_b16 a[56:57], v5 offset:28672
    ds_read_b64_tr_b16 a[58:59], v5 offset:29184
    ds_read_b64_tr_b16 a[184:185], v5 offset:28736
    ds_read_b64_tr_b16 a[186:187], v5 offset:29248
    ds_read_b64_tr_b16 a[60:61], v5 offset:30720
    ds_read_b64_tr_b16 a[62:63], v5 offset:31232
    ds_read_b64_tr_b16 a[188:189], v5 offset:30784
    ds_read_b64_tr_b16 a[190:191], v5 offset:31296
    s_waitcnt lgkmcnt(0)
    s_add_u32 m0, s27, 16384
    s_nop 0
    buffer_load_dwordx4 v4, s[12:15], s29 offen lds
    s_add_u32 s29, s29, s30
    s_add_u32 m0, s27, 17408
    s_nop 0
    buffer_load_dwordx4 v4, s[12:15], s29 offen lds
    s_add_u32 s29, s29, s30
    s_add_u32 m0, s27, 18432
    s_nop 0
    buffer_load_dwordx4 v4, s[12:15], s29 offen lds
    s_add_u32 s29, s29, s30
    s_add_u32 m0, s27, 19456
    s_nop 0
    buffer_load_dwordx4 v4, s[12:15], s29 offen lds
    s_add_u32 s29, s29, s30
    s_add_u32 m0, s27, 20480
    s_nop 0
    buffer_load_dwordx4 v4, s[12:15], s29 offen lds
    s_add_u32 s29, s29, s30
    s_add_u32 m0, s27, 21504
    s_nop 0
    buffer_load_dwordx4 v4, s[12:15], s29 offen lds
    s_add_u32 s29, s29, s30
    s_add_u32 m0, s27, 22528
    s_nop 0
    buffer_load_dwordx4 v4, s[12:15], s29 offen lds
    s_add_u32 s29, s29, s30
    s_add_u32 m0, s27, 23552
    s_nop 0
    buffer_load_dwordx4 v4, s[12:15], s29 offen lds
    s_add_u32 s29, s29, s30
    s_add_u32 m0, s27, 24576
    s_nop 0
    buffer_load_dwordx4 v4, s[12:15], s29 offen lds
    s_add_u32 s29, s29, s30
    s_add_u32 m0, s27, 25600
    s_nop 0
    buffer_load_dwordx4 v4, s[12:15], s29 offen lds
    s_add_u32 s29, s29, s30
    s_add_u32 m0, s27, 26624
    s_nop 0
    buffer_load_dwordx4 v4, s[12:15], s29 offen lds
    s_add_u32 s29, s29, s30
    s_add_u32 m0, s27, 27648
    s_nop 0
    buffer_load_dwordx4 v4, s[12:15], s29 offen lds
    s_add_u32 s29, s29, s30
    s_add_u32 m0, s27, 28672
    s_nop 0
    buffer_load_dwordx4 v4, s[12:15], s29 offen lds
    s_add_u32 s29, s29, s30
    s_add_u32 m0, s27, 29696
    s_nop 0
    buffer_load_dwordx4 v4, s[12:15], s29 offen lds
    s_add_u32 s29, s29, s30
    s_add_u32 m0, s27, 30720
    s_nop 0
    buffer_load_dwordx4 v4, s[12:15], s29 offen lds
    s_add_u32 s29, s29, s30
    s_add_u32 m0, s27, 31744
    s_nop 0
    buffer_load_dwordx4 v4, s[12:15], s29 offen lds
    s_add_u32 s29, s29, s30
    s_waitcnt vmcnt(16)
    ds_read_b64_tr_b16 a[64:65], v5 offset:0
    ds_read_b64_tr_b16 a[66:67], v5 offset:512
    ds_read_b64_tr_b16 a[192:193], v5 offset:64
    ds_read_b64_tr_b16 a[194:195], v5 offset:576
    ds_read_b64_tr_b16 a[68:69], v5 offset:2048
    ds_read_b64_tr_b16 a[70:71], v5 offset:2560
    ds_read_b64_tr_b16 a[196:197], v5 offset:2112
    ds_read_b64_tr_b16 a[198:199], v5 offset:2624
    ds_read_b64_tr_b16 a[72:73], v5 offset:4096
    ds_read_b64_tr_b16 a[74:75], v5 offset:4608
    ds_read_b64_tr_b16 a[200:201], v5 offset:4160
    ds_read_b64_tr_b16 a[202:203], v5 offset:4672
    ds_read_b64_tr_b16 a[76:77], v5 offset:6144
    ds_read_b64_tr_b16 a[78:79], v5 offset:6656
    ds_read_b64_tr_b16 a[204:205], v5 offset:6208
    ds_read_b64_tr_b16 a[206:207], v5 offset:6720
    ds_read_b64_tr_b16 a[80:81], v5 offset:8192
    ds_read_b64_tr_b16 a[82:83], v5 offset:8704
    ds_read_b64_tr_b16 a[208:209], v5 offset:8256
    ds_read_b64_tr_b16 a[210:211], v5 offset:8768
    ds_read_b64_tr_b16 a[84:85], v5 offset:10240
    ds_read_b64_tr_b16 a[86:87], v5 offset:10752
    ds_read_b64_tr_b16 a[212:213], v5 offset:10304
    ds_read_b64_tr_b16 a[214:215], v5 offset:10816
    ds_read_b64_tr_b16 a[88:89], v5 offset:12288
    ds_read_b64_tr_b16 a[90:91], v5 offset:12800
    ds_read_b64_tr_b16 a[216:217], v5 offset:12352
    ds_read_b64_tr_b16 a[218:219], v5 offset:12864
    ds_read_b64_tr_b16 a[92:93], v5 offset:14336
    ds_read_b64_tr_b16 a[94:95], v5 offset:14848
    ds_read_b64_tr_b16 a[220:221], v5 offset:14400
    ds_read_b64_tr_b16 a[222:223], v5 offset:14912
    s_waitcnt vmcnt(0)
    ds_read_b64_tr_b16 a[96:97], v5 offset:16384
    ds_read_b64_tr_b16 a[98:99], v5 offset:16896
    ds_read_b64_tr_b16 a[224:225], v5 offset:16448
    ds_read_b64_tr_b16 a[226:227], v5 offset:16960
    ds_read_b64_tr_b16 a[100:101], v5 offset:18432
    ds_read_b64_tr_b16 a[102:103], v5 offset:18944
    ds_read_b64_tr_b16 a[228:229], v5 offset:18496
    ds_read_b64_tr_b16 a[230:231], v5 offset:19008
    ds_read_b64_tr_b16 a[104:105], v5 offset:20480
    ds_read_b64_tr_b16 a[106:107], v5 offset:20992
    ds_read_b64_tr_b16 a[232:233], v5 offset:20544
    ds_read_b64_tr_b16 a[234:235], v5 offset:21056
    ds_read_b64_tr_b16 a[108:109], v5 offset:22528
    ds_read_b64_tr_b16 a[110:111], v5 offset:23040
    ds_read_b64_tr_b16 a[236:237], v5 offset:22592
    ds_read_b64_tr_b16 a[238:239], v5 offset:23104
    ds_read_b64_tr_b16 a[112:113], v5 offset:24576
    ds_read_b64_tr_b16 a[114:115], v5 offset:25088
    ds_read_b64_tr_b16 a[240:241], v5 offset:24640
    ds_read_b64_tr_b16 a[242:243], v5 offset:25152
    ds_read_b64_tr_b16 a[116:117], v5 offset:26624
    ds_read_b64_tr_b16 a[118:119], v5 offset:27136
    ds_read_b64_tr_b16 a[244:245], v5 offset:26688
    ds_read_b64_tr_b16 a[246:247], v5 offset:27200
    ds_read_b64_tr_b16 a[120:121], v5 offset:28672
    ds_read_b64_tr_b16 a[122:123], v5 offset:29184
    ds_read_b64_tr_b16 a[248:249], v5 offset:28736
    ds_read_b64_tr_b16 a[250:251], v5 offset:29248
    ds_read_b64_tr_b16 a[124:125], v5 offset:30720
    ds_read_b64_tr_b16 a[126:127], v5 offset:31232
    ds_read_b64_tr_b16 a[252:253], v5 offset:30784
    ds_read_b64_tr_b16 a[254:255], v5 offset:31296
    s_waitcnt lgkmcnt(0)
    s_cmp_eq_u32 s62, 0
    s_cbranch_scc0 WW_5_ok
WW_5:
    v_mov_b32 v254, 140
    global_load_dword v255, v254, s[64:65] sc1
    s_sub_u32 s70, s70, 1
    s_cbranch_scc1 WW_5_to
    s_waitcnt vmcnt(0)
    v_readfirstlane_b32 s71, v255
    s_cmp_ge_u32 s71, 32
    s_cbranch_scc1 WW_5_ok
    s_sleep 8
    s_branch WW_5
WW_5_to:
    s_mov_b32 s70, 0
    s_waitcnt vmcnt(0)
WW_5_ok:
    s_barrier
    v_lshlrev_b32 v7, 4, v0
    v_and_b32 v4, 31, v0
    v_mul_u32_u24 v1, 1040, v4
    v_lshrrev_b32 v4, 5, v0
    v_lshl_add_u32 v1, v4, 4, v1
    s_lshl_b32 s28, s17, 15
    s_lshl_b32 s29, s18, 13
    s_add_u32 s28, s28, s29
    s_mul_i32 s32, s18, 8320
    s_barrier
    s_add_u32 s30, s28, 0
    s_add_u32 m0, s32, 0
    s_nop 0
    buffer_load_dwordx4 v7, s[8:11], s30 offen offset:0 lds
    s_add_u32 m0, s32, 16
    s_nop 0
    buffer_load_dwordx4 v7, s[8:11], s30 offen offset:1024 lds
    s_add_u32 m0, s32, 32
    s_nop 0
    buffer_load_dwordx4 v7, s[8:11], s30 offen offset:2048 lds
    s_add_u32 m0, s32, 48
    s_nop 0
    buffer_load_dwordx4 v7, s[8:11], s30 offen offset:3072 lds
    s_add_u32 s30, s28, 4096
    s_add_u32 m0, s32, 4160
    s_nop 0
    buffer_load_dwordx4 v7, s[8:11], s30 offen offset:0 lds
    s_add_u32 m0, s32, 4176
    s_nop 0
    buffer_load_dwordx4 v7, s[8:11], s30 offen offset:1024 lds
    s_add_u32 m0, s32, 4192
    s_nop 0
    buffer_load_dwordx4 v7, s[8:11], s30 offen offset:2048 lds
    s_add_u32 m0, s32, 4208
    s_nop 0
    buffer_load_dwordx4 v7, s[8:11], s30 offen offset:3072 lds
    s_add_u32 s28, s28, 131072
    s_add_u32 s32, s32, 33280
    s_add_u32 s30, s28, 0
    s_add_u32 m0, s32, 0
    s_nop 0
    buffer_load_dwordx4 v7, s[8:11], s30 offen offset:0 lds
    s_add_u32 m0, s32, 16
    s_nop 0
    buffer_load_dwordx4 v7, s[8:11], s30 offen offset:1024 lds
    s_add_u32 m0, s32, 32
    s_nop 0
    buffer_load_dwordx4 v7, s[8:11], s30 offen offset:2048 lds
    s_add_u32 m0, s32, 48
    s_nop 0
    buffer_load_dwordx4 v7, s[8:11], s30 offen offset:3072 lds
    s_add_u32 s30, s28, 4096
    s_add_u32 m0, s32, 4160
    s_nop 0
    buffer_load_dwordx4 v7, s[8:11], s30 offen offset:0 lds
    s_add_u32 m0, s32, 4176
    s_nop 0
    buffer_load_dwordx4 v7, s[8:11], s30 offen offset:1024 lds
    s_add_u32 m0, s32, 4192
    s_nop 0
    buffer_load_dwordx4 v7, s[8:11], s30 offen offset:2048 lds
    s_add_u32 m0, s32, 4208
    s_nop 0
    buffer_load_dwordx4 v7, s[8:11], s30 offen offset:3072 lds
    s_cmp_eq_u32 s31, 1
    s_cbranch_scc1 PR_3_t1
    s_cmp_eq_u32 s31, 2
    s_cbranch_scc1 PR_3_t2
    s_cmp_eq_u32 s31, 3
    s_cbranch_scc1 PR_3_t3
PR_3_t0:
    v_bfe_u32 v4, v0, 4, 1
    v_mul_u32_u24 v3, 4096, v4
    v_lshrrev_b32 v4, 5, v0
    v_mul_u32_u24 v4, 256, v4
    v_add_u32 v3, v3, v4
    v_and_b32 v4, 15, v0
    v_lshl_add_u32 v3, v4, 4, v3
    v_mov_b32 v120, 0x40000000
    s_mov_b32 s33, 0
    s_waitcnt vmcnt(8)
    s_barrier
    v_mov_b32 v2, v1
    ds_read_b128 v[72:75], v2 offset:0
    ds_read_b128 v[76:79], v2 offset:32
    ds_read_b128 v[80:83], v2 offset:64
    ds_read_b128 v[84:87], v2 offset:96
    ds_read_b128 v[88:91], v2 offset:128
    ds_read_b128 v[92:95], v2 offset:160
    s_mov_b32 s26, 0
    s_mov_b32 s27, 0
PM0_6_loop:
    s_waitcnt lgkmcnt(5)
    v_mfma_f32_32x32x16_bf16 v[8:23], a[0:3], v[72:75], 0
    s_nop 0
    s_nop 0
    v_mfma_f32_32x32x16_bf16 v[24:39], a[128:131], v[72:75], 0
    ds_read_b128 v[96:99], v2 offset:192
    s_nop 0
    s_nop 0
    s_waitcnt lgkmcnt(5)
    v_mfma_f32_32x32x16_bf16 v[8:23], a[4:7], v[76:79], v[8:23]
    v_cvt_pk_bf16_f32 v104, v40, v48
    v_cvt_pk_bf16_f32 v105, v41, v49
    v_mfma_f32_32x32x16_bf16 v[24:39], a[132:135], v[76:79], v[24:39]
    ds_read_b128 v[100:103], v2 offset:224
    v_cvt_pk_bf16_f32 v106, v42, v50
    v_cvt_pk_bf16_f32 v107, v43, v51
    s_waitcnt lgkmcnt(5)
    v_mfma_f32_32x32x16_bf16 v[8:23], a[8:11], v[80:83], v[8:23]
    s_mov_b32 s29, s21
    buffer_store_dwordx4 v[104:107], v120, s[4:7], s29 offen sc1
    v_mfma_f32_32x32x16_bf16 v[24:39], a[136:139], v[80:83], v[24:39]
    ds_read_b128 v[72:75], v2 offset:256
    v_cvt_pk_bf16_f32 v108, v44, v52
    v_cvt_pk_bf16_f32 v109, v45, v53
    s_waitcnt lgkmcnt(5)
    v_mfma_f32_32x32x16_bf16 v[8:23], a[12:15], v[84:87], v[8:23]
    v_cvt_pk_bf16_f32 v110, v46, v54
    v_cvt_pk_bf16_f32 v111, v47, v55
    v_mfma_f32_32x32x16_bf16 v[24:39], a[140:143], v[84:87], v[24:39]
    ds_read_b128 v[76:79], v2 offset:288
    s_add_u32 s29, s29, s23
    buffer_store_dwordx4 v[108:111], v120, s[4:7], s29 offen sc1
    s_waitcnt lgkmcnt(5)
    v_mfma_f32_32x32x16_bf16 v[8:23], a[16:19], v[88:91], v[8:23]
    v_cvt_pk_bf16_f32 v112, v56, v64
    v_cvt_pk_bf16_f32 v113, v57, v65
    v_mfma_f32_32x32x16_bf16 v[24:39], a[144:147], v[88:91], v[24:39]
    ds_read_b128 v[80:83], v2 offset:320
    v_cvt_pk_bf16_f32 v114, v58, v66
    v_cvt_pk_bf16_f32 v115, v59, v67
    s_waitcnt lgkmcnt(5)
    v_mfma_f32_32x32x16_bf16 v[8:23], a[20:23], v[92:95], v[8:23]
    s_add_u32 s29, s21, s24
    buffer_store_dwordx4 v[112:115], v120, s[4:7], s29 offen sc1
    v_mfma_f32_32x32x16_bf16 v[24:39], a[148:151], v[92:95], v[24:39]
    ds_read_b128 v[84:87], v2 offset:352
    v_cvt_pk_bf16_f32 v116, v60, v68
    v_cvt_pk_bf16_f32 v117, v61, v69
    s_waitcnt lgkmcnt(5)
    v_mfma_f32_32x32x16_bf16 v[8:23], a[24:27], v[96:99], v[8:23]
    v_cvt_pk_bf16_f32 v118, v62, v70
    v_cvt_pk_bf16_f32 v119, v63, v71
    v_mfma_f32_32x32x16_bf16 v[24:39], a[152:155], v[96:99], v[24:39]
    ds_read_b128 v[88:91], v2 offset:384
    s_add_u32 s29, s29, s23
    buffer_store_dwordx4 v[116:119], v120, s[4:7], s29 offen sc1
    s_waitcnt lgkmcnt(5)
    v_mfma_f32_32x32x16_bf16 v[8:23], a[28:31], v[100:103], v[8:23]
    s_add_u32 s21, s21, s33
    s_mov_b32 s33, s22
    v_mfma_f32_32x32x16_bf16 v[24:39], a[156:159], v[100:103], v[24:39]
    ds_read_b128 v[92:95], v2 offset:416
    v_mov_b32 v120, v3
    s_add_u32 s28, s28, 131072
    s_waitcnt lgkmcnt(5)
    v_mfma_f32_32x32x16_bf16 v[8:23], a[32:35], v[72:75], v[8:23]
    s_add_u32 s32, s32, 33280
    s_cmp_ge_u32 s32, 133120
    v_mfma_f32_32x32x16_bf16 v[24:39], a[160:163], v[72:75], v[24:39]
    ds_read_b128 v[96:99], v2 offset:448
    s_cselect_b32 s29, 133120, 0
    s_sub_u32 s32, s32, s29
    s_waitcnt lgkmcnt(5)
    v_mfma_f32_32x32x16_bf16 v[8:23], a[36:39], v[76:79], v[8:23]
    s_add_u32 s30, s28, 0
    s_add_u32 m0, s32, 0
    v_mfma_f32_32x32x16_bf16 v[24:39], a[164:167], v[76:79], v[24:39]
    ds_read_b128 v[100:103], v2 offset:480
    buffer_load_dwordx4 v7, s[8:11], s30 offen offset:0 lds
    s_add_u32 m0, s32, 16
    s_waitcnt lgkmcnt(5)
    v_mfma_f32_32x32x16_bf16 v[8:23], a[40:43], v[80:83], v[8:23]
    buffer_load_dwordx4 v7, s[8:11], s30 offen offset:1024 lds
    s_add_u32 m0, s32, 32
    v_mfma_f32_32x32x16_bf16 v[24:39], a[168:171], v[80:83], v[24:39]
    ds_read_b128 v[72:75], v2 offset:512
    buffer_load_dwordx4 v7, s[8:11], s30 offen offset:2048 lds
    s_add_u32 m0, s32, 48
    s_waitcnt lgkmcnt(5)
    v_mfma_f32_32x32x16_bf16 v[8:23], a[44:47], v[84:87], v[8:23]
    buffer_load_dwordx4 v7, s[8:11], s30 offen offset:3072 lds
    s_add_u32 s30, s28, 4096
    v_mfma_f32_32x32x16_bf16 v[24:39], a[172:175], v[84:87], v[24:39]
    ds_read_b128 v[76:79], v2 offset:544
    s_add_u32 m0, s32, 4160
    s_nop 0
    buffer_load_dwordx4 v7, s[8:11], s30 offen offset:0 lds
    s_waitcnt lgkmcnt(5)
    v_mfma_f32_32x32x16_bf16 v[8:23], a[48:51], v[88:91], v[8:23]
    s_add_u32 m0, s32, 4176
    s_nop 0
    buffer_load_dwordx4 v7, s[8:11], s30 offen offset:1024 lds
    v_mfma_f32_32x32x16_bf16 v[24:39], a[176:179], v[88:91], v[24:39]
    ds_read_b128 v[80:83], v2 offset:576
    s_add_u32 m0, s32, 4192
    s_nop 0
    buffer_load_dwordx4 v7, s[8:11], s30 offen offset:2048 lds
    s_waitcnt lgkmcnt(5)
    v_mfma_f32_32x32x16_bf16 v[8:23], a[52:55], v[92:95], v[8:23]
    s_add_u32 m0, s32, 4208
    s_nop 0
    buffer_load_dwordx4 v7, s[8:11], s30 offen offset:3072 lds
    v_mfma_f32_32x32x16_bf16 v[24:39], a[180:183], v[92:95], v[24:39]
    ds_read_b128 v[84:87], v2 offset:608
    s_waitcnt lgkmcnt(5)
    v_mfma_f32_32x32x16_bf16 v[8:23], a[56:59], v[96:99], v[8:23]
    v_mfma_f32_32x32x16_bf16 v[24:39], a[184:187], v[96:99], v[24:39]
    ds_read_b128 v[88:91], v2 offset:640
    s_waitcnt lgkmcnt(5)
    v_mfma_f32_32x32x16_bf16 v[8:23], a[60:63], v[100:103], v[8:23]
    v_mfma_f32_32x32x16_bf16 v[24:39], a[188:191], v[100:103], v[24:39]
    ds_read_b128 v[92:95], v2 offset:672
    s_waitcnt lgkmcnt(5)
    v_mfma_f32_32x32x16_bf16 v[8:23], a[64:67], v[72:75], v[8:23]
    v_mfma_f32_32x32x16_bf16 v[24:39], a[192:195], v[72:75], v[24:39]
    ds_read_b128 v[96:99], v2 offset:704
    s_waitcnt lgkmcnt(5)
    v_mfma_f32_32x32x16_bf16 v[8:23], a[68:71], v[76:79], v[8:23]
    v_mfma_f32_32x32x16_bf16 v[24:39], a[196:199], v[76:79], v[24:39]
    ds_read_b128 v[100:103], v2 offset:736
    s_waitcnt lgkmcnt(5)
    v_mfma_f32_32x32x16_bf16 v[8:23], a[72:75], v[80:83], v[8:23]
    v_mfma_f32_32x32x16_bf16 v[24:39], a[200:203], v[80:83], v[24:39]
    ds_read_b128 v[72:75], v2 offset:768
    s_waitcnt lgkmcnt(5)
    v_mfma_f32_32x32x16_bf16 v[8:23], a[76:79], v[84:87], v[8:23]
    v_mfma_f32_32x32x16_bf16 v[24:39], a[204:207], v[84:87], v[24:39]
    ds_read_b128 v[76:79], v2 offset:800
    s_waitcnt lgkmcnt(5)
    v_mfma_f32_32x32x16_bf16 v[8:23], a[80:83], v[88:91], v[8:23]
    v_mfma_f32_32x32x16_bf16 v[24:39], a[208:211], v[88:91], v[24:39]
    ds_read_b128 v[80:83], v2 offset:832
    s_waitcnt lgkmcnt(5)
    v_mfma_f32_32x32x16_bf16 v[8:23], a[84:87], v[92:95], v[8:23]
    v_mfma_f32_32x32x16_bf16 v[24:39], a[212:215], v[92:95], v[24:39]
    ds_read_b128 v[84:87], v2 offset:864
    s_waitcnt lgkmcnt(5)
    v_mfma_f32_32x32x16_bf16 v[8:23], a[88:91], v[96:99], v[8:23]
    v_mfma_f32_32x32x16_bf16 v[24:39], a[216:219], v[96:99], v[24:39]
    ds_read_b128 v[88:91], v2 offset:896
    s_waitcnt lgkmcnt(5)
    v_mfma_f32_32x32x16_bf16 v[8:23], a[92:95], v[100:103], v[8:23]
    v_mfma_f32_32x32x16_bf16 v[24:39], a[220:223], v[100:103], v[24:39]
    ds_read_b128 v[92:95], v2 offset:928
    s_waitcnt lgkmcnt(5)
    v_mfma_f32_32x32x16_bf16 v[8:23], a[96:99], v[72:75], v[8:23]
    v_mfma_f32_32x32x16_bf16 v[24:39], a[224:227], v[72:75], v[24:39]
    ds_read_b128 v[96:99], v2 offset:960
    s_waitcnt lgkmcnt(5)
    v_mfma_f32_32x32x16_bf16 v[8:23], a[100:103], v[76:79], v[8:23]
    v_mfma_f32_32x32x16_bf16 v[24:39], a[228:231], v[76:79], v[24:39]
    ds_read_b128 v[100:103], v2 offset:992
    s_waitcnt lgkmcnt(5)
    v_mfma_f32_32x32x16_bf16 v[8:23], a[104:107], v[80:83], v[8:23]
    v_mfma_f32_32x32x16_bf16 v[24:39], a[232:235], v[80:83], v[24:39]
    s_add_u32 s27, s27, 33280
    s_cmp_ge_u32 s27, 133120
    s_cselect_b32 s27, 0, s27
    v_add_u32 v2, s27, v1
    s_waitcnt vmcnt(8)
    s_barrier
    s_cmp_eq_u32 s58, 0
    s_cbranch_scc1 PB_7
    s_add_u32 s56, s26, 0
    v_mov_b32 v123, s56
    s_mov_b64 exec, 1
    buffer_store_dword v123, off, s[4:7], s57 sc1
    s_mov_b64 exec, -1
PB_7:
    ds_read_b128 v[72:75], v2 offset:0
    s_waitcnt lgkmcnt(5)
    v_mfma_f32_32x32x16_bf16 v[8:23], a[108:111], v[84:87], v[8:23]
    v_mfma_f32_32x32x16_bf16 v[24:39], a[236:239], v[84:87], v[24:39]
    ds_read_b128 v[76:79], v2 offset:32
    s_waitcnt lgkmcnt(5)
    v_mfma_f32_32x32x16_bf16 v[8:23], a[112:115], v[88:91], v[8:23]
    v_mfma_f32_32x32x16_bf16 v[24:39], a[240:243], v[88:91], v[24:39]
    ds_read_b128 v[80:83], v2 offset:64
    s_waitcnt lgkmcnt(5)
    v_mfma_f32_32x32x16_bf16 v[8:23], a[116:119], v[92:95], v[8:23]
    v_mfma_f32_32x32x16_bf16 v[24:39], a[244:247], v[92:95], v[24:39]
    ds_read_b128 v[84:87], v2 offset:96
    s_waitcnt lgkmcnt(5)
    v_mfma_f32_32x32x16_bf16 v[8:23], a[120:123], v[96:99], v[8:23]
    v_mfma_f32_32x32x16_bf16 v[24:39], a[248:251], v[96:99], v[24:39]
    ds_read_b128 v[88:91], v2 offset:128
    s_waitcnt lgkmcnt(5)
    v_mfma_f32_32x32x16_bf16 v[8:23], a[124:127], v[100:103], v[8:23]
    v_mfma_f32_32x32x16_bf16 v[24:39], a[252:255], v[100:103], v[24:39]
    ds_read_b128 v[92:95], v2 offset:160
    s_waitcnt lgkmcnt(5)
    v_mfma_f32_32x32x16_bf16 v[40:55], a[0:3], v[72:75], 0
    s_nop 0
    s_nop 0
    v_mfma_f32_32x32x16_bf16 v[56:71], a[128:131], v[72:75], 0
    ds_read_b128 v[96:99], v2 offset:192
    s_nop 0
    s_nop 0
    s_waitcnt lgkmcnt(5)
    v_mfma_f32_32x32x16_bf16 v[40:55], a[4:7], v[76:79], v[40:55]
    v_cvt_pk_bf16_f32 v104, v8, v16
    v_cvt_pk_bf16_f32 v105, v9, v17
    v_mfma_f32_32x32x16_bf16 v[56:71], a[132:135], v[76:79], v[56:71]
    ds_read_b128 v[100:103], v2 offset:224
    v_cvt_pk_bf16_f32 v106, v10, v18
    v_cvt_pk_bf16_f32 v107, v11, v19
    s_waitcnt lgkmcnt(5)
    v_mfma_f32_32x32x16_bf16 v[40:55], a[8:11], v[80:83], v[40:55]
    s_mov_b32 s29, s21
    buffer_store_dwordx4 v[104:107], v120, s[4:7], s29 offen sc1
    v_mfma_f32_32x32x16_bf16 v[56:71], a[136:139], v[80:83], v[56:71]
    ds_read_b128 v[72:75], v2 offset:256
    v_cvt_pk_bf16_f32 v108, v12, v20
    v_cvt_pk_bf16_f32 v109, v13, v21
    s_waitcnt lgkmcnt(5)
    v_mfma_f32_32x32x16_bf16 v[40:55], a[12:15], v[84:87], v[40:55]
    v_cvt_pk_bf16_f32 v110, v14, v22
    v_cvt_pk_bf16_f32 v111, v15, v23
    v_mfma_f32_32x32x16_bf16 v[56:71], a[140:143], v[84:87], v[56:71]
    ds_read_b128 v[76:79], v2 offset:288
    s_add_u32 s29, s29, s23
    buffer_store_dwordx4 v[108:111], v120, s[4:7], s29 offen sc1
    s_waitcnt lgkmcnt(5)
    v_mfma_f32_32x32x16_bf16 v[40:55], a[16:19], v[88:91], v[40:55]
    v_cvt_pk_bf16_f32 v112, v24, v32
    v_cvt_pk_bf16_f32 v113, v25, v33
    v_mfma_f32_32x32x16_bf16 v[56:71], a[144:147], v[88:91], v[56:71]
    ds_read_b128 v[80:83], v2 offset:320
    v_cvt_pk_bf16_f32 v114, v26, v34
    v_cvt_pk_bf16_f32 v115, v27, v35
    s_waitcnt lgkmcnt(5)
    v_mfma_f32_32x32x16_bf16 v[40:55], a[20:23], v[92:95], v[40:55]
    s_add_u32 s29, s21, s24
    buffer_store_dwordx4 v[112:115], v120, s[4:7], s29 offen sc1
    v_mfma_f32_32x32x16_bf16 v[56:71], a[148:151], v[92:95], v[56:71]
    ds_read_b128 v[84:87], v2 offset:352
    v_cvt_pk_bf16_f32 v116, v28, v36
    v_cvt_pk_bf16_f32 v117, v29, v37
    s_waitcnt lgkmcnt(5)
    v_mfma_f32_32x32x16_bf16 v[40:55], a[24:27], v[96:99], v[40:55]
    v_cvt_pk_bf16_f32 v118, v30, v38
    v_cvt_pk_bf16_f32 v119, v31, v39
    v_mfma_f32_32x32x16_bf16 v[56:71], a[152:155], v[96:99], v[56:71]
    ds_read_b128 v[88:91], v2 offset:384
    s_add_u32 s29, s29, s23
    buffer_store_dwordx4 v[116:119], v120, s[4:7], s29 offen sc1
    s_waitcnt lgkmcnt(5)
    v_mfma_f32_32x32x16_bf16 v[40:55], a[28:31], v[100:103], v[40:55]
    s_add_u32 s21, s21, s33
    s_mov_b32 s33, s22
    v_mfma_f32_32x32x16_bf16 v[56:71], a[156:159], v[100:103], v[56:71]
    ds_read_b128 v[92:95], v2 offset:416
    v_mov_b32 v120, v3
    s_add_u32 s28, s28, 131072
    s_waitcnt lgkmcnt(5)
    v_mfma_f32_32x32x16_bf16 v[40:55], a[32:35], v[72:75], v[40:55]
    s_add_u32 s32, s32, 33280
    s_cmp_ge_u32 s32, 133120
    v_mfma_f32_32x32x16_bf16 v[56:71], a[160:163], v[72:75], v[56:71]
    ds_read_b128 v[96:99], v2 offset:448
    s_cselect_b32 s29, 133120, 0
    s_sub_u32 s32, s32, s29
    s_waitcnt lgkmcnt(5)
    v_mfma_f32_32x32x16_bf16 v[40:55], a[36:39], v[76:79], v[40:55]
    s_add_u32 s30, s28, 0
    s_add_u32 m0, s32, 0
    v_mfma_f32_32x32x16_bf16 v[56:71], a[164:167], v[76:79], v[56:71]
    ds_read_b128 v[100:103], v2 offset:480
    buffer_load_dwordx4 v7, s[8:11], s30 offen offset:0 lds
    s_add_u32 m0, s32, 16
    s_waitcnt lgkmcnt(5)
    v_mfma_f32_32x32x16_bf16 v[40:55], a[40:43], v[80:83], v[40:55]
    buffer_load_dwordx4 v7, s[8:11], s30 offen offset:1024 lds
    s_add_u32 m0, s32, 32
    v_mfma_f32_32x32x16_bf16 v[56:71], a[168:171], v[80:83], v[56:71]
    ds_read_b128 v[72:75], v2 offset:512
    buffer_load_dwordx4 v7, s[8:11], s30 offen offset:2048 lds
    s_add_u32 m0, s32, 48
    s_waitcnt lgkmcnt(5)
    v_mfma_f32_32x32x16_bf16 v[40:55], a[44:47], v[84:87], v[40:55]
    buffer_load_dwordx4 v7, s[8:11], s30 offen offset:3072 lds
    s_add_u32 s30, s28, 4096
    v_mfma_f32_32x32x16_bf16 v[56:71], a[172:175], v[84:87], v[56:71]
    ds_read_b128 v[76:79], v2 offset:544
    s_add_u32 m0, s32, 4160
    s_nop 0
    buffer_load_dwordx4 v7, s[8:11], s30 offen offset:0 lds
    s_waitcnt lgkmcnt(5)
    v_mfma_f32_32x32x16_bf16 v[40:55], a[48:51], v[88:91], v[40:55]
    s_add_u32 m0, s32, 4176
    s_nop 0
    buffer_load_dwordx4 v7, s[8:11], s30 offen offset:1024 lds
    v_mfma_f32_32x32x16_bf16 v[56:71], a[176:179], v[88:91], v[56:71]
    ds_read_b128 v[80:83], v2 offset:576
    s_add_u32 m0, s32, 4192
    s_nop 0
    buffer_load_dwordx4 v7, s[8:11], s30 offen offset:2048 lds
    s_waitcnt lgkmcnt(5)
    v_mfma_f32_32x32x16_bf16 v[40:55], a[52:55], v[92:95], v[40:55]
    s_add_u32 m0, s32, 4208
    s_nop 0
    buffer_load_dwordx4 v7, s[8:11], s30 offen offset:3072 lds
    v_mfma_f32_32x32x16_bf16 v[56:71], a[180:183], v[92:95], v[56:71]
    ds_read_b128 v[84:87], v2 offset:608
    s_waitcnt lgkmcnt(5)
    v_mfma_f32_32x32x16_bf16 v[40:55], a[56:59], v[96:99], v[40:55]
    v_mfma_f32_32x32x16_bf16 v[56:71], a[184:187], v[96:99], v[56:71]
    ds_read_b128 v[88:91], v2 offset:640
    s_waitcnt lgkmcnt(5)
    v_mfma_f32_32x32x16_bf16 v[40:55], a[60:63], v[100:103], v[40:55]
    v_mfma_f32_32x32x16_bf16 v[56:71], a[188:191], v[100:103], v[56:71]
    ds_read_b128 v[92:95], v2 offset:672
    s_waitcnt lgkmcnt(5)
    v_mfma_f32_32x32x16_bf16 v[40:55], a[64:67], v[72:75], v[40:55]
    v_mfma_f32_32x32x16_bf16 v[56:71], a[192:195], v[72:75], v[56:71]
    ds_read_b128 v[96:99], v2 offset:704
    s_waitcnt lgkmcnt(5)
    v_mfma_f32_32x32x16_bf16 v[40:55], a[68:71], v[76:79], v[40:55]
    v_mfma_f32_32x32x16_bf16 v[56:71], a[196:199], v[76:79], v[56:71]
    ds_read_b128 v[100:103], v2 offset:736
    s_waitcnt lgkmcnt(5)
    v_mfma_f32_32x32x16_bf16 v[40:55], a[72:75], v[80:83], v[40:55]
    v_mfma_f32_32x32x16_bf16 v[56:71], a[200:203], v[80:83], v[56:71]
    ds_read_b128 v[72:75], v2 offset:768
    s_waitcnt lgkmcnt(5)
    v_mfma_f32_32x32x16_bf16 v[40:55], a[76:79], v[84:87], v[40:55]
    v_mfma_f32_32x32x16_bf16 v[56:71], a[204:207], v[84:87], v[56:71]
    ds_read_b128 v[76:79], v2 offset:800
    s_waitcnt lgkmcnt(5)
    v_mfma_f32_32x32x16_bf16 v[40:55], a[80:83], v[88:91], v[40:55]
    v_mfma_f32_32x32x16_bf16 v[56:71], a[208:211], v[88:91], v[56:71]
    ds_read_b128 v[80:83], v2 offset:832
    s_waitcnt lgkmcnt(5)
    v_mfma_f32_32x32x16_bf16 v[40:55], a[84:87], v[92:95], v[40:55]
    v_mfma_f32_32x32x16_bf16 v[56:71], a[212:215], v[92:95], v[56:71]
    ds_read_b128 v[84:87], v2 offset:864
    s_waitcnt lgkmcnt(5)
    v_mfma_f32_32x32x16_bf16 v[40:55], a[88:91], v[96:99], v[40:55]
    v_mfma_f32_32x32x16_bf16 v[56:71], a[216:219], v[96:99], v[56:71]
    ds_read_b128 v[88:91], v2 offset:896
    s_waitcnt lgkmcnt(5)
    v_mfma_f32_32x32x16_bf16 v[40:55], a[92:95], v[100:103], v[40:55]
    v_mfma_f32_32x32x16_bf16 v[56:71], a[220:223], v[100:103], v[56:71]
    ds_read_b128 v[92:95], v2 offset:928
    s_waitcnt lgkmcnt(5)
    v_mfma_f32_32x32x16_bf16 v[40:55], a[96:99], v[72:75], v[40:55]
    v_mfma_f32_32x32x16_bf16 v[56:71], a[224:227], v[72:75], v[56:71]
    ds_read_b128 v[96:99], v2 offset:960
    s_waitcnt lgkmcnt(5)
    v_mfma_f32_32x32x16_bf16 v[40:55], a[100:103], v[76:79], v[40:55]
    v_mfma_f32_32x32x16_bf16 v[56:71], a[228:231], v[76:79], v[56:71]
    ds_read_b128 v[100:103], v2 offset:992
    s_waitcnt lgkmcnt(5)
    v_mfma_f32_32x32x16_bf16 v[40:55], a[104:107], v[80:83], v[40:55]
    v_mfma_f32_32x32x16_bf16 v[56:71], a[232:235], v[80:83], v[56:71]
    s_add_u32 s27, s27, 33280
    s_cmp_ge_u32 s27, 133120
    s_cselect_b32 s27, 0, s27
    v_add_u32 v2, s27, v1
    s_waitcnt vmcnt(8)
    s_barrier
    s_cmp_eq_u32 s58, 0
    s_cbranch_scc1 PB_8
    s_add_u32 s56, s26, 1
    v_mov_b32 v123, s56
    s_mov_b64 exec, 1
    buffer_store_dword v123, off, s[4:7], s57 sc1
    s_mov_b64 exec, -1
PB_8:
    ds_read_b128 v[72:75], v2 offset:0
    s_waitcnt lgkmcnt(5)
    v_mfma_f32_32x32x16_bf16 v[40:55], a[108:111], v[84:87], v[40:55]
    v_mfma_f32_32x32x16_bf16 v[56:71], a[236:239], v[84:87], v[56:71]
    ds_read_b128 v[76:79], v2 offset:32
    s_waitcnt lgkmcnt(5)
    v_mfma_f32_32x32x16_bf16 v[40:55], a[112:115], v[88:91], v[40:55]
    v_mfma_f32_32x32x16_bf16 v[56:71], a[240:243], v[88:91], v[56:71]
    ds_read_b128 v[80:83], v2 offset:64
    s_waitcnt lgkmcnt(5)
    v_mfma_f32_32x32x16_bf16 v[40:55], a[116:119], v[92:95], v[40:55]
    v_mfma_f32_32x32x16_bf16 v[56:71], a[244:247], v[92:95], v[56:71]
    ds_read_b128 v[84:87], v2 offset:96
    s_waitcnt lgkmcnt(5)
    v_mfma_f32_32x32x16_bf16 v[40:55], a[120:123], v[96:99], v[40:55]
    v_mfma_f32_32x32x16_bf16 v[56:71], a[248:251], v[96:99], v[56:71]
    ds_read_b128 v[88:91], v2 offset:128
    s_waitcnt lgkmcnt(5)
    v_mfma_f32_32x32x16_bf16 v[40:55], a[124:127], v[100:103], v[40:55]
    v_mfma_f32_32x32x16_bf16 v[56:71], a[252:255], v[100:103], v[56:71]
    ds_read_b128 v[92:95], v2 offset:160
    s_add_u32 s26, s26, 2
    s_cmp_lt_u32 s26, 16
    s_cbranch_scc1 PM0_6_loop
    v_cvt_pk_bf16_f32 v104, v40, v48
    v_cvt_pk_bf16_f32 v105, v41, v49
    v_cvt_pk_bf16_f32 v106, v42, v50
    v_cvt_pk_bf16_f32 v107, v43, v51
    s_mov_b32 s29, s21
    buffer_store_dwordx4 v[104:107], v120, s[4:7], s29 offen sc1
    v_cvt_pk_bf16_f32 v108, v44, v52
    v_cvt_pk_bf16_f32 v109, v45, v53
    v_cvt_pk_bf16_f32 v110, v46, v54
    v_cvt_pk_bf16_f32 v111, v47, v55
    s_add_u32 s29, s29, s23
    buffer_store_dwordx4 v[108:111], v120, s[4:7], s29 offen sc1
    v_cvt_pk_bf16_f32 v112, v56, v64
    v_cvt_pk_bf16_f32 v113, v57, v65
    v_cvt_pk_bf16_f32 v114, v58, v66
    v_cvt_pk_bf16_f32 v115, v59, v67
    s_add_u32 s29, s21, s24
    buffer_store_dwordx4 v[112:115], v120, s[4:7], s29 offen sc1
    v_cvt_pk_bf16_f32 v116, v60, v68
    v_cvt_pk_bf16_f32 v117, v61, v69
    v_cvt_pk_bf16_f32 v118, v62, v70
    v_cvt_pk_bf16_f32 v119, v63, v71
    s_add_u32 s29, s29, s23
    buffer_store_dwordx4 v[116:119], v120, s[4:7], s29 offen sc1
    s_add_u32 s21, s21, s33
    s_mov_b32 s33, s22
    v_mov_b32 v120, v3
    s_waitcnt vmcnt(0) lgkmcnt(0)
    s_branch PR_3_end
PR_3_t1:
    v_bfe_u32 v4, v0, 4, 1
    v_mul_u32_u24 v3, 1024, v4
    v_lshrrev_b32 v4, 5, v0
    v_mul_u32_u24 v4, 256, v4
    v_add_u32 v3, v3, v4
    v_and_b32 v4, 15, v0
    v_lshl_add_u32 v3, v4, 4, v3
    v_mov_b32 v120, 0x40000000
    s_mov_b32 s33, 0
    s_waitcnt vmcnt(8)
    s_barrier
    v_mov_b32 v2, v1
    ds_read_b128 v[72:75], v2 offset:0
    ds_read_b128 v[76:79], v2 offset:32
    ds_read_b128 v[80:83], v2 offset:64
    ds_read_b128 v[84:87], v2 offset:96
    ds_read_b128 v[88:91], v2 offset:128
    ds_read_b128 v[92:95], v2 offset:160
    s_mov_b32 s26, 0
    s_mov_b32 s27, 0
PM1_9_loop:
    s_waitcnt lgkmcnt(5)
    v_mfma_f32_32x32x16_bf16 v[8:23], v[72:75], a[0:3], 0
    s_nop 0
    s_nop 0
    v_mfma_f32_32x32x16_bf16 v[24:39], v[72:75], a[128:131], 0
    ds_read_b128 v[96:99], v2 offset:192
    s_nop 0
    s_nop 0
    s_waitcnt lgkmcnt(5)
    v_mfma_f32_32x32x16_bf16 v[8:23], v[76:79], a[4:7], v[8:23]
    v_cvt_pk_bf16_f32 v104, v40, v41
    v_cvt_pk_bf16_f32 v105, v42, v43
    v_mfma_f32_32x32x16_bf16 v[24:39], v[76:79], a[132:135], v[24:39]
    ds_read_b128 v[100:103], v2 offset:224
    v_cvt_pk_bf16_f32 v106, v48, v49
    v_cvt_pk_bf16_f32 v107, v50, v51
    s_waitcnt lgkmcnt(5)
    v_mfma_f32_32x32x16_bf16 v[8:23], v[80:83], a[8:11], v[8:23]
    s_mov_b32 s29, s21
    buffer_store_dwordx4 v[104:107], v120, s[4:7], s29 offen sc1
    v_mfma_f32_32x32x16_bf16 v[24:39], v[80:83], a[136:139], v[24:39]
    ds_read_b128 v[72:75], v2 offset:256
    v_cvt_pk_bf16_f32 v108, v44, v45
    v_cvt_pk_bf16_f32 v109, v46, v47
    s_waitcnt lgkmcnt(5)
    v_mfma_f32_32x32x16_bf16 v[8:23], v[84:87], a[12:15], v[8:23]
    v_cvt_pk_bf16_f32 v110, v52, v53
    v_cvt_pk_bf16_f32 v111, v54, v55
    v_mfma_f32_32x32x16_bf16 v[24:39], v[84:87], a[140:143], v[24:39]
    ds_read_b128 v[76:79], v2 offset:288
    s_add_u32 s29, s29, s23
    buffer_store_dwordx4 v[108:111], v120, s[4:7], s29 offen sc1
    s_waitcnt lgkmcnt(5)
    v_mfma_f32_32x32x16_bf16 v[8:23], v[88:91], a[16:19], v[8:23]
    v_cvt_pk_bf16_f32 v112, v56, v57
    v_cvt_pk_bf16_f32 v113, v58, v59
    v_mfma_f32_32x32x16_bf16 v[24:39], v[88:91], a[144:147], v[24:39]
    ds_read_b128 v[80:83], v2 offset:320
    v_cvt_pk_bf16_f32 v114, v64, v65
    v_cvt_pk_bf16_f32 v115, v66, v67
    s_waitcnt lgkmcnt(5)
    v_mfma_f32_32x32x16_bf16 v[8:23], v[92:95], a[20:23], v[8:23]
    s_add_u32 s29, s21, s24
    buffer_store_dwordx4 v[112:115], v120, s[4:7], s29 offen sc1
    v_mfma_f32_32x32x16_bf16 v[24:39], v[92:95], a[148:151], v[24:39]
    ds_read_b128 v[84:87], v2 offset:352
    v_cvt_pk_bf16_f32 v116, v60, v61
    v_cvt_pk_bf16_f32 v117, v62, v63
    s_waitcnt lgkmcnt(5)
    v_mfma_f32_32x32x16_bf16 v[8:23], v[96:99], a[24:27], v[8:23]
    v_cvt_pk_bf16_f32 v118, v68, v69
    v_cvt_pk_bf16_f32 v119, v70, v71
    v_mfma_f32_32x32x16_bf16 v[24:39], v[96:99], a[152:155], v[24:39]
    ds_read_b128 v[88:91], v2 offset:384
    s_add_u32 s29, s29, s23
    buffer_store_dwordx4 v[116:119], v120, s[4:7], s29 offen sc1
    s_waitcnt lgkmcnt(5)
    v_mfma_f32_32x32x16_bf16 v[8:23], v[100:103], a[28:31], v[8:23]
    s_add_u32 s21, s21, s33
    s_mov_b32 s33, s22
    v_mfma_f32_32x32x16_bf16 v[24:39], v[100:103], a[156:159], v[24:39]
    ds_read_b128 v[92:95], v2 offset:416
    v_mov_b32 v120, v3
    s_add_u32 s28, s28, 131072
    s_waitcnt lgkmcnt(5)
    v_mfma_f32_32x32x16_bf16 v[8:23], v[72:75], a[32:35], v[8:23]
    s_add_u32 s32, s32, 33280
    s_cmp_ge_u32 s32, 133120
    v_mfma_f32_32x32x16_bf16 v[24:39], v[72:75], a[160:163], v[24:39]
    ds_read_b128 v[96:99], v2 offset:448
    s_cselect_b32 s29, 133120, 0
    s_sub_u32 s32, s32, s29
    s_waitcnt lgkmcnt(5)
    v_mfma_f32_32x32x16_bf16 v[8:23], v[76:79], a[36:39], v[8:23]
    s_add_u32 s30, s28, 0
    s_add_u32 m0, s32, 0
    v_mfma_f32_32x32x16_bf16 v[24:39], v[76:79], a[164:167], v[24:39]
    ds_read_b128 v[100:103], v2 offset:480
    buffer_load_dwordx4 v7, s[8:11], s30 offen offset:0 lds
    s_add_u32 m0, s32, 16
    s_waitcnt lgkmcnt(5)
    v_mfma_f32_32x32x16_bf16 v[8:23], v[80:83], a[40:43], v[8:23]
    buffer_load_dwordx4 v7, s[8:11], s30 offen offset:1024 lds
    s_add_u32 m0, s32, 32
    v_mfma_f32_32x32x16_bf16 v[24:39], v[80:83], a[168:171], v[24:39]
    ds_read_b128 v[72:75], v2 offset:512
    buffer_load_dwordx4 v7, s[8:11], s30 offen offset:2048 lds
    s_add_u32 m0, s32, 48
    s_waitcnt lgkmcnt(5)
    v_mfma_f32_32x32x16_bf16 v[8:23], v[84:87], a[44:47], v[8:23]
    buffer_load_dwordx4 v7, s[8:11], s30 offen offset:3072 lds
    s_add_u32 s30, s28, 4096
    v_mfma_f32_32x32x16_bf16 v[24:39], v[84:87], a[172:175], v[24:39]
    ds_read_b128 v[76:79], v2 offset:544
    s_add_u32 m0, s32, 4160
    s_nop 0
    buffer_load_dwordx4 v7, s[8:11], s30 offen offset:0 lds
    s_waitcnt lgkmcnt(5)
    v_mfma_f32_32x32x16_bf16 v[8:23], v[88:91], a[48:51], v[8:23]
    s_add_u32 m0, s32, 4176
    s_nop 0
    buffer_load_dwordx4 v7, s[8:11], s30 offen offset:1024 lds
    v_mfma_f32_32x32x16_bf16 v[24:39], v[88:91], a[176:179], v[24:39]
    ds_read_b128 v[80:83], v2 offset:576
    s_add_u32 m0, s32, 4192
    s_nop 0
    buffer_load_dwordx4 v7, s[8:11], s30 offen offset:2048 lds
    s_waitcnt lgkmcnt(5)
    v_mfma_f32_32x32x16_bf16 v[8:23], v[92:95], a[52:55], v[8:23]
    s_add_u32 m0, s32, 4208
    s_nop 0
    buffer_load_dwordx4 v7, s[8:11], s30 offen offset:3072 lds
    v_mfma_f32_32x32x16_bf16 v[24:39], v[92:95], a[180:183], v[24:39]
    ds_read_b128 v[84:87], v2 offset:608
    s_waitcnt lgkmcnt(5)
    v_mfma_f32_32x32x16_bf16 v[8:23], v[96:99], a[56:59], v[8:23]
    v_mfma_f32_32x32x16_bf16 v[24:39], v[96:99], a[184:187], v[24:39]
    ds_read_b128 v[88:91], v2 offset:640
    s_waitcnt lgkmcnt(5)
    v_mfma_f32_32x32x16_bf16 v[8:23], v[100:103], a[60:63], v[8:23]
    v_mfma_f32_32x32x16_bf16 v[24:39], v[100:103], a[188:191], v[24:39]
    ds_read_b128 v[92:95], v2 offset:672
    s_waitcnt lgkmcnt(5)
    v_mfma_f32_32x32x16_bf16 v[8:23], v[72:75], a[64:67], v[8:23]
    v_mfma_f32_32x32x16_bf16 v[24:39], v[72:75], a[192:195], v[24:39]
    ds_read_b128 v[96:99], v2 offset:704
    s_waitcnt lgkmcnt(5)
    v_mfma_f32_32x32x16_bf16 v[8:23], v[76:79], a[68:71], v[8:23]
    v_mfma_f32_32x32x16_bf16 v[24:39], v[76:79], a[196:199], v[24:39]
    ds_read_b128 v[100:103], v2 offset:736
    s_waitcnt lgkmcnt(5)
    v_mfma_f32_32x32x16_bf16 v[8:23], v[80:83], a[72:75], v[8:23]
    v_mfma_f32_32x32x16_bf16 v[24:39], v[80:83], a[200:203], v[24:39]
    ds_read_b128 v[72:75], v2 offset:768
    s_waitcnt lgkmcnt(5)
    v_mfma_f32_32x32x16_bf16 v[8:23], v[84:87], a[76:79], v[8:23]
    v_mfma_f32_32x32x16_bf16 v[24:39], v[84:87], a[204:207], v[24:39]
    ds_read_b128 v[76:79], v2 offset:800
    s_waitcnt lgkmcnt(5)
    v_mfma_f32_32x32x16_bf16 v[8:23], v[88:91], a[80:83], v[8:23]
    v_mfma_f32_32x32x16_bf16 v[24:39], v[88:91], a[208:211], v[24:39]
    ds_read_b128 v[80:83], v2 offset:832
    s_waitcnt lgkmcnt(5)
    v_mfma_f32_32x32x16_bf16 v[8:23], v[92:95], a[84:87], v[8:23]
    v_mfma_f32_32x32x16_bf16 v[24:39], v[92:95], a[212:215], v[24:39]
    ds_read_b128 v[84:87], v2 offset:864
    s_waitcnt lgkmcnt(5)
    v_mfma_f32_32x32x16_bf16 v[8:23], v[96:99], a[88:91], v[8:23]
    v_mfma_f32_32x32x16_bf16 v[24:39], v[96:99], a[216:219], v[24:39]
    ds_read_b128 v[88:91], v2 offset:896
    s_waitcnt lgkmcnt(5)
    v_mfma_f32_32x32x16_bf16 v[8:23], v[100:103], a[92:95], v[8:23]
    v_mfma_f32_32x32x16_bf16 v[24:39], v[100:103], a[220:223], v[24:39]
    ds_read_b128 v[92:95], v2 offset:928
    s_waitcnt lgkmcnt(5)
    v_mfma_f32_32x32x16_bf16 v[8:23], v[72:75], a[96:99], v[8:23]
    v_mfma_f32_32x32x16_bf16 v[24:39], v[72:75], a[224:227], v[24:39]
    ds_read_b128 v[96:99], v2 offset:960
    s_waitcnt lgkmcnt(5)
    v_mfma_f32_32x32x16_bf16 v[8:23], v[76:79], a[100:103], v[8:23]
    v_mfma_f32_32x32x16_bf16 v[24:39], v[76:79], a[228:231], v[24:39]
    ds_read_b128 v[100:103], v2 offset:992
    s_waitcnt lgkmcnt(5)
    v_mfma_f32_32x32x16_bf16 v[8:23], v[80:83], a[104:107], v[8:23]
    v_mfma_f32_32x32x16_bf16 v[24:39], v[80:83], a[232:235], v[24:39]
    s_add_u32 s27, s27, 33280
    s_cmp_ge_u32 s27, 133120
    s_cselect_b32 s27, 0, s27
    v_add_u32 v2, s27, v1
    s_waitcnt vmcnt(8)
    s_barrier
    ds_read_b128 v[72:75], v2 offset:0
    s_waitcnt lgkmcnt(5)
    v_mfma_f32_32x32x16_bf16 v[8:23], v[84:87], a[108:111], v[8:23]
    v_mfma_f32_32x32x16_bf16 v[24:39], v[84:87], a[236:239], v[24:39]
    ds_read_b128 v[76:79], v2 offset:32
    s_waitcnt lgkmcnt(5)
    v_mfma_f32_32x32x16_bf16 v[8:23], v[88:91], a[112:115], v[8:23]
    v_mfma_f32_32x32x16_bf16 v[24:39], v[88:91], a[240:243], v[24:39]
    ds_read_b128 v[80:83], v2 offset:64
    s_waitcnt lgkmcnt(5)
    v_mfma_f32_32x32x16_bf16 v[8:23], v[92:95], a[116:119], v[8:23]
    v_mfma_f32_32x32x16_bf16 v[24:39], v[92:95], a[244:247], v[24:39]
    ds_read_b128 v[84:87], v2 offset:96
    s_waitcnt lgkmcnt(5)
    v_mfma_f32_32x32x16_bf16 v[8:23], v[96:99], a[120:123], v[8:23]
    v_mfma_f32_32x32x16_bf16 v[24:39], v[96:99], a[248:251], v[24:39]
    ds_read_b128 v[88:91], v2 offset:128
    s_waitcnt lgkmcnt(5)
    v_mfma_f32_32x32x16_bf16 v[8:23], v[100:103], a[124:127], v[8:23]
    v_mfma_f32_32x32x16_bf16 v[24:39], v[100:103], a[252:255], v[24:39]
    ds_read_b128 v[92:95], v2 offset:160
    s_waitcnt lgkmcnt(5)
    v_mfma_f32_32x32x16_bf16 v[40:55], v[72:75], a[0:3], 0
    s_nop 0
    s_nop 0
    v_mfma_f32_32x32x16_bf16 v[56:71], v[72:75], a[128:131], 0
    ds_read_b128 v[96:99], v2 offset:192
    s_nop 0
    s_nop 0
    s_waitcnt lgkmcnt(5)
    v_mfma_f32_32x32x16_bf16 v[40:55], v[76:79], a[4:7], v[40:55]
    v_cvt_pk_bf16_f32 v104, v8, v9
    v_cvt_pk_bf16_f32 v105, v10, v11
    v_mfma_f32_32x32x16_bf16 v[56:71], v[76:79], a[132:135], v[56:71]
    ds_read_b128 v[100:103], v2 offset:224
    v_cvt_pk_bf16_f32 v106, v16, v17
    v_cvt_pk_bf16_f32 v107, v18, v19
    s_waitcnt lgkmcnt(5)
    v_mfma_f32_32x32x16_bf16 v[40:55], v[80:83], a[8:11], v[40:55]
    s_mov_b32 s29, s21
    buffer_store_dwordx4 v[104:107], v120, s[4:7], s29 offen sc1
    v_mfma_f32_32x32x16_bf16 v[56:71], v[80:83], a[136:139], v[56:71]
    ds_read_b128 v[72:75], v2 offset:256
    v_cvt_pk_bf16_f32 v108, v12, v13
    v_cvt_pk_bf16_f32 v109, v14, v15
    s_waitcnt lgkmcnt(5)
    v_mfma_f32_32x32x16_bf16 v[40:55], v[84:87], a[12:15], v[40:55]
    v_cvt_pk_bf16_f32 v110, v20, v21
    v_cvt_pk_bf16_f32 v111, v22, v23
    v_mfma_f32_32x32x16_bf16 v[56:71], v[84:87], a[140:143], v[56:71]
    ds_read_b128 v[76:79], v2 offset:288
    s_add_u32 s29, s29, s23
    buffer_store_dwordx4 v[108:111], v120, s[4:7], s29 offen sc1
    s_waitcnt lgkmcnt(5)
    v_mfma_f32_32x32x16_bf16 v[40:55], v[88:91], a[16:19], v[40:55]
    v_cvt_pk_bf16_f32 v112, v24, v25
    v_cvt_pk_bf16_f32 v113, v26, v27
    v_mfma_f32_32x32x16_bf16 v[56:71], v[88:91], a[144:147], v[56:71]
    ds_read_b128 v[80:83], v2 offset:320
    v_cvt_pk_bf16_f32 v114, v32, v33
    v_cvt_pk_bf16_f32 v115, v34, v35
    s_waitcnt lgkmcnt(5)
    v_mfma_f32_32x32x16_bf16 v[40:55], v[92:95], a[20:23], v[40:55]
    s_add_u32 s29, s21, s24
    buffer_store_dwordx4 v[112:115], v120, s[4:7], s29 offen sc1
    v_mfma_f32_32x32x16_bf16 v[56:71], v[92:95], a[148:151], v[56:71]
    ds_read_b128 v[84:87], v2 offset:352
    v_cvt_pk_bf16_f32 v116, v28, v29
    v_cvt_pk_bf16_f32 v117, v30, v31
    s_waitcnt lgkmcnt(5)
    v_mfma_f32_32x32x16_bf16 v[40:55], v[96:99], a[24:27], v[40:55]
    v_cvt_pk_bf16_f32 v118, v36, v37
    v_cvt_pk_bf16_f32 v119, v38, v39
    v_mfma_f32_32x32x16_bf16 v[56:71], v[96:99], a[152:155], v[56:71]
    ds_read_b128 v[88:91], v2 offset:384
    s_add_u32 s29, s29, s23
    buffer_store_dwordx4 v[116:119], v120, s[4:7], s29 offen sc1
    s_waitcnt lgkmcnt(5)
    v_mfma_f32_32x32x16_bf16 v[40:55], v[100:103], a[28:31], v[40:55]
    s_add_u32 s21, s21, s33
    s_mov_b32 s33, s22
    v_mfma_f32_32x32x16_bf16 v[56:71], v[100:103], a[156:159], v[56:71]
    ds_read_b128 v[92:95], v2 offset:416
    v_mov_b32 v120, v3
    s_add_u32 s28, s28, 131072
    s_waitcnt lgkmcnt(5)
    v_mfma_f32_32x32x16_bf16 v[40:55], v[72:75], a[32:35], v[40:55]
    s_add_u32 s32, s32, 33280
    s_cmp_ge_u32 s32, 133120
    v_mfma_f32_32x32x16_bf16 v[56:71], v[72:75], a[160:163], v[56:71]
    ds_read_b128 v[96:99], v2 offset:448
    s_cselect_b32 s29, 133120, 0
    s_sub_u32 s32, s32, s29
    s_waitcnt lgkmcnt(5)
    v_mfma_f32_32x32x16_bf16 v[40:55], v[76:79], a[36:39], v[40:55]
    s_add_u32 s30, s28, 0
    s_add_u32 m0, s32, 0
    v_mfma_f32_32x32x16_bf16 v[56:71], v[76:79], a[164:167], v[56:71]
    ds_read_b128 v[100:103], v2 offset:480
    buffer_load_dwordx4 v7, s[8:11], s30 offen offset:0 lds
    s_add_u32 m0, s32, 16
    s_waitcnt lgkmcnt(5)
    v_mfma_f32_32x32x16_bf16 v[40:55], v[80:83], a[40:43], v[40:55]
    buffer_load_dwordx4 v7, s[8:11], s30 offen offset:1024 lds
    s_add_u32 m0, s32, 32
    v_mfma_f32_32x32x16_bf16 v[56:71], v[80:83], a[168:171], v[56:71]
    ds_read_b128 v[72:75], v2 offset:512
    buffer_load_dwordx4 v7, s[8:11], s30 offen offset:2048 lds
    s_add_u32 m0, s32, 48
    s_waitcnt lgkmcnt(5)
    v_mfma_f32_32x32x16_bf16 v[40:55], v[84:87], a[44:47], v[40:55]
    buffer_load_dwordx4 v7, s[8:11], s30 offen offset:3072 lds
    s_add_u32 s30, s28, 4096
    v_mfma_f32_32x32x16_bf16 v[56:71], v[84:87], a[172:175], v[56:71]
    ds_read_b128 v[76:79], v2 offset:544
    s_add_u32 m0, s32, 4160
    s_nop 0
    buffer_load_dwordx4 v7, s[8:11], s30 offen offset:0 lds
    s_waitcnt lgkmcnt(5)
    v_mfma_f32_32x32x16_bf16 v[40:55], v[88:91], a[48:51], v[40:55]
    s_add_u32 m0, s32, 4176
    s_nop 0
    buffer_load_dwordx4 v7, s[8:11], s30 offen offset:1024 lds
    v_mfma_f32_32x32x16_bf16 v[56:71], v[88:91], a[176:179], v[56:71]
    ds_read_b128 v[80:83], v2 offset:576
    s_add_u32 m0, s32, 4192
    s_nop 0
    buffer_load_dwordx4 v7, s[8:11], s30 offen offset:2048 lds
    s_waitcnt lgkmcnt(5)
    v_mfma_f32_32x32x16_bf16 v[40:55], v[92:95], a[52:55], v[40:55]
    s_add_u32 m0, s32, 4208
    s_nop 0
    buffer_load_dwordx4 v7, s[8:11], s30 offen offset:3072 lds
    v_mfma_f32_32x32x16_bf16 v[56:71], v[92:95], a[180:183], v[56:71]
    ds_read_b128 v[84:87], v2 offset:608
    s_waitcnt lgkmcnt(5)
    v_mfma_f32_32x32x16_bf16 v[40:55], v[96:99], a[56:59], v[40:55]
    v_mfma_f32_32x32x16_bf16 v[56:71], v[96:99], a[184:187], v[56:71]
    ds_read_b128 v[88:91], v2 offset:640
    s_waitcnt lgkmcnt(5)
    v_mfma_f32_32x32x16_bf16 v[40:55], v[100:103], a[60:63], v[40:55]
    v_mfma_f32_32x32x16_bf16 v[56:71], v[100:103], a[188:191], v[56:71]
    ds_read_b128 v[92:95], v2 offset:672
    s_waitcnt lgkmcnt(5)
    v_mfma_f32_32x32x16_bf16 v[40:55], v[72:75], a[64:67], v[40:55]
    v_mfma_f32_32x32x16_bf16 v[56:71], v[72:75], a[192:195], v[56:71]
    ds_read_b128 v[96:99], v2 offset:704
    s_waitcnt lgkmcnt(5)
    v_mfma_f32_32x32x16_bf16 v[40:55], v[76:79], a[68:71], v[40:55]
    v_mfma_f32_32x32x16_bf16 v[56:71], v[76:79], a[196:199], v[56:71]
    ds_read_b128 v[100:103], v2 offset:736
    s_waitcnt lgkmcnt(5)
    v_mfma_f32_32x32x16_bf16 v[40:55], v[80:83], a[72:75], v[40:55]
    v_mfma_f32_32x32x16_bf16 v[56:71], v[80:83], a[200:203], v[56:71]
    ds_read_b128 v[72:75], v2 offset:768
    s_waitcnt lgkmcnt(5)
    v_mfma_f32_32x32x16_bf16 v[40:55], v[84:87], a[76:79], v[40:55]
    v_mfma_f32_32x32x16_bf16 v[56:71], v[84:87], a[204:207], v[56:71]
    ds_read_b128 v[76:79], v2 offset:800
    s_waitcnt lgkmcnt(5)
    v_mfma_f32_32x32x16_bf16 v[40:55], v[88:91], a[80:83], v[40:55]
    v_mfma_f32_32x32x16_bf16 v[56:71], v[88:91], a[208:211], v[56:71]
    ds_read_b128 v[80:83], v2 offset:832
    s_waitcnt lgkmcnt(5)
    v_mfma_f32_32x32x16_bf16 v[40:55], v[92:95], a[84:87], v[40:55]
    v_mfma_f32_32x32x16_bf16 v[56:71], v[92:95], a[212:215], v[56:71]
    ds_read_b128 v[84:87], v2 offset:864
    s_waitcnt lgkmcnt(5)
    v_mfma_f32_32x32x16_bf16 v[40:55], v[96:99], a[88:91], v[40:55]
    v_mfma_f32_32x32x16_bf16 v[56:71], v[96:99], a[216:219], v[56:71]
    ds_read_b128 v[88:91], v2 offset:896
    s_waitcnt lgkmcnt(5)
    v_mfma_f32_32x32x16_bf16 v[40:55], v[100:103], a[92:95], v[40:55]
    v_mfma_f32_32x32x16_bf16 v[56:71], v[100:103], a[220:223], v[56:71]
    ds_read_b128 v[92:95], v2 offset:928
    s_waitcnt lgkmcnt(5)
    v_mfma_f32_32x32x16_bf16 v[40:55], v[72:75], a[96:99], v[40:55]
    v_mfma_f32_32x32x16_bf16 v[56:71], v[72:75], a[224:227], v[56:71]
    ds_read_b128 v[96:99], v2 offset:960
    s_waitcnt lgkmcnt(5)
    v_mfma_f32_32x32x16_bf16 v[40:55], v[76:79], a[100:103], v[40:55]
    v_mfma_f32_32x32x16_bf16 v[56:71], v[76:79], a[228:231], v[56:71]
    ds_read_b128 v[100:103], v2 offset:992
    s_waitcnt lgkmcnt(5)
    v_mfma_f32_32x32x16_bf16 v[40:55], v[80:83], a[104:107], v[40:55]
    v_mfma_f32_32x32x16_bf16 v[56:71], v[80:83], a[232:235], v[56:71]
    s_add_u32 s27, s27, 33280
    s_cmp_ge_u32 s27, 133120
    s_cselect_b32 s27, 0, s27
    v_add_u32 v2, s27, v1
    s_waitcnt vmcnt(8)
    s_barrier
    ds_read_b128 v[72:75], v2 offset:0
    s_waitcnt lgkmcnt(5)
    v_mfma_f32_32x32x16_bf16 v[40:55], v[84:87], a[108:111], v[40:55]
    v_mfma_f32_32x32x16_bf16 v[56:71], v[84:87], a[236:239], v[56:71]
    ds_read_b128 v[76:79], v2 offset:32
    s_waitcnt lgkmcnt(5)
    v_mfma_f32_32x32x16_bf16 v[40:55], v[88:91], a[112:115], v[40:55]
    v_mfma_f32_32x32x16_bf16 v[56:71], v[88:91], a[240:243], v[56:71]
    ds_read_b128 v[80:83], v2 offset:64
    s_waitcnt lgkmcnt(5)
    v_mfma_f32_32x32x16_bf16 v[40:55], v[92:95], a[116:119], v[40:55]
    v_mfma_f32_32x32x16_bf16 v[56:71], v[92:95], a[244:247], v[56:71]
    ds_read_b128 v[84:87], v2 offset:96
    s_waitcnt lgkmcnt(5)
    v_mfma_f32_32x32x16_bf16 v[40:55], v[96:99], a[120:123], v[40:55]
    v_mfma_f32_32x32x16_bf16 v[56:71], v[96:99], a[248:251], v[56:71]
    ds_read_b128 v[88:91], v2 offset:128
    s_waitcnt lgkmcnt(5)
    v_mfma_f32_32x32x16_bf16 v[40:55], v[100:103], a[124:127], v[40:55]
    v_mfma_f32_32x32x16_bf16 v[56:71], v[100:103], a[252:255], v[56:71]
    ds_read_b128 v[92:95], v2 offset:160
    s_add_u32 s26, s26, 2
    s_cmp_lt_u32 s26, 16
    s_cbranch_scc1 PM1_9_loop
    v_cvt_pk_bf16_f32 v104, v40, v41
    v_cvt_pk_bf16_f32 v105, v42, v43
    v_cvt_pk_bf16_f32 v106, v48, v49
    v_cvt_pk_bf16_f32 v107, v50, v51
    s_mov_b32 s29, s21
    buffer_store_dwordx4 v[104:107], v120, s[4:7], s29 offen sc1
    v_cvt_pk_bf16_f32 v108, v44, v45
    v_cvt_pk_bf16_f32 v109, v46, v47
    v_cvt_pk_bf16_f32 v110, v52, v53
    v_cvt_pk_bf16_f32 v111, v54, v55
    s_add_u32 s29, s29, s23
    buffer_store_dwordx4 v[108:111], v120, s[4:7], s29 offen sc1
    v_cvt_pk_bf16_f32 v112, v56, v57
    v_cvt_pk_bf16_f32 v113, v58, v59
    v_cvt_pk_bf16_f32 v114, v64, v65
    v_cvt_pk_bf16_f32 v115, v66, v67
    s_add_u32 s29, s21, s24
    buffer_store_dwordx4 v[112:115], v120, s[4:7], s29 offen sc1
    v_cvt_pk_bf16_f32 v116, v60, v61
    v_cvt_pk_bf16_f32 v117, v62, v63
    v_cvt_pk_bf16_f32 v118, v68, v69
    v_cvt_pk_bf16_f32 v119, v70, v71
    s_add_u32 s29, s29, s23
    buffer_store_dwordx4 v[116:119], v120, s[4:7], s29 offen sc1
    s_add_u32 s21, s21, s33
    s_mov_b32 s33, s22
    v_mov_b32 v120, v3
    s_waitcnt vmcnt(0) lgkmcnt(0)
    s_branch PR_3_end
PR_3_t2:
    v_bfe_u32 v4, v0, 4, 1
    v_mul_u32_u24 v3, 256, v4
    v_lshrrev_b32 v4, 5, v0
    v_mul_u32_u24 v4, 512, v4
    v_add_u32 v3, v3, v4
    v_and_b32 v4, 15, v0
    v_lshl_add_u32 v3, v4, 4, v3
    v_mov_b32 v120, 0x40000000
    s_mov_b32 s33, 0
    s_waitcnt vmcnt(8)
    s_barrier
    v_mov_b32 v2, v1
    ds_read_b128 v[72:75], v2 offset:0
    ds_read_b128 v[76:79], v2 offset:32
    ds_read_b128 v[80:83], v2 offset:64
    ds_read_b128 v[84:87], v2 offset:96
    ds_read_b128 v[88:91], v2 offset:128
    ds_read_b128 v[92:95], v2 offset:160
    s_mov_b32 s26, 0
    s_mov_b32 s27, 0
PM2_10_loop:
    s_waitcnt lgkmcnt(5)
    v_mfma_f32_32x32x16_bf16 v[8:23], a[0:3], v[72:75], 0
    s_nop 0
    s_nop 0
    v_mfma_f32_32x32x16_bf16 v[24:39], a[128:131], v[72:75], 0
    ds_read_b128 v[96:99], v2 offset:192
    s_nop 0
    s_nop 0
    s_waitcnt lgkmcnt(5)
    v_mfma_f32_32x32x16_bf16 v[8:23], a[4:7], v[76:79], v[8:23]
    v_mul_f32 v40, s25, v40
    v_mul_f32 v41, s25, v41
    v_mfma_f32_32x32x16_bf16 v[24:39], a[132:135], v[76:79], v[24:39]
    ds_read_b128 v[100:103], v2 offset:224
    v_mul_f32 v42, s25, v42
    v_mul_f32 v43, s25, v43
    s_waitcnt lgkmcnt(5)
    v_mfma_f32_32x32x16_bf16 v[8:23], a[8:11], v[80:83], v[8:23]
    v_mul_f32 v44, s25, v44
    v_mul_f32 v45, s25, v45
    v_mfma_f32_32x32x16_bf16 v[24:39], a[136:139], v[80:83], v[24:39]
    ds_read_b128 v[72:75], v2 offset:256
    v_mul_f32 v46, s25, v46
    v_mul_f32 v47, s25, v47
    s_waitcnt lgkmcnt(5)
    v_mfma_f32_32x32x16_bf16 v[8:23], a[12:15], v[84:87], v[8:23]
    v_mul_f32 v48, s25, v48
    v_mul_f32 v49, s25, v49
    v_mfma_f32_32x32x16_bf16 v[24:39], a[140:143], v[84:87], v[24:39]
    ds_read_b128 v[76:79], v2 offset:288
    v_mul_f32 v50, s25, v50
    v_mul_f32 v51, s25, v51
    s_waitcnt lgkmcnt(5)
    v_mfma_f32_32x32x16_bf16 v[8:23], a[16:19], v[88:91], v[8:23]
    v_mul_f32 v52, s25, v52
    v_mul_f32 v53, s25, v53
    v_mfma_f32_32x32x16_bf16 v[24:39], a[144:147], v[88:91], v[24:39]
    ds_read_b128 v[80:83], v2 offset:320
    v_mul_f32 v54, s25, v54
    v_mul_f32 v55, s25, v55
    s_waitcnt lgkmcnt(5)
    v_mfma_f32_32x32x16_bf16 v[8:23], a[20:23], v[92:95], v[8:23]
    v_cvt_pk_bf16_f32 v104, v40, v41
    v_cvt_pk_bf16_f32 v105, v42, v43
    v_mfma_f32_32x32x16_bf16 v[24:39], a[148:151], v[92:95], v[24:39]
    ds_read_b128 v[84:87], v2 offset:352
    v_cvt_pk_bf16_f32 v106, v44, v45
    v_cvt_pk_bf16_f32 v107, v46, v47
    s_waitcnt lgkmcnt(5)
    v_mfma_f32_32x32x16_bf16 v[8:23], a[24:27], v[96:99], v[8:23]
    s_mov_b32 s29, s21
    buffer_store_dwordx4 v[104:107], v120, s[4:7], s29 offen sc1
    v_mfma_f32_32x32x16_bf16 v[24:39], a[152:155], v[96:99], v[24:39]
    ds_read_b128 v[88:91], v2 offset:384
    v_cvt_pk_bf16_f32 v108, v48, v49
    v_cvt_pk_bf16_f32 v109, v50, v51
    s_waitcnt lgkmcnt(5)
    v_mfma_f32_32x32x16_bf16 v[8:23], a[28:31], v[100:103], v[8:23]
    v_cvt_pk_bf16_f32 v110, v52, v53
    v_cvt_pk_bf16_f32 v111, v54, v55
    v_mfma_f32_32x32x16_bf16 v[24:39], a[156:159], v[100:103], v[24:39]
    ds_read_b128 v[92:95], v2 offset:416
    s_add_u32 s29, s29, s23
    buffer_store_dwordx4 v[108:111], v120, s[4:7], s29 offen sc1
    s_waitcnt lgkmcnt(5)
    v_mfma_f32_32x32x16_bf16 v[8:23], a[32:35], v[72:75], v[8:23]
    v_mul_f32 v56, s25, v56
    v_mul_f32 v57, s25, v57
    v_mfma_f32_32x32x16_bf16 v[24:39], a[160:163], v[72:75], v[24:39]
    ds_read_b128 v[96:99], v2 offset:448
    v_mul_f32 v58, s25, v58
    v_mul_f32 v59, s25, v59
    s_waitcnt lgkmcnt(5)
    v_mfma_f32_32x32x16_bf16 v[8:23], a[36:39], v[76:79], v[8:23]
    v_mul_f32 v60, s25, v60
    v_mul_f32 v61, s25, v61
    v_mfma_f32_32x32x16_bf16 v[24:39], a[164:167], v[76:79], v[24:39]
    ds_read_b128 v[100:103], v2 offset:480
    v_mul_f32 v62, s25, v62
    v_mul_f32 v63, s25, v63
    s_waitcnt lgkmcnt(5)
    v_mfma_f32_32x32x16_bf16 v[8:23], a[40:43], v[80:83], v[8:23]
    v_mul_f32 v64, s25, v64
    v_mul_f32 v65, s25, v65
    v_mfma_f32_32x32x16_bf16 v[24:39], a[168:171], v[80:83], v[24:39]
    ds_read_b128 v[72:75], v2 offset:512
    v_mul_f32 v66, s25, v66
    v_mul_f32 v67, s25, v67
    s_waitcnt lgkmcnt(5)
    v_mfma_f32_32x32x16_bf16 v[8:23], a[44:47], v[84:87], v[8:23]
    v_mul_f32 v68, s25, v68
    v_mul_f32 v69, s25, v69
    v_mfma_f32_32x32x16_bf16 v[24:39], a[172:175], v[84:87], v[24:39]
    ds_read_b128 v[76:79], v2 offset:544
    v_mul_f32 v70, s25, v70
    v_mul_f32 v71, s25, v71
    s_waitcnt lgkmcnt(5)
    v_mfma_f32_32x32x16_bf16 v[8:23], a[48:51], v[88:91], v[8:23]
    v_cvt_pk_bf16_f32 v112, v56, v57
    v_cvt_pk_bf16_f32 v113, v58, v59
    v_mfma_f32_32x32x16_bf16 v[24:39], a[176:179], v[88:91], v[24:39]
    ds_read_b128 v[80:83], v2 offset:576
    v_cvt_pk_bf16_f32 v114, v60, v61
    v_cvt_pk_bf16_f32 v115, v62, v63
    s_waitcnt lgkmcnt(5)
    v_mfma_f32_32x32x16_bf16 v[8:23], a[52:55], v[92:95], v[8:23]
    s_add_u32 s29, s21, s24
    buffer_store_dwordx4 v[112:115], v120, s[4:7], s29 offen sc1
    v_mfma_f32_32x32x16_bf16 v[24:39], a[180:183], v[92:95], v[24:39]
    ds_read_b128 v[84:87], v2 offset:608
    v_cvt_pk_bf16_f32 v116, v64, v65
    v_cvt_pk_bf16_f32 v117, v66, v67
    s_waitcnt lgkmcnt(5)
    v_mfma_f32_32x32x16_bf16 v[8:23], a[56:59], v[96:99], v[8:23]
    v_cvt_pk_bf16_f32 v118, v68, v69
    v_cvt_pk_bf16_f32 v119, v70, v71
    v_mfma_f32_32x32x16_bf16 v[24:39], a[184:187], v[96:99], v[24:39]
    ds_read_b128 v[88:91], v2 offset:640
    s_add_u32 s29, s29, s23
    buffer_store_dwordx4 v[116:119], v120, s[4:7], s29 offen sc1
    s_waitcnt lgkmcnt(5)
    v_mfma_f32_32x32x16_bf16 v[8:23], a[60:63], v[100:103], v[8:23]
    s_add_u32 s21, s21, s33
    s_mov_b32 s33, s22
    v_mfma_f32_32x32x16_bf16 v[24:39], a[188:191], v[100:103], v[24:39]
    ds_read_b128 v[92:95], v2 offset:672
    v_mov_b32 v120, v3
    s_add_u32 s28, s28, 131072
    s_waitcnt lgkmcnt(5)
    v_mfma_f32_32x32x16_bf16 v[8:23], a[64:67], v[72:75], v[8:23]
    s_add_u32 s32, s32, 33280
    s_cmp_ge_u32 s32, 133120
    v_mfma_f32_32x32x16_bf16 v[24:39], a[192:195], v[72:75], v[24:39]
    ds_read_b128 v[96:99], v2 offset:704
    s_cselect_b32 s29, 133120, 0
    s_sub_u32 s32, s32, s29
    s_waitcnt lgkmcnt(5)
    v_mfma_f32_32x32x16_bf16 v[8:23], a[68:71], v[76:79], v[8:23]
    s_add_u32 s30, s28, 0
    s_add_u32 m0, s32, 0
    v_mfma_f32_32x32x16_bf16 v[24:39], a[196:199], v[76:79], v[24:39]
    ds_read_b128 v[100:103], v2 offset:736
    buffer_load_dwordx4 v7, s[8:11], s30 offen offset:0 lds
    s_add_u32 m0, s32, 16
    s_waitcnt lgkmcnt(5)
    v_mfma_f32_32x32x16_bf16 v[8:23], a[72:75], v[80:83], v[8:23]
    buffer_load_dwordx4 v7, s[8:11], s30 offen offset:1024 lds
    s_add_u32 m0, s32, 32
    v_mfma_f32_32x32x16_bf16 v[24:39], a[200:203], v[80:83], v[24:39]
    ds_read_b128 v[72:75], v2 offset:768
    buffer_load_dwordx4 v7, s[8:11], s30 offen offset:2048 lds
    s_add_u32 m0, s32, 48
    s_waitcnt lgkmcnt(5)
    v_mfma_f32_32x32x16_bf16 v[8:23], a[76:79], v[84:87], v[8:23]
    buffer_load_dwordx4 v7, s[8:11], s30 offen offset:3072 lds
    s_add_u32 s30, s28, 4096
    v_mfma_f32_32x32x16_bf16 v[24:39], a[204:207], v[84:87], v[24:39]
    ds_read_b128 v[76:79], v2 offset:800
    s_add_u32 m0, s32, 4160
    s_nop 0
    buffer_load_dwordx4 v7, s[8:11], s30 offen offset:0 lds
    s_waitcnt lgkmcnt(5)
    v_mfma_f32_32x32x16_bf16 v[8:23], a[80:83], v[88:91], v[8:23]
    s_add_u32 m0, s32, 4176
    s_nop 0
    buffer_load_dwordx4 v7, s[8:11], s30 offen offset:1024 lds
    v_mfma_f32_32x32x16_bf16 v[24:39], a[208:211], v[88:91], v[24:39]
    ds_read_b128 v[80:83], v2 offset:832
    s_add_u32 m0, s32, 4192
    s_nop 0
    buffer_load_dwordx4 v7, s[8:11], s30 offen offset:2048 lds
    s_waitcnt lgkmcnt(5)
    v_mfma_f32_32x32x16_bf16 v[8:23], a[84:87], v[92:95], v[8:23]
    s_add_u32 m0, s32, 4208
    s_nop 0
    buffer_load_dwordx4 v7, s[8:11], s30 offen offset:3072 lds
    v_mfma_f32_32x32x16_bf16 v[24:39], a[212:215], v[92:95], v[24:39]
    ds_read_b128 v[84:87], v2 offset:864
    s_waitcnt lgkmcnt(5)
    v_mfma_f32_32x32x16_bf16 v[8:23], a[88:91], v[96:99], v[8:23]
    v_mfma_f32_32x32x16_bf16 v[24:39], a[216:219], v[96:99], v[24:39]
    ds_read_b128 v[88:91], v2 offset:896
    s_waitcnt lgkmcnt(5)
    v_mfma_f32_32x32x16_bf16 v[8:23], a[92:95], v[100:103], v[8:23]
    v_mfma_f32_32x32x16_bf16 v[24:39], a[220:223], v[100:103], v[24:39]
    ds_read_b128 v[92:95], v2 offset:928
    s_waitcnt lgkmcnt(5)
    v_mfma_f32_32x32x16_bf16 v[8:23], a[96:99], v[72:75], v[8:23]
    v_mfma_f32_32x32x16_bf16 v[24:39], a[224:227], v[72:75], v[24:39]
    ds_read_b128 v[96:99], v2 offset:960
    s_waitcnt lgkmcnt(5)
    v_mfma_f32_32x32x16_bf16 v[8:23], a[100:103], v[76:79], v[8:23]
    v_mfma_f32_32x32x16_bf16 v[24:39], a[228:231], v[76:79], v[24:39]
    ds_read_b128 v[100:103], v2 offset:992
    s_waitcnt lgkmcnt(5)
    v_mfma_f32_32x32x16_bf16 v[8:23], a[104:107], v[80:83], v[8:23]
    v_mfma_f32_32x32x16_bf16 v[24:39], a[232:235], v[80:83], v[24:39]
    s_add_u32 s27, s27, 33280
    s_cmp_ge_u32 s27, 133120
    s_cselect_b32 s27, 0, s27
    v_add_u32 v2, s27, v1
    s_waitcnt vmcnt(12)
    s_barrier
    ds_read_b128 v[72:75], v2 offset:0
    s_waitcnt lgkmcnt(5)
    v_mfma_f32_32x32x16_bf16 v[8:23], a[108:111], v[84:87], v[8:23]
    v_mfma_f32_32x32x16_bf16 v[24:39], a[236:239], v[84:87], v[24:39]
    ds_read_b128 v[76:79], v2 offset:32
    s_waitcnt lgkmcnt(5)
    v_mfma_f32_32x32x16_bf16 v[8:23], a[112:115], v[88:91], v[8:23]
    v_mfma_f32_32x32x16_bf16 v[24:39], a[240:243], v[88:91], v[24:39]
    ds_read_b128 v[80:83], v2 offset:64
    s_waitcnt lgkmcnt(5)
    v_mfma_f32_32x32x16_bf16 v[8:23], a[116:119], v[92:95], v[8:23]
    v_mfma_f32_32x32x16_bf16 v[24:39], a[244:247], v[92:95], v[24:39]
    ds_read_b128 v[84:87], v2 offset:96
    s_waitcnt lgkmcnt(5)
    v_mfma_f32_32x32x16_bf16 v[8:23], a[120:123], v[96:99], v[8:23]
    v_mfma_f32_32x32x16_bf16 v[24:39], a[248:251], v[96:99], v[24:39]
    ds_read_b128 v[88:91], v2 offset:128
    s_waitcnt lgkmcnt(5)
    v_mfma_f32_32x32x16_bf16 v[8:23], a[124:127], v[100:103], v[8:23]
    v_mfma_f32_32x32x16_bf16 v[24:39], a[252:255], v[100:103], v[24:39]
    ds_read_b128 v[92:95], v2 offset:160
    s_waitcnt lgkmcnt(5)
    v_mfma_f32_32x32x16_bf16 v[40:55], a[0:3], v[72:75], 0
    s_nop 0
    s_nop 0
    v_mfma_f32_32x32x16_bf16 v[56:71], a[128:131], v[72:75], 0
    ds_read_b128 v[96:99], v2 offset:192
    s_nop 0
    s_nop 0
    s_waitcnt lgkmcnt(5)
    v_mfma_f32_32x32x16_bf16 v[40:55], a[4:7], v[76:79], v[40:55]
    v_mul_f32 v8, s25, v8
    v_mul_f32 v9, s25, v9
    v_mfma_f32_32x32x16_bf16 v[56:71], a[132:135], v[76:79], v[56:71]
    ds_read_b128 v[100:103], v2 offset:224
    v_mul_f32 v10, s25, v10
    v_mul_f32 v11, s25, v11
    s_waitcnt lgkmcnt(5)
    v_mfma_f32_32x32x16_bf16 v[40:55], a[8:11], v[80:83], v[40:55]
    v_mul_f32 v12, s25, v12
    v_mul_f32 v13, s25, v13
    v_mfma_f32_32x32x16_bf16 v[56:71], a[136:139], v[80:83], v[56:71]
    ds_read_b128 v[72:75], v2 offset:256
    v_mul_f32 v14, s25, v14
    v_mul_f32 v15, s25, v15
    s_waitcnt lgkmcnt(5)
    v_mfma_f32_32x32x16_bf16 v[40:55], a[12:15], v[84:87], v[40:55]
    v_mul_f32 v16, s25, v16
    v_mul_f32 v17, s25, v17
    v_mfma_f32_32x32x16_bf16 v[56:71], a[140:143], v[84:87], v[56:71]
    ds_read_b128 v[76:79], v2 offset:288
    v_mul_f32 v18, s25, v18
    v_mul_f32 v19, s25, v19
    s_waitcnt lgkmcnt(5)
    v_mfma_f32_32x32x16_bf16 v[40:55], a[16:19], v[88:91], v[40:55]
    v_mul_f32 v20, s25, v20
    v_mul_f32 v21, s25, v21
    v_mfma_f32_32x32x16_bf16 v[56:71], a[144:147], v[88:91], v[56:71]
    ds_read_b128 v[80:83], v2 offset:320
    v_mul_f32 v22, s25, v22
    v_mul_f32 v23, s25, v23
    s_waitcnt lgkmcnt(5)
    v_mfma_f32_32x32x16_bf16 v[40:55], a[20:23], v[92:95], v[40:55]
    v_cvt_pk_bf16_f32 v104, v8, v9
    v_cvt_pk_bf16_f32 v105, v10, v11
    v_mfma_f32_32x32x16_bf16 v[56:71], a[148:151], v[92:95], v[56:71]
    ds_read_b128 v[84:87], v2 offset:352
    v_cvt_pk_bf16_f32 v106, v12, v13
    v_cvt_pk_bf16_f32 v107, v14, v15
    s_waitcnt lgkmcnt(5)
    v_mfma_f32_32x32x16_bf16 v[40:55], a[24:27], v[96:99], v[40:55]
    s_mov_b32 s29, s21
    buffer_store_dwordx4 v[104:107], v120, s[4:7], s29 offen sc1
    v_mfma_f32_32x32x16_bf16 v[56:71], a[152:155], v[96:99], v[56:71]
    ds_read_b128 v[88:91], v2 offset:384
    v_cvt_pk_bf16_f32 v108, v16, v17
    v_cvt_pk_bf16_f32 v109, v18, v19
    s_waitcnt lgkmcnt(5)
    v_mfma_f32_32x32x16_bf16 v[40:55], a[28:31], v[100:103], v[40:55]
    v_cvt_pk_bf16_f32 v110, v20, v21
    v_cvt_pk_bf16_f32 v111, v22, v23
    v_mfma_f32_32x32x16_bf16 v[56:71], a[156:159], v[100:103], v[56:71]
    ds_read_b128 v[92:95], v2 offset:416
    s_add_u32 s29, s29, s23
    buffer_store_dwordx4 v[108:111], v120, s[4:7], s29 offen sc1
    s_waitcnt lgkmcnt(5)
    v_mfma_f32_32x32x16_bf16 v[40:55], a[32:35], v[72:75], v[40:55]
    v_mul_f32 v24, s25, v24
    v_mul_f32 v25, s25, v25
    v_mfma_f32_32x32x16_bf16 v[56:71], a[160:163], v[72:75], v[56:71]
    ds_read_b128 v[96:99], v2 offset:448
    v_mul_f32 v26, s25, v26
    v_mul_f32 v27, s25, v27
    s_waitcnt lgkmcnt(5)
    v_mfma_f32_32x32x16_bf16 v[40:55], a[36:39], v[76:79], v[40:55]
    v_mul_f32 v28, s25, v28
    v_mul_f32 v29, s25, v29
    v_mfma_f32_32x32x16_bf16 v[56:71], a[164:167], v[76:79], v[56:71]
    ds_read_b128 v[100:103], v2 offset:480
    v_mul_f32 v30, s25, v30
    v_mul_f32 v31, s25, v31
    s_waitcnt lgkmcnt(5)
    v_mfma_f32_32x32x16_bf16 v[40:55], a[40:43], v[80:83], v[40:55]
    v_mul_f32 v32, s25, v32
    v_mul_f32 v33, s25, v33
    v_mfma_f32_32x32x16_bf16 v[56:71], a[168:171], v[80:83], v[56:71]
    ds_read_b128 v[72:75], v2 offset:512
    v_mul_f32 v34, s25, v34
    v_mul_f32 v35, s25, v35
    s_waitcnt lgkmcnt(5)
    v_mfma_f32_32x32x16_bf16 v[40:55], a[44:47], v[84:87], v[40:55]
    v_mul_f32 v36, s25, v36
    v_mul_f32 v37, s25, v37
    v_mfma_f32_32x32x16_bf16 v[56:71], a[172:175], v[84:87], v[56:71]
    ds_read_b128 v[76:79], v2 offset:544
    v_mul_f32 v38, s25, v38
    v_mul_f32 v39, s25, v39
    s_waitcnt lgkmcnt(5)
    v_mfma_f32_32x32x16_bf16 v[40:55], a[48:51], v[88:91], v[40:55]
    v_cvt_pk_bf16_f32 v112, v24, v25
    v_cvt_pk_bf16_f32 v113, v26, v27
    v_mfma_f32_32x32x16_bf16 v[56:71], a[176:179], v[88:91], v[56:71]
    ds_read_b128 v[80:83], v2 offset:576
    v_cvt_pk_bf16_f32 v114, v28, v29
    v_cvt_pk_bf16_f32 v115, v30, v31
    s_waitcnt lgkmcnt(5)
    v_mfma_f32_32x32x16_bf16 v[40:55], a[52:55], v[92:95], v[40:55]
    s_add_u32 s29, s21, s24
    buffer_store_dwordx4 v[112:115], v120, s[4:7], s29 offen sc1
    v_mfma_f32_32x32x16_bf16 v[56:71], a[180:183], v[92:95], v[56:71]
    ds_read_b128 v[84:87], v2 offset:608
    v_cvt_pk_bf16_f32 v116, v32, v33
    v_cvt_pk_bf16_f32 v117, v34, v35
    s_waitcnt lgkmcnt(5)
    v_mfma_f32_32x32x16_bf16 v[40:55], a[56:59], v[96:99], v[40:55]
    v_cvt_pk_bf16_f32 v118, v36, v37
    v_cvt_pk_bf16_f32 v119, v38, v39
    v_mfma_f32_32x32x16_bf16 v[56:71], a[184:187], v[96:99], v[56:71]
    ds_read_b128 v[88:91], v2 offset:640
    s_add_u32 s29, s29, s23
    buffer_store_dwordx4 v[116:119], v120, s[4:7], s29 offen sc1
    s_waitcnt lgkmcnt(5)
    v_mfma_f32_32x32x16_bf16 v[40:55], a[60:63], v[100:103], v[40:55]
    s_add_u32 s21, s21, s33
    s_mov_b32 s33, s22
    v_mfma_f32_32x32x16_bf16 v[56:71], a[188:191], v[100:103], v[56:71]
    ds_read_b128 v[92:95], v2 offset:672
    v_mov_b32 v120, v3
    s_add_u32 s28, s28, 131072
    s_waitcnt lgkmcnt(5)
    v_mfma_f32_32x32x16_bf16 v[40:55], a[64:67], v[72:75], v[40:55]
    s_add_u32 s32, s32, 33280
    s_cmp_ge_u32 s32, 133120
    v_mfma_f32_32x32x16_bf16 v[56:71], a[192:195], v[72:75], v[56:71]
    ds_read_b128 v[96:99], v2 offset:704
    s_cselect_b32 s29, 133120, 0
    s_sub_u32 s32, s32, s29
    s_waitcnt lgkmcnt(5)
    v_mfma_f32_32x32x16_bf16 v[40:55], a[68:71], v[76:79], v[40:55]
    s_add_u32 s30, s28, 0
    s_add_u32 m0, s32, 0
    v_mfma_f32_32x32x16_bf16 v[56:71], a[196:199], v[76:79], v[56:71]
    ds_read_b128 v[100:103], v2 offset:736
    buffer_load_dwordx4 v7, s[8:11], s30 offen offset:0 lds
    s_add_u32 m0, s32, 16
    s_waitcnt lgkmcnt(5)
    v_mfma_f32_32x32x16_bf16 v[40:55], a[72:75], v[80:83], v[40:55]
    buffer_load_dwordx4 v7, s[8:11], s30 offen offset:1024 lds
    s_add_u32 m0, s32, 32
    v_mfma_f32_32x32x16_bf16 v[56:71], a[200:203], v[80:83], v[56:71]
    ds_read_b128 v[72:75], v2 offset:768
    buffer_load_dwordx4 v7, s[8:11], s30 offen offset:2048 lds
    s_add_u32 m0, s32, 48
    s_waitcnt lgkmcnt(5)
    v_mfma_f32_32x32x16_bf16 v[40:55], a[76:79], v[84:87], v[40:55]
    buffer_load_dwordx4 v7, s[8:11], s30 offen offset:3072 lds
    s_add_u32 s30, s28, 4096
    v_mfma_f32_32x32x16_bf16 v[56:71], a[204:207], v[84:87], v[56:71]
    ds_read_b128 v[76:79], v2 offset:800
    s_add_u32 m0, s32, 4160
    s_nop 0
    buffer_load_dwordx4 v7, s[8:11], s30 offen offset:0 lds
    s_waitcnt lgkmcnt(5)
    v_mfma_f32_32x32x16_bf16 v[40:55], a[80:83], v[88:91], v[40:55]
    s_add_u32 m0, s32, 4176
    s_nop 0
    buffer_load_dwordx4 v7, s[8:11], s30 offen offset:1024 lds
    v_mfma_f32_32x32x16_bf16 v[56:71], a[208:211], v[88:91], v[56:71]
    ds_read_b128 v[80:83], v2 offset:832
    s_add_u32 m0, s32, 4192
    s_nop 0
    buffer_load_dwordx4 v7, s[8:11], s30 offen offset:2048 lds
    s_waitcnt lgkmcnt(5)
    v_mfma_f32_32x32x16_bf16 v[40:55], a[84:87], v[92:95], v[40:55]
    s_add_u32 m0, s32, 4208
    s_nop 0
    buffer_load_dwordx4 v7, s[8:11], s30 offen offset:3072 lds
    v_mfma_f32_32x32x16_bf16 v[56:71], a[212:215], v[92:95], v[56:71]
    ds_read_b128 v[84:87], v2 offset:864
    s_waitcnt lgkmcnt(5)
    v_mfma_f32_32x32x16_bf16 v[40:55], a[88:91], v[96:99], v[40:55]
    v_mfma_f32_32x32x16_bf16 v[56:71], a[216:219], v[96:99], v[56:71]
    ds_read_b128 v[88:91], v2 offset:896
    s_waitcnt lgkmcnt(5)
    v_mfma_f32_32x32x16_bf16 v[40:55], a[92:95], v[100:103], v[40:55]
    v_mfma_f32_32x32x16_bf16 v[56:71], a[220:223], v[100:103], v[56:71]
    ds_read_b128 v[92:95], v2 offset:928
    s_waitcnt lgkmcnt(5)
    v_mfma_f32_32x32x16_bf16 v[40:55], a[96:99], v[72:75], v[40:55]
    v_mfma_f32_32x32x16_bf16 v[56:71], a[224:227], v[72:75], v[56:71]
    ds_read_b128 v[96:99], v2 offset:960
    s_waitcnt lgkmcnt(5)
    v_mfma_f32_32x32x16_bf16 v[40:55], a[100:103], v[76:79], v[40:55]
    v_mfma_f32_32x32x16_bf16 v[56:71], a[228:231], v[76:79], v[56:71]
    ds_read_b128 v[100:103], v2 offset:992
    s_waitcnt lgkmcnt(5)
    v_mfma_f32_32x32x16_bf16 v[40:55], a[104:107], v[80:83], v[40:55]
    v_mfma_f32_32x32x16_bf16 v[56:71], a[232:235], v[80:83], v[56:71]
    s_add_u32 s27, s27, 33280
    s_cmp_ge_u32 s27, 133120
    s_cselect_b32 s27, 0, s27
    v_add_u32 v2, s27, v1
    s_waitcnt vmcnt(12)
    s_barrier
    ds_read_b128 v[72:75], v2 offset:0
    s_waitcnt lgkmcnt(5)
    v_mfma_f32_32x32x16_bf16 v[40:55], a[108:111], v[84:87], v[40:55]
    v_mfma_f32_32x32x16_bf16 v[56:71], a[236:239], v[84:87], v[56:71]
    ds_read_b128 v[76:79], v2 offset:32
    s_waitcnt lgkmcnt(5)
    v_mfma_f32_32x32x16_bf16 v[40:55], a[112:115], v[88:91], v[40:55]
    v_mfma_f32_32x32x16_bf16 v[56:71], a[240:243], v[88:91], v[56:71]
    ds_read_b128 v[80:83], v2 offset:64
    s_waitcnt lgkmcnt(5)
    v_mfma_f32_32x32x16_bf16 v[40:55], a[116:119], v[92:95], v[40:55]
    v_mfma_f32_32x32x16_bf16 v[56:71], a[244:247], v[92:95], v[56:71]
    ds_read_b128 v[84:87], v2 offset:96
    s_waitcnt lgkmcnt(5)
    v_mfma_f32_32x32x16_bf16 v[40:55], a[120:123], v[96:99], v[40:55]
    v_mfma_f32_32x32x16_bf16 v[56:71], a[248:251], v[96:99], v[56:71]
    ds_read_b128 v[88:91], v2 offset:128
    s_waitcnt lgkmcnt(5)
    v_mfma_f32_32x32x16_bf16 v[40:55], a[124:127], v[100:103], v[40:55]
    v_mfma_f32_32x32x16_bf16 v[56:71], a[252:255], v[100:103], v[56:71]
    ds_read_b128 v[92:95], v2 offset:160
    s_add_u32 s26, s26, 2
    s_cmp_lt_u32 s26, 16
    s_cbranch_scc1 PM2_10_loop
    v_mul_f32 v40, s25, v40
    v_mul_f32 v41, s25, v41
    v_mul_f32 v42, s25, v42
    v_mul_f32 v43, s25, v43
    v_mul_f32 v44, s25, v44
    v_mul_f32 v45, s25, v45
    v_mul_f32 v46, s25, v46
    v_mul_f32 v47, s25, v47
    v_mul_f32 v48, s25, v48
    v_mul_f32 v49, s25, v49
    v_mul_f32 v50, s25, v50
    v_mul_f32 v51, s25, v51
    v_mul_f32 v52, s25, v52
    v_mul_f32 v53, s25, v53
    v_mul_f32 v54, s25, v54
    v_mul_f32 v55, s25, v55
    v_cvt_pk_bf16_f32 v104, v40, v41
    v_cvt_pk_bf16_f32 v105, v42, v43
    v_cvt_pk_bf16_f32 v106, v44, v45
    v_cvt_pk_bf16_f32 v107, v46, v47
    s_mov_b32 s29, s21
    buffer_store_dwordx4 v[104:107], v120, s[4:7], s29 offen sc1
    v_cvt_pk_bf16_f32 v108, v48, v49
    v_cvt_pk_bf16_f32 v109, v50, v51
    v_cvt_pk_bf16_f32 v110, v52, v53
    v_cvt_pk_bf16_f32 v111, v54, v55
    s_add_u32 s29, s29, s23
    buffer_store_dwordx4 v[108:111], v120, s[4:7], s29 offen sc1
    v_mul_f32 v56, s25, v56
    v_mul_f32 v57, s25, v57
    v_mul_f32 v58, s25, v58
    v_mul_f32 v59, s25, v59
    v_mul_f32 v60, s25, v60
    v_mul_f32 v61, s25, v61
    v_mul_f32 v62, s25, v62
    v_mul_f32 v63, s25, v63
    v_mul_f32 v64, s25, v64
    v_mul_f32 v65, s25, v65
    v_mul_f32 v66, s25, v66
    v_mul_f32 v67, s25, v67
    v_mul_f32 v68, s25, v68
    v_mul_f32 v69, s25, v69
    v_mul_f32 v70, s25, v70
    v_mul_f32 v71, s25, v71
    v_cvt_pk_bf16_f32 v112, v56, v57
    v_cvt_pk_bf16_f32 v113, v58, v59
    v_cvt_pk_bf16_f32 v114, v60, v61
    v_cvt_pk_bf16_f32 v115, v62, v63
    s_add_u32 s29, s21, s24
    buffer_store_dwordx4 v[112:115], v120, s[4:7], s29 offen sc1
    v_cvt_pk_bf16_f32 v116, v64, v65
    v_cvt_pk_bf16_f32 v117, v66, v67
    v_cvt_pk_bf16_f32 v118, v68, v69
    v_cvt_pk_bf16_f32 v119, v70, v71
    s_add_u32 s29, s29, s23
    buffer_store_dwordx4 v[116:119], v120, s[4:7], s29 offen sc1
    s_add_u32 s21, s21, s33
    s_mov_b32 s33, s22
    v_mov_b32 v120, v3
    s_waitcnt vmcnt(0) lgkmcnt(0)
    s_branch PR_3_end
PR_3_t3:
    v_bfe_u32 v4, v0, 4, 1
    v_mul_u32_u24 v3, 65536, v4
    v_lshrrev_b32 v4, 5, v0
    v_mul_u32_u24 v4, 256, v4
    v_add_u32 v3, v3, v4
    v_and_b32 v4, 15, v0
    v_lshl_add_u32 v3, v4, 4, v3
    v_mov_b32 v120, 0x40000000
    s_mov_b32 s33, 0
    s_waitcnt vmcnt(8)
    s_barrier
    v_mov_b32 v2, v1
    ds_read_b128 v[72:75], v2 offset:0
    ds_read_b128 v[76:79], v2 offset:32
    ds_read_b128 v[80:83], v2 offset:64
    ds_read_b128 v[84:87], v2 offset:96
    ds_read_b128 v[88:91], v2 offset:128
    ds_read_b128 v[92:95], v2 offset:160
    s_mov_b32 s26, 0
    s_mov_b32 s27, 0
PM3_11_loop:
    s_waitcnt lgkmcnt(5)
    v_mfma_f32_32x32x16_bf16 v[8:23], v[72:75], a[0:3], 0
    s_nop 0
    s_nop 0
    v_mfma_f32_32x32x16_bf16 v[24:39], v[72:75], a[128:131], 0
    ds_read_b128 v[96:99], v2 offset:192
    s_nop 0
    s_nop 0
    s_waitcnt lgkmcnt(5)
    v_mfma_f32_32x32x16_bf16 v[8:23], v[76:79], a[4:7], v[8:23]
    v_cvt_pk_bf16_f32 v104, v40, v41
    v_cvt_pk_bf16_f32 v105, v42, v43
    v_mfma_f32_32x32x16_bf16 v[24:39], v[76:79], a[132:135], v[24:39]
    ds_read_b128 v[100:103], v2 offset:224
    v_cvt_pk_bf16_f32 v106, v44, v45
    v_cvt_pk_bf16_f32 v107, v46, v47
    s_waitcnt lgkmcnt(5)
    v_mfma_f32_32x32x16_bf16 v[8:23], v[80:83], a[8:11], v[8:23]
    s_mov_b32 s29, s21
    buffer_store_dwordx4 v[104:107], v120, s[4:7], s29 offen sc1
    v_mfma_f32_32x32x16_bf16 v[24:39], v[80:83], a[136:139], v[24:39]
    ds_read_b128 v[72:75], v2 offset:256
    v_cvt_pk_bf16_f32 v108, v48, v49
    v_cvt_pk_bf16_f32 v109, v50, v51
    s_waitcnt lgkmcnt(5)
    v_mfma_f32_32x32x16_bf16 v[8:23], v[84:87], a[12:15], v[8:23]
    v_cvt_pk_bf16_f32 v110, v52, v53
    v_cvt_pk_bf16_f32 v111, v54, v55
    v_mfma_f32_32x32x16_bf16 v[24:39], v[84:87], a[140:143], v[24:39]
    ds_read_b128 v[76:79], v2 offset:288
    s_add_u32 s29, s29, s23
    buffer_store_dwordx4 v[108:111], v120, s[4:7], s29 offen sc1
    s_waitcnt lgkmcnt(5)
    v_mfma_f32_32x32x16_bf16 v[8:23], v[88:91], a[16:19], v[8:23]
    v_cvt_pk_bf16_f32 v112, v56, v57
    v_cvt_pk_bf16_f32 v113, v58, v59
    v_mfma_f32_32x32x16_bf16 v[24:39], v[88:91], a[144:147], v[24:39]
    ds_read_b128 v[80:83], v2 offset:320
    v_cvt_pk_bf16_f32 v114, v60, v61
    v_cvt_pk_bf16_f32 v115, v62, v63
    s_waitcnt lgkmcnt(5)
    v_mfma_f32_32x32x16_bf16 v[8:23], v[92:95], a[20:23], v[8:23]
    s_add_u32 s29, s21, s24
    buffer_store_dwordx4 v[112:115], v120, s[4:7], s29 offen sc1
    v_mfma_f32_32x32x16_bf16 v[24:39], v[92:95], a[148:151], v[24:39]
    ds_read_b128 v[84:87], v2 offset:352
    v_cvt_pk_bf16_f32 v116, v64, v65
    v_cvt_pk_bf16_f32 v117, v66, v67
    s_waitcnt lgkmcnt(5)
    v_mfma_f32_32x32x16_bf16 v[8:23], v[96:99], a[24:27], v[8:23]
    v_cvt_pk_bf16_f32 v118, v68, v69
    v_cvt_pk_bf16_f32 v119, v70, v71
    v_mfma_f32_32x32x16_bf16 v[24:39], v[96:99], a[152:155], v[24:39]
    ds_read_b128 v[88:91], v2 offset:384
    s_add_u32 s29, s29, s23
    buffer_store_dwordx4 v[116:119], v120, s[4:7], s29 offen sc1
    s_waitcnt lgkmcnt(5)
    v_mfma_f32_32x32x16_bf16 v[8:23], v[100:103], a[28:31], v[8:23]
    s_add_u32 s21, s21, s33
    s_mov_b32 s33, s22
    v_mfma_f32_32x32x16_bf16 v[24:39], v[100:103], a[156:159], v[24:39]
    ds_read_b128 v[92:95], v2 offset:416
    v_mov_b32 v120, v3
    s_add_u32 s28, s28, 131072
    s_waitcnt lgkmcnt(5)
    v_mfma_f32_32x32x16_bf16 v[8:23], v[72:75], a[32:35], v[8:23]
    s_add_u32 s32, s32, 33280
    s_cmp_ge_u32 s32, 133120
    v_mfma_f32_32x32x16_bf16 v[24:39], v[72:75], a[160:163], v[24:39]
    ds_read_b128 v[96:99], v2 offset:448
    s_cselect_b32 s29, 133120, 0
    s_sub_u32 s32, s32, s29
    s_waitcnt lgkmcnt(5)
    v_mfma_f32_32x32x16_bf16 v[8:23], v[76:79], a[36:39], v[8:23]
    s_add_u32 s30, s28, 0
    s_add_u32 m0, s32, 0
    v_mfma_f32_32x32x16_bf16 v[24:39], v[76:79], a[164:167], v[24:39]
    ds_read_b128 v[100:103], v2 offset:480
    buffer_load_dwordx4 v7, s[8:11], s30 offen offset:0 lds
    s_add_u32 m0, s32, 16
    s_waitcnt lgkmcnt(5)
    v_mfma_f32_32x32x16_bf16 v[8:23], v[80:83], a[40:43], v[8:23]
    buffer_load_dwordx4 v7, s[8:11], s30 offen offset:1024 lds
    s_add_u32 m0, s32, 32
    v_mfma_f32_32x32x16_bf16 v[24:39], v[80:83], a[168:171], v[24:39]
    ds_read_b128 v[72:75], v2 offset:512
    buffer_load_dwordx4 v7, s[8:11], s30 offen offset:2048 lds
    s_add_u32 m0, s32, 48
    s_waitcnt lgkmcnt(5)
    v_mfma_f32_32x32x16_bf16 v[8:23], v[84:87], a[44:47], v[8:23]
    buffer_load_dwordx4 v7, s[8:11], s30 offen offset:3072 lds
    s_add_u32 s30, s28, 4096
    v_mfma_f32_32x32x16_bf16 v[24:39], v[84:87], a[172:175], v[24:39]
    ds_read_b128 v[76:79], v2 offset:544
    s_add_u32 m0, s32, 4160
    s_nop 0
    buffer_load_dwordx4 v7, s[8:11], s30 offen offset:0 lds
    s_waitcnt lgkmcnt(5)
    v_mfma_f32_32x32x16_bf16 v[8:23], v[88:91], a[48:51], v[8:23]
    s_add_u32 m0, s32, 4176
    s_nop 0
    buffer_load_dwordx4 v7, s[8:11], s30 offen offset:1024 lds
    v_mfma_f32_32x32x16_bf16 v[24:39], v[88:91], a[176:179], v[24:39]
    ds_read_b128 v[80:83], v2 offset:576
    s_add_u32 m0, s32, 4192
    s_nop 0
    buffer_load_dwordx4 v7, s[8:11], s30 offen offset:2048 lds
    s_waitcnt lgkmcnt(5)
    v_mfma_f32_32x32x16_bf16 v[8:23], v[92:95], a[52:55], v[8:23]
    s_add_u32 m0, s32, 4208
    s_nop 0
    buffer_load_dwordx4 v7, s[8:11], s30 offen offset:3072 lds
    v_mfma_f32_32x32x16_bf16 v[24:39], v[92:95], a[180:183], v[24:39]
    ds_read_b128 v[84:87], v2 offset:608
    s_waitcnt lgkmcnt(5)
    v_mfma_f32_32x32x16_bf16 v[8:23], v[96:99], a[56:59], v[8:23]
    v_mfma_f32_32x32x16_bf16 v[24:39], v[96:99], a[184:187], v[24:39]
    ds_read_b128 v[88:91], v2 offset:640
    s_waitcnt lgkmcnt(5)
    v_mfma_f32_32x32x16_bf16 v[8:23], v[100:103], a[60:63], v[8:23]
    v_mfma_f32_32x32x16_bf16 v[24:39], v[100:103], a[188:191], v[24:39]
    ds_read_b128 v[92:95], v2 offset:672
    s_waitcnt lgkmcnt(5)
    v_mfma_f32_32x32x16_bf16 v[8:23], v[72:75], a[64:67], v[8:23]
    v_mfma_f32_32x32x16_bf16 v[24:39], v[72:75], a[192:195], v[24:39]
    ds_read_b128 v[96:99], v2 offset:704
    s_waitcnt lgkmcnt(5)
    v_mfma_f32_32x32x16_bf16 v[8:23], v[76:79], a[68:71], v[8:23]
    v_mfma_f32_32x32x16_bf16 v[24:39], v[76:79], a[196:199], v[24:39]
    ds_read_b128 v[100:103], v2 offset:736
    s_waitcnt lgkmcnt(5)
    v_mfma_f32_32x32x16_bf16 v[8:23], v[80:83], a[72:75], v[8:23]
    v_mfma_f32_32x32x16_bf16 v[24:39], v[80:83], a[200:203], v[24:39]
    ds_read_b128 v[72:75], v2 offset:768
    s_waitcnt lgkmcnt(5)
    v_mfma_f32_32x32x16_bf16 v[8:23], v[84:87], a[76:79], v[8:23]
    v_mfma_f32_32x32x16_bf16 v[24:39], v[84:87], a[204:207], v[24:39]
    ds_read_b128 v[76:79], v2 offset:800
    s_waitcnt lgkmcnt(5)
    v_mfma_f32_32x32x16_bf16 v[8:23], v[88:91], a[80:83], v[8:23]
    v_mfma_f32_32x32x16_bf16 v[24:39], v[88:91], a[208:211], v[24:39]
    ds_read_b128 v[80:83], v2 offset:832
    s_waitcnt lgkmcnt(5)
    v_mfma_f32_32x32x16_bf16 v[8:23], v[92:95], a[84:87], v[8:23]
    v_mfma_f32_32x32x16_bf16 v[24:39], v[92:95], a[212:215], v[24:39]
    ds_read_b128 v[84:87], v2 offset:864
    s_waitcnt lgkmcnt(5)
    v_mfma_f32_32x32x16_bf16 v[8:23], v[96:99], a[88:91], v[8:23]
    v_mfma_f32_32x32x16_bf16 v[24:39], v[96:99], a[216:219], v[24:39]
    ds_read_b128 v[88:91], v2 offset:896
    s_waitcnt lgkmcnt(5)
    v_mfma_f32_32x32x16_bf16 v[8:23], v[100:103], a[92:95], v[8:23]
    v_mfma_f32_32x32x16_bf16 v[24:39], v[100:103], a[220:223], v[24:39]
    ds_read_b128 v[92:95], v2 offset:928
    s_waitcnt lgkmcnt(5)
    v_mfma_f32_32x32x16_bf16 v[8:23], v[72:75], a[96:99], v[8:23]
    v_mfma_f32_32x32x16_bf16 v[24:39], v[72:75], a[224:227], v[24:39]
    ds_read_b128 v[96:99], v2 offset:960
    s_waitcnt lgkmcnt(5)
    v_mfma_f32_32x32x16_bf16 v[8:23], v[76:79], a[100:103], v[8:23]
    v_mfma_f32_32x32x16_bf16 v[24:39], v[76:79], a[228:231], v[24:39]
    ds_read_b128 v[100:103], v2 offset:992
    s_waitcnt lgkmcnt(5)
    v_mfma_f32_32x32x16_bf16 v[8:23], v[80:83], a[104:107], v[8:23]
    v_mfma_f32_32x32x16_bf16 v[24:39], v[80:83], a[232:235], v[24:39]
    s_add_u32 s27, s27, 33280
    s_cmp_ge_u32 s27, 133120
    s_cselect_b32 s27, 0, s27
    v_add_u32 v2, s27, v1
    s_waitcnt vmcnt(12)
    s_barrier
    ds_read_b128 v[72:75], v2 offset:0
    s_waitcnt lgkmcnt(5)
    v_mfma_f32_32x32x16_bf16 v[8:23], v[84:87], a[108:111], v[8:23]
    v_mfma_f32_32x32x16_bf16 v[24:39], v[84:87], a[236:239], v[24:39]
    ds_read_b128 v[76:79], v2 offset:32
    s_waitcnt lgkmcnt(5)
    v_mfma_f32_32x32x16_bf16 v[8:23], v[88:91], a[112:115], v[8:23]
    v_mfma_f32_32x32x16_bf16 v[24:39], v[88:91], a[240:243], v[24:39]
    ds_read_b128 v[80:83], v2 offset:64
    s_waitcnt lgkmcnt(5)
    v_mfma_f32_32x32x16_bf16 v[8:23], v[92:95], a[116:119], v[8:23]
    v_mfma_f32_32x32x16_bf16 v[24:39], v[92:95], a[244:247], v[24:39]
    ds_read_b128 v[84:87], v2 offset:96
    s_waitcnt lgkmcnt(5)
    v_mfma_f32_32x32x16_bf16 v[8:23], v[96:99], a[120:123], v[8:23]
    v_mfma_f32_32x32x16_bf16 v[24:39], v[96:99], a[248:251], v[24:39]
    ds_read_b128 v[88:91], v2 offset:128
    s_waitcnt lgkmcnt(5)
    v_mfma_f32_32x32x16_bf16 v[8:23], v[100:103], a[124:127], v[8:23]
    v_mfma_f32_32x32x16_bf16 v[24:39], v[100:103], a[252:255], v[24:39]
    ds_read_b128 v[92:95], v2 offset:160
    s_waitcnt lgkmcnt(5)
    v_mfma_f32_32x32x16_bf16 v[40:55], v[72:75], a[0:3], 0
    s_nop 0
    s_nop 0
    v_mfma_f32_32x32x16_bf16 v[56:71], v[72:75], a[128:131], 0
    ds_read_b128 v[96:99], v2 offset:192
    s_nop 0
    s_nop 0
    s_waitcnt lgkmcnt(5)
    v_mfma_f32_32x32x16_bf16 v[40:55], v[76:79], a[4:7], v[40:55]
    v_cvt_pk_bf16_f32 v104, v8, v9
    v_cvt_pk_bf16_f32 v105, v10, v11
    v_mfma_f32_32x32x16_bf16 v[56:71], v[76:79], a[132:135], v[56:71]
    ds_read_b128 v[100:103], v2 offset:224
    v_cvt_pk_bf16_f32 v106, v12, v13
    v_cvt_pk_bf16_f32 v107, v14, v15
    s_waitcnt lgkmcnt(5)
    v_mfma_f32_32x32x16_bf16 v[40:55], v[80:83], a[8:11], v[40:55]
    s_mov_b32 s29, s21
    buffer_store_dwordx4 v[104:107], v120, s[4:7], s29 offen sc1
    v_mfma_f32_32x32x16_bf16 v[56:71], v[80:83], a[136:139], v[56:71]
    ds_read_b128 v[72:75], v2 offset:256
    v_cvt_pk_bf16_f32 v108, v16, v17
    v_cvt_pk_bf16_f32 v109, v18, v19
    s_waitcnt lgkmcnt(5)
    v_mfma_f32_32x32x16_bf16 v[40:55], v[84:87], a[12:15], v[40:55]
    v_cvt_pk_bf16_f32 v110, v20, v21
    v_cvt_pk_bf16_f32 v111, v22, v23
    v_mfma_f32_32x32x16_bf16 v[56:71], v[84:87], a[140:143], v[56:71]
    ds_read_b128 v[76:79], v2 offset:288
    s_add_u32 s29, s29, s23
    buffer_store_dwordx4 v[108:111], v120, s[4:7], s29 offen sc1
    s_waitcnt lgkmcnt(5)
    v_mfma_f32_32x32x16_bf16 v[40:55], v[88:91], a[16:19], v[40:55]
    v_cvt_pk_bf16_f32 v112, v24, v25
    v_cvt_pk_bf16_f32 v113, v26, v27
    v_mfma_f32_32x32x16_bf16 v[56:71], v[88:91], a[144:147], v[56:71]
    ds_read_b128 v[80:83], v2 offset:320
    v_cvt_pk_bf16_f32 v114, v28, v29
    v_cvt_pk_bf16_f32 v115, v30, v31
    s_waitcnt lgkmcnt(5)
    v_mfma_f32_32x32x16_bf16 v[40:55], v[92:95], a[20:23], v[40:55]
    s_add_u32 s29, s21, s24
    buffer_store_dwordx4 v[112:115], v120, s[4:7], s29 offen sc1
    v_mfma_f32_32x32x16_bf16 v[56:71], v[92:95], a[148:151], v[56:71]
    ds_read_b128 v[84:87], v2 offset:352
    v_cvt_pk_bf16_f32 v116, v32, v33
    v_cvt_pk_bf16_f32 v117, v34, v35
    s_waitcnt lgkmcnt(5)
    v_mfma_f32_32x32x16_bf16 v[40:55], v[96:99], a[24:27], v[40:55]
    v_cvt_pk_bf16_f32 v118, v36, v37
    v_cvt_pk_bf16_f32 v119, v38, v39
    v_mfma_f32_32x32x16_bf16 v[56:71], v[96:99], a[152:155], v[56:71]
    ds_read_b128 v[88:91], v2 offset:384
    s_add_u32 s29, s29, s23
    buffer_store_dwordx4 v[116:119], v120, s[4:7], s29 offen sc1
    s_waitcnt lgkmcnt(5)
    v_mfma_f32_32x32x16_bf16 v[40:55], v[100:103], a[28:31], v[40:55]
    s_add_u32 s21, s21, s33
    s_mov_b32 s33, s22
    v_mfma_f32_32x32x16_bf16 v[56:71], v[100:103], a[156:159], v[56:71]
    ds_read_b128 v[92:95], v2 offset:416
    v_mov_b32 v120, v3
    s_add_u32 s28, s28, 131072
    s_waitcnt lgkmcnt(5)
    v_mfma_f32_32x32x16_bf16 v[40:55], v[72:75], a[32:35], v[40:55]
    s_add_u32 s32, s32, 33280
    s_cmp_ge_u32 s32, 133120
    v_mfma_f32_32x32x16_bf16 v[56:71], v[72:75], a[160:163], v[56:71]
    ds_read_b128 v[96:99], v2 offset:448
    s_cselect_b32 s29, 133120, 0
    s_sub_u32 s32, s32, s29
    s_waitcnt lgkmcnt(5)
    v_mfma_f32_32x32x16_bf16 v[40:55], v[76:79], a[36:39], v[40:55]
    s_add_u32 s30, s28, 0
    s_add_u32 m0, s32, 0
    v_mfma_f32_32x32x16_bf16 v[56:71], v[76:79], a[164:167], v[56:71]
    ds_read_b128 v[100:103], v2 offset:480
    buffer_load_dwordx4 v7, s[8:11], s30 offen offset:0 lds
    s_add_u32 m0, s32, 16
    s_waitcnt lgkmcnt(5)
    v_mfma_f32_32x32x16_bf16 v[40:55], v[80:83], a[40:43], v[40:55]
    buffer_load_dwordx4 v7, s[8:11], s30 offen offset:1024 lds
    s_add_u32 m0, s32, 32
    v_mfma_f32_32x32x16_bf16 v[56:71], v[80:83], a[168:171], v[56:71]
    ds_read_b128 v[72:75], v2 offset:512
    buffer_load_dwordx4 v7, s[8:11], s30 offen offset:2048 lds
    s_add_u32 m0, s32, 48
    s_waitcnt lgkmcnt(5)
    v_mfma_f32_32x32x16_bf16 v[40:55], v[84:87], a[44:47], v[40:55]
    buffer_load_dwordx4 v7, s[8:11], s30 offen offset:3072 lds
    s_add_u32 s30, s28, 4096
    v_mfma_f32_32x32x16_bf16 v[56:71], v[84:87], a[172:175], v[56:71]
    ds_read_b128 v[76:79], v2 offset:544
    s_add_u32 m0, s32, 4160
    s_nop 0
    buffer_load_dwordx4 v7, s[8:11], s30 offen offset:0 lds
    s_waitcnt lgkmcnt(5)
    v_mfma_f32_32x32x16_bf16 v[40:55], v[88:91], a[48:51], v[40:55]
    s_add_u32 m0, s32, 4176
    s_nop 0
    buffer_load_dwordx4 v7, s[8:11], s30 offen offset:1024 lds
    v_mfma_f32_32x32x16_bf16 v[56:71], v[88:91], a[176:179], v[56:71]
    ds_read_b128 v[80:83], v2 offset:576
    s_add_u32 m0, s32, 4192
    s_nop 0
    buffer_load_dwordx4 v7, s[8:11], s30 offen offset:2048 lds
    s_waitcnt lgkmcnt(5)
    v_mfma_f32_32x32x16_bf16 v[40:55], v[92:95], a[52:55], v[40:55]
    s_add_u32 m0, s32, 4208
    s_nop 0
    buffer_load_dwordx4 v7, s[8:11], s30 offen offset:3072 lds
    v_mfma_f32_32x32x16_bf16 v[56:71], v[92:95], a[180:183], v[56:71]
    ds_read_b128 v[84:87], v2 offset:608
    s_waitcnt lgkmcnt(5)
    v_mfma_f32_32x32x16_bf16 v[40:55], v[96:99], a[56:59], v[40:55]
    v_mfma_f32_32x32x16_bf16 v[56:71], v[96:99], a[184:187], v[56:71]
    ds_read_b128 v[88:91], v2 offset:640
    s_waitcnt lgkmcnt(5)
    v_mfma_f32_32x32x16_bf16 v[40:55], v[100:103], a[60:63], v[40:55]
    v_mfma_f32_32x32x16_bf16 v[56:71], v[100:103], a[188:191], v[56:71]
    ds_read_b128 v[92:95], v2 offset:672
    s_waitcnt lgkmcnt(5)
    v_mfma_f32_32x32x16_bf16 v[40:55], v[72:75], a[64:67], v[40:55]
    v_mfma_f32_32x32x16_bf16 v[56:71], v[72:75], a[192:195], v[56:71]
    ds_read_b128 v[96:99], v2 offset:704
    s_waitcnt lgkmcnt(5)
    v_mfma_f32_32x32x16_bf16 v[40:55], v[76:79], a[68:71], v[40:55]
    v_mfma_f32_32x32x16_bf16 v[56:71], v[76:79], a[196:199], v[56:71]
    ds_read_b128 v[100:103], v2 offset:736
    s_waitcnt lgkmcnt(5)
    v_mfma_f32_32x32x16_bf16 v[40:55], v[80:83], a[72:75], v[40:55]
    v_mfma_f32_32x32x16_bf16 v[56:71], v[80:83], a[200:203], v[56:71]
    ds_read_b128 v[72:75], v2 offset:768
    s_waitcnt lgkmcnt(5)
    v_mfma_f32_32x32x16_bf16 v[40:55], v[84:87], a[76:79], v[40:55]
    v_mfma_f32_32x32x16_bf16 v[56:71], v[84:87], a[204:207], v[56:71]
    ds_read_b128 v[76:79], v2 offset:800
    s_waitcnt lgkmcnt(5)
    v_mfma_f32_32x32x16_bf16 v[40:55], v[88:91], a[80:83], v[40:55]
    v_mfma_f32_32x32x16_bf16 v[56:71], v[88:91], a[208:211], v[56:71]
    ds_read_b128 v[80:83], v2 offset:832
    s_waitcnt lgkmcnt(5)
    v_mfma_f32_32x32x16_bf16 v[40:55], v[92:95], a[84:87], v[40:55]
    v_mfma_f32_32x32x16_bf16 v[56:71], v[92:95], a[212:215], v[56:71]
    ds_read_b128 v[84:87], v2 offset:864
    s_waitcnt lgkmcnt(5)
    v_mfma_f32_32x32x16_bf16 v[40:55], v[96:99], a[88:91], v[40:55]
    v_mfma_f32_32x32x16_bf16 v[56:71], v[96:99], a[216:219], v[56:71]
    ds_read_b128 v[88:91], v2 offset:896
    s_waitcnt lgkmcnt(5)
    v_mfma_f32_32x32x16_bf16 v[40:55], v[100:103], a[92:95], v[40:55]
    v_mfma_f32_32x32x16_bf16 v[56:71], v[100:103], a[220:223], v[56:71]
    ds_read_b128 v[92:95], v2 offset:928
    s_waitcnt lgkmcnt(5)
    v_mfma_f32_32x32x16_bf16 v[40:55], v[72:75], a[96:99], v[40:55]
    v_mfma_f32_32x32x16_bf16 v[56:71], v[72:75], a[224:227], v[56:71]
    ds_read_b128 v[96:99], v2 offset:960
    s_waitcnt lgkmcnt(5)
    v_mfma_f32_32x32x16_bf16 v[40:55], v[76:79], a[100:103], v[40:55]
    v_mfma_f32_32x32x16_bf16 v[56:71], v[76:79], a[228:231], v[56:71]
    ds_read_b128 v[100:103], v2 offset:992
    s_waitcnt lgkmcnt(5)
    v_mfma_f32_32x32x16_bf16 v[40:55], v[80:83], a[104:107], v[40:55]
    v_mfma_f32_32x32x16_bf16 v[56:71], v[80:83], a[232:235], v[56:71]
    s_add_u32 s27, s27, 33280
    s_cmp_ge_u32 s27, 133120
    s_cselect_b32 s27, 0, s27
    v_add_u32 v2, s27, v1
    s_waitcnt vmcnt(12)
    s_barrier
    ds_read_b128 v[72:75], v2 offset:0
    s_waitcnt lgkmcnt(5)
    v_mfma_f32_32x32x16_bf16 v[40:55], v[84:87], a[108:111], v[40:55]
    v_mfma_f32_32x32x16_bf16 v[56:71], v[84:87], a[236:239], v[56:71]
    ds_read_b128 v[76:79], v2 offset:32
    s_waitcnt lgkmcnt(5)
    v_mfma_f32_32x32x16_bf16 v[40:55], v[88:91], a[112:115], v[40:55]
    v_mfma_f32_32x32x16_bf16 v[56:71], v[88:91], a[240:243], v[56:71]
    ds_read_b128 v[80:83], v2 offset:64
    s_waitcnt lgkmcnt(5)
    v_mfma_f32_32x32x16_bf16 v[40:55], v[92:95], a[116:119], v[40:55]
    v_mfma_f32_32x32x16_bf16 v[56:71], v[92:95], a[244:247], v[56:71]
    ds_read_b128 v[84:87], v2 offset:96
    s_waitcnt lgkmcnt(5)
    v_mfma_f32_32x32x16_bf16 v[40:55], v[96:99], a[120:123], v[40:55]
    v_mfma_f32_32x32x16_bf16 v[56:71], v[96:99], a[248:251], v[56:71]
    ds_read_b128 v[88:91], v2 offset:128
    s_waitcnt lgkmcnt(5)
    v_mfma_f32_32x32x16_bf16 v[40:55], v[100:103], a[124:127], v[40:55]
    v_mfma_f32_32x32x16_bf16 v[56:71], v[100:103], a[252:255], v[56:71]
    ds_read_b128 v[92:95], v2 offset:160
    s_add_u32 s26, s26, 2
    s_cmp_lt_u32 s26, 16
    s_cbranch_scc1 PM3_11_loop
    v_cvt_pk_bf16_f32 v104, v40, v41
    v_cvt_pk_bf16_f32 v105, v42, v43
    v_cvt_pk_bf16_f32 v106, v44, v45
    v_cvt_pk_bf16_f32 v107, v46, v47
    s_mov_b32 s29, s21
    buffer_store_dwordx4 v[104:107], v120, s[4:7], s29 offen sc1
    v_cvt_pk_bf16_f32 v108, v48, v49
    v_cvt_pk_bf16_f32 v109, v50, v51
    v_cvt_pk_bf16_f32 v110, v52, v53
    v_cvt_pk_bf16_f32 v111, v54, v55
    s_add_u32 s29, s29, s23
    buffer_store_dwordx4 v[108:111], v120, s[4:7], s29 offen sc1
    v_cvt_pk_bf16_f32 v112, v56, v57
    v_cvt_pk_bf16_f32 v113, v58, v59
    v_cvt_pk_bf16_f32 v114, v60, v61
    v_cvt_pk_bf16_f32 v115, v62, v63
    s_add_u32 s29, s21, s24
    buffer_store_dwordx4 v[112:115], v120, s[4:7], s29 offen sc1
    v_cvt_pk_bf16_f32 v116, v64, v65
    v_cvt_pk_bf16_f32 v117, v66, v67
    v_cvt_pk_bf16_f32 v118, v68, v69
    v_cvt_pk_bf16_f32 v119, v70, v71
    s_add_u32 s29, s29, s23
    buffer_store_dwordx4 v[116:119], v120, s[4:7], s29 offen sc1
    s_add_u32 s21, s21, s33
    s_mov_b32 s33, s22
    v_mov_b32 v120, v3
    s_waitcnt vmcnt(0) lgkmcnt(0)
PR_3_end:
    s_barrier
    s_cmp_eq_u32 s58, 0
    s_cbranch_scc1 PB_12
    s_mov_b32 s56, 16
    v_mov_b32 v123, s56
    s_mov_b64 exec, 1
    buffer_store_dword v123, off, s[4:7], s57 sc1
    s_mov_b64 exec, -1
PB_12:
L_p1done:
    s_lshl_b32 s56, s60, 2
    s_add_u32 s56, s56, 95424512
    s_waitcnt vmcnt(0) lgkmcnt(0)
    s_barrier
    s_cmp_eq_u32 s62, 0
    s_cbranch_scc0 SG_13
    v_mov_b32 v254, 1
    s_mov_b64 exec, 1
    buffer_store_dword v254, off, s[4:7], s56 sc1
    s_mov_b64 exec, -1
SG_13:
    s_cmp_ge_u32 s60, 192
    s_cbranch_scc1 L_p2done
    s_mov_b32 s56, 95425280
    s_cmp_eq_u32 s62, 0
    s_cbranch_scc0 WF_14_ok
    v_min_u32 v254, 31, v0
    v_lshlrev_b32 v254, 2, v254
WF_14:
    buffer_load_dword v250, v254, s[4:7], s56 offen sc1
    s_sub_u32 s70, s70, 1
    s_cbranch_scc1 WF_14_to
    s_waitcnt vmcnt(0)
    v_cmp_eq_u32 vcc, 0, v250
    s_cbranch_vccz WF_14_ok
    s_sleep 16
    s_branch WF_14
WF_14_to:
    s_mov_b32 s70, 0
    s_waitcnt vmcnt(0)
WF_14_ok:
    s_barrier
    s_mul_i32 s61, s60, 43691
    s_lshr_b32 s61, s61, 18
    s_mul_i32 s59, s61, 6
    s_sub_u32 s59, s60, s59
    v_lshlrev_b32 v1, 4, v0
    s_lshl_b32 s16, s61, 16
    s_lshl_b32 s17, s62, 14
    s_add_u32 s16, s16, s17
    s_add_u32 m0, s17, 0
    s_add_u32 s20, s16, 67108864
    buffer_load_dwordx4 v1, s[4:7], s20 offen offset:0 sc1 lds
    buffer_load_dwordx4 v1, s[4:7], s20 offen offset:1024 sc1 lds
    buffer_load_dwordx4 v1, s[4:7], s20 offen offset:2048 sc1 lds
    buffer_load_dwordx4 v1, s[4:7], s20 offen offset:3072 sc1 lds
    s_add_u32 m0, s17, 4096
    s_add_u32 s20, s16, 67112960
    buffer_load_dwordx4 v1, s[4:7], s20 offen offset:0 sc1 lds
    buffer_load_dwordx4 v1, s[4:7], s20 offen offset:1024 sc1 lds
    buffer_load_dwordx4 v1, s[4:7], s20 offen offset:2048 sc1 lds
    buffer_load_dwordx4 v1, s[4:7], s20 offen offset:3072 sc1 lds
    s_add_u32 m0, s17, 8192
    s_add_u32 s20, s16, 67117056
    buffer_load_dwordx4 v1, s[4:7], s20 offen offset:0 sc1 lds
    buffer_load_dwordx4 v1, s[4:7], s20 offen offset:1024 sc1 lds
    buffer_load_dwordx4 v1, s[4:7], s20 offen offset:2048 sc1 lds
    buffer_load_dwordx4 v1, s[4:7], s20 offen offset:3072 sc1 lds
    s_add_u32 m0, s17, 12288
    s_add_u32 s20, s16, 67121152
    buffer_load_dwordx4 v1, s[4:7], s20 offen offset:0 sc1 lds
    buffer_load_dwordx4 v1, s[4:7], s20 offen offset:1024 sc1 lds
    buffer_load_dwordx4 v1, s[4:7], s20 offen offset:2048 sc1 lds
    buffer_load_dwordx4 v1, s[4:7], s20 offen offset:3072 sc1 lds
    s_mul_i32 s21, s59, 12
    s_mul_i32 s20, s62, 3
    s_add_u32 s21, s21, s20
    s_cmp_gt_u32 s21, 63
    s_cselect_b32 s24, 1, 0
    v_and_b32 v4, 31, v0
    v_lshlrev_b32 v4, 3, v4
    s_add_u32 s23, s21, 2
    s_min_u32 s23, s23, 63
    s_add_u32 s22, s21, 1
    s_min_u32 s22, s22, 63
    s_add_u32 s21, s21, 0
    s_min_u32 s21, s21, 63
    s_lshl_b32 s20, s61, 6
    s_add_u32 s20, s20, s21
    s_lshl_b32 s20, s20, 10
    s_add_u32 s20, s20, 65011712
    buffer_load_dwordx4 v[8:11], v1, s[4:7], s20 offen sc1
    s_lshl_b32 s20, s21, 8
    s_add_u32 s20, s20, 71303168
    buffer_load_dword v216, v4, s[4:7], s20 offen offset:4 sc1
    s_lshl_b32 s20, s61, 6
    s_add_u32 s20, s20, s22
    s_lshl_b32 s20, s20, 10
    s_add_u32 s20, s20, 65011712
    buffer_load_dwordx4 v[12:15], v1, s[4:7], s20 offen sc1
    s_lshl_b32 s20, s22, 8
    s_add_u32 s20, s20, 71303168
    buffer_load_dword v217, v4, s[4:7], s20 offen offset:4 sc1
    s_lshl_b32 s20, s61, 6
    s_add_u32 s20, s20, s23
    s_lshl_b32 s20, s20, 10
    s_add_u32 s20, s20, 65011712
    buffer_load_dwordx4 v[16:19], v1, s[4:7], s20 offen sc1
    s_lshl_b32 s20, s23, 8
    s_add_u32 s20, s20, 71303168
    buffer_load_dword v218, v4, s[4:7], s20 offen offset:4 sc1
    s_add_u32 m0, s17, 65536
    s_add_u32 s20, s16, 69206016
    buffer_load_dwordx4 v1, s[4:7], s20 offen offset:0 sc1 lds
    buffer_load_dwordx4 v1, s[4:7], s20 offen offset:1024 sc1 lds
    buffer_load_dwordx4 v1, s[4:7], s20 offen offset:2048 sc1 lds
    buffer_load_dwordx4 v1, s[4:7], s20 offen offset:3072 sc1 lds
    s_add_u32 m0, s17, 69632
    s_add_u32 s20, s16, 69210112
    buffer_load_dwordx4 v1, s[4:7], s20 offen offset:0 sc1 lds
    buffer_load_dwordx4 v1, s[4:7], s20 offen offset:1024 sc1 lds
    buffer_load_dwordx4 v1, s[4:7], s20 offen offset:2048 sc1 lds
    buffer_load_dwordx4 v1, s[4:7], s20 offen offset:3072 sc1 lds
    s_add_u32 m0, s17, 73728
    s_add_u32 s20, s16, 69214208
    buffer_load_dwordx4 v1, s[4:7], s20 offen offset:0 sc1 lds
    buffer_load_dwordx4 v1, s[4:7], s20 offen offset:1024 sc1 lds
    buffer_load_dwordx4 v1, s[4:7], s20 offen offset:2048 sc1 lds
    buffer_load_dwordx4 v1, s[4:7], s20 offen offset:3072 sc1 lds
    s_add_u32 m0, s17, 77824
    s_add_u32 s20, s16, 69218304
    buffer_load_dwordx4 v1, s[4:7], s20 offen offset:0 sc1 lds
    buffer_load_dwordx4 v1, s[4:7], s20 offen offset:1024 sc1 lds
    buffer_load_dwordx4 v1, s[4:7], s20 offen offset:2048 sc1 lds
    buffer_load_dwordx4 v1, s[4:7], s20 offen offset:3072 sc1 lds
    s_mov_b32 s18, 0xffff
    s_mov_b32 s19, 0xffff
    v_lshrrev_b32 v3, 5, v0
    v_lshlrev_b32 v3, 8, v3
    v_and_b32 v4, 15, v0
    v_lshl_add_u32 v3, v4, 4, v3
    v_add_u32 v3, 65536, v3
    v_and_b32 v4, 27, v0
    v_cmp_eq_u32 vcc, 16, v4
    v_mov_b32 v4, 0x3f803f80
    s_nop 0
    v_cndmask_b32 v28, 0, v4, vcc
    v_mov_b32 v29, v28
    v_mov_b32 v30, v28
    v_mov_b32 v31, v28
    v_mov_b32 v32, v28
    v_mov_b32 v33, v28
    v_mov_b32 v34, v28
    v_mov_b32 v35, v28
    v_mov_b32 v36, v28
    v_mov_b32 v37, v28
    v_mov_b32 v38, v28
    v_mov_b32 v39, v28
    v_mov_b32 v40, v28
    v_mov_b32 v41, v28
    v_mov_b32 v42, v28
    v_mov_b32 v43, v28
    v_mov_b32 v208, 0xff800000
    v_mov_b32 v209, 0xff800000
    v_mov_b64 v[112:113], 0
    v_mov_b64 v[114:115], 0
    v_mov_b64 v[116:117], 0
    v_mov_b64 v[118:119], 0
    v_mov_b64 v[120:121], 0
    v_mov_b64 v[122:123], 0
    v_mov_b64 v[124:125], 0
    v_mov_b64 v[126:127], 0
    v_mov_b32 v210, 0xff800000
    v_mov_b32 v211, 0xff800000
    v_mov_b64 v[128:129], 0
    v_mov_b64 v[130:131], 0
    v_mov_b64 v[132:133], 0
    v_mov_b64 v[134:135], 0
    v_mov_b64 v[136:137], 0
    v_mov_b64 v[138:139], 0
    v_mov_b64 v[140:141], 0
    v_mov_b64 v[142:143], 0
    v_mov_b32 v212, 0xff800000
    v_mov_b32 v213, 0xff800000
    v_mov_b64 v[144:145], 0
    v_mov_b64 v[146:147], 0
    v_mov_b64 v[148:149], 0
    v_mov_b64 v[150:151], 0
    v_mov_b64 v[152:153], 0
    v_mov_b64 v[154:155], 0
    v_mov_b64 v[156:157], 0
    v_mov_b64 v[158:159], 0
    s_waitcnt vmcnt(16)
    s_barrier
    s_cmp_eq_u32 s24, 1
    s_cbranch_scc1 BA_15_sk1
    s_mov_b32 s25, 64
BA_15_again:
    v_mov_b32 v2, v1
    ds_read_b128 v[20:23], v2
    ds_read_b128 v[24:27], v2 offset:1024
    s_mov_b32 s20, 0
    s_waitcnt lgkmcnt(1)
    v_mfma_f32_32x32x16_bf16 v[160:175], v[20:23], v[8:11], 0
    v_mfma_f32_32x32x16_bf16 v[176:191], v[20:23], v[12:15], 0
BA_15_p1:
    v_mfma_f32_32x32x16_bf16 v[192:207], v[20:23], v[16:19], 0
    ds_read_b128 v[20:23], v2 offset:2048
    v_max3_f32 v208, v208, v160, v161
    v_max3_f32 v209, v209, v162, v163
    v_max3_f32 v208, v208, v164, v165
    v_max3_f32 v209, v209, v166, v167
    v_max3_f32 v208, v208, v168, v169
    v_max3_f32 v209, v209, v170, v171
    v_max3_f32 v208, v208, v172, v173
    v_max3_f32 v209, v209, v174, v175
    s_waitcnt lgkmcnt(1)
    v_mfma_f32_32x32x16_bf16 v[160:175], v[24:27], v[8:11], 0
    v_max3_f32 v210, v210, v176, v177
    v_max3_f32 v211, v211, v178, v179
    v_max3_f32 v210, v210, v180, v181
    v_max3_f32 v211, v211, v182, v183
    v_max3_f32 v210, v210, v184, v185
    v_max3_f32 v211, v211, v186, v187
    v_max3_f32 v210, v210, v188, v189
    v_max3_f32 v211, v211, v190, v191
    v_mfma_f32_32x32x16_bf16 v[176:191], v[24:27], v[12:15], 0
    v_max3_f32 v212, v212, v192, v193
    v_max3_f32 v213, v213, v194, v195
    v_max3_f32 v212, v212, v196, v197
    v_max3_f32 v213, v213, v198, v199
    v_max3_f32 v212, v212, v200, v201
    v_max3_f32 v213, v213, v202, v203
    v_max3_f32 v212, v212, v204, v205
    v_max3_f32 v213, v213, v206, v207
    v_mfma_f32_32x32x16_bf16 v[192:207], v[24:27], v[16:19], 0
    ds_read_b128 v[24:27], v2 offset:3072
    v_max3_f32 v208, v208, v160, v161
    v_max3_f32 v209, v209, v162, v163
    v_max3_f32 v208, v208, v164, v165
    v_max3_f32 v209, v209, v166, v167
    v_max3_f32 v208, v208, v168, v169
    v_max3_f32 v209, v209, v170, v171
    v_max3_f32 v208, v208, v172, v173
    v_max3_f32 v209, v209, v174, v175
    s_waitcnt lgkmcnt(1)
    v_mfma_f32_32x32x16_bf16 v[160:175], v[20:23], v[8:11], 0
    v_max3_f32 v210, v210, v176, v177
    v_max3_f32 v211, v211, v178, v179
    v_max3_f32 v210, v210, v180, v181
    v_max3_f32 v211, v211, v182, v183
    v_max3_f32 v210, v210, v184, v185
    v_max3_f32 v211, v211, v186, v187
    v_max3_f32 v210, v210, v188, v189
    v_max3_f32 v211, v211, v190, v191
    v_mfma_f32_32x32x16_bf16 v[176:191], v[20:23], v[12:15], 0
    v_max3_f32 v212, v212, v192, v193
    v_max3_f32 v213, v213, v194, v195
    v_max3_f32 v212, v212, v196, v197
    v_max3_f32 v213, v213, v198, v199
    v_max3_f32 v212, v212, v200, v201
    v_max3_f32 v213, v213, v202, v203
    v_max3_f32 v212, v212, v204, v205
    v_max3_f32 v213, v213, v206, v207
    v_add_u32 v2, 2048, v2
    s_add_u32 s20, s20, 2
    s_cmp_lt_u32 s20, s25
    s_cbranch_scc1 BA_15_p1
    v_max_f32 v208, v208, v209
    v_mov_b32 v209, v208
    s_nop 1
    v_permlane32_swap_b32 v208, v209
    v_max_f32 v208, v208, v209
    v_sub_f32 v64, 0, v208
    v_sub_f32 v65, 0, v208
    v_sub_f32 v66, 0, v208
    v_sub_f32 v67, 0, v208
    v_sub_f32 v68, 0, v208
    v_sub_f32 v69, 0, v208
    v_sub_f32 v70, 0, v208
    v_sub_f32 v71, 0, v208
    v_sub_f32 v72, 0, v208
    v_sub_f32 v73, 0, v208
    v_sub_f32 v74, 0, v208
    v_sub_f32 v75, 0, v208
    v_sub_f32 v76, 0, v208
    v_sub_f32 v77, 0, v208
    v_sub_f32 v78, 0, v208
    v_sub_f32 v79, 0, v208
    v_max_f32 v210, v210, v211
    v_mov_b32 v211, v210
    s_nop 1
    v_permlane32_swap_b32 v210, v211
    v_max_f32 v210, v210, v211
    v_sub_f32 v80, 0, v210
    v_sub_f32 v81, 0, v210
    v_sub_f32 v82, 0, v210
    v_sub_f32 v83, 0, v210
    v_sub_f32 v84, 0, v210
    v_sub_f32 v85, 0, v210
    v_sub_f32 v86, 0, v210
    v_sub_f32 v87, 0, v210
    v_sub_f32 v88, 0, v210
    v_sub_f32 v89, 0, v210
    v_sub_f32 v90, 0, v210
    v_sub_f32 v91, 0, v210
    v_sub_f32 v92, 0, v210
    v_sub_f32 v93, 0, v210
    v_sub_f32 v94, 0, v210
    v_sub_f32 v95, 0, v210
    v_max_f32 v212, v212, v213
    v_mov_b32 v213, v212
    s_nop 1
    v_permlane32_swap_b32 v212, v213
    v_max_f32 v212, v212, v213
    v_sub_f32 v96, 0, v212
    v_sub_f32 v97, 0, v212
    v_sub_f32 v98, 0, v212
    v_sub_f32 v99, 0, v212
    v_sub_f32 v100, 0, v212
    v_sub_f32 v101, 0, v212
    v_sub_f32 v102, 0, v212
    v_sub_f32 v103, 0, v212
    v_sub_f32 v104, 0, v212
    v_sub_f32 v105, 0, v212
    v_sub_f32 v106, 0, v212
    v_sub_f32 v107, 0, v212
    v_sub_f32 v108, 0, v212
    v_sub_f32 v109, 0, v212
    v_sub_f32 v110, 0, v212
    v_sub_f32 v111, 0, v212
BA_15_sk1:
    s_waitcnt vmcnt(0) lgkmcnt(0)
    s_barrier
    s_cmp_eq_u32 s24, 1
    s_cbranch_scc1 BA_15_sk2
BA_15_go2:
    s_waitcnt lgkmcnt(0)
    v_mov_b32 v2, v1
    ds_read_b128 v[20:23], v2
    ds_read_b128 v[24:27], v2 offset:1024
    s_mov_b64 exec, s[18:19]
    ds_read_b128 v[28:31], v3 offset:0
    ds_read_b128 v[32:35], v3 offset:512
    s_mov_b64 exec, -1
    v_mov_b32 v52, 0
    v_mov_b32 v53, 0
    v_mov_b32 v54, 0
    v_mov_b32 v55, 0
    v_mov_b32 v56, 0
    v_mov_b32 v57, 0
    v_mov_b32 v58, 0
    v_mov_b32 v59, 0
    s_mov_b32 s20, 0
    s_waitcnt lgkmcnt(0)
    v_mfma_f32_32x32x16_bf16 v[160:175], v[20:23], v[8:11], v[64:79]
    v_mfma_f32_32x32x16_bf16 v[176:191], v[20:23], v[12:15], v[80:95]
BA_15_p2:
    v_mfma_f32_32x32x16_bf16 v[192:207], v[20:23], v[16:19], v[96:111]
    ds_read_b128 v[20:23], v2 offset:2048
    v_exp_f32 v160, v160
    v_exp_f32 v161, v161
    v_exp_f32 v162, v162
    v_exp_f32 v163, v163
    v_cvt_pk_bf16_f32 v44, v160, v161
    v_exp_f32 v164, v164
    v_mfma_f32_32x32x16_bf16 v[144:159], v[36:39], v[52:55], v[144:159]
    v_exp_f32 v165, v165
    v_cvt_pk_bf16_f32 v45, v162, v163
    v_exp_f32 v166, v166
    v_exp_f32 v167, v167
    v_cvt_pk_bf16_f32 v46, v164, v165
    v_exp_f32 v168, v168
    v_exp_f32 v169, v169
    v_mfma_f32_32x32x16_bf16 v[144:159], v[40:43], v[56:59], v[144:159]
    s_mov_b64 exec, s[18:19]
    ds_read_b128 v[36:39], v3 offset:1024
    ds_read_b128 v[40:43], v3 offset:1536
    s_mov_b64 exec, -1
    v_cvt_pk_bf16_f32 v47, v166, v167
    v_exp_f32 v170, v170
    v_exp_f32 v171, v171
    v_cvt_pk_bf16_f32 v48, v168, v169
    v_exp_f32 v172, v172
    v_exp_f32 v173, v173
    v_cvt_pk_bf16_f32 v49, v170, v171
    v_exp_f32 v174, v174
    v_exp_f32 v175, v175
    v_cvt_pk_bf16_f32 v50, v172, v173
    v_cvt_pk_bf16_f32 v51, v174, v175
    s_waitcnt lgkmcnt(3)
    v_mfma_f32_32x32x16_bf16 v[160:175], v[24:27], v[8:11], v[64:79]
    v_exp_f32 v176, v176
    v_exp_f32 v177, v177
    v_exp_f32 v178, v178
    v_exp_f32 v179, v179
    v_cvt_pk_bf16_f32 v52, v176, v177
    v_exp_f32 v180, v180
    v_mfma_f32_32x32x16_bf16 v[112:127], v[28:31], v[44:47], v[112:127]
    v_exp_f32 v181, v181
    v_cvt_pk_bf16_f32 v53, v178, v179
    v_exp_f32 v182, v182
    v_exp_f32 v183, v183
    v_cvt_pk_bf16_f32 v54, v180, v181
    v_exp_f32 v184, v184
    v_exp_f32 v185, v185
    v_mfma_f32_32x32x16_bf16 v[112:127], v[32:35], v[48:51], v[112:127]
    v_cvt_pk_bf16_f32 v55, v182, v183
    v_exp_f32 v186, v186
    v_exp_f32 v187, v187
    v_cvt_pk_bf16_f32 v56, v184, v185
    v_exp_f32 v188, v188
    v_exp_f32 v189, v189
    v_cvt_pk_bf16_f32 v57, v186, v187
    v_exp_f32 v190, v190
    v_exp_f32 v191, v191
    v_cvt_pk_bf16_f32 v58, v188, v189
    v_cvt_pk_bf16_f32 v59, v190, v191
    v_mfma_f32_32x32x16_bf16 v[176:191], v[24:27], v[12:15], v[80:95]
    v_exp_f32 v192, v192
    v_exp_f32 v193, v193
    v_exp_f32 v194, v194
    v_exp_f32 v195, v195
    v_cvt_pk_bf16_f32 v44, v192, v193
    v_exp_f32 v196, v196
    v_mfma_f32_32x32x16_bf16 v[128:143], v[28:31], v[52:55], v[128:143]
    v_exp_f32 v197, v197
    v_cvt_pk_bf16_f32 v45, v194, v195
    v_exp_f32 v198, v198
    v_exp_f32 v199, v199
    v_cvt_pk_bf16_f32 v46, v196, v197
    v_exp_f32 v200, v200
    v_exp_f32 v201, v201
    v_mfma_f32_32x32x16_bf16 v[128:143], v[32:35], v[56:59], v[128:143]
    v_cvt_pk_bf16_f32 v47, v198, v199
    v_exp_f32 v202, v202
    v_exp_f32 v203, v203
    v_cvt_pk_bf16_f32 v48, v200, v201
    v_exp_f32 v204, v204
    v_exp_f32 v205, v205
    v_cvt_pk_bf16_f32 v49, v202, v203
    v_exp_f32 v206, v206
    v_exp_f32 v207, v207
    v_cvt_pk_bf16_f32 v50, v204, v205
    v_cvt_pk_bf16_f32 v51, v206, v207
    v_mfma_f32_32x32x16_bf16 v[192:207], v[24:27], v[16:19], v[96:111]
    ds_read_b128 v[24:27], v2 offset:3072
    v_exp_f32 v160, v160
    v_exp_f32 v161, v161
    v_exp_f32 v162, v162
    v_exp_f32 v163, v163
    v_cvt_pk_bf16_f32 v52, v160, v161
    v_exp_f32 v164, v164
    v_mfma_f32_32x32x16_bf16 v[144:159], v[28:31], v[44:47], v[144:159]
    v_exp_f32 v165, v165
    v_cvt_pk_bf16_f32 v53, v162, v163
    v_exp_f32 v166, v166
    v_exp_f32 v167, v167
    v_cvt_pk_bf16_f32 v54, v164, v165
    v_exp_f32 v168, v168
    v_exp_f32 v169, v169
    v_mfma_f32_32x32x16_bf16 v[144:159], v[32:35], v[48:51], v[144:159]
    s_mov_b64 exec, s[18:19]
    ds_read_b128 v[28:31], v3 offset:2048
    ds_read_b128 v[32:35], v3 offset:2560
    s_mov_b64 exec, -1
    v_cvt_pk_bf16_f32 v55, v166, v167
    v_exp_f32 v170, v170
    v_exp_f32 v171, v171
    v_cvt_pk_bf16_f32 v56, v168, v169
    v_exp_f32 v172, v172
    v_exp_f32 v173, v173
    v_cvt_pk_bf16_f32 v57, v170, v171
    v_exp_f32 v174, v174
    v_exp_f32 v175, v175
    v_cvt_pk_bf16_f32 v58, v172, v173
    v_cvt_pk_bf16_f32 v59, v174, v175
    s_waitcnt lgkmcnt(3)
    v_mfma_f32_32x32x16_bf16 v[160:175], v[20:23], v[8:11], v[64:79]
    v_exp_f32 v176, v176
    v_exp_f32 v177, v177
    v_exp_f32 v178, v178
    v_exp_f32 v179, v179
    v_cvt_pk_bf16_f32 v44, v176, v177
    v_exp_f32 v180, v180
    v_mfma_f32_32x32x16_bf16 v[112:127], v[36:39], v[52:55], v[112:127]
    v_exp_f32 v181, v181
    v_cvt_pk_bf16_f32 v45, v178, v179
    v_exp_f32 v182, v182
    v_exp_f32 v183, v183
    v_cvt_pk_bf16_f32 v46, v180, v181
    v_exp_f32 v184, v184
    v_exp_f32 v185, v185
    v_mfma_f32_32x32x16_bf16 v[112:127], v[40:43], v[56:59], v[112:127]
    v_cvt_pk_bf16_f32 v47, v182, v183
    v_exp_f32 v186, v186
    v_exp_f32 v187, v187
    v_cvt_pk_bf16_f32 v48, v184, v185
    v_exp_f32 v188, v188
    v_exp_f32 v189, v189
    v_cvt_pk_bf16_f32 v49, v186, v187
    v_exp_f32 v190, v190
    v_exp_f32 v191, v191
    v_cvt_pk_bf16_f32 v50, v188, v189
    v_cvt_pk_bf16_f32 v51, v190, v191
    v_mfma_f32_32x32x16_bf16 v[176:191], v[20:23], v[12:15], v[80:95]
    v_exp_f32 v192, v192
    v_exp_f32 v193, v193
    v_exp_f32 v194, v194
    v_exp_f32 v195, v195
    v_cvt_pk_bf16_f32 v52, v192, v193
    v_exp_f32 v196, v196
    v_mfma_f32_32x32x16_bf16 v[128:143], v[36:39], v[44:47], v[128:143]
    v_exp_f32 v197, v197
    v_cvt_pk_bf16_f32 v53, v194, v195
    v_exp_f32 v198, v198
    v_exp_f32 v199, v199
    v_cvt_pk_bf16_f32 v54, v196, v197
    v_exp_f32 v200, v200
    v_exp_f32 v201, v201
    v_mfma_f32_32x32x16_bf16 v[128:143], v[40:43], v[48:51], v[128:143]
    v_cvt_pk_bf16_f32 v55, v198, v199
    v_exp_f32 v202, v202
    v_exp_f32 v203, v203
    v_cvt_pk_bf16_f32 v56, v200, v201
    v_exp_f32 v204, v204
    v_exp_f32 v205, v205
    v_cvt_pk_bf16_f32 v57, v202, v203
    v_exp_f32 v206, v206
    v_exp_f32 v207, v207
    v_cvt_pk_bf16_f32 v58, v204, v205
    v_cvt_pk_bf16_f32 v59, v206, v207
    v_add_u32 v2, 2048, v2
    v_add_u32 v3, 2048, v3
    s_add_u32 s20, s20, 2
    s_cmp_lt_u32 s20, 64
    s_cbranch_scc1 BA_15_p2
    v_mfma_f32_32x32x16_bf16 v[144:159], v[36:39], v[52:55], v[144:159]
    v_mfma_f32_32x32x16_bf16 v[144:159], v[40:43], v[56:59], v[144:159]
BA_15_fin:
    v_rcp_f32 v4, v120
    s_nop 0
    v_mul_f32 v4, v4, v216
    v_mul_f32 v112, v112, v4
    v_mul_f32 v113, v113, v4
    v_mul_f32 v114, v114, v4
    v_mul_f32 v115, v115, v4
    v_mul_f32 v116, v116, v4
    v_mul_f32 v117, v117, v4
    v_mul_f32 v118, v118, v4
    v_mul_f32 v119, v119, v4
    v_cvt_pk_bf16_f32 v120, v112, v113
    v_cvt_pk_bf16_f32 v121, v114, v115
    v_cvt_pk_bf16_f32 v122, v116, v117
    v_cvt_pk_bf16_f32 v123, v118, v119
    s_mul_i32 s20, s21, 288
    s_add_u32 s20, s20, s61
    s_lshl_b32 s20, s20, 10
    s_add_u32 s20, s20, 73662464
    buffer_store_dwordx4 v[120:123], v1, s[4:7], s20 offen sc1
    v_rcp_f32 v4, v136
    s_nop 0
    v_mul_f32 v4, v4, v217
    v_mul_f32 v128, v128, v4
    v_mul_f32 v129, v129, v4
    v_mul_f32 v130, v130, v4
    v_mul_f32 v131, v131, v4
    v_mul_f32 v132, v132, v4
    v_mul_f32 v133, v133, v4
    v_mul_f32 v134, v134, v4
    v_mul_f32 v135, v135, v4
    v_cvt_pk_bf16_f32 v136, v128, v129
    v_cvt_pk_bf16_f32 v137, v130, v131
    v_cvt_pk_bf16_f32 v138, v132, v133
    v_cvt_pk_bf16_f32 v139, v134, v135
    s_mul_i32 s20, s22, 288
    s_add_u32 s20, s20, s61
    s_lshl_b32 s20, s20, 10
    s_add_u32 s20, s20, 73662464
    buffer_store_dwordx4 v[136:139], v1, s[4:7], s20 offen sc1
    v_rcp_f32 v4, v152
    s_nop 0
    v_mul_f32 v4, v4, v218
    v_mul_f32 v144, v144, v4
    v_mul_f32 v145, v145, v4
    v_mul_f32 v146, v146, v4
    v_mul_f32 v147, v147, v4
    v_mul_f32 v148, v148, v4
    v_mul_f32 v149, v149, v4
    v_mul_f32 v150, v150, v4
    v_mul_f32 v151, v151, v4
    v_cvt_pk_bf16_f32 v152, v144, v145
    v_cvt_pk_bf16_f32 v153, v146, v147
    v_cvt_pk_bf16_f32 v154, v148, v149
    v_cvt_pk_bf16_f32 v155, v150, v151
    s_mul_i32 s20, s23, 288
    s_add_u32 s20, s20, s61
    s_lshl_b32 s20, s20, 10
    s_add_u32 s20, s20, 73662464
    buffer_store_dwordx4 v[152:155], v1, s[4:7], s20 offen sc1
BA_15_sk2:
    s_waitcnt vmcnt(0) lgkmcnt(0)
    s_lshl_b32 s56, s60, 2
    s_add_u32 s56, s56, 95425536
    s_waitcnt vmcnt(0) lgkmcnt(0)
    s_barrier
    s_cmp_eq_u32 s62, 0
    s_cbranch_scc0 SG_16
    v_mov_b32 v254, 1
    s_mov_b64 exec, 1
    buffer_store_dword v254, off, s[4:7], s56 sc1
    s_mov_b64 exec, -1
SG_16:
L_p2done:
    s_cmp_ge_u32 s60, 128
    s_cbranch_scc1 L_t6
    s_lshr_b32 s61, s60, 2
    s_and_b32 s59, s60, 3
    s_lshr_b32 s56, s61, 1
    s_lshl_b32 s56, s56, 2
    s_add_u32 s56, s56, s59
    s_lshl_b32 s56, s56, 2
    s_add_u32 s56, s56, 95425024
    s_cmp_eq_u32 s62, 0
    s_cbranch_scc0 WF_17_ok
    v_min_u32 v254, 0, v0
    v_lshlrev_b32 v254, 2, v254
WF_17:
    buffer_load_dword v250, v254, s[4:7], s56 offen sc1
    s_sub_u32 s70, s70, 1
    s_cbranch_scc1 WF_17_to
    s_waitcnt vmcnt(0)
    v_cmp_eq_u32 vcc, 0, v250
    s_cbranch_vccz WF_17_ok
    s_sleep 16
    s_branch WF_17
WF_17_to:
    s_mov_b32 s70, 0
    s_waitcnt vmcnt(0)
WF_17_ok:
    s_barrier
    v_lshlrev_b32 v1, 4, v0
    v_lshlrev_b32 v2, 3, v0
    v_and_b32 v5, 15, v0
    v_lshlrev_b32 v3, 3, v5
    v_lshrrev_b32 v6, 4, v0
    v_lshlrev_b32 v4, 9, v6
    v_lshl_add_u32 v4, v5, 4, v4
    v_lshl_add_u32 v7, v6, 2, 0
    v_cmp_le_u32 s[24:25], v7, v5
    v_lshl_add_u32 v7, v6, 2, 1
    v_cmp_le_u32 s[26:27], v7, v5
    v_lshl_add_u32 v7, v6, 2, 2
    v_cmp_le_u32 s[28:29], v7, v5
    v_lshl_add_u32 v7, v6, 2, 3
    v_cmp_le_u32 s[30:31], v7, v5
    s_mov_b32 s22, 0x3e0293ee
    v_mov_b32 v5, 0xf149f2ca
    v_mov_b32 v9, 0
    v_mov_b32 v10, 0
    v_and_b32 v13, 15, v0
    v_lshrrev_b32 v14, 4, v0
    v_lshrrev_b32 v15, 2, v13
    v_lshlrev_b32 v15, 1, v15
    v_and_b32 v6, 1, v13
    v_add_u32 v15, v15, v6
    v_mul_u32_u24 v15, 1040, v15
    v_bfe_u32 v6, v13, 1, 1
    v_lshlrev_b32 v6, 6, v6
    v_lshl_add_u32 v6, v14, 3, v6
    v_add_u32 v6, v6, v15
    s_lshl_b32 s16, s62, 8
    v_add_u32 v6, s16, v6
    v_lshrrev_b32 v7, 1, v13
    v_mul_u32_u24 v7, 1040, v7
    v_lshrrev_b32 v15, 1, v14
    v_lshl_add_u32 v7, v15, 4, v7
    v_xor_b32 v15, v13, v14
    v_and_b32 v15, 1, v15
    v_cmp_eq_u32 vcc, 1, v15
    v_mov_b32 v15, 8320
    s_nop 0
    v_cndmask_b32 v7, v7, v15, vcc
    v_mov_b64 v[16:17], 0
    v_mov_b64 v[18:19], 0
    ds_write_b128 v1, v[16:19] offset:8320
    v_lshrrev_b32 v15, 2, v13
    v_lshlrev_b32 v15, 1, v15
    v_and_b32 v102, 1, v13
    v_add_u32 v15, v15, v102
    v_mul_u32_u24 v102, 288, v15
    v_lshl_add_u32 v102, v14, 4, v102
    s_mov_b32 s20, 0x05040100
    s_mov_b32 s21, 0x07060302
    s_and_b32 s23, s62, 1
    s_lshl_b32 s16, s23, 10
    v_add_u32 v2, s16, v2
    v_mul_u32_u24 v12, 576, v14
    v_lshl_add_u32 v12, v13, 2, v12
    s_lshl_b32 s16, s23, 7
    s_add_u32 s16, s16, 16384
    v_add_u32 v12, s16, v12
    s_cmp_ge_u32 s62, 2
    s_cbranch_scc1 T5_18_v
    s_lshl_b32 s16, s59, 5
    s_add_u32 s16, s16, s61
    s_lshl_b32 s17, s16, 13
    s_lshl_b32 s32, s59, 13
    s_lshl_b32 s19, s62, 11
    s_add_u32 s32, s32, s19
    s_add_u32 s32, s32, 50855936
    buffer_load_dwordx4 v[144:147], v1, s[4:7], s32 offen offset:0 sc1
    buffer_load_dwordx4 v[148:151], v1, s[4:7], s32 offen offset:1024 sc1
    s_add_u32 s18, s17, 0
    buffer_load_dwordx4 v[16:19], v1, s[4:7], s18 offen offset:0 sc1
    buffer_load_dwordx4 v[20:23], v1, s[4:7], s18 offen offset:1024 sc1
    buffer_load_dwordx4 v[24:27], v1, s[4:7], s18 offen offset:2048 sc1
    buffer_load_dwordx4 v[28:31], v1, s[4:7], s18 offen offset:3072 sc1
    s_add_u32 s18, s17, 16777216
    buffer_load_dwordx4 v[32:35], v1, s[4:7], s18 offen offset:0 sc1
    buffer_load_dwordx4 v[36:39], v1, s[4:7], s18 offen offset:1024 sc1
    buffer_load_dwordx4 v[40:43], v1, s[4:7], s18 offen offset:2048 sc1
    buffer_load_dwordx4 v[44:47], v1, s[4:7], s18 offen offset:3072 sc1
    s_lshl_b32 s18, s23, 12
    s_add_u32 s18, s18, s17
    s_add_u32 s18, s18, 33554432
    buffer_load_dwordx4 v[64:67], v1, s[4:7], s18 offen offset:0 sc1
    buffer_load_dwordx4 v[68:71], v1, s[4:7], s18 offen offset:1024 sc1
    buffer_load_dwordx4 v[72:75], v1, s[4:7], s18 offen offset:2048 sc1
    buffer_load_dwordx4 v[76:79], v1, s[4:7], s18 offen offset:3072 sc1
    s_lshl_b32 s18, s59, 8
    s_add_u32 s18, s18, 71303168
    buffer_load_dword v100, v3, s[4:7], s18 offen offset:0 sc1
T5_18_0_loop:
    s_waitcnt vmcnt(13)
    s_branch T5_18_0_chk
T5_18_0_poll:
    s_cmp_ge_u32 s59, 61
    s_cbranch_scc1 T5_18_0_fast
    s_sleep 32
T5_18_0_fast:
    s_sleep 2
    buffer_load_dwordx4 v[144:147], v1, s[4:7], s32 offen offset:0 sc1
    buffer_load_dwordx4 v[148:151], v1, s[4:7], s32 offen offset:1024 sc1
    s_sub_u32 s70, s70, 1
    s_cbranch_scc1 T5_18_0_to
    s_waitcnt vmcnt(0)
T5_18_0_chk:
    v_max3_u32 v120, v144, v145, v146
    v_max3_u32 v121, v147, v148, v149
    v_max3_u32 v120, v120, v150, v151
    v_max_u32 v120, v120, v121
    v_cmp_eq_u32 vcc, -1, v120
    s_cbranch_vccnz T5_18_0_poll
    s_branch T5_18_0_ok
T5_18_0_to:
    s_mov_b32 s70, 0
    s_waitcnt vmcnt(0)
T5_18_0_ok:
    v_perm_b32 v152, v145, v144, s20
    v_perm_b32 v153, v147, v146, s20
    v_perm_b32 v154, v145, v144, s21
    v_perm_b32 v155, v147, v146, s21
    v_perm_b32 v156, v149, v148, s20
    v_perm_b32 v157, v151, v150, s20
    v_perm_b32 v158, v149, v148, s21
    v_perm_b32 v159, v151, v150, s21
    ds_write2_b64 v6, v[152:153], v[154:155] offset0:0 offset1:4
    ds_write2_b64 v6, v[156:157], v[158:159] offset0:16 offset1:20
    s_waitcnt lgkmcnt(0)
    s_barrier
    ds_read_b128 v[160:163], v7 offset:0
    ds_read_b128 v[164:167], v7 offset:32
    ds_read_b128 v[168:171], v7 offset:64
    ds_read_b128 v[172:175], v7 offset:96
    ds_read_b128 v[176:179], v7 offset:128
    ds_read_b128 v[180:183], v7 offset:160
    ds_read_b128 v[184:187], v7 offset:192
    s_waitcnt lgkmcnt(6)
    v_mfma_f32_16x16x32_bf16 v[192:195], v[160:163], a[0:3], 0
    ds_read_b128 v[188:191], v7 offset:224
    v_mfma_f32_16x16x32_bf16 v[196:199], v[160:163], a[128:131], 0
    s_waitcnt lgkmcnt(6)
    v_mfma_f32_16x16x32_bf16 v[192:195], v[164:167], a[4:7], v[192:195]
    ds_read_b128 v[160:163], v7 offset:256
    v_mfma_f32_16x16x32_bf16 v[196:199], v[164:167], a[132:135], v[196:199]
    s_waitcnt lgkmcnt(6)
    v_mfma_f32_16x16x32_bf16 v[192:195], v[168:171], a[8:11], v[192:195]
    ds_read_b128 v[164:167], v7 offset:288
    v_mfma_f32_16x16x32_bf16 v[196:199], v[168:171], a[136:139], v[196:199]
    s_waitcnt lgkmcnt(6)
    v_mfma_f32_16x16x32_bf16 v[192:195], v[172:175], a[12:15], v[192:195]
    ds_read_b128 v[168:171], v7 offset:320
    v_mfma_f32_16x16x32_bf16 v[196:199], v[172:175], a[140:143], v[196:199]
    s_waitcnt lgkmcnt(6)
    v_mfma_f32_16x16x32_bf16 v[192:195], v[176:179], a[16:19], v[192:195]
    ds_read_b128 v[172:175], v7 offset:352
    v_mfma_f32_16x16x32_bf16 v[196:199], v[176:179], a[144:147], v[196:199]
    s_waitcnt lgkmcnt(6)
    v_mfma_f32_16x16x32_bf16 v[192:195], v[180:183], a[20:23], v[192:195]
    ds_read_b128 v[176:179], v7 offset:384
    v_mfma_f32_16x16x32_bf16 v[196:199], v[180:183], a[148:151], v[196:199]
    s_waitcnt lgkmcnt(6)
    v_mfma_f32_16x16x32_bf16 v[192:195], v[184:187], a[24:27], v[192:195]
    ds_read_b128 v[180:183], v7 offset:416
    v_mfma_f32_16x16x32_bf16 v[196:199], v[184:187], a[152:155], v[196:199]
    s_waitcnt lgkmcnt(6)
    v_mfma_f32_16x16x32_bf16 v[192:195], v[188:191], a[28:31], v[192:195]
    ds_read_b128 v[184:187], v7 offset:448
    v_mfma_f32_16x16x32_bf16 v[196:199], v[188:191], a[156:159], v[196:199]
    s_waitcnt lgkmcnt(6)
    v_mfma_f32_16x16x32_bf16 v[192:195], v[160:163], a[32:35], v[192:195]
    ds_read_b128 v[188:191], v7 offset:480
    v_mfma_f32_16x16x32_bf16 v[196:199], v[160:163], a[160:163], v[196:199]
    s_waitcnt lgkmcnt(6)
    v_mfma_f32_16x16x32_bf16 v[192:195], v[164:167], a[36:39], v[192:195]
    ds_read_b128 v[160:163], v7 offset:512
    v_mfma_f32_16x16x32_bf16 v[196:199], v[164:167], a[164:167], v[196:199]
    s_waitcnt lgkmcnt(6)
    v_mfma_f32_16x16x32_bf16 v[192:195], v[168:171], a[40:43], v[192:195]
    ds_read_b128 v[164:167], v7 offset:544
    v_mfma_f32_16x16x32_bf16 v[196:199], v[168:171], a[168:171], v[196:199]
    s_waitcnt lgkmcnt(6)
    v_mfma_f32_16x16x32_bf16 v[192:195], v[172:175], a[44:47], v[192:195]
    ds_read_b128 v[168:171], v7 offset:576
    v_mfma_f32_16x16x32_bf16 v[196:199], v[172:175], a[172:175], v[196:199]
    s_waitcnt lgkmcnt(6)
    v_mfma_f32_16x16x32_bf16 v[192:195], v[176:179], a[48:51], v[192:195]
    ds_read_b128 v[172:175], v7 offset:608
    v_mfma_f32_16x16x32_bf16 v[196:199], v[176:179], a[176:179], v[196:199]
    s_waitcnt lgkmcnt(6)
    v_mfma_f32_16x16x32_bf16 v[192:195], v[180:183], a[52:55], v[192:195]
    ds_read_b128 v[176:179], v7 offset:640
    v_mfma_f32_16x16x32_bf16 v[196:199], v[180:183], a[180:183], v[196:199]
    s_waitcnt lgkmcnt(6)
    v_mfma_f32_16x16x32_bf16 v[192:195], v[184:187], a[56:59], v[192:195]
    ds_read_b128 v[180:183], v7 offset:672
    v_mfma_f32_16x16x32_bf16 v[196:199], v[184:187], a[184:187], v[196:199]
    s_waitcnt lgkmcnt(6)
    v_mfma_f32_16x16x32_bf16 v[192:195], v[188:191], a[60:63], v[192:195]
    ds_read_b128 v[184:187], v7 offset:704
    v_mfma_f32_16x16x32_bf16 v[196:199], v[188:191], a[188:191], v[196:199]
    s_waitcnt lgkmcnt(6)
    v_mfma_f32_16x16x32_bf16 v[192:195], v[160:163], a[64:67], v[192:195]
    ds_read_b128 v[188:191], v7 offset:736
    v_mfma_f32_16x16x32_bf16 v[196:199], v[160:163], a[192:195], v[196:199]
    s_waitcnt lgkmcnt(6)
    v_mfma_f32_16x16x32_bf16 v[192:195], v[164:167], a[68:71], v[192:195]
    ds_read_b128 v[160:163], v7 offset:768
    v_mfma_f32_16x16x32_bf16 v[196:199], v[164:167], a[196:199], v[196:199]
    s_waitcnt lgkmcnt(6)
    v_mfma_f32_16x16x32_bf16 v[192:195], v[168:171], a[72:75], v[192:195]
    ds_read_b128 v[164:167], v7 offset:800
    v_mfma_f32_16x16x32_bf16 v[196:199], v[168:171], a[200:203], v[196:199]
    s_waitcnt lgkmcnt(6)
    v_mfma_f32_16x16x32_bf16 v[192:195], v[172:175], a[76:79], v[192:195]
    ds_read_b128 v[168:171], v7 offset:832
    v_mfma_f32_16x16x32_bf16 v[196:199], v[172:175], a[204:207], v[196:199]
    s_waitcnt lgkmcnt(6)
    v_mfma_f32_16x16x32_bf16 v[192:195], v[176:179], a[80:83], v[192:195]
    ds_read_b128 v[172:175], v7 offset:864
    v_mfma_f32_16x16x32_bf16 v[196:199], v[176:179], a[208:211], v[196:199]
    s_waitcnt lgkmcnt(6)
    v_mfma_f32_16x16x32_bf16 v[192:195], v[180:183], a[84:87], v[192:195]
    ds_read_b128 v[176:179], v7 offset:896
    v_mfma_f32_16x16x32_bf16 v[196:199], v[180:183], a[212:215], v[196:199]
    s_waitcnt lgkmcnt(6)
    v_mfma_f32_16x16x32_bf16 v[192:195], v[184:187], a[88:91], v[192:195]
    ds_read_b128 v[180:183], v7 offset:928
    v_mfma_f32_16x16x32_bf16 v[196:199], v[184:187], a[216:219], v[196:199]
    s_waitcnt lgkmcnt(6)
    v_mfma_f32_16x16x32_bf16 v[192:195], v[188:191], a[92:95], v[192:195]
    ds_read_b128 v[184:187], v7 offset:960
    v_mfma_f32_16x16x32_bf16 v[196:199], v[188:191], a[220:223], v[196:199]
    s_waitcnt lgkmcnt(6)
    v_mfma_f32_16x16x32_bf16 v[192:195], v[160:163], a[96:99], v[192:195]
    ds_read_b128 v[188:191], v7 offset:992
    v_mfma_f32_16x16x32_bf16 v[196:199], v[160:163], a[224:227], v[196:199]
    s_waitcnt lgkmcnt(6)
    v_mfma_f32_16x16x32_bf16 v[192:195], v[164:167], a[100:103], v[192:195]
    v_mfma_f32_16x16x32_bf16 v[196:199], v[164:167], a[228:231], v[196:199]
    s_waitcnt lgkmcnt(5)
    v_mfma_f32_16x16x32_bf16 v[192:195], v[168:171], a[104:107], v[192:195]
    v_mfma_f32_16x16x32_bf16 v[196:199], v[168:171], a[232:235], v[196:199]
    s_waitcnt lgkmcnt(4)
    v_mfma_f32_16x16x32_bf16 v[192:195], v[172:175], a[108:111], v[192:195]
    v_mfma_f32_16x16x32_bf16 v[196:199], v[172:175], a[236:239], v[196:199]
    s_waitcnt lgkmcnt(3)
    v_mfma_f32_16x16x32_bf16 v[192:195], v[176:179], a[112:115], v[192:195]
    v_mfma_f32_16x16x32_bf16 v[196:199], v[176:179], a[240:243], v[196:199]
    s_waitcnt lgkmcnt(2)
    v_mfma_f32_16x16x32_bf16 v[192:195], v[180:183], a[116:119], v[192:195]
    v_mfma_f32_16x16x32_bf16 v[196:199], v[180:183], a[244:247], v[196:199]
    s_waitcnt lgkmcnt(1)
    v_mfma_f32_16x16x32_bf16 v[192:195], v[184:187], a[120:123], v[192:195]
    v_mfma_f32_16x16x32_bf16 v[196:199], v[184:187], a[248:251], v[196:199]
    s_waitcnt lgkmcnt(0)
    v_mfma_f32_16x16x32_bf16 v[192:195], v[188:191], a[124:127], v[192:195]
    v_mfma_f32_16x16x32_bf16 v[196:199], v[188:191], a[252:255], v[196:199]
    s_nop 3
    v_cvt_pk_bf16_f32 v224, v192, v193
    v_cvt_pk_bf16_f32 v225, v194, v195
    ds_write2_b32 v12, v224, v225 offset0:0 offset1:72
    s_nop 0
    v_cvt_pk_bf16_f32 v226, v196, v197
    v_cvt_pk_bf16_f32 v227, v198, v199
    ds_write2_b32 v12, v226, v227 offset0:16 offset1:88
    s_waitcnt vmcnt(0)
    v_mfma_f32_16x16x32_bf16 v[108:111], v[32:35], v[16:19], 0
    v_mfma_f32_16x16x32_bf16 v[108:111], v[36:39], v[20:23], v[108:111]
    v_mfma_f32_16x16x32_bf16 v[108:111], v[40:43], v[24:27], v[108:111]
    v_mfma_f32_16x16x32_bf16 v[108:111], v[44:47], v[28:31], v[108:111]
    s_waitcnt lgkmcnt(0)
    s_barrier
    ds_read_b128 v[80:83], v102 offset:16384
    ds_read_b128 v[84:87], v102 offset:16448
    ds_read_b128 v[88:91], v102 offset:16512
    ds_read_b128 v[92:95], v102 offset:16576
    ds_read_b64 v[96:97], v2 offset:20480
    ds_read_b64 v[98:99], v2 offset:20992
    s_mul_i32 s18, s59, 288
    s_lshl_b32 s19, s61, 3
    s_add_u32 s18, s18, s19
    s_lshl_b32 s18, s18, 10
    s_lshl_b32 s19, s23, 12
    s_add_u32 s18, s18, s19
    s_add_u32 s18, s18, 73400320
    s_waitcnt lgkmcnt(0)
    v_mfma_f32_16x16x32_bf16 v[104:107], v[80:83], v[16:19], 0
    v_mfma_f32_16x16x32_bf16 v[104:107], v[84:87], v[20:23], v[104:107]
    v_mfma_f32_16x16x32_bf16 v[104:107], v[88:91], v[24:27], v[104:107]
    v_mfma_f32_16x16x32_bf16 v[104:107], v[92:95], v[28:31], v[104:107]
    v_cndmask_b32 v108, v5, v108, s[24:25]
    v_cndmask_b32 v109, v5, v109, s[26:27]
    v_cndmask_b32 v110, v5, v110, s[28:29]
    v_cndmask_b32 v111, v5, v111, s[30:31]
    v_max3_f32 v120, v108, v109, v110
    v_max_f32 v120, v120, v111
    s_nop 0
    v_max3_f32 v120, v120, v104, v105
    v_mov_b32 v121, v120
    s_nop 1
    v_permlane16_swap_b32 v120, v121
    v_max_f32 v120, v120, v121
    v_mov_b32 v121, v120
    s_nop 1
    v_permlane32_swap_b32 v120, v121
    v_max_f32 v120, v120, v121
    v_mul_f32 v120, s22, v120
    v_fma_f32 v108, v108, s22, -v120
    v_fma_f32 v109, v109, s22, -v120
    v_fma_f32 v110, v110, s22, -v120
    v_fma_f32 v111, v111, s22, -v120
    v_fma_f32 v104, v104, s22, -v120
    v_fma_f32 v105, v105, s22, -v120
    v_exp_f32 v108, v108
    v_exp_f32 v109, v109
    v_exp_f32 v110, v110
    v_exp_f32 v111, v111
    v_exp_f32 v104, v104
    v_exp_f32 v105, v105
    v_cvt_pk_bf16_f32 v116, v108, v109
    v_cvt_pk_bf16_f32 v117, v110, v111
    v_mov_b64 v[118:119], 0
    v_cvt_pk_bf16_f32 v8, v104, v105
    v_cvt_pk_bf16_f32 v11, v104, v105
    v_mfma_f32_16x16x32_bf16 v[124:127], v[64:67], v[116:119], 0
    v_mfma_f32_16x16x32_bf16 v[128:131], v[68:71], v[116:119], 0
    v_mfma_f32_16x16x32_bf16 v[132:135], v[72:75], v[116:119], 0
    v_mfma_f32_16x16x32_bf16 v[136:139], v[76:79], v[116:119], 0
    v_mfma_f32_16x16x16_bf16 v[124:127], v[96:97], v[8:9], v[124:127]
    v_mfma_f32_16x16x16_bf16 v[128:131], v[96:97], v[10:11], v[128:131]
    v_mfma_f32_16x16x16_bf16 v[132:135], v[98:99], v[8:9], v[132:135]
    v_mfma_f32_16x16x16_bf16 v[136:139], v[98:99], v[10:11], v[136:139]
    v_add_f32 v120, v108, v109
    v_add_f32 v120, v120, v110
    v_add_f32 v120, v120, v111
    v_add_f32 v120, v120, v104
    v_add_f32 v120, v120, v105
    v_mov_b32 v121, v120
    s_nop 1
    v_permlane16_swap_b32 v120, v121
    v_add_f32 v120, v120, v121
    v_mov_b32 v121, v120
    s_nop 1
    v_permlane32_swap_b32 v120, v121
    v_add_f32 v120, v120, v121
    v_rcp_f32 v120, v120
    s_nop 0
    v_mul_f32 v120, v120, v100
    v_mul_f32 v124, v124, v120
    v_mul_f32 v125, v125, v120
    v_mul_f32 v126, v126, v120
    v_mul_f32 v127, v127, v120
    v_mul_f32 v128, v128, v120
    v_mul_f32 v129, v129, v120
    v_mul_f32 v130, v130, v120
    v_mul_f32 v131, v131, v120
    v_cvt_pk_bf16_f32 v240, v124, v125
    v_cvt_pk_bf16_f32 v241, v126, v127
    v_cvt_pk_bf16_f32 v242, v128, v129
    v_cvt_pk_bf16_f32 v243, v130, v131
    buffer_store_dwordx4 v[240:243], v4, s[4:7], s18 offen offset:0 sc1
    v_mul_f32 v132, v132, v120
    v_mul_f32 v133, v133, v120
    v_mul_f32 v134, v134, v120
    v_mul_f32 v135, v135, v120
    v_mul_f32 v136, v136, v120
    v_mul_f32 v137, v137, v120
    v_mul_f32 v138, v138, v120
    v_mul_f32 v139, v139, v120
    v_cvt_pk_bf16_f32 v244, v132, v133
    v_cvt_pk_bf16_f32 v245, v134, v135
    v_cvt_pk_bf16_f32 v246, v136, v137
    v_cvt_pk_bf16_f32 v247, v138, v139
    buffer_store_dwordx4 v[244:247], v4, s[4:7], s18 offen offset:2048 sc1
    s_lshl_b32 s33, s16, 2
    s_add_u32 s33, s33, 95428608
    s_add_u32 s59, s59, 4
    s_cmp_lt_u32 s59, 64
    s_cbranch_scc0 T5_18_0_last
    s_lshl_b32 s16, s59, 5
    s_add_u32 s16, s16, s61
    s_lshl_b32 s17, s16, 13
    s_lshl_b32 s32, s59, 13
    s_lshl_b32 s19, s62, 11
    s_add_u32 s32, s32, s19
    s_add_u32 s32, s32, 50855936
    buffer_load_dwordx4 v[144:147], v1, s[4:7], s32 offen offset:0 sc1
    buffer_load_dwordx4 v[148:151], v1, s[4:7], s32 offen offset:1024 sc1
    s_add_u32 s18, s17, 0
    buffer_load_dwordx4 v[16:19], v1, s[4:7], s18 offen offset:0 sc1
    buffer_load_dwordx4 v[20:23], v1, s[4:7], s18 offen offset:1024 sc1
    buffer_load_dwordx4 v[24:27], v1, s[4:7], s18 offen offset:2048 sc1
    buffer_load_dwordx4 v[28:31], v1, s[4:7], s18 offen offset:3072 sc1
    s_add_u32 s18, s17, 16777216
    buffer_load_dwordx4 v[32:35], v1, s[4:7], s18 offen offset:0 sc1
    buffer_load_dwordx4 v[36:39], v1, s[4:7], s18 offen offset:1024 sc1
    buffer_load_dwordx4 v[40:43], v1, s[4:7], s18 offen offset:2048 sc1
    buffer_load_dwordx4 v[44:47], v1, s[4:7], s18 offen offset:3072 sc1
    s_lshl_b32 s18, s23, 12
    s_add_u32 s18, s18, s17
    s_add_u32 s18, s18, 33554432
    buffer_load_dwordx4 v[64:67], v1, s[4:7], s18 offen offset:0 sc1
    buffer_load_dwordx4 v[68:71], v1, s[4:7], s18 offen offset:1024 sc1
    buffer_load_dwordx4 v[72:75], v1, s[4:7], s18 offen offset:2048 sc1
    buffer_load_dwordx4 v[76:79], v1, s[4:7], s18 offen offset:3072 sc1
    s_lshl_b32 s18, s59, 8
    s_add_u32 s18, s18, 71303168
    buffer_load_dword v100, v3, s[4:7], s18 offen offset:0 sc1
    s_waitcnt vmcnt(15) lgkmcnt(0)
    s_barrier
    s_cmp_eq_u32 s62, 0
    s_cbranch_scc0 SG_19
    v_mov_b32 v254, 1
    s_mov_b64 exec, 1
    buffer_store_dword v254, off, s[4:7], s33 sc1
    s_mov_b64 exec, -1
SG_19:
    s_branch T5_18_0_loop
T5_18_0_last:
    s_waitcnt vmcnt(0) lgkmcnt(0)
    s_barrier
    s_cmp_eq_u32 s62, 0
    s_cbranch_scc0 SG_20
    v_mov_b32 v254, 1
    s_mov_b64 exec, 1
    buffer_store_dword v254, off, s[4:7], s33 sc1
    s_mov_b64 exec, -1
SG_20:
    s_branch T5_18_end
T5_18_v:
    s_lshl_b32 s16, s59, 5
    s_add_u32 s16, s16, s61
    s_lshl_b32 s17, s16, 13
    s_lshl_b32 s32, s59, 13
    s_lshl_b32 s19, s62, 11
    s_add_u32 s32, s32, s19
    s_add_u32 s32, s32, 50855936
    buffer_load_dwordx4 v[144:147], v1, s[4:7], s32 offen offset:0 sc1
    buffer_load_dwordx4 v[148:151], v1, s[4:7], s32 offen offset:1024 sc1
    s_add_u32 s18, s17, 4096
    buffer_load_dwordx4 v[16:19], v1, s[4:7], s18 offen offset:0 sc1
    buffer_load_dwordx4 v[20:23], v1, s[4:7], s18 offen offset:1024 sc1
    buffer_load_dwordx4 v[24:27], v1, s[4:7], s18 offen offset:2048 sc1
    buffer_load_dwordx4 v[28:31], v1, s[4:7], s18 offen offset:3072 sc1
    s_add_u32 s18, s17, 16777216
    buffer_load_dwordx4 v[32:35], v1, s[4:7], s18 offen offset:0 sc1
    buffer_load_dwordx4 v[36:39], v1, s[4:7], s18 offen offset:1024 sc1
    buffer_load_dwordx4 v[40:43], v1, s[4:7], s18 offen offset:2048 sc1
    buffer_load_dwordx4 v[44:47], v1, s[4:7], s18 offen offset:3072 sc1
    s_add_u32 s18, s17, 16781312
    buffer_load_dwordx4 v[48:51], v1, s[4:7], s18 offen offset:0 sc1
    buffer_load_dwordx4 v[52:55], v1, s[4:7], s18 offen offset:1024 sc1
    buffer_load_dwordx4 v[56:59], v1, s[4:7], s18 offen offset:2048 sc1
    buffer_load_dwordx4 v[60:63], v1, s[4:7], s18 offen offset:3072 sc1
    s_lshl_b32 s18, s23, 12
    s_add_u32 s18, s18, s17
    s_add_u32 s18, s18, 33554432
    buffer_load_dwordx4 v[64:67], v1, s[4:7], s18 offen offset:0 sc1
    buffer_load_dwordx4 v[68:71], v1, s[4:7], s18 offen offset:1024 sc1
    buffer_load_dwordx4 v[72:75], v1, s[4:7], s18 offen offset:2048 sc1
    buffer_load_dwordx4 v[76:79], v1, s[4:7], s18 offen offset:3072 sc1
    s_lshl_b32 s18, s59, 8
    s_add_u32 s18, s18, 71303168
    buffer_load_dword v100, v3, s[4:7], s18 offen offset:128 sc1
T5_18_1_loop:
    s_waitcnt vmcnt(17)
    s_branch T5_18_1_chk
T5_18_1_poll:
    s_cmp_ge_u32 s59, 61
    s_cbranch_scc1 T5_18_1_fast
    s_sleep 32
T5_18_1_fast:
    s_sleep 2
    buffer_load_dwordx4 v[144:147], v1, s[4:7], s32 offen offset:0 sc1
    buffer_load_dwordx4 v[148:151], v1, s[4:7], s32 offen offset:1024 sc1
    s_sub_u32 s70, s70, 1
    s_cbranch_scc1 T5_18_1_to
    s_waitcnt vmcnt(0)
T5_18_1_chk:
    v_max3_u32 v120, v144, v145, v146
    v_max3_u32 v121, v147, v148, v149
    v_max3_u32 v120, v120, v150, v151
    v_max_u32 v120, v120, v121
    v_cmp_eq_u32 vcc, -1, v120
    s_cbranch_vccnz T5_18_1_poll
    s_branch T5_18_1_ok
T5_18_1_to:
    s_mov_b32 s70, 0
    s_waitcnt vmcnt(0)
T5_18_1_ok:
    v_perm_b32 v152, v145, v144, s20
    v_perm_b32 v153, v147, v146, s20
    v_perm_b32 v154, v145, v144, s21
    v_perm_b32 v155, v147, v146, s21
    v_perm_b32 v156, v149, v148, s20
    v_perm_b32 v157, v151, v150, s20
    v_perm_b32 v158, v149, v148, s21
    v_perm_b32 v159, v151, v150, s21
    ds_write2_b64 v6, v[152:153], v[154:155] offset0:0 offset1:4
    ds_write2_b64 v6, v[156:157], v[158:159] offset0:16 offset1:20
    s_waitcnt lgkmcnt(0)
    s_barrier
    ds_read_b128 v[160:163], v7 offset:0
    ds_read_b128 v[164:167], v7 offset:32
    ds_read_b128 v[168:171], v7 offset:64
    ds_read_b128 v[172:175], v7 offset:96
    ds_read_b128 v[176:179], v7 offset:128
    ds_read_b128 v[180:183], v7 offset:160
    ds_read_b128 v[184:187], v7 offset:192
    s_waitcnt lgkmcnt(6)
    v_mfma_f32_16x16x32_bf16 v[192:195], v[160:163], a[0:3], 0
    ds_read_b128 v[188:191], v7 offset:224
    v_mfma_f32_16x16x32_bf16 v[196:199], v[160:163], a[128:131], 0
    s_waitcnt lgkmcnt(6)
    v_mfma_f32_16x16x32_bf16 v[192:195], v[164:167], a[4:7], v[192:195]
    ds_read_b128 v[160:163], v7 offset:256
    v_mfma_f32_16x16x32_bf16 v[196:199], v[164:167], a[132:135], v[196:199]
    s_waitcnt lgkmcnt(6)
    v_mfma_f32_16x16x32_bf16 v[192:195], v[168:171], a[8:11], v[192:195]
    ds_read_b128 v[164:167], v7 offset:288
    v_mfma_f32_16x16x32_bf16 v[196:199], v[168:171], a[136:139], v[196:199]
    s_waitcnt lgkmcnt(6)
    v_mfma_f32_16x16x32_bf16 v[192:195], v[172:175], a[12:15], v[192:195]
    ds_read_b128 v[168:171], v7 offset:320
    v_mfma_f32_16x16x32_bf16 v[196:199], v[172:175], a[140:143], v[196:199]
    s_waitcnt lgkmcnt(6)
    v_mfma_f32_16x16x32_bf16 v[192:195], v[176:179], a[16:19], v[192:195]
    ds_read_b128 v[172:175], v7 offset:352
    v_mfma_f32_16x16x32_bf16 v[196:199], v[176:179], a[144:147], v[196:199]
    s_waitcnt lgkmcnt(6)
    v_mfma_f32_16x16x32_bf16 v[192:195], v[180:183], a[20:23], v[192:195]
    ds_read_b128 v[176:179], v7 offset:384
    v_mfma_f32_16x16x32_bf16 v[196:199], v[180:183], a[148:151], v[196:199]
    s_waitcnt lgkmcnt(6)
    v_mfma_f32_16x16x32_bf16 v[192:195], v[184:187], a[24:27], v[192:195]
    ds_read_b128 v[180:183], v7 offset:416
    v_mfma_f32_16x16x32_bf16 v[196:199], v[184:187], a[152:155], v[196:199]
    s_waitcnt lgkmcnt(6)
    v_mfma_f32_16x16x32_bf16 v[192:195], v[188:191], a[28:31], v[192:195]
    ds_read_b128 v[184:187], v7 offset:448
    v_mfma_f32_16x16x32_bf16 v[196:199], v[188:191], a[156:159], v[196:199]
    s_waitcnt lgkmcnt(6)
    v_mfma_f32_16x16x32_bf16 v[192:195], v[160:163], a[32:35], v[192:195]
    ds_read_b128 v[188:191], v7 offset:480
    v_mfma_f32_16x16x32_bf16 v[196:199], v[160:163], a[160:163], v[196:199]
    s_waitcnt lgkmcnt(6)
    v_mfma_f32_16x16x32_bf16 v[192:195], v[164:167], a[36:39], v[192:195]
    ds_read_b128 v[160:163], v7 offset:512
    v_mfma_f32_16x16x32_bf16 v[196:199], v[164:167], a[164:167], v[196:199]
    s_waitcnt lgkmcnt(6)
    v_mfma_f32_16x16x32_bf16 v[192:195], v[168:171], a[40:43], v[192:195]
    ds_read_b128 v[164:167], v7 offset:544
    v_mfma_f32_16x16x32_bf16 v[196:199], v[168:171], a[168:171], v[196:199]
    s_waitcnt lgkmcnt(6)
    v_mfma_f32_16x16x32_bf16 v[192:195], v[172:175], a[44:47], v[192:195]
    ds_read_b128 v[168:171], v7 offset:576
    v_mfma_f32_16x16x32_bf16 v[196:199], v[172:175], a[172:175], v[196:199]
    s_waitcnt lgkmcnt(6)
    v_mfma_f32_16x16x32_bf16 v[192:195], v[176:179], a[48:51], v[192:195]
    ds_read_b128 v[172:175], v7 offset:608
    v_mfma_f32_16x16x32_bf16 v[196:199], v[176:179], a[176:179], v[196:199]
    s_waitcnt lgkmcnt(6)
    v_mfma_f32_16x16x32_bf16 v[192:195], v[180:183], a[52:55], v[192:195]
    ds_read_b128 v[176:179], v7 offset:640
    v_mfma_f32_16x16x32_bf16 v[196:199], v[180:183], a[180:183], v[196:199]
    s_waitcnt lgkmcnt(6)
    v_mfma_f32_16x16x32_bf16 v[192:195], v[184:187], a[56:59], v[192:195]
    ds_read_b128 v[180:183], v7 offset:672
    v_mfma_f32_16x16x32_bf16 v[196:199], v[184:187], a[184:187], v[196:199]
    s_waitcnt lgkmcnt(6)
    v_mfma_f32_16x16x32_bf16 v[192:195], v[188:191], a[60:63], v[192:195]
    ds_read_b128 v[184:187], v7 offset:704
    v_mfma_f32_16x16x32_bf16 v[196:199], v[188:191], a[188:191], v[196:199]
    s_waitcnt lgkmcnt(6)
    v_mfma_f32_16x16x32_bf16 v[192:195], v[160:163], a[64:67], v[192:195]
    ds_read_b128 v[188:191], v7 offset:736
    v_mfma_f32_16x16x32_bf16 v[196:199], v[160:163], a[192:195], v[196:199]
    s_waitcnt lgkmcnt(6)
    v_mfma_f32_16x16x32_bf16 v[192:195], v[164:167], a[68:71], v[192:195]
    ds_read_b128 v[160:163], v7 offset:768
    v_mfma_f32_16x16x32_bf16 v[196:199], v[164:167], a[196:199], v[196:199]
    s_waitcnt lgkmcnt(6)
    v_mfma_f32_16x16x32_bf16 v[192:195], v[168:171], a[72:75], v[192:195]
    ds_read_b128 v[164:167], v7 offset:800
    v_mfma_f32_16x16x32_bf16 v[196:199], v[168:171], a[200:203], v[196:199]
    s_waitcnt lgkmcnt(6)
    v_mfma_f32_16x16x32_bf16 v[192:195], v[172:175], a[76:79], v[192:195]
    ds_read_b128 v[168:171], v7 offset:832
    v_mfma_f32_16x16x32_bf16 v[196:199], v[172:175], a[204:207], v[196:199]
    s_waitcnt lgkmcnt(6)
    v_mfma_f32_16x16x32_bf16 v[192:195], v[176:179], a[80:83], v[192:195]
    ds_read_b128 v[172:175], v7 offset:864
    v_mfma_f32_16x16x32_bf16 v[196:199], v[176:179], a[208:211], v[196:199]
    s_waitcnt lgkmcnt(6)
    v_mfma_f32_16x16x32_bf16 v[192:195], v[180:183], a[84:87], v[192:195]
    ds_read_b128 v[176:179], v7 offset:896
    v_mfma_f32_16x16x32_bf16 v[196:199], v[180:183], a[212:215], v[196:199]
    s_waitcnt lgkmcnt(6)
    v_mfma_f32_16x16x32_bf16 v[192:195], v[184:187], a[88:91], v[192:195]
    ds_read_b128 v[180:183], v7 offset:928
    v_mfma_f32_16x16x32_bf16 v[196:199], v[184:187], a[216:219], v[196:199]
    s_waitcnt lgkmcnt(6)
    v_mfma_f32_16x16x32_bf16 v[192:195], v[188:191], a[92:95], v[192:195]
    ds_read_b128 v[184:187], v7 offset:960
    v_mfma_f32_16x16x32_bf16 v[196:199], v[188:191], a[220:223], v[196:199]
    s_waitcnt lgkmcnt(6)
    v_mfma_f32_16x16x32_bf16 v[192:195], v[160:163], a[96:99], v[192:195]
    ds_read_b128 v[188:191], v7 offset:992
    v_mfma_f32_16x16x32_bf16 v[196:199], v[160:163], a[224:227], v[196:199]
    s_waitcnt lgkmcnt(6)
    v_mfma_f32_16x16x32_bf16 v[192:195], v[164:167], a[100:103], v[192:195]
    v_mfma_f32_16x16x32_bf16 v[196:199], v[164:167], a[228:231], v[196:199]
    s_waitcnt lgkmcnt(5)
    v_mfma_f32_16x16x32_bf16 v[192:195], v[168:171], a[104:107], v[192:195]
    v_mfma_f32_16x16x32_bf16 v[196:199], v[168:171], a[232:235], v[196:199]
    s_waitcnt lgkmcnt(4)
    v_mfma_f32_16x16x32_bf16 v[192:195], v[172:175], a[108:111], v[192:195]
    v_mfma_f32_16x16x32_bf16 v[196:199], v[172:175], a[236:239], v[196:199]
    s_waitcnt lgkmcnt(3)
    v_mfma_f32_16x16x32_bf16 v[192:195], v[176:179], a[112:115], v[192:195]
    v_mfma_f32_16x16x32_bf16 v[196:199], v[176:179], a[240:243], v[196:199]
    s_waitcnt lgkmcnt(2)
    v_mfma_f32_16x16x32_bf16 v[192:195], v[180:183], a[116:119], v[192:195]
    v_mfma_f32_16x16x32_bf16 v[196:199], v[180:183], a[244:247], v[196:199]
    s_waitcnt lgkmcnt(1)
    v_mfma_f32_16x16x32_bf16 v[192:195], v[184:187], a[120:123], v[192:195]
    v_mfma_f32_16x16x32_bf16 v[196:199], v[184:187], a[248:251], v[196:199]
    s_waitcnt lgkmcnt(0)
    v_mfma_f32_16x16x32_bf16 v[192:195], v[188:191], a[124:127], v[192:195]
    v_mfma_f32_16x16x32_bf16 v[196:199], v[188:191], a[252:255], v[196:199]
    s_nop 3
    v_cvt_pk_bf16_f32 v224, v192, v194
    v_cvt_pk_bf16_f32 v225, v193, v195
    ds_write_b64 v2, v[224:225] offset:20480
    s_nop 0
    v_cvt_pk_bf16_f32 v226, v196, v198
    v_cvt_pk_bf16_f32 v227, v197, v199
    ds_write_b64 v2, v[226:227] offset:20992
    s_waitcnt vmcnt(0)
    v_mfma_f32_16x16x32_bf16 v[108:111], v[32:35], v[16:19], 0
    v_mfma_f32_16x16x32_bf16 v[112:115], v[48:51], v[16:19], 0
    v_mfma_f32_16x16x32_bf16 v[108:111], v[36:39], v[20:23], v[108:111]
    v_mfma_f32_16x16x32_bf16 v[112:115], v[52:55], v[20:23], v[112:115]
    v_mfma_f32_16x16x32_bf16 v[108:111], v[40:43], v[24:27], v[108:111]
    v_mfma_f32_16x16x32_bf16 v[112:115], v[56:59], v[24:27], v[112:115]
    v_mfma_f32_16x16x32_bf16 v[108:111], v[44:47], v[28:31], v[108:111]
    v_mfma_f32_16x16x32_bf16 v[112:115], v[60:63], v[28:31], v[112:115]
    s_waitcnt lgkmcnt(0)
    s_barrier
    ds_read_b128 v[80:83], v102 offset:16384
    ds_read_b128 v[84:87], v102 offset:16448
    ds_read_b128 v[88:91], v102 offset:16512
    ds_read_b128 v[92:95], v102 offset:16576
    ds_read_b64 v[96:97], v2 offset:20480
    ds_read_b64 v[98:99], v2 offset:20992
    s_mul_i32 s18, s59, 288
    s_lshl_b32 s19, s61, 3
    s_add_u32 s18, s18, s19
    s_lshl_b32 s18, s18, 10
    s_lshl_b32 s19, s23, 12
    s_add_u32 s18, s18, s19
    s_add_u32 s18, s18, 73400320
    s_waitcnt lgkmcnt(0)
    v_mfma_f32_16x16x32_bf16 v[104:107], v[80:83], v[16:19], 0
    v_mfma_f32_16x16x32_bf16 v[104:107], v[84:87], v[20:23], v[104:107]
    v_mfma_f32_16x16x32_bf16 v[104:107], v[88:91], v[24:27], v[104:107]
    v_mfma_f32_16x16x32_bf16 v[104:107], v[92:95], v[28:31], v[104:107]
    v_cndmask_b32 v112, v5, v112, s[24:25]
    v_cndmask_b32 v113, v5, v113, s[26:27]
    v_cndmask_b32 v114, v5, v114, s[28:29]
    v_cndmask_b32 v115, v5, v115, s[30:31]
    v_max3_f32 v120, v108, v109, v110
    v_max3_f32 v120, v120, v112, v113
    v_max3_f32 v120, v120, v114, v115
    v_max_f32 v120, v120, v111
    v_max3_f32 v120, v120, v104, v105
    v_mov_b32 v121, v120
    s_nop 1
    v_permlane16_swap_b32 v120, v121
    v_max_f32 v120, v120, v121
    v_mov_b32 v121, v120
    s_nop 1
    v_permlane32_swap_b32 v120, v121
    v_max_f32 v120, v120, v121
    v_mul_f32 v120, s22, v120
    v_fma_f32 v108, v108, s22, -v120
    v_fma_f32 v109, v109, s22, -v120
    v_fma_f32 v110, v110, s22, -v120
    v_fma_f32 v111, v111, s22, -v120
    v_fma_f32 v112, v112, s22, -v120
    v_fma_f32 v113, v113, s22, -v120
    v_fma_f32 v114, v114, s22, -v120
    v_fma_f32 v115, v115, s22, -v120
    v_fma_f32 v104, v104, s22, -v120
    v_fma_f32 v105, v105, s22, -v120
    v_exp_f32 v108, v108
    v_exp_f32 v109, v109
    v_exp_f32 v110, v110
    v_exp_f32 v111, v111
    v_exp_f32 v112, v112
    v_exp_f32 v113, v113
    v_exp_f32 v114, v114
    v_exp_f32 v115, v115
    v_exp_f32 v104, v104
    v_exp_f32 v105, v105
    v_cvt_pk_bf16_f32 v116, v108, v109
    v_cvt_pk_bf16_f32 v117, v110, v111
    v_cvt_pk_bf16_f32 v118, v112, v113
    v_cvt_pk_bf16_f32 v119, v114, v115
    v_cvt_pk_bf16_f32 v8, v104, v105
    v_cvt_pk_bf16_f32 v11, v104, v105
    v_mfma_f32_16x16x32_bf16 v[124:127], v[64:67], v[116:119], 0
    v_mfma_f32_16x16x32_bf16 v[128:131], v[68:71], v[116:119], 0
    v_mfma_f32_16x16x32_bf16 v[132:135], v[72:75], v[116:119], 0
    v_mfma_f32_16x16x32_bf16 v[136:139], v[76:79], v[116:119], 0
    v_mfma_f32_16x16x16_bf16 v[124:127], v[96:97], v[8:9], v[124:127]
    v_mfma_f32_16x16x16_bf16 v[128:131], v[96:97], v[10:11], v[128:131]
    v_mfma_f32_16x16x16_bf16 v[132:135], v[98:99], v[8:9], v[132:135]
    v_mfma_f32_16x16x16_bf16 v[136:139], v[98:99], v[10:11], v[136:139]
    v_add_f32 v120, v108, v109
    v_add_f32 v120, v120, v110
    v_add_f32 v120, v120, v111
    v_add_f32 v120, v120, v112
    v_add_f32 v120, v120, v113
    v_add_f32 v120, v120, v114
    v_add_f32 v120, v120, v115
    v_add_f32 v120, v120, v104
    v_add_f32 v120, v120, v105
    v_mov_b32 v121, v120
    s_nop 1
    v_permlane16_swap_b32 v120, v121
    v_add_f32 v120, v120, v121
    v_mov_b32 v121, v120
    s_nop 1
    v_permlane32_swap_b32 v120, v121
    v_add_f32 v120, v120, v121
    v_rcp_f32 v120, v120
    s_nop 0
    v_mul_f32 v120, v120, v100
    v_mul_f32 v124, v124, v120
    v_mul_f32 v125, v125, v120
    v_mul_f32 v126, v126, v120
    v_mul_f32 v127, v127, v120
    v_mul_f32 v128, v128, v120
    v_mul_f32 v129, v129, v120
    v_mul_f32 v130, v130, v120
    v_mul_f32 v131, v131, v120
    v_cvt_pk_bf16_f32 v240, v124, v125
    v_cvt_pk_bf16_f32 v241, v126, v127
    v_cvt_pk_bf16_f32 v242, v128, v129
    v_cvt_pk_bf16_f32 v243, v130, v131
    buffer_store_dwordx4 v[240:243], v4, s[4:7], s18 offen offset:256 sc1
    v_mul_f32 v132, v132, v120
    v_mul_f32 v133, v133, v120
    v_mul_f32 v134, v134, v120
    v_mul_f32 v135, v135, v120
    v_mul_f32 v136, v136, v120
    v_mul_f32 v137, v137, v120
    v_mul_f32 v138, v138, v120
    v_mul_f32 v139, v139, v120
    v_cvt_pk_bf16_f32 v244, v132, v133
    v_cvt_pk_bf16_f32 v245, v134, v135
    v_cvt_pk_bf16_f32 v246, v136, v137
    v_cvt_pk_bf16_f32 v247, v138, v139
    buffer_store_dwordx4 v[244:247], v4, s[4:7], s18 offen offset:2304 sc1
    s_lshl_b32 s33, s16, 2
    s_add_u32 s33, s33, 95428608
    s_add_u32 s59, s59, 4
    s_cmp_lt_u32 s59, 64
    s_cbranch_scc0 T5_18_1_last
    s_lshl_b32 s16, s59, 5
    s_add_u32 s16, s16, s61
    s_lshl_b32 s17, s16, 13
    s_lshl_b32 s32, s59, 13
    s_lshl_b32 s19, s62, 11
    s_add_u32 s32, s32, s19
    s_add_u32 s32, s32, 50855936
    buffer_load_dwordx4 v[144:147], v1, s[4:7], s32 offen offset:0 sc1
    buffer_load_dwordx4 v[148:151], v1, s[4:7], s32 offen offset:1024 sc1
    s_add_u32 s18, s17, 4096
    buffer_load_dwordx4 v[16:19], v1, s[4:7], s18 offen offset:0 sc1
    buffer_load_dwordx4 v[20:23], v1, s[4:7], s18 offen offset:1024 sc1
    buffer_load_dwordx4 v[24:27], v1, s[4:7], s18 offen offset:2048 sc1
    buffer_load_dwordx4 v[28:31], v1, s[4:7], s18 offen offset:3072 sc1
    s_add_u32 s18, s17, 16777216
    buffer_load_dwordx4 v[32:35], v1, s[4:7], s18 offen offset:0 sc1
    buffer_load_dwordx4 v[36:39], v1, s[4:7], s18 offen offset:1024 sc1
    buffer_load_dwordx4 v[40:43], v1, s[4:7], s18 offen offset:2048 sc1
    buffer_load_dwordx4 v[44:47], v1, s[4:7], s18 offen offset:3072 sc1
    s_add_u32 s18, s17, 16781312
    buffer_load_dwordx4 v[48:51], v1, s[4:7], s18 offen offset:0 sc1
    buffer_load_dwordx4 v[52:55], v1, s[4:7], s18 offen offset:1024 sc1
    buffer_load_dwordx4 v[56:59], v1, s[4:7], s18 offen offset:2048 sc1
    buffer_load_dwordx4 v[60:63], v1, s[4:7], s18 offen offset:3072 sc1
    s_lshl_b32 s18, s23, 12
    s_add_u32 s18, s18, s17
    s_add_u32 s18, s18, 33554432
    buffer_load_dwordx4 v[64:67], v1, s[4:7], s18 offen offset:0 sc1
    buffer_load_dwordx4 v[68:71], v1, s[4:7], s18 offen offset:1024 sc1
    buffer_load_dwordx4 v[72:75], v1, s[4:7], s18 offen offset:2048 sc1
    buffer_load_dwordx4 v[76:79], v1, s[4:7], s18 offen offset:3072 sc1
    s_lshl_b32 s18, s59, 8
    s_add_u32 s18, s18, 71303168
    buffer_load_dword v100, v3, s[4:7], s18 offen offset:128 sc1
    s_waitcnt vmcnt(19) lgkmcnt(0)
    s_barrier
    s_cmp_eq_u32 s62, 0
    s_cbranch_scc0 SG_21
    v_mov_b32 v254, 1
    s_mov_b64 exec, 1
    buffer_store_dword v254, off, s[4:7], s33 sc1
    s_mov_b64 exec, -1
SG_21:
    s_branch T5_18_1_loop
T5_18_1_last:
    s_waitcnt vmcnt(0) lgkmcnt(0)
    s_barrier
    s_cmp_eq_u32 s62, 0
    s_cbranch_scc0 SG_22
    v_mov_b32 v254, 1
    s_mov_b64 exec, 1
    buffer_store_dword v254, off, s[4:7], s33 sc1
    s_mov_b64 exec, -1
SG_22:
T5_18_end:
    s_branch L_wend
L_t6:
    s_sub_u32 s59, s60, 128
    s_and_b32 s61, s59, 15
    s_lshr_b32 s59, s59, 4
    s_load_dwordx2 s[8:9], s[0:1], 40
    s_load_dwordx2 s[12:13], s[0:1], 72
    s_mov_b32 s10, 4194304
    s_mov_b32 s11, 0x20000
    s_mov_b32 s14, 524288
    s_mov_b32 s15, 0x20000
    v_lshlrev_b32 v1, 4, v0
    v_lshrrev_b32 v2, 2, v0
    v_lshlrev_b32 v2, 10, v2
    v_and_b32 v3, 3, v0
    v_lshl_add_u32 v2, v3, 4, v2
    s_lshl_b32 s16, s61, 6
    v_add_u32 v2, s16, v2
    s_mul_i32 s17, s62, 36864
    v_lshrrev_b32 v4, 5, v0
    v_lshlrev_b32 v4, 8, v4
    v_bfe_u32 v5, v0, 2, 2
    v_lshl_add_u32 v4, v5, 6, v4
    v_bfe_u32 v5, v0, 4, 1
    v_lshl_add_u32 v4, v5, 5, v4
    v_lshl_add_u32 v4, v3, 3, v4
    v_add_u32 v4, s17, v4
    s_mul_i32 s18, s62, 1179648
    s_waitcnt lgkmcnt(0)
    s_cmp_eq_u32 s62, 3
    s_cbranch_scc1 T6_23_w3
    s_add_u32 m0, s17, 0
    s_add_u32 s19, s18, 0
    buffer_load_dwordx4 v2, s[8:11], s19 offen lds
    s_add_u32 m0, s17, 1024
    s_add_u32 s19, s18, 16384
    buffer_load_dwordx4 v2, s[8:11], s19 offen lds
    s_add_u32 m0, s17, 2048
    s_add_u32 s19, s18, 32768
    buffer_load_dwordx4 v2, s[8:11], s19 offen lds
    s_add_u32 m0, s17, 3072
    s_add_u32 s19, s18, 49152
    buffer_load_dwordx4 v2, s[8:11], s19 offen lds
    s_add_u32 m0, s17, 4096
    s_add_u32 s19, s18, 65536
    buffer_load_dwordx4 v2, s[8:11], s19 offen lds
    s_add_u32 m0, s17, 5120
    s_add_u32 s19, s18, 81920
    buffer_load_dwordx4 v2, s[8:11], s19 offen lds
    s_add_u32 m0, s17, 6144
    s_add_u32 s19, s18, 98304
    buffer_load_dwordx4 v2, s[8:11], s19 offen lds
    s_add_u32 m0, s17, 7168
    s_add_u32 s19, s18, 114688
    buffer_load_dwordx4 v2, s[8:11], s19 offen lds
    s_add_u32 m0, s17, 8192
    s_add_u32 s19, s18, 131072
    buffer_load_dwordx4 v2, s[8:11], s19 offen lds
    s_add_u32 m0, s17, 9216
    s_add_u32 s19, s18, 147456
    buffer_load_dwordx4 v2, s[8:11], s19 offen lds
    s_add_u32 m0, s17, 10240
    s_add_u32 s19, s18, 163840
    buffer_load_dwordx4 v2, s[8:11], s19 offen lds
    s_add_u32 m0, s17, 11264
    s_add_u32 s19, s18, 180224
    buffer_load_dwordx4 v2, s[8:11], s19 offen lds
    s_add_u32 m0, s17, 12288
    s_add_u32 s19, s18, 196608
    buffer_load_dwordx4 v2, s[8:11], s19 offen lds
    s_add_u32 m0, s17, 13312
    s_add_u32 s19, s18, 212992
    buffer_load_dwordx4 v2, s[8:11], s19 offen lds
    s_add_u32 m0, s17, 14336
    s_add_u32 s19, s18, 229376
    buffer_load_dwordx4 v2, s[8:11], s19 offen lds
    s_add_u32 m0, s17, 15360
    s_add_u32 s19, s18, 245760
    buffer_load_dwordx4 v2, s[8:11], s19 offen lds
    s_add_u32 m0, s17, 16384
    s_add_u32 s19, s18, 262144
    buffer_load_dwordx4 v2, s[8:11], s19 offen lds
    s_add_u32 m0, s17, 17408
    s_add_u32 s19, s18, 278528
    buffer_load_dwordx4 v2, s[8:11], s19 offen lds
    s_add_u32 m0, s17, 18432
    s_add_u32 s19, s18, 294912
    buffer_load_dwordx4 v2, s[8:11], s19 offen lds
    s_add_u32 m0, s17, 19456
    s_add_u32 s19, s18, 311296
    buffer_load_dwordx4 v2, s[8:11], s19 offen lds
    s_add_u32 m0, s17, 20480
    s_add_u32 s19, s18, 327680
    buffer_load_dwordx4 v2, s[8:11], s19 offen lds
    s_add_u32 m0, s17, 21504
    s_add_u32 s19, s18, 344064
    buffer_load_dwordx4 v2, s[8:11], s19 offen lds
    s_add_u32 m0, s17, 22528
    s_add_u32 s19, s18, 360448
    buffer_load_dwordx4 v2, s[8:11], s19 offen lds
    s_add_u32 m0, s17, 23552
    s_add_u32 s19, s18, 376832
    buffer_load_dwordx4 v2, s[8:11], s19 offen lds
    s_add_u32 m0, s17, 24576
    s_add_u32 s19, s18, 393216
    buffer_load_dwordx4 v2, s[8:11], s19 offen lds
    s_add_u32 m0, s17, 25600
    s_add_u32 s19, s18, 409600
    buffer_load_dwordx4 v2, s[8:11], s19 offen lds
    s_add_u32 m0, s17, 26624
    s_add_u32 s19, s18, 425984
    buffer_load_dwordx4 v2, s[8:11], s19 offen lds
    s_add_u32 m0, s17, 27648
    s_add_u32 s19, s18, 442368
    buffer_load_dwordx4 v2, s[8:11], s19 offen lds
    s_add_u32 m0, s17, 28672
    s_add_u32 s19, s18, 458752
    buffer_load_dwordx4 v2, s[8:11], s19 offen lds
    s_add_u32 m0, s17, 29696
    s_add_u32 s19, s18, 475136
    buffer_load_dwordx4 v2, s[8:11], s19 offen lds
    s_add_u32 m0, s17, 30720
    s_add_u32 s19, s18, 491520
    buffer_load_dwordx4 v2, s[8:11], s19 offen lds
    s_add_u32 m0, s17, 31744
    s_add_u32 s19, s18, 507904
    buffer_load_dwordx4 v2, s[8:11], s19 offen lds
    s_add_u32 m0, s17, 32768
    s_add_u32 s19, s18, 524288
    buffer_load_dwordx4 v2, s[8:11], s19 offen lds
    s_add_u32 m0, s17, 33792
    s_add_u32 s19, s18, 540672
    buffer_load_dwordx4 v2, s[8:11], s19 offen lds
    s_add_u32 m0, s17, 34816
    s_add_u32 s19, s18, 557056
    buffer_load_dwordx4 v2, s[8:11], s19 offen lds
    s_add_u32 m0, s17, 35840
    s_add_u32 s19, s18, 573440
    buffer_load_dwordx4 v2, s[8:11], s19 offen lds
    s_waitcnt vmcnt(0)
    ds_read_b64_tr_b16 a[0:1], v4 offset:0
    ds_read_b64_tr_b16 a[2:3], v4 offset:1024
    ds_read_b64_tr_b16 a[4:5], v4 offset:512
    ds_read_b64_tr_b16 a[6:7], v4 offset:1536
    ds_read_b64_tr_b16 a[8:9], v4 offset:2048
    ds_read_b64_tr_b16 a[10:11], v4 offset:3072
    ds_read_b64_tr_b16 a[12:13], v4 offset:2560
    ds_read_b64_tr_b16 a[14:15], v4 offset:3584
    ds_read_b64_tr_b16 a[16:17], v4 offset:4096
    ds_read_b64_tr_b16 a[18:19], v4 offset:5120
    ds_read_b64_tr_b16 a[20:21], v4 offset:4608
    ds_read_b64_tr_b16 a[22:23], v4 offset:5632
    ds_read_b64_tr_b16 a[24:25], v4 offset:6144
    ds_read_b64_tr_b16 a[26:27], v4 offset:7168
    ds_read_b64_tr_b16 a[28:29], v4 offset:6656
    ds_read_b64_tr_b16 a[30:31], v4 offset:7680
    ds_read_b64_tr_b16 a[32:33], v4 offset:8192
    ds_read_b64_tr_b16 a[34:35], v4 offset:9216
    ds_read_b64_tr_b16 a[36:37], v4 offset:8704
    ds_read_b64_tr_b16 a[38:39], v4 offset:9728
    ds_read_b64_tr_b16 a[40:41], v4 offset:10240
    ds_read_b64_tr_b16 a[42:43], v4 offset:11264
    ds_read_b64_tr_b16 a[44:45], v4 offset:10752
    ds_read_b64_tr_b16 a[46:47], v4 offset:11776
    ds_read_b64_tr_b16 a[48:49], v4 offset:12288
    ds_read_b64_tr_b16 a[50:51], v4 offset:13312
    ds_read_b64_tr_b16 a[52:53], v4 offset:12800
    ds_read_b64_tr_b16 a[54:55], v4 offset:13824
    ds_read_b64_tr_b16 a[56:57], v4 offset:14336
    ds_read_b64_tr_b16 a[58:59], v4 offset:15360
    ds_read_b64_tr_b16 a[60:61], v4 offset:14848
    ds_read_b64_tr_b16 a[62:63], v4 offset:15872
    ds_read_b64_tr_b16 a[64:65], v4 offset:16384
    ds_read_b64_tr_b16 a[66:67], v4 offset:17408
    ds_read_b64_tr_b16 a[68:69], v4 offset:16896
    ds_read_b64_tr_b16 a[70:71], v4 offset:17920
    ds_read_b64_tr_b16 a[72:73], v4 offset:18432
    ds_read_b64_tr_b16 a[74:75], v4 offset:19456
    ds_read_b64_tr_b16 a[76:77], v4 offset:18944
    ds_read_b64_tr_b16 a[78:79], v4 offset:19968
    ds_read_b64_tr_b16 a[80:81], v4 offset:20480
    ds_read_b64_tr_b16 a[82:83], v4 offset:21504
    ds_read_b64_tr_b16 a[84:85], v4 offset:20992
    ds_read_b64_tr_b16 a[86:87], v4 offset:22016
    ds_read_b64_tr_b16 a[88:89], v4 offset:22528
    ds_read_b64_tr_b16 a[90:91], v4 offset:23552
    ds_read_b64_tr_b16 a[92:93], v4 offset:23040
    ds_read_b64_tr_b16 a[94:95], v4 offset:24064
    ds_read_b64_tr_b16 a[96:97], v4 offset:24576
    ds_read_b64_tr_b16 a[98:99], v4 offset:25600
    ds_read_b64_tr_b16 a[100:101], v4 offset:25088
    ds_read_b64_tr_b16 a[102:103], v4 offset:26112
    ds_read_b64_tr_b16 a[104:105], v4 offset:26624
    ds_read_b64_tr_b16 a[106:107], v4 offset:27648
    ds_read_b64_tr_b16 a[108:109], v4 offset:27136
    ds_read_b64_tr_b16 a[110:111], v4 offset:28160
    ds_read_b64_tr_b16 a[112:113], v4 offset:28672
    ds_read_b64_tr_b16 a[114:115], v4 offset:29696
    ds_read_b64_tr_b16 a[116:117], v4 offset:29184
    ds_read_b64_tr_b16 a[118:119], v4 offset:30208
    ds_read_b64_tr_b16 a[120:121], v4 offset:30720
    ds_read_b64_tr_b16 a[122:123], v4 offset:31744
    ds_read_b64_tr_b16 a[124:125], v4 offset:31232
    ds_read_b64_tr_b16 a[126:127], v4 offset:32256
    ds_read_b64_tr_b16 a[128:129], v4 offset:32768
    ds_read_b64_tr_b16 a[130:131], v4 offset:33792
    ds_read_b64_tr_b16 a[132:133], v4 offset:33280
    ds_read_b64_tr_b16 a[134:135], v4 offset:34304
    ds_read_b64_tr_b16 a[136:137], v4 offset:34816
    ds_read_b64_tr_b16 a[138:139], v4 offset:35840
    ds_read_b64_tr_b16 a[140:141], v4 offset:35328
    ds_read_b64_tr_b16 a[142:143], v4 offset:36352
    s_waitcnt lgkmcnt(0)
    s_add_u32 m0, s17, 0
    s_add_u32 s19, s18, 589824
    buffer_load_dwordx4 v2, s[8:11], s19 offen lds
    s_add_u32 m0, s17, 1024
    s_add_u32 s19, s18, 606208
    buffer_load_dwordx4 v2, s[8:11], s19 offen lds
    s_add_u32 m0, s17, 2048
    s_add_u32 s19, s18, 622592
    buffer_load_dwordx4 v2, s[8:11], s19 offen lds
    s_add_u32 m0, s17, 3072
    s_add_u32 s19, s18, 638976
    buffer_load_dwordx4 v2, s[8:11], s19 offen lds
    s_add_u32 m0, s17, 4096
    s_add_u32 s19, s18, 655360
    buffer_load_dwordx4 v2, s[8:11], s19 offen lds
    s_add_u32 m0, s17, 5120
    s_add_u32 s19, s18, 671744
    buffer_load_dwordx4 v2, s[8:11], s19 offen lds
    s_add_u32 m0, s17, 6144
    s_add_u32 s19, s18, 688128
    buffer_load_dwordx4 v2, s[8:11], s19 offen lds
    s_add_u32 m0, s17, 7168
    s_add_u32 s19, s18, 704512
    buffer_load_dwordx4 v2, s[8:11], s19 offen lds
    s_add_u32 m0, s17, 8192
    s_add_u32 s19, s18, 720896
    buffer_load_dwordx4 v2, s[8:11], s19 offen lds
    s_add_u32 m0, s17, 9216
    s_add_u32 s19, s18, 737280
    buffer_load_dwordx4 v2, s[8:11], s19 offen lds
    s_add_u32 m0, s17, 10240
    s_add_u32 s19, s18, 753664
    buffer_load_dwordx4 v2, s[8:11], s19 offen lds
    s_add_u32 m0, s17, 11264
    s_add_u32 s19, s18, 770048
    buffer_load_dwordx4 v2, s[8:11], s19 offen lds
    s_add_u32 m0, s17, 12288
    s_add_u32 s19, s18, 786432
    buffer_load_dwordx4 v2, s[8:11], s19 offen lds
    s_add_u32 m0, s17, 13312
    s_add_u32 s19, s18, 802816
    buffer_load_dwordx4 v2, s[8:11], s19 offen lds
    s_add_u32 m0, s17, 14336
    s_add_u32 s19, s18, 819200
    buffer_load_dwordx4 v2, s[8:11], s19 offen lds
    s_add_u32 m0, s17, 15360
    s_add_u32 s19, s18, 835584
    buffer_load_dwordx4 v2, s[8:11], s19 offen lds
    s_add_u32 m0, s17, 16384
    s_add_u32 s19, s18, 851968
    buffer_load_dwordx4 v2, s[8:11], s19 offen lds
    s_add_u32 m0, s17, 17408
    s_add_u32 s19, s18, 868352
    buffer_load_dwordx4 v2, s[8:11], s19 offen lds
    s_add_u32 m0, s17, 18432
    s_add_u32 s19, s18, 884736
    buffer_load_dwordx4 v2, s[8:11], s19 offen lds
    s_add_u32 m0, s17, 19456
    s_add_u32 s19, s18, 901120
    buffer_load_dwordx4 v2, s[8:11], s19 offen lds
    s_add_u32 m0, s17, 20480
    s_add_u32 s19, s18, 917504
    buffer_load_dwordx4 v2, s[8:11], s19 offen lds
    s_add_u32 m0, s17, 21504
    s_add_u32 s19, s18, 933888
    buffer_load_dwordx4 v2, s[8:11], s19 offen lds
    s_add_u32 m0, s17, 22528
    s_add_u32 s19, s18, 950272
    buffer_load_dwordx4 v2, s[8:11], s19 offen lds
    s_add_u32 m0, s17, 23552
    s_add_u32 s19, s18, 966656
    buffer_load_dwordx4 v2, s[8:11], s19 offen lds
    s_add_u32 m0, s17, 24576
    s_add_u32 s19, s18, 983040
    buffer_load_dwordx4 v2, s[8:11], s19 offen lds
    s_add_u32 m0, s17, 25600
    s_add_u32 s19, s18, 999424
    buffer_load_dwordx4 v2, s[8:11], s19 offen lds
    s_add_u32 m0, s17, 26624
    s_add_u32 s19, s18, 1015808
    buffer_load_dwordx4 v2, s[8:11], s19 offen lds
    s_add_u32 m0, s17, 27648
    s_add_u32 s19, s18, 1032192
    buffer_load_dwordx4 v2, s[8:11], s19 offen lds
    s_add_u32 m0, s17, 28672
    s_add_u32 s19, s18, 1048576
    buffer_load_dwordx4 v2, s[8:11], s19 offen lds
    s_add_u32 m0, s17, 29696
    s_add_u32 s19, s18, 1064960
    buffer_load_dwordx4 v2, s[8:11], s19 offen lds
    s_add_u32 m0, s17, 30720
    s_add_u32 s19, s18, 1081344
    buffer_load_dwordx4 v2, s[8:11], s19 offen lds
    s_add_u32 m0, s17, 31744
    s_add_u32 s19, s18, 1097728
    buffer_load_dwordx4 v2, s[8:11], s19 offen lds
    s_add_u32 m0, s17, 32768
    s_add_u32 s19, s18, 1114112
    buffer_load_dwordx4 v2, s[8:11], s19 offen lds
    s_add_u32 m0, s17, 33792
    s_add_u32 s19, s18, 1130496
    buffer_load_dwordx4 v2, s[8:11], s19 offen lds
    s_add_u32 m0, s17, 34816
    s_add_u32 s19, s18, 1146880
    buffer_load_dwordx4 v2, s[8:11], s19 offen lds
    s_add_u32 m0, s17, 35840
    s_add_u32 s19, s18, 1163264
    buffer_load_dwordx4 v2, s[8:11], s19 offen lds
    s_waitcnt vmcnt(0)
    ds_read_b64_tr_b16 a[144:145], v4 offset:0
    ds_read_b64_tr_b16 a[146:147], v4 offset:1024
    ds_read_b64_tr_b16 a[148:149], v4 offset:512
    ds_read_b64_tr_b16 a[150:151], v4 offset:1536
    ds_read_b64_tr_b16 a[152:153], v4 offset:2048
    ds_read_b64_tr_b16 a[154:155], v4 offset:3072
    ds_read_b64_tr_b16 a[156:157], v4 offset:2560
    ds_read_b64_tr_b16 a[158:159], v4 offset:3584
    ds_read_b64_tr_b16 a[160:161], v4 offset:4096
    ds_read_b64_tr_b16 a[162:163], v4 offset:5120
    ds_read_b64_tr_b16 a[164:165], v4 offset:4608
    ds_read_b64_tr_b16 a[166:167], v4 offset:5632
    ds_read_b64_tr_b16 a[168:169], v4 offset:6144
    ds_read_b64_tr_b16 a[170:171], v4 offset:7168
    ds_read_b64_tr_b16 a[172:173], v4 offset:6656
    ds_read_b64_tr_b16 a[174:175], v4 offset:7680
    ds_read_b64_tr_b16 a[176:177], v4 offset:8192
    ds_read_b64_tr_b16 a[178:179], v4 offset:9216
    ds_read_b64_tr_b16 a[180:181], v4 offset:8704
    ds_read_b64_tr_b16 a[182:183], v4 offset:9728
    ds_read_b64_tr_b16 a[184:185], v4 offset:10240
    ds_read_b64_tr_b16 a[186:187], v4 offset:11264
    ds_read_b64_tr_b16 a[188:189], v4 offset:10752
    ds_read_b64_tr_b16 a[190:191], v4 offset:11776
    ds_read_b64_tr_b16 a[192:193], v4 offset:12288
    ds_read_b64_tr_b16 a[194:195], v4 offset:13312
    ds_read_b64_tr_b16 a[196:197], v4 offset:12800
    ds_read_b64_tr_b16 a[198:199], v4 offset:13824
    ds_read_b64_tr_b16 a[200:201], v4 offset:14336
    ds_read_b64_tr_b16 a[202:203], v4 offset:15360
    ds_read_b64_tr_b16 a[204:205], v4 offset:14848
    ds_read_b64_tr_b16 a[206:207], v4 offset:15872
    ds_read_b64_tr_b16 a[208:209], v4 offset:16384
    ds_read_b64_tr_b16 a[210:211], v4 offset:17408
    ds_read_b64_tr_b16 a[212:213], v4 offset:16896
    ds_read_b64_tr_b16 a[214:215], v4 offset:17920
    ds_read_b64_tr_b16 a[216:217], v4 offset:18432
    ds_read_b64_tr_b16 a[218:219], v4 offset:19456
    ds_read_b64_tr_b16 a[220:221], v4 offset:18944
    ds_read_b64_tr_b16 a[222:223], v4 offset:19968
    ds_read_b64_tr_b16 a[224:225], v4 offset:20480
    ds_read_b64_tr_b16 a[226:227], v4 offset:21504
    ds_read_b64_tr_b16 a[228:229], v4 offset:20992
    ds_read_b64_tr_b16 a[230:231], v4 offset:22016
    ds_read_b64_tr_b16 a[232:233], v4 offset:22528
    ds_read_b64_tr_b16 a[234:235], v4 offset:23552
    ds_read_b64_tr_b16 a[236:237], v4 offset:23040
    ds_read_b64_tr_b16 a[238:239], v4 offset:24064
    ds_read_b64_tr_b16 a[240:241], v4 offset:24576
    ds_read_b64_tr_b16 a[242:243], v4 offset:25600
    ds_read_b64_tr_b16 a[244:245], v4 offset:25088
    ds_read_b64_tr_b16 a[246:247], v4 offset:26112
    ds_read_b64_tr_b16 a[248:249], v4 offset:26624
    ds_read_b64_tr_b16 a[250:251], v4 offset:27648
    ds_read_b64_tr_b16 a[252:253], v4 offset:27136
    ds_read_b64_tr_b16 a[254:255], v4 offset:28160
    ds_read_b64_tr_b16 v[224:225], v4 offset:28672
    ds_read_b64_tr_b16 v[226:227], v4 offset:29696
    ds_read_b64_tr_b16 v[228:229], v4 offset:29184
    ds_read_b64_tr_b16 v[230:231], v4 offset:30208
    ds_read_b64_tr_b16 v[232:233], v4 offset:30720
    ds_read_b64_tr_b16 v[234:235], v4 offset:31744
    ds_read_b64_tr_b16 v[236:237], v4 offset:31232
    ds_read_b64_tr_b16 v[238:239], v4 offset:32256
    ds_read_b64_tr_b16 v[240:241], v4 offset:32768
    ds_read_b64_tr_b16 v[242:243], v4 offset:33792
    ds_read_b64_tr_b16 v[244:245], v4 offset:33280
    ds_read_b64_tr_b16 v[246:247], v4 offset:34304
    ds_read_b64_tr_b16 v[248:249], v4 offset:34816
    ds_read_b64_tr_b16 v[250:251], v4 offset:35840
    ds_read_b64_tr_b16 v[252:253], v4 offset:35328
    ds_read_b64_tr_b16 v[254:255], v4 offset:36352
    s_waitcnt lgkmcnt(0)
    s_branch T6_23_e
T6_23_w3:
    s_add_u32 m0, s17, 0
    s_add_u32 s19, s18, 0
    buffer_load_dwordx4 v2, s[8:11], s19 offen lds
    s_add_u32 m0, s17, 1024
    s_add_u32 s19, s18, 16384
    buffer_load_dwordx4 v2, s[8:11], s19 offen lds
    s_add_u32 m0, s17, 2048
    s_add_u32 s19, s18, 32768
    buffer_load_dwordx4 v2, s[8:11], s19 offen lds
    s_add_u32 m0, s17, 3072
    s_add_u32 s19, s18, 49152
    buffer_load_dwordx4 v2, s[8:11], s19 offen lds
    s_add_u32 m0, s17, 4096
    s_add_u32 s19, s18, 65536
    buffer_load_dwordx4 v2, s[8:11], s19 offen lds
    s_add_u32 m0, s17, 5120
    s_add_u32 s19, s18, 81920
    buffer_load_dwordx4 v2, s[8:11], s19 offen lds
    s_add_u32 m0, s17, 6144
    s_add_u32 s19, s18, 98304
    buffer_load_dwordx4 v2, s[8:11], s19 offen lds
    s_add_u32 m0, s17, 7168
    s_add_u32 s19, s18, 114688
    buffer_load_dwordx4 v2, s[8:11], s19 offen lds
    s_add_u32 m0, s17, 8192
    s_add_u32 s19, s18, 131072
    buffer_load_dwordx4 v2, s[8:11], s19 offen lds
    s_add_u32 m0, s17, 9216
    s_add_u32 s19, s18, 147456
    buffer_load_dwordx4 v2, s[8:11], s19 offen lds
    s_add_u32 m0, s17, 10240
    s_add_u32 s19, s18, 163840
    buffer_load_dwordx4 v2, s[8:11], s19 offen lds
    s_add_u32 m0, s17, 11264
    s_add_u32 s19, s18, 180224
    buffer_load_dwordx4 v2, s[8:11], s19 offen lds
    s_add_u32 m0, s17, 12288
    s_add_u32 s19, s18, 196608
    buffer_load_dwordx4 v2, s[8:11], s19 offen lds
    s_add_u32 m0, s17, 13312
    s_add_u32 s19, s18, 212992
    buffer_load_dwordx4 v2, s[8:11], s19 offen lds
    s_add_u32 m0, s17, 14336
    s_add_u32 s19, s18, 229376
    buffer_load_dwordx4 v2, s[8:11], s19 offen lds
    s_add_u32 m0, s17, 15360
    s_add_u32 s19, s18, 245760
    buffer_load_dwordx4 v2, s[8:11], s19 offen lds
    s_add_u32 m0, s17, 16384
    s_add_u32 s19, s18, 262144
    buffer_load_dwordx4 v2, s[8:11], s19 offen lds
    s_add_u32 m0, s17, 17408
    s_add_u32 s19, s18, 278528
    buffer_load_dwordx4 v2, s[8:11], s19 offen lds
    s_add_u32 m0, s17, 18432
    s_add_u32 s19, s18, 294912
    buffer_load_dwordx4 v2, s[8:11], s19 offen lds
    s_add_u32 m0, s17, 19456
    s_add_u32 s19, s18, 311296
    buffer_load_dwordx4 v2, s[8:11], s19 offen lds
    s_add_u32 m0, s17, 20480
    s_add_u32 s19, s18, 327680
    buffer_load_dwordx4 v2, s[8:11], s19 offen lds
    s_add_u32 m0, s17, 21504
    s_add_u32 s19, s18, 344064
    buffer_load_dwordx4 v2, s[8:11], s19 offen lds
    s_add_u32 m0, s17, 22528
    s_add_u32 s19, s18, 360448
    buffer_load_dwordx4 v2, s[8:11], s19 offen lds
    s_add_u32 m0, s17, 23552
    s_add_u32 s19, s18, 376832
    buffer_load_dwordx4 v2, s[8:11], s19 offen lds
    s_add_u32 m0, s17, 24576
    s_add_u32 s19, s18, 393216
    buffer_load_dwordx4 v2, s[8:11], s19 offen lds
    s_add_u32 m0, s17, 25600
    s_add_u32 s19, s18, 409600
    buffer_load_dwordx4 v2, s[8:11], s19 offen lds
    s_add_u32 m0, s17, 26624
    s_add_u32 s19, s18, 425984
    buffer_load_dwordx4 v2, s[8:11], s19 offen lds
    s_add_u32 m0, s17, 27648
    s_add_u32 s19, s18, 442368
    buffer_load_dwordx4 v2, s[8:11], s19 offen lds
    s_add_u32 m0, s17, 28672
    s_add_u32 s19, s18, 458752
    buffer_load_dwordx4 v2, s[8:11], s19 offen lds
    s_add_u32 m0, s17, 29696
    s_add_u32 s19, s18, 475136
    buffer_load_dwordx4 v2, s[8:11], s19 offen lds
    s_add_u32 m0, s17, 30720
    s_add_u32 s19, s18, 491520
    buffer_load_dwordx4 v2, s[8:11], s19 offen lds
    s_add_u32 m0, s17, 31744
    s_add_u32 s19, s18, 507904
    buffer_load_dwordx4 v2, s[8:11], s19 offen lds
    s_add_u32 m0, s17, 32768
    s_add_u32 s19, s18, 524288
    buffer_load_dwordx4 v2, s[8:11], s19 offen lds
    s_add_u32 m0, s17, 33792
    s_add_u32 s19, s18, 540672
    buffer_load_dwordx4 v2, s[8:11], s19 offen lds
    s_add_u32 m0, s17, 34816
    s_add_u32 s19, s18, 557056
    buffer_load_dwordx4 v2, s[8:11], s19 offen lds
    s_add_u32 m0, s17, 35840
    s_add_u32 s19, s18, 573440
    buffer_load_dwordx4 v2, s[8:11], s19 offen lds
    s_waitcnt vmcnt(0)
    ds_read_b64_tr_b16 a[0:1], v4 offset:0
    ds_read_b64_tr_b16 a[2:3], v4 offset:1024
    ds_read_b64_tr_b16 a[4:5], v4 offset:512
    ds_read_b64_tr_b16 a[6:7], v4 offset:1536
    ds_read_b64_tr_b16 a[8:9], v4 offset:2048
    ds_read_b64_tr_b16 a[10:11], v4 offset:3072
    ds_read_b64_tr_b16 a[12:13], v4 offset:2560
    ds_read_b64_tr_b16 a[14:15], v4 offset:3584
    ds_read_b64_tr_b16 a[16:17], v4 offset:4096
    ds_read_b64_tr_b16 a[18:19], v4 offset:5120
    ds_read_b64_tr_b16 a[20:21], v4 offset:4608
    ds_read_b64_tr_b16 a[22:23], v4 offset:5632
    ds_read_b64_tr_b16 a[24:25], v4 offset:6144
    ds_read_b64_tr_b16 a[26:27], v4 offset:7168
    ds_read_b64_tr_b16 a[28:29], v4 offset:6656
    ds_read_b64_tr_b16 a[30:31], v4 offset:7680
    ds_read_b64_tr_b16 a[32:33], v4 offset:8192
    ds_read_b64_tr_b16 a[34:35], v4 offset:9216
    ds_read_b64_tr_b16 a[36:37], v4 offset:8704
    ds_read_b64_tr_b16 a[38:39], v4 offset:9728
    ds_read_b64_tr_b16 a[40:41], v4 offset:10240
    ds_read_b64_tr_b16 a[42:43], v4 offset:11264
    ds_read_b64_tr_b16 a[44:45], v4 offset:10752
    ds_read_b64_tr_b16 a[46:47], v4 offset:11776
    ds_read_b64_tr_b16 a[48:49], v4 offset:12288
    ds_read_b64_tr_b16 a[50:51], v4 offset:13312
    ds_read_b64_tr_b16 a[52:53], v4 offset:12800
    ds_read_b64_tr_b16 a[54:55], v4 offset:13824
    ds_read_b64_tr_b16 a[56:57], v4 offset:14336
    ds_read_b64_tr_b16 a[58:59], v4 offset:15360
    ds_read_b64_tr_b16 a[60:61], v4 offset:14848
    ds_read_b64_tr_b16 a[62:63], v4 offset:15872
    ds_read_b64_tr_b16 a[64:65], v4 offset:16384
    ds_read_b64_tr_b16 a[66:67], v4 offset:17408
    ds_read_b64_tr_b16 a[68:69], v4 offset:16896
    ds_read_b64_tr_b16 a[70:71], v4 offset:17920
    ds_read_b64_tr_b16 a[72:73], v4 offset:18432
    ds_read_b64_tr_b16 a[74:75], v4 offset:19456
    ds_read_b64_tr_b16 a[76:77], v4 offset:18944
    ds_read_b64_tr_b16 a[78:79], v4 offset:19968
    ds_read_b64_tr_b16 a[80:81], v4 offset:20480
    ds_read_b64_tr_b16 a[82:83], v4 offset:21504
    ds_read_b64_tr_b16 a[84:85], v4 offset:20992
    ds_read_b64_tr_b16 a[86:87], v4 offset:22016
    ds_read_b64_tr_b16 a[88:89], v4 offset:22528
    ds_read_b64_tr_b16 a[90:91], v4 offset:23552
    ds_read_b64_tr_b16 a[92:93], v4 offset:23040
    ds_read_b64_tr_b16 a[94:95], v4 offset:24064
    ds_read_b64_tr_b16 a[96:97], v4 offset:24576
    ds_read_b64_tr_b16 a[98:99], v4 offset:25600
    ds_read_b64_tr_b16 a[100:101], v4 offset:25088
    ds_read_b64_tr_b16 a[102:103], v4 offset:26112
    ds_read_b64_tr_b16 a[104:105], v4 offset:26624
    ds_read_b64_tr_b16 a[106:107], v4 offset:27648
    ds_read_b64_tr_b16 a[108:109], v4 offset:27136
    ds_read_b64_tr_b16 a[110:111], v4 offset:28160
    ds_read_b64_tr_b16 a[112:113], v4 offset:28672
    ds_read_b64_tr_b16 a[114:115], v4 offset:29696
    ds_read_b64_tr_b16 a[116:117], v4 offset:29184
    ds_read_b64_tr_b16 a[118:119], v4 offset:30208
    ds_read_b64_tr_b16 a[120:121], v4 offset:30720
    ds_read_b64_tr_b16 a[122:123], v4 offset:31744
    ds_read_b64_tr_b16 a[124:125], v4 offset:31232
    ds_read_b64_tr_b16 a[126:127], v4 offset:32256
    ds_read_b64_tr_b16 a[128:129], v4 offset:32768
    ds_read_b64_tr_b16 a[130:131], v4 offset:33792
    ds_read_b64_tr_b16 a[132:133], v4 offset:33280
    ds_read_b64_tr_b16 a[134:135], v4 offset:34304
    ds_read_b64_tr_b16 a[136:137], v4 offset:34816
    ds_read_b64_tr_b16 a[138:139], v4 offset:35840
    ds_read_b64_tr_b16 a[140:141], v4 offset:35328
    ds_read_b64_tr_b16 a[142:143], v4 offset:36352
    s_waitcnt lgkmcnt(0)
    s_add_u32 m0, s17, 0
    s_add_u32 s19, s18, 589824
    buffer_load_dwordx4 v2, s[8:11], s19 offen lds
    s_add_u32 m0, s17, 1024
    s_add_u32 s19, s18, 606208
    buffer_load_dwordx4 v2, s[8:11], s19 offen lds
    s_add_u32 m0, s17, 2048
    s_add_u32 s19, s18, 622592
    buffer_load_dwordx4 v2, s[8:11], s19 offen lds
    s_add_u32 m0, s17, 3072
    s_add_u32 s19, s18, 638976
    buffer_load_dwordx4 v2, s[8:11], s19 offen lds
    s_add_u32 m0, s17, 4096
    s_mov_b32 s19, 0
    buffer_load_dwordx4 v2, s[12:15], s19 offen lds
    s_add_u32 m0, s17, 5120
    s_mov_b32 s19, 16384
    buffer_load_dwordx4 v2, s[12:15], s19 offen lds
    s_add_u32 m0, s17, 6144
    s_mov_b32 s19, 32768
    buffer_load_dwordx4 v2, s[12:15], s19 offen lds
    s_add_u32 m0, s17, 7168
    s_mov_b32 s19, 49152
    buffer_load_dwordx4 v2, s[12:15], s19 offen lds
    s_add_u32 m0, s17, 8192
    s_mov_b32 s19, 65536
    buffer_load_dwordx4 v2, s[12:15], s19 offen lds
    s_add_u32 m0, s17, 9216
    s_mov_b32 s19, 81920
    buffer_load_dwordx4 v2, s[12:15], s19 offen lds
    s_add_u32 m0, s17, 10240
    s_mov_b32 s19, 98304
    buffer_load_dwordx4 v2, s[12:15], s19 offen lds
    s_add_u32 m0, s17, 11264
    s_mov_b32 s19, 114688
    buffer_load_dwordx4 v2, s[12:15], s19 offen lds
    s_add_u32 m0, s17, 12288
    s_mov_b32 s19, 131072
    buffer_load_dwordx4 v2, s[12:15], s19 offen lds
    s_add_u32 m0, s17, 13312
    s_mov_b32 s19, 147456
    buffer_load_dwordx4 v2, s[12:15], s19 offen lds
    s_add_u32 m0, s17, 14336
    s_mov_b32 s19, 163840
    buffer_load_dwordx4 v2, s[12:15], s19 offen lds
    s_add_u32 m0, s17, 15360
    s_mov_b32 s19, 180224
    buffer_load_dwordx4 v2, s[12:15], s19 offen lds
    s_add_u32 m0, s17, 16384
    s_mov_b32 s19, 196608
    buffer_load_dwordx4 v2, s[12:15], s19 offen lds
    s_add_u32 m0, s17, 17408
    s_mov_b32 s19, 212992
    buffer_load_dwordx4 v2, s[12:15], s19 offen lds
    s_add_u32 m0, s17, 18432
    s_mov_b32 s19, 229376
    buffer_load_dwordx4 v2, s[12:15], s19 offen lds
    s_add_u32 m0, s17, 19456
    s_mov_b32 s19, 245760
    buffer_load_dwordx4 v2, s[12:15], s19 offen lds
    s_add_u32 m0, s17, 20480
    s_mov_b32 s19, 262144
    buffer_load_dwordx4 v2, s[12:15], s19 offen lds
    s_add_u32 m0, s17, 21504
    s_mov_b32 s19, 278528
    buffer_load_dwordx4 v2, s[12:15], s19 offen lds
    s_add_u32 m0, s17, 22528
    s_mov_b32 s19, 294912
    buffer_load_dwordx4 v2, s[12:15], s19 offen lds
    s_add_u32 m0, s17, 23552
    s_mov_b32 s19, 311296
    buffer_load_dwordx4 v2, s[12:15], s19 offen lds
    s_add_u32 m0, s17, 24576
    s_mov_b32 s19, 327680
    buffer_load_dwordx4 v2, s[12:15], s19 offen lds
    s_add_u32 m0, s17, 25600
    s_mov_b32 s19, 344064
    buffer_load_dwordx4 v2, s[12:15], s19 offen lds
    s_add_u32 m0, s17, 26624
    s_mov_b32 s19, 360448
    buffer_load_dwordx4 v2, s[12:15], s19 offen lds
    s_add_u32 m0, s17, 27648
    s_mov_b32 s19, 376832
    buffer_load_dwordx4 v2, s[12:15], s19 offen lds
    s_add_u32 m0, s17, 28672
    s_mov_b32 s19, 393216
    buffer_load_dwordx4 v2, s[12:15], s19 offen lds
    s_add_u32 m0, s17, 29696
    s_mov_b32 s19, 409600
    buffer_load_dwordx4 v2, s[12:15], s19 offen lds
    s_add_u32 m0, s17, 30720
    s_mov_b32 s19, 425984
    buffer_load_dwordx4 v2, s[12:15], s19 offen lds
    s_add_u32 m0, s17, 31744
    s_mov_b32 s19, 442368
    buffer_load_dwordx4 v2, s[12:15], s19 offen lds
    s_add_u32 m0, s17, 32768
    s_mov_b32 s19, 458752
    buffer_load_dwordx4 v2, s[12:15], s19 offen lds
    s_add_u32 m0, s17, 33792
    s_mov_b32 s19, 475136
    buffer_load_dwordx4 v2, s[12:15], s19 offen lds
    s_add_u32 m0, s17, 34816
    s_mov_b32 s19, 491520
    buffer_load_dwordx4 v2, s[12:15], s19 offen lds
    s_add_u32 m0, s17, 35840
    s_mov_b32 s19, 507904
    buffer_load_dwordx4 v2, s[12:15], s19 offen lds
    s_waitcnt vmcnt(0)
    ds_read_b64_tr_b16 a[144:145], v4 offset:0
    ds_read_b64_tr_b16 a[146:147], v4 offset:1024
    ds_read_b64_tr_b16 a[148:149], v4 offset:512
    ds_read_b64_tr_b16 a[150:151], v4 offset:1536
    ds_read_b64_tr_b16 a[152:153], v4 offset:2048
    ds_read_b64_tr_b16 a[154:155], v4 offset:3072
    ds_read_b64_tr_b16 a[156:157], v4 offset:2560
    ds_read_b64_tr_b16 a[158:159], v4 offset:3584
    ds_read_b64_tr_b16 a[160:161], v4 offset:4096
    ds_read_b64_tr_b16 a[162:163], v4 offset:4608
    ds_read_b64_tr_b16 a[164:165], v4 offset:5120
    ds_read_b64_tr_b16 a[166:167], v4 offset:5632
    ds_read_b64_tr_b16 a[168:169], v4 offset:6144
    ds_read_b64_tr_b16 a[170:171], v4 offset:6656
    ds_read_b64_tr_b16 a[172:173], v4 offset:7168
    ds_read_b64_tr_b16 a[174:175], v4 offset:7680
    ds_read_b64_tr_b16 a[176:177], v4 offset:8192
    ds_read_b64_tr_b16 a[178:179], v4 offset:8704
    ds_read_b64_tr_b16 a[180:181], v4 offset:9216
    ds_read_b64_tr_b16 a[182:183], v4 offset:9728
    ds_read_b64_tr_b16 a[184:185], v4 offset:10240
    ds_read_b64_tr_b16 a[186:187], v4 offset:10752
    ds_read_b64_tr_b16 a[188:189], v4 offset:11264
    ds_read_b64_tr_b16 a[190:191], v4 offset:11776
    ds_read_b64_tr_b16 a[192:193], v4 offset:12288
    ds_read_b64_tr_b16 a[194:195], v4 offset:12800
    ds_read_b64_tr_b16 a[196:197], v4 offset:13312
    ds_read_b64_tr_b16 a[198:199], v4 offset:13824
    ds_read_b64_tr_b16 a[200:201], v4 offset:14336
    ds_read_b64_tr_b16 a[202:203], v4 offset:14848
    ds_read_b64_tr_b16 a[204:205], v4 offset:15360
    ds_read_b64_tr_b16 a[206:207], v4 offset:15872
    ds_read_b64_tr_b16 a[208:209], v4 offset:16384
    ds_read_b64_tr_b16 a[210:211], v4 offset:16896
    ds_read_b64_tr_b16 a[212:213], v4 offset:17408
    ds_read_b64_tr_b16 a[214:215], v4 offset:17920
    ds_read_b64_tr_b16 a[216:217], v4 offset:18432
    ds_read_b64_tr_b16 a[218:219], v4 offset:18944
    ds_read_b64_tr_b16 a[220:221], v4 offset:19456
    ds_read_b64_tr_b16 a[222:223], v4 offset:19968
    ds_read_b64_tr_b16 a[224:225], v4 offset:20480
    ds_read_b64_tr_b16 a[226:227], v4 offset:20992
    ds_read_b64_tr_b16 a[228:229], v4 offset:21504
    ds_read_b64_tr_b16 a[230:231], v4 offset:22016
    ds_read_b64_tr_b16 a[232:233], v4 offset:22528
    ds_read_b64_tr_b16 a[234:235], v4 offset:23040
    ds_read_b64_tr_b16 a[236:237], v4 offset:23552
    ds_read_b64_tr_b16 a[238:239], v4 offset:24064
    ds_read_b64_tr_b16 a[240:241], v4 offset:24576
    ds_read_b64_tr_b16 a[242:243], v4 offset:25088
    ds_read_b64_tr_b16 a[244:245], v4 offset:25600
    ds_read_b64_tr_b16 a[246:247], v4 offset:26112
    ds_read_b64_tr_b16 a[248:249], v4 offset:26624
    ds_read_b64_tr_b16 a[250:251], v4 offset:27136
    ds_read_b64_tr_b16 a[252:253], v4 offset:27648
    ds_read_b64_tr_b16 a[254:255], v4 offset:28160
    ds_read_b64_tr_b16 v[224:225], v4 offset:28672
    ds_read_b64_tr_b16 v[226:227], v4 offset:29184
    ds_read_b64_tr_b16 v[228:229], v4 offset:29696
    ds_read_b64_tr_b16 v[230:231], v4 offset:30208
    ds_read_b64_tr_b16 v[232:233], v4 offset:30720
    ds_read_b64_tr_b16 v[234:235], v4 offset:31232
    ds_read_b64_tr_b16 v[236:237], v4 offset:31744
    ds_read_b64_tr_b16 v[238:239], v4 offset:32256
    ds_read_b64_tr_b16 v[240:241], v4 offset:32768
    ds_read_b64_tr_b16 v[242:243], v4 offset:33280
    ds_read_b64_tr_b16 v[244:245], v4 offset:33792
    ds_read_b64_tr_b16 v[246:247], v4 offset:34304
    ds_read_b64_tr_b16 v[248:249], v4 offset:34816
    ds_read_b64_tr_b16 v[250:251], v4 offset:35328
    ds_read_b64_tr_b16 v[252:253], v4 offset:35840
    ds_read_b64_tr_b16 v[254:255], v4 offset:36352
    s_waitcnt lgkmcnt(0)
T6_23_e:
    s_load_dwordx2 s[12:13], s[0:1], 88
    s_mov_b32 s14, 2097152
    v_and_b32 v2, 31, v0
    v_lshlrev_b32 v2, 10, v2
    v_lshrrev_b32 v3, 5, v0
    v_lshl_add_u32 v2, v3, 3, v2
    s_lshl_b32 s19, s62, 4
    s_add_u32 s19, s19, s16
    v_add_u32 v2, s19, v2
    s_lshl_b32 s19, s62, 12
    v_add_u32 v3, s19, v1
    s_lshl_b32 s19, s62, 10
    v_add_u32 v4, s19, v1
    s_mul_i32 s17, s62, 73728
    s_add_u32 s17, s17, 73400320
    s_waitcnt lgkmcnt(0)
    s_barrier
    s_mov_b32 s56, 95425536
    s_cmp_eq_u32 s62, 0
    s_cbranch_scc0 WF_24_ok
    v_min_u32 v30, 47, v0
    v_lshlrev_b32 v30, 4, v30
WF_24:
    buffer_load_dwordx4 v[26:29], v30, s[4:7], s56 offen sc1
    s_sub_u32 s70, s70, 1
    s_cbranch_scc1 WF_24_to
    s_waitcnt vmcnt(0)
    v_min3_u32 v26, v26, v27, v28
    v_min_u32 v26, v26, v29
    v_cmp_eq_u32 vcc, 0, v26
    s_cbranch_vccz WF_24_ok
    s_sleep 32
    s_branch WF_24
WF_24_to:
    s_mov_b32 s70, 0
    s_waitcnt vmcnt(0)
WF_24_ok:
    s_barrier
    v_min_u32 v30, 31, v0
    v_lshlrev_b32 v30, 2, v30
T6L_25_w:
    s_lshl_b32 s56, s59, 7
    s_add_u32 s56, s56, 95428608
TP_26:
    buffer_load_dword v31, v30, s[4:7], s56 offen sc1
    s_sub_u32 s70, s70, 1
    s_cbranch_scc1 TP_26_to
    s_waitcnt vmcnt(0)
    v_cmp_eq_u32 vcc, 0, v31
    s_cbranch_vccz TP_26_ok
    s_sleep 4
    s_branch TP_26
TP_26_to:
    s_mov_b32 s70, 0
    s_waitcnt vmcnt(0)
TP_26_ok:
    s_mul_i32 s18, s59, 294912
    s_add_u32 s18, s18, s17
    buffer_load_dwordx4 v[32:35], v1, s[4:7], s18 offen offset:0 sc1
    buffer_load_dwordx4 v[36:39], v1, s[4:7], s18 offen offset:1024 sc1
    buffer_load_dwordx4 v[40:43], v1, s[4:7], s18 offen offset:2048 sc1
    buffer_load_dwordx4 v[44:47], v1, s[4:7], s18 offen offset:3072 sc1
    s_add_u32 s18, s18, 4096
    buffer_load_dwordx4 v[48:51], v1, s[4:7], s18 offen offset:0 sc1
    buffer_load_dwordx4 v[52:55], v1, s[4:7], s18 offen offset:1024 sc1
    buffer_load_dwordx4 v[56:59], v1, s[4:7], s18 offen offset:2048 sc1
    buffer_load_dwordx4 v[60:63], v1, s[4:7], s18 offen offset:3072 sc1
    s_add_u32 s18, s18, 4096
    buffer_load_dwordx4 v[64:67], v1, s[4:7], s18 offen offset:0 sc1
    buffer_load_dwordx4 v[68:71], v1, s[4:7], s18 offen offset:1024 sc1
    buffer_load_dwordx4 v[72:75], v1, s[4:7], s18 offen offset:2048 sc1
    buffer_load_dwordx4 v[76:79], v1, s[4:7], s18 offen offset:3072 sc1
    s_add_u32 s18, s18, 4096
    buffer_load_dwordx4 v[80:83], v1, s[4:7], s18 offen offset:0 sc1
    buffer_load_dwordx4 v[84:87], v1, s[4:7], s18 offen offset:1024 sc1
    buffer_load_dwordx4 v[88:91], v1, s[4:7], s18 offen offset:2048 sc1
    buffer_load_dwordx4 v[92:95], v1, s[4:7], s18 offen offset:3072 sc1
    s_add_u32 s18, s18, 4096
    buffer_load_dwordx4 v[96:99], v1, s[4:7], s18 offen offset:0 sc1
    buffer_load_dwordx4 v[100:103], v1, s[4:7], s18 offen offset:1024 sc1
    buffer_load_dwordx4 v[104:107], v1, s[4:7], s18 offen offset:2048 sc1
    buffer_load_dwordx4 v[108:111], v1, s[4:7], s18 offen offset:3072 sc1
    s_add_u32 s18, s18, 4096
    buffer_load_dwordx4 v[112:115], v1, s[4:7], s18 offen offset:0 sc1
    buffer_load_dwordx4 v[116:119], v1, s[4:7], s18 offen offset:1024 sc1
    buffer_load_dwordx4 v[120:123], v1, s[4:7], s18 offen offset:2048 sc1
    buffer_load_dwordx4 v[124:127], v1, s[4:7], s18 offen offset:3072 sc1
T6L_25:
    s_add_u32 s20, s59, 6
    s_lshl_b32 s56, s20, 7
    s_add_u32 s56, s56, 95428608
    s_waitcnt vmcnt(23)
    v_mfma_f32_32x32x16_bf16 v[8:23], a[0:3], v[32:35], 0
    s_add_u32 s18, s18, 4096
    buffer_load_dwordx4 v[32:35], v1, s[4:7], s18 offen offset:0 sc1
    s_waitcnt vmcnt(23)
    v_mfma_f32_32x32x16_bf16 v[8:23], a[4:7], v[36:39], v[8:23]
    buffer_load_dwordx4 v[36:39], v1, s[4:7], s18 offen offset:1024 sc1
    s_waitcnt vmcnt(23)
    v_mfma_f32_32x32x16_bf16 v[8:23], a[8:11], v[40:43], v[8:23]
    buffer_load_dwordx4 v[40:43], v1, s[4:7], s18 offen offset:2048 sc1
    s_waitcnt vmcnt(23)
    v_mfma_f32_32x32x16_bf16 v[8:23], a[12:15], v[44:47], v[8:23]
    buffer_load_dwordx4 v[44:47], v1, s[4:7], s18 offen offset:3072 sc1
    s_waitcnt vmcnt(23)
    v_mfma_f32_32x32x16_bf16 v[8:23], a[16:19], v[48:51], v[8:23]
    s_add_u32 s18, s18, 4096
    buffer_load_dwordx4 v[48:51], v1, s[4:7], s18 offen offset:0 sc1
    s_waitcnt vmcnt(23)
    v_mfma_f32_32x32x16_bf16 v[8:23], a[20:23], v[52:55], v[8:23]
    buffer_load_dwordx4 v[52:55], v1, s[4:7], s18 offen offset:1024 sc1
    s_waitcnt vmcnt(23)
    v_mfma_f32_32x32x16_bf16 v[8:23], a[24:27], v[56:59], v[8:23]
    buffer_load_dwordx4 v[56:59], v1, s[4:7], s18 offen offset:2048 sc1
    s_waitcnt vmcnt(23)
    v_mfma_f32_32x32x16_bf16 v[8:23], a[28:31], v[60:63], v[8:23]
    buffer_load_dwordx4 v[60:63], v1, s[4:7], s18 offen offset:3072 sc1
    s_waitcnt vmcnt(23)
    v_mfma_f32_32x32x16_bf16 v[8:23], a[32:35], v[64:67], v[8:23]
    s_add_u32 s18, s18, 4096
    buffer_load_dwordx4 v[64:67], v1, s[4:7], s18 offen offset:0 sc1
    s_waitcnt vmcnt(23)
    v_mfma_f32_32x32x16_bf16 v[8:23], a[36:39], v[68:71], v[8:23]
    buffer_load_dwordx4 v[68:71], v1, s[4:7], s18 offen offset:1024 sc1
    s_waitcnt vmcnt(23)
    v_mfma_f32_32x32x16_bf16 v[8:23], a[40:43], v[72:75], v[8:23]
    buffer_load_dwordx4 v[72:75], v1, s[4:7], s18 offen offset:2048 sc1
    s_waitcnt vmcnt(23)
    v_mfma_f32_32x32x16_bf16 v[8:23], a[44:47], v[76:79], v[8:23]
    buffer_load_dwordx4 v[76:79], v1, s[4:7], s18 offen offset:3072 sc1
    s_waitcnt vmcnt(23)
    v_mfma_f32_32x32x16_bf16 v[8:23], a[48:51], v[80:83], v[8:23]
    s_add_u32 s18, s18, 4096
    buffer_load_dwordx4 v[80:83], v1, s[4:7], s18 offen offset:0 sc1
    s_waitcnt vmcnt(23)
    v_mfma_f32_32x32x16_bf16 v[8:23], a[52:55], v[84:87], v[8:23]
    buffer_load_dwordx4 v[84:87], v1, s[4:7], s18 offen offset:1024 sc1
    s_waitcnt vmcnt(23)
    v_mfma_f32_32x32x16_bf16 v[8:23], a[56:59], v[88:91], v[8:23]
    buffer_load_dwordx4 v[88:91], v1, s[4:7], s18 offen offset:2048 sc1
    s_waitcnt vmcnt(23)
    v_mfma_f32_32x32x16_bf16 v[8:23], a[60:63], v[92:95], v[8:23]
    buffer_load_dwordx4 v[92:95], v1, s[4:7], s18 offen offset:3072 sc1
    s_waitcnt vmcnt(23)
    v_mfma_f32_32x32x16_bf16 v[8:23], a[64:67], v[96:99], v[8:23]
    s_add_u32 s18, s18, 4096
    buffer_load_dwordx4 v[96:99], v1, s[4:7], s18 offen offset:0 sc1
    s_waitcnt vmcnt(23)
    v_mfma_f32_32x32x16_bf16 v[8:23], a[68:71], v[100:103], v[8:23]
    buffer_load_dwordx4 v[100:103], v1, s[4:7], s18 offen offset:1024 sc1
    s_waitcnt vmcnt(23)
    v_mfma_f32_32x32x16_bf16 v[8:23], a[72:75], v[104:107], v[8:23]
    buffer_load_dwordx4 v[104:107], v1, s[4:7], s18 offen offset:2048 sc1
    s_waitcnt vmcnt(23)
    v_mfma_f32_32x32x16_bf16 v[8:23], a[76:79], v[108:111], v[8:23]
    buffer_load_dwordx4 v[108:111], v1, s[4:7], s18 offen offset:3072 sc1
    s_waitcnt vmcnt(23)
    v_mfma_f32_32x32x16_bf16 v[8:23], a[80:83], v[112:115], v[8:23]
    s_add_u32 s18, s18, 4096
    buffer_load_dwordx4 v[112:115], v1, s[4:7], s18 offen offset:0 sc1
    s_waitcnt vmcnt(23)
    v_mfma_f32_32x32x16_bf16 v[8:23], a[84:87], v[116:119], v[8:23]
    buffer_load_dwordx4 v[116:119], v1, s[4:7], s18 offen offset:1024 sc1
    s_waitcnt vmcnt(23)
    v_mfma_f32_32x32x16_bf16 v[8:23], a[88:91], v[120:123], v[8:23]
    buffer_load_dwordx4 v[120:123], v1, s[4:7], s18 offen offset:2048 sc1
    s_waitcnt vmcnt(23)
    v_mfma_f32_32x32x16_bf16 v[8:23], a[92:95], v[124:127], v[8:23]
    buffer_load_dwordx4 v[124:127], v1, s[4:7], s18 offen offset:3072 sc1
    s_waitcnt vmcnt(23)
    v_mfma_f32_32x32x16_bf16 v[8:23], a[96:99], v[32:35], v[8:23]
    s_add_u32 s18, s18, 4096
    buffer_load_dwordx4 v[32:35], v1, s[4:7], s18 offen offset:0 sc1
    s_waitcnt vmcnt(23)
    v_mfma_f32_32x32x16_bf16 v[8:23], a[100:103], v[36:39], v[8:23]
    buffer_load_dwordx4 v[36:39], v1, s[4:7], s18 offen offset:1024 sc1
    s_waitcnt vmcnt(23)
    v_mfma_f32_32x32x16_bf16 v[8:23], a[104:107], v[40:43], v[8:23]
    buffer_load_dwordx4 v[40:43], v1, s[4:7], s18 offen offset:2048 sc1
    s_waitcnt vmcnt(23)
    v_mfma_f32_32x32x16_bf16 v[8:23], a[108:111], v[44:47], v[8:23]
    buffer_load_dwordx4 v[44:47], v1, s[4:7], s18 offen offset:3072 sc1
    s_waitcnt vmcnt(23)
    v_mfma_f32_32x32x16_bf16 v[8:23], a[112:115], v[48:51], v[8:23]
    s_add_u32 s18, s18, 4096
    buffer_load_dwordx4 v[48:51], v1, s[4:7], s18 offen offset:0 sc1
    s_waitcnt vmcnt(23)
    v_mfma_f32_32x32x16_bf16 v[8:23], a[116:119], v[52:55], v[8:23]
    buffer_load_dwordx4 v[52:55], v1, s[4:7], s18 offen offset:1024 sc1
    s_waitcnt vmcnt(23)
    v_mfma_f32_32x32x16_bf16 v[8:23], a[120:123], v[56:59], v[8:23]
    buffer_load_dwordx4 v[56:59], v1, s[4:7], s18 offen offset:2048 sc1
    s_waitcnt vmcnt(23)
    v_mfma_f32_32x32x16_bf16 v[8:23], a[124:127], v[60:63], v[8:23]
    buffer_load_dwordx4 v[60:63], v1, s[4:7], s18 offen offset:3072 sc1
    s_waitcnt vmcnt(23)
    v_mfma_f32_32x32x16_bf16 v[8:23], a[128:131], v[64:67], v[8:23]
    s_add_u32 s18, s18, 4096
    buffer_load_dwordx4 v[64:67], v1, s[4:7], s18 offen offset:0 sc1
    s_waitcnt vmcnt(23)
    v_mfma_f32_32x32x16_bf16 v[8:23], a[132:135], v[68:71], v[8:23]
    buffer_load_dwordx4 v[68:71], v1, s[4:7], s18 offen offset:1024 sc1
    s_waitcnt vmcnt(23)
    v_mfma_f32_32x32x16_bf16 v[8:23], a[136:139], v[72:75], v[8:23]
    buffer_load_dwordx4 v[72:75], v1, s[4:7], s18 offen offset:2048 sc1
    s_waitcnt vmcnt(23)
    v_mfma_f32_32x32x16_bf16 v[8:23], a[140:143], v[76:79], v[8:23]
    buffer_load_dwordx4 v[76:79], v1, s[4:7], s18 offen offset:3072 sc1
    s_waitcnt vmcnt(23)
    v_mfma_f32_32x32x16_bf16 v[8:23], a[144:147], v[80:83], v[8:23]
    s_add_u32 s18, s18, 4096
    buffer_load_dwordx4 v[80:83], v1, s[4:7], s18 offen offset:0 sc1
    s_waitcnt vmcnt(23)
    v_mfma_f32_32x32x16_bf16 v[8:23], a[148:151], v[84:87], v[8:23]
    buffer_load_dwordx4 v[84:87], v1, s[4:7], s18 offen offset:1024 sc1
    s_waitcnt vmcnt(23)
    v_mfma_f32_32x32x16_bf16 v[8:23], a[152:155], v[88:91], v[8:23]
    buffer_load_dwordx4 v[88:91], v1, s[4:7], s18 offen offset:2048 sc1
    s_waitcnt vmcnt(23)
    v_mfma_f32_32x32x16_bf16 v[8:23], a[156:159], v[92:95], v[8:23]
    buffer_load_dwordx4 v[92:95], v1, s[4:7], s18 offen offset:3072 sc1
    s_waitcnt vmcnt(23)
    v_mfma_f32_32x32x16_bf16 v[8:23], a[160:163], v[96:99], v[8:23]
    s_add_u32 s18, s18, 4096
    buffer_load_dwordx4 v[96:99], v1, s[4:7], s18 offen offset:0 sc1
    s_waitcnt vmcnt(23)
    v_mfma_f32_32x32x16_bf16 v[8:23], a[164:167], v[100:103], v[8:23]
    buffer_load_dwordx4 v[100:103], v1, s[4:7], s18 offen offset:1024 sc1
    s_waitcnt vmcnt(23)
    v_mfma_f32_32x32x16_bf16 v[8:23], a[168:171], v[104:107], v[8:23]
    buffer_load_dwordx4 v[104:107], v1, s[4:7], s18 offen offset:2048 sc1
    s_waitcnt vmcnt(23)
    v_mfma_f32_32x32x16_bf16 v[8:23], a[172:175], v[108:111], v[8:23]
    buffer_load_dwordx4 v[108:111], v1, s[4:7], s18 offen offset:3072 sc1
    s_waitcnt vmcnt(23)
    v_mfma_f32_32x32x16_bf16 v[8:23], a[176:179], v[112:115], v[8:23]
    s_add_u32 s18, s18, 4096
    buffer_load_dwordx4 v[112:115], v1, s[4:7], s18 offen offset:0 sc1
    s_waitcnt vmcnt(23)
    v_mfma_f32_32x32x16_bf16 v[8:23], a[180:183], v[116:119], v[8:23]
    buffer_load_dwordx4 v[116:119], v1, s[4:7], s18 offen offset:1024 sc1
    s_waitcnt vmcnt(23)
    v_mfma_f32_32x32x16_bf16 v[8:23], a[184:187], v[120:123], v[8:23]
    buffer_load_dwordx4 v[120:123], v1, s[4:7], s18 offen offset:2048 sc1
    s_waitcnt vmcnt(23)
    v_mfma_f32_32x32x16_bf16 v[8:23], a[188:191], v[124:127], v[8:23]
    buffer_load_dword v31, v30, s[4:7], s56 offen sc1
    buffer_load_dwordx4 v[124:127], v1, s[4:7], s18 offen offset:3072 sc1
    s_waitcnt vmcnt(23)
    v_mfma_f32_32x32x16_bf16 v[8:23], a[192:195], v[32:35], v[8:23]
    s_waitcnt vmcnt(22)
    v_mfma_f32_32x32x16_bf16 v[8:23], a[196:199], v[36:39], v[8:23]
    s_waitcnt vmcnt(21)
    v_mfma_f32_32x32x16_bf16 v[8:23], a[200:203], v[40:43], v[8:23]
    s_waitcnt vmcnt(20)
    v_mfma_f32_32x32x16_bf16 v[8:23], a[204:207], v[44:47], v[8:23]
    s_waitcnt vmcnt(19)
    v_mfma_f32_32x32x16_bf16 v[8:23], a[208:211], v[48:51], v[8:23]
    s_waitcnt vmcnt(18)
    v_mfma_f32_32x32x16_bf16 v[8:23], a[212:215], v[52:55], v[8:23]
    s_waitcnt vmcnt(17)
    v_mfma_f32_32x32x16_bf16 v[8:23], a[216:219], v[56:59], v[8:23]
    s_waitcnt vmcnt(16)
    v_mfma_f32_32x32x16_bf16 v[8:23], a[220:223], v[60:63], v[8:23]
    s_waitcnt vmcnt(15)
    v_mfma_f32_32x32x16_bf16 v[8:23], a[224:227], v[64:67], v[8:23]
    s_waitcnt vmcnt(14)
    v_mfma_f32_32x32x16_bf16 v[8:23], a[228:231], v[68:71], v[8:23]
    s_waitcnt vmcnt(13)
    v_mfma_f32_32x32x16_bf16 v[8:23], a[232:235], v[72:75], v[8:23]
    s_waitcnt vmcnt(12)
    v_mfma_f32_32x32x16_bf16 v[8:23], a[236:239], v[76:79], v[8:23]
    s_waitcnt vmcnt(11)
    v_mfma_f32_32x32x16_bf16 v[8:23], a[240:243], v[80:83], v[8:23]
    s_waitcnt vmcnt(10)
    v_mfma_f32_32x32x16_bf16 v[8:23], a[244:247], v[84:87], v[8:23]
    s_waitcnt vmcnt(9)
    v_mfma_f32_32x32x16_bf16 v[8:23], a[248:251], v[88:91], v[8:23]
    s_waitcnt vmcnt(8)
    v_mfma_f32_32x32x16_bf16 v[8:23], a[252:255], v[92:95], v[8:23]
    s_waitcnt vmcnt(7)
    v_mfma_f32_32x32x16_bf16 v[8:23], v[224:227], v[96:99], v[8:23]
    s_waitcnt vmcnt(6)
    v_mfma_f32_32x32x16_bf16 v[8:23], v[228:231], v[100:103], v[8:23]
    s_waitcnt vmcnt(5)
    v_mfma_f32_32x32x16_bf16 v[8:23], v[232:235], v[104:107], v[8:23]
    s_waitcnt vmcnt(4)
    v_mfma_f32_32x32x16_bf16 v[8:23], v[236:239], v[108:111], v[8:23]
    s_waitcnt vmcnt(3)
    v_mfma_f32_32x32x16_bf16 v[8:23], v[240:243], v[112:115], v[8:23]
    s_waitcnt vmcnt(2)
    v_mfma_f32_32x32x16_bf16 v[8:23], v[244:247], v[116:119], v[8:23]
    s_waitcnt vmcnt(1)
    v_mfma_f32_32x32x16_bf16 v[8:23], v[248:251], v[120:123], v[8:23]
    s_waitcnt vmcnt(0)
    v_mfma_f32_32x32x16_bf16 v[8:23], v[252:255], v[124:127], v[8:23]
    v_cmp_eq_u32 vcc, 0, v31
    s_mov_b32 s21, 0
    s_cbranch_vccnz T6L_25_e
    s_cmp_ge_u32 s20, 62
    s_cbranch_scc1 T6L_25_e
    s_mov_b32 s21, 1
    s_mul_i32 s18, s20, 294912
    s_add_u32 s18, s18, s17
    buffer_load_dwordx4 v[32:35], v1, s[4:7], s18 offen offset:0 sc1
    buffer_load_dwordx4 v[36:39], v1, s[4:7], s18 offen offset:1024 sc1
    buffer_load_dwordx4 v[40:43], v1, s[4:7], s18 offen offset:2048 sc1
    buffer_load_dwordx4 v[44:47], v1, s[4:7], s18 offen offset:3072 sc1
    s_add_u32 s18, s18, 4096
    buffer_load_dwordx4 v[48:51], v1, s[4:7], s18 offen offset:0 sc1
    buffer_load_dwordx4 v[52:55], v1, s[4:7], s18 offen offset:1024 sc1
    buffer_load_dwordx4 v[56:59], v1, s[4:7], s18 offen offset:2048 sc1
    buffer_load_dwordx4 v[60:63], v1, s[4:7], s18 offen offset:3072 sc1
    s_add_u32 s18, s18, 4096
    buffer_load_dwordx4 v[64:67], v1, s[4:7], s18 offen offset:0 sc1
    buffer_load_dwordx4 v[68:71], v1, s[4:7], s18 offen offset:1024 sc1
    buffer_load_dwordx4 v[72:75], v1, s[4:7], s18 offen offset:2048 sc1
    buffer_load_dwordx4 v[76:79], v1, s[4:7], s18 offen offset:3072 sc1
    s_add_u32 s18, s18, 4096
    buffer_load_dwordx4 v[80:83], v1, s[4:7], s18 offen offset:0 sc1
    buffer_load_dwordx4 v[84:87], v1, s[4:7], s18 offen offset:1024 sc1
    buffer_load_dwordx4 v[88:91], v1, s[4:7], s18 offen offset:2048 sc1
    buffer_load_dwordx4 v[92:95], v1, s[4:7], s18 offen offset:3072 sc1
    s_add_u32 s18, s18, 4096
    buffer_load_dwordx4 v[96:99], v1, s[4:7], s18 offen offset:0 sc1
    buffer_load_dwordx4 v[100:103], v1, s[4:7], s18 offen offset:1024 sc1
    buffer_load_dwordx4 v[104:107], v1, s[4:7], s18 offen offset:2048 sc1
    buffer_load_dwordx4 v[108:111], v1, s[4:7], s18 offen offset:3072 sc1
    s_add_u32 s18, s18, 4096
    buffer_load_dwordx4 v[112:115], v1, s[4:7], s18 offen offset:0 sc1
    buffer_load_dwordx4 v[116:119], v1, s[4:7], s18 offen offset:1024 sc1
    buffer_load_dwordx4 v[120:123], v1, s[4:7], s18 offen offset:2048 sc1
    buffer_load_dwordx4 v[124:127], v1, s[4:7], s18 offen offset:3072 sc1
T6L_25_e:
    s_nop 7
    ds_write_b128 v3, v[8:11] offset:0
    ds_write_b128 v3, v[12:15] offset:1024
    ds_write_b128 v3, v[16:19] offset:2048
    ds_write_b128 v3, v[20:23] offset:3072
    s_waitcnt lgkmcnt(0)
    s_barrier
    ds_read_b128 v[8:11], v4 offset:0
    ds_read_b128 v[12:15], v4 offset:4096
    ds_read_b128 v[16:19], v4 offset:8192
    ds_read_b128 v[20:23], v4 offset:12288
    s_lshl_b32 s19, s59, 15
    s_waitcnt lgkmcnt(0)
    s_barrier
    v_add_f32 v8, v8, v12
    v_add_f32 v16, v16, v20
    v_add_f32 v8, v8, v16
    v_add_f32 v9, v9, v13
    v_add_f32 v17, v17, v21
    v_add_f32 v9, v9, v17
    v_add_f32 v10, v10, v14
    v_add_f32 v18, v18, v22
    v_add_f32 v10, v10, v18
    v_add_f32 v11, v11, v15
    v_add_f32 v19, v19, v23
    v_add_f32 v11, v11, v19
    v_cvt_pk_bf16_f32 v24, v8, v9
    v_cvt_pk_bf16_f32 v25, v10, v11
    buffer_store_dwordx2 v[24:25], v2, s[12:15], s19 offen nt
    s_mov_b32 s59, s20
    s_cmp_eq_u32 s21, 1
    s_cbranch_scc1 T6L_25
    s_cmp_lt_u32 s59, 62
    s_cbranch_scc1 T6L_25_w
    s_cmp_lg_u32 s62, 3
    s_cbranch_scc1 L_nwb
    s_cmp_lg_u32 s61, 0
    s_cbranch_scc1 L_nwb
    s_waitcnt vmcnt(0)
    buffer_wbl2 sc1
L_nwb:
    s_cmp_ge_u32 s59, 66
    s_cbranch_scc1 L_wend
    s_cmp_ge_u32 s59, 64
    s_cselect_b32 s20, 16, 0
    s_cselect_b32 s21, 2, 0
    s_sub_u32 s59, s59, s21
    v_and_b32 v8, 15, v0
    v_bfe_u32 v9, v0, 4, 1
    v_lshrrev_b32 v10, 5, v0
    v_add_u32 v11, s20, v8
    v_lshlrev_b32 v5, 4, v11
    v_lshl_add_u32 v5, v9, 10, v5
    v_lshl_add_u32 v5, v10, 9, v5
    s_lshl_b32 s19, s20, 10
    v_add_u32 v6, s19, v2
    v_mov_b32 v11, 0x40000000
    v_cmp_eq_u32 vcc, 0, v9
    s_nop 1
    v_cndmask_b32 v6, v11, v6, vcc
    v_and_b32 v7, 0xfffffeff, v4
    s_mov_b64 s[22:23], vcc
    s_lshl_b32 s56, s59, 7
    s_add_u32 s56, s56, 95428608
TP_28:
    buffer_load_dword v31, v30, s[4:7], s56 offen sc1
    s_sub_u32 s70, s70, 1
    s_cbranch_scc1 TP_28_to
    s_waitcnt vmcnt(0)
    v_cmp_eq_u32 vcc, 0, v31
    s_cbranch_vccz TP_28_ok
    s_sleep 1
    s_branch TP_28
TP_28_to:
    s_mov_b32 s70, 0
    s_waitcnt vmcnt(0)
TP_28_ok:
TH_27:
    s_mul_i32 s18, s59, 294912
    s_add_u32 s18, s18, s17
    buffer_load_dwordx4 v[64:67], v5, s[4:7], s18 offen offset:0 sc1
    buffer_load_dwordx4 v[68:71], v5, s[4:7], s18 offen offset:2048 sc1
    s_add_u32 s18, s18, 4096
    buffer_load_dwordx4 v[72:75], v5, s[4:7], s18 offen offset:0 sc1
    buffer_load_dwordx4 v[76:79], v5, s[4:7], s18 offen offset:2048 sc1
    s_add_u32 s18, s18, 4096
    buffer_load_dwordx4 v[80:83], v5, s[4:7], s18 offen offset:0 sc1
    buffer_load_dwordx4 v[84:87], v5, s[4:7], s18 offen offset:2048 sc1
    s_add_u32 s18, s18, 4096
    buffer_load_dwordx4 v[88:91], v5, s[4:7], s18 offen offset:0 sc1
    buffer_load_dwordx4 v[92:95], v5, s[4:7], s18 offen offset:2048 sc1
    s_add_u32 s18, s18, 4096
    buffer_load_dwordx4 v[96:99], v5, s[4:7], s18 offen offset:0 sc1
    buffer_load_dwordx4 v[100:103], v5, s[4:7], s18 offen offset:2048 sc1
    s_add_u32 s18, s18, 4096
    buffer_load_dwordx4 v[104:107], v5, s[4:7], s18 offen offset:0 sc1
    buffer_load_dwordx4 v[108:111], v5, s[4:7], s18 offen offset:2048 sc1
    s_add_u32 s18, s18, 4096
    buffer_load_dwordx4 v[112:115], v5, s[4:7], s18 offen offset:0 sc1
    buffer_load_dwordx4 v[116:119], v5, s[4:7], s18 offen offset:2048 sc1
    s_add_u32 s18, s18, 4096
    buffer_load_dwordx4 v[120:123], v5, s[4:7], s18 offen offset:0 sc1
    buffer_load_dwordx4 v[124:127], v5, s[4:7], s18 offen offset:2048 sc1
    s_add_u32 s18, s18, 4096
    buffer_load_dwordx4 v[128:131], v5, s[4:7], s18 offen offset:0 sc1
    buffer_load_dwordx4 v[132:135], v5, s[4:7], s18 offen offset:2048 sc1
    s_waitcnt vmcnt(17)
    v_mfma_f32_32x32x16_bf16 v[32:47], a[0:3], v[64:67], 0
    v_mfma_f32_32x32x16_bf16 v[48:63], a[4:7], v[64:67], 0
    s_add_u32 s18, s18, 4096
    buffer_load_dwordx4 v[64:67], v5, s[4:7], s18 offen offset:0 sc1
    s_waitcnt vmcnt(17)
    v_mfma_f32_32x32x16_bf16 v[32:47], a[8:11], v[68:71], v[32:47]
    v_mfma_f32_32x32x16_bf16 v[48:63], a[12:15], v[68:71], v[48:63]
    buffer_load_dwordx4 v[68:71], v5, s[4:7], s18 offen offset:2048 sc1
    s_waitcnt vmcnt(17)
    v_mfma_f32_32x32x16_bf16 v[32:47], a[16:19], v[72:75], v[32:47]
    v_mfma_f32_32x32x16_bf16 v[48:63], a[20:23], v[72:75], v[48:63]
    s_add_u32 s18, s18, 4096
    buffer_load_dwordx4 v[72:75], v5, s[4:7], s18 offen offset:0 sc1
    s_waitcnt vmcnt(17)
    v_mfma_f32_32x32x16_bf16 v[32:47], a[24:27], v[76:79], v[32:47]
    v_mfma_f32_32x32x16_bf16 v[48:63], a[28:31], v[76:79], v[48:63]
    buffer_load_dwordx4 v[76:79], v5, s[4:7], s18 offen offset:2048 sc1
    s_waitcnt vmcnt(17)
    v_mfma_f32_32x32x16_bf16 v[32:47], a[32:35], v[80:83], v[32:47]
    v_mfma_f32_32x32x16_bf16 v[48:63], a[36:39], v[80:83], v[48:63]
    s_add_u32 s18, s18, 4096
    buffer_load_dwordx4 v[80:83], v5, s[4:7], s18 offen offset:0 sc1
    s_waitcnt vmcnt(17)
    v_mfma_f32_32x32x16_bf16 v[32:47], a[40:43], v[84:87], v[32:47]
    v_mfma_f32_32x32x16_bf16 v[48:63], a[44:47], v[84:87], v[48:63]
    buffer_load_dwordx4 v[84:87], v5, s[4:7], s18 offen offset:2048 sc1
    s_waitcnt vmcnt(17)
    v_mfma_f32_32x32x16_bf16 v[32:47], a[48:51], v[88:91], v[32:47]
    v_mfma_f32_32x32x16_bf16 v[48:63], a[52:55], v[88:91], v[48:63]
    s_add_u32 s18, s18, 4096
    buffer_load_dwordx4 v[88:91], v5, s[4:7], s18 offen offset:0 sc1
    s_waitcnt vmcnt(17)
    v_mfma_f32_32x32x16_bf16 v[32:47], a[56:59], v[92:95], v[32:47]
    v_mfma_f32_32x32x16_bf16 v[48:63], a[60:63], v[92:95], v[48:63]
    buffer_load_dwordx4 v[92:95], v5, s[4:7], s18 offen offset:2048 sc1
    s_waitcnt vmcnt(17)
    v_mfma_f32_32x32x16_bf16 v[32:47], a[64:67], v[96:99], v[32:47]
    v_mfma_f32_32x32x16_bf16 v[48:63], a[68:71], v[96:99], v[48:63]
    s_add_u32 s18, s18, 4096
    buffer_load_dwordx4 v[96:99], v5, s[4:7], s18 offen offset:0 sc1
    s_waitcnt vmcnt(17)
    v_mfma_f32_32x32x16_bf16 v[32:47], a[72:75], v[100:103], v[32:47]
    v_mfma_f32_32x32x16_bf16 v[48:63], a[76:79], v[100:103], v[48:63]
    buffer_load_dwordx4 v[100:103], v5, s[4:7], s18 offen offset:2048 sc1
    s_waitcnt vmcnt(17)
    v_mfma_f32_32x32x16_bf16 v[32:47], a[80:83], v[104:107], v[32:47]
    v_mfma_f32_32x32x16_bf16 v[48:63], a[84:87], v[104:107], v[48:63]
    s_add_u32 s18, s18, 4096
    buffer_load_dwordx4 v[104:107], v5, s[4:7], s18 offen offset:0 sc1
    s_waitcnt vmcnt(17)
    v_mfma_f32_32x32x16_bf16 v[32:47], a[88:91], v[108:111], v[32:47]
    v_mfma_f32_32x32x16_bf16 v[48:63], a[92:95], v[108:111], v[48:63]
    buffer_load_dwordx4 v[108:111], v5, s[4:7], s18 offen offset:2048 sc1
    s_waitcnt vmcnt(17)
    v_mfma_f32_32x32x16_bf16 v[32:47], a[96:99], v[112:115], v[32:47]
    v_mfma_f32_32x32x16_bf16 v[48:63], a[100:103], v[112:115], v[48:63]
    s_add_u32 s18, s18, 4096
    buffer_load_dwordx4 v[112:115], v5, s[4:7], s18 offen offset:0 sc1
    s_waitcnt vmcnt(17)
    v_mfma_f32_32x32x16_bf16 v[32:47], a[104:107], v[116:119], v[32:47]
    v_mfma_f32_32x32x16_bf16 v[48:63], a[108:111], v[116:119], v[48:63]
    buffer_load_dwordx4 v[116:119], v5, s[4:7], s18 offen offset:2048 sc1
    s_waitcnt vmcnt(17)
    v_mfma_f32_32x32x16_bf16 v[32:47], a[112:115], v[120:123], v[32:47]
    v_mfma_f32_32x32x16_bf16 v[48:63], a[116:119], v[120:123], v[48:63]
    s_add_u32 s18, s18, 4096
    buffer_load_dwordx4 v[120:123], v5, s[4:7], s18 offen offset:0 sc1
    s_waitcnt vmcnt(17)
    v_mfma_f32_32x32x16_bf16 v[32:47], a[120:123], v[124:127], v[32:47]
    v_mfma_f32_32x32x16_bf16 v[48:63], a[124:127], v[124:127], v[48:63]
    buffer_load_dwordx4 v[124:127], v5, s[4:7], s18 offen offset:2048 sc1
    s_waitcnt vmcnt(17)
    v_mfma_f32_32x32x16_bf16 v[32:47], a[128:131], v[128:131], v[32:47]
    v_mfma_f32_32x32x16_bf16 v[48:63], a[132:135], v[128:131], v[48:63]
    s_add_u32 s18, s18, 4096
    buffer_load_dwordx4 v[128:131], v5, s[4:7], s18 offen offset:0 sc1
    s_waitcnt vmcnt(17)
    v_mfma_f32_32x32x16_bf16 v[32:47], a[136:139], v[132:135], v[32:47]
    v_mfma_f32_32x32x16_bf16 v[48:63], a[140:143], v[132:135], v[48:63]
    buffer_load_dwordx4 v[132:135], v5, s[4:7], s18 offen offset:2048 sc1
    s_waitcnt vmcnt(17)
    v_mfma_f32_32x32x16_bf16 v[32:47], a[144:147], v[64:67], v[32:47]
    v_mfma_f32_32x32x16_bf16 v[48:63], a[148:151], v[64:67], v[48:63]
    s_waitcnt vmcnt(16)
    v_mfma_f32_32x32x16_bf16 v[32:47], a[152:155], v[68:71], v[32:47]
    v_mfma_f32_32x32x16_bf16 v[48:63], a[156:159], v[68:71], v[48:63]
    s_waitcnt vmcnt(15)
    v_mfma_f32_32x32x16_bf16 v[32:47], a[160:163], v[72:75], v[32:47]
    v_mfma_f32_32x32x16_bf16 v[48:63], a[164:167], v[72:75], v[48:63]
    s_waitcnt vmcnt(14)
    v_mfma_f32_32x32x16_bf16 v[32:47], a[168:171], v[76:79], v[32:47]
    v_mfma_f32_32x32x16_bf16 v[48:63], a[172:175], v[76:79], v[48:63]
    s_waitcnt vmcnt(13)
    v_mfma_f32_32x32x16_bf16 v[32:47], a[176:179], v[80:83], v[32:47]
    v_mfma_f32_32x32x16_bf16 v[48:63], a[180:183], v[80:83], v[48:63]
    s_waitcnt vmcnt(12)
    v_mfma_f32_32x32x16_bf16 v[32:47], a[184:187], v[84:87], v[32:47]
    v_mfma_f32_32x32x16_bf16 v[48:63], a[188:191], v[84:87], v[48:63]
    s_waitcnt vmcnt(11)
    v_mfma_f32_32x32x16_bf16 v[32:47], a[192:195], v[88:91], v[32:47]
    v_mfma_f32_32x32x16_bf16 v[48:63], a[196:199], v[88:91], v[48:63]
    s_waitcnt vmcnt(10)
    v_mfma_f32_32x32x16_bf16 v[32:47], a[200:203], v[92:95], v[32:47]
    v_mfma_f32_32x32x16_bf16 v[48:63], a[204:207], v[92:95], v[48:63]
    s_waitcnt vmcnt(9)
    v_mfma_f32_32x32x16_bf16 v[32:47], a[208:211], v[96:99], v[32:47]
    v_mfma_f32_32x32x16_bf16 v[48:63], a[212:215], v[96:99], v[48:63]
    s_waitcnt vmcnt(8)
    v_mfma_f32_32x32x16_bf16 v[32:47], a[216:219], v[100:103], v[32:47]
    v_mfma_f32_32x32x16_bf16 v[48:63], a[220:223], v[100:103], v[48:63]
    s_waitcnt vmcnt(7)
    v_mfma_f32_32x32x16_bf16 v[32:47], a[224:227], v[104:107], v[32:47]
    v_mfma_f32_32x32x16_bf16 v[48:63], a[228:231], v[104:107], v[48:63]
    s_waitcnt vmcnt(6)
    v_mfma_f32_32x32x16_bf16 v[32:47], a[232:235], v[108:111], v[32:47]
    v_mfma_f32_32x32x16_bf16 v[48:63], a[236:239], v[108:111], v[48:63]
    s_waitcnt vmcnt(5)
    v_mfma_f32_32x32x16_bf16 v[32:47], a[240:243], v[112:115], v[32:47]
    v_mfma_f32_32x32x16_bf16 v[48:63], a[244:247], v[112:115], v[48:63]
    s_waitcnt vmcnt(4)
    v_mfma_f32_32x32x16_bf16 v[32:47], a[248:251], v[116:119], v[32:47]
    v_mfma_f32_32x32x16_bf16 v[48:63], a[252:255], v[116:119], v[48:63]
    s_waitcnt vmcnt(3)
    v_mfma_f32_32x32x16_bf16 v[32:47], v[224:227], v[120:123], v[32:47]
    v_mfma_f32_32x32x16_bf16 v[48:63], v[228:231], v[120:123], v[48:63]
    s_waitcnt vmcnt(2)
    v_mfma_f32_32x32x16_bf16 v[32:47], v[232:235], v[124:127], v[32:47]
    v_mfma_f32_32x32x16_bf16 v[48:63], v[236:239], v[124:127], v[48:63]
    s_waitcnt vmcnt(1)
    v_mfma_f32_32x32x16_bf16 v[32:47], v[240:243], v[128:131], v[32:47]
    v_mfma_f32_32x32x16_bf16 v[48:63], v[244:247], v[128:131], v[48:63]
    s_waitcnt vmcnt(0)
    v_mfma_f32_32x32x16_bf16 v[32:47], v[248:251], v[132:135], v[32:47]
    v_mfma_f32_32x32x16_bf16 v[48:63], v[252:255], v[132:135], v[48:63]
    s_nop 11
    v_cndmask_b32 v32, v48, v32, s[22:23]
    v_cndmask_b32 v33, v49, v33, s[22:23]
    v_cndmask_b32 v34, v50, v34, s[22:23]
    v_cndmask_b32 v35, v51, v35, s[22:23]
    v_cndmask_b32 v36, v52, v36, s[22:23]
    v_cndmask_b32 v37, v53, v37, s[22:23]
    v_cndmask_b32 v38, v54, v38, s[22:23]
    v_cndmask_b32 v39, v55, v39, s[22:23]
    v_cndmask_b32 v40, v56, v40, s[22:23]
    v_cndmask_b32 v41, v57, v41, s[22:23]
    v_cndmask_b32 v42, v58, v42, s[22:23]
    v_cndmask_b32 v43, v59, v43, s[22:23]
    v_cndmask_b32 v44, v60, v44, s[22:23]
    v_cndmask_b32 v45, v61, v45, s[22:23]
    v_cndmask_b32 v46, v62, v46, s[22:23]
    v_cndmask_b32 v47, v63, v47, s[22:23]
    ds_write_b128 v3, v[32:35] offset:0
    ds_write_b128 v3, v[36:39] offset:1024
    ds_write_b128 v3, v[40:43] offset:2048
    ds_write_b128 v3, v[44:47] offset:3072
    s_waitcnt lgkmcnt(0)
    s_barrier
    ds_read_b128 v[32:35], v7 offset:0
    ds_read_b128 v[36:39], v7 offset:256
    ds_read_b128 v[40:43], v7 offset:4096
    ds_read_b128 v[44:47], v7 offset:4352
    ds_read_b128 v[48:51], v7 offset:8192
    ds_read_b128 v[52:55], v7 offset:8448
    ds_read_b128 v[56:59], v7 offset:12288
    ds_read_b128 v[60:63], v7 offset:12544
    s_lshl_b32 s18, s59, 15
    s_waitcnt lgkmcnt(0)
    v_add_f32 v32, v32, v48
    v_add_f32 v33, v33, v49
    v_add_f32 v34, v34, v50
    v_add_f32 v35, v35, v51
    v_add_f32 v36, v36, v52
    v_add_f32 v37, v37, v53
    v_add_f32 v38, v38, v54
    v_add_f32 v39, v39, v55
    v_add_f32 v40, v40, v56
    v_add_f32 v41, v41, v57
    v_add_f32 v42, v42, v58
    v_add_f32 v43, v43, v59
    v_add_f32 v44, v44, v60
    v_add_f32 v45, v45, v61
    v_add_f32 v46, v46, v62
    v_add_f32 v47, v47, v63
    v_add_f32 v32, v32, v40
    v_add_f32 v33, v33, v41
    v_add_f32 v34, v34, v42
    v_add_f32 v35, v35, v43
    v_add_f32 v36, v36, v44
    v_add_f32 v37, v37, v45
    v_add_f32 v38, v38, v46
    v_add_f32 v39, v39, v47
    v_add_f32 v32, v32, v36
    v_add_f32 v33, v33, v37
    v_add_f32 v34, v34, v38
    v_add_f32 v35, v35, v39
    v_cvt_pk_bf16_f32 v24, v32, v33
    v_cvt_pk_bf16_f32 v25, v34, v35
    buffer_store_dwordx2 v[24:25], v6, s[12:15], s18 offen nt
L_wend:
    s_branch L_end
L_rec2:
    s_load_dwordx2 s[50:51], s[0:1], 8
    s_mov_b32 s32, s16
    s_mov_b32 s33, s17
    s_mov_b32 s34, 4194304
    s_mov_b32 s35, 0x20000
    s_mov_b32 s36, s18
    s_mov_b32 s37, s19
    s_mov_b32 s38, 4194304
    s_mov_b32 s39, 0x20000
    s_mov_b32 s40, s20
    s_mov_b32 s41, s21
    s_mov_b32 s42, 4194304
    s_mov_b32 s43, 0x20000
    s_lshl_b32 s98, s8, 7
    s_add_u32 s98, s98, 95420416
    s_cmp_eq_u32 s62, 1
    s_cbranch_scc1 RR_29_w1
    s_cmp_eq_u32 s62, 2
    s_cbranch_scc1 RR_29_w2
    s_cmp_eq_u32 s62, 3
    s_cbranch_scc1 RR_29_w3
RR_29_w0:
    v_mov_b32 v20, v0
    v_lshrrev_b32 v32, 4, v20
    v_lshlrev_b32 v32, 13, v32
    v_and_b32 v21, 15, v20
    v_lshrrev_b32 v22, 5, v20
    v_lshlrev_b32 v22, 1, v22
    v_xor_b32 v21, v21, v22
    v_xor_b32 v21, 0, v21
    v_lshl_add_u32 v32, v21, 4, v32
    v_and_b32 v21, 3, v20
    s_lshl_b32 s48, s8, 8
    s_mov_b32 m0, 24576
    s_add_u32 s20, s48, 0
    buffer_load_dwordx4 v32, s[36:39], s20 offen lds
    s_mov_b32 m0, 25600
    s_add_u32 s20, s48, 32768
    buffer_load_dwordx4 v32, s[36:39], s20 offen lds
    s_mov_b32 m0, 26624
    s_add_u32 s20, s48, 65536
    buffer_load_dwordx4 v32, s[36:39], s20 offen lds
    s_mov_b32 m0, 27648
    s_add_u32 s20, s48, 98304
    buffer_load_dwordx4 v32, s[36:39], s20 offen lds
    s_mov_b32 m0, 28672
    s_add_u32 s20, s48, 0
    buffer_load_dwordx4 v32, s[40:43], s20 offen lds
    s_mov_b32 m0, 29696
    s_add_u32 s20, s48, 32768
    buffer_load_dwordx4 v32, s[40:43], s20 offen lds
    s_mov_b32 m0, 30720
    s_add_u32 s20, s48, 65536
    buffer_load_dwordx4 v32, s[40:43], s20 offen lds
    s_mov_b32 m0, 31744
    s_add_u32 s20, s48, 98304
    buffer_load_dwordx4 v32, s[40:43], s20 offen lds
    s_mov_b32 m0, 32768
    s_add_u32 s20, s48, 524288
    buffer_load_dwordx4 v32, s[36:39], s20 offen lds
    s_mov_b32 m0, 33792
    s_add_u32 s20, s48, 557056
    buffer_load_dwordx4 v32, s[36:39], s20 offen lds
    s_mov_b32 m0, 34816
    s_add_u32 s20, s48, 589824
    buffer_load_dwordx4 v32, s[36:39], s20 offen lds
    s_mov_b32 m0, 35840
    s_add_u32 s20, s48, 622592
    buffer_load_dwordx4 v32, s[36:39], s20 offen lds
    s_mov_b32 m0, 36864
    s_add_u32 s20, s48, 524288
    buffer_load_dwordx4 v32, s[40:43], s20 offen lds
    s_mov_b32 m0, 37888
    s_add_u32 s20, s48, 557056
    buffer_load_dwordx4 v32, s[40:43], s20 offen lds
    s_mov_b32 m0, 38912
    s_add_u32 s20, s48, 589824
    buffer_load_dwordx4 v32, s[40:43], s20 offen lds
    s_mov_b32 m0, 39936
    s_add_u32 s20, s48, 622592
    buffer_load_dwordx4 v32, s[40:43], s20 offen lds
    v_lshlrev_b32 v34, 3, v21
    v_add_u32 v35, 24576, v34
    v_add_u32 v34, 24576, v34
    v_bfe_u32 v22, v20, 2, 2
    v_mul_u32_u24 v22, 34816, v22
    v_add_u32 v34, v34, v22
    v_lshrrev_b32 v22, 4, v20
    v_lshl_add_u32 v34, v22, 9, v34
    v_bfe_u32 v22, v20, 4, 1
    v_lshlrev_b32 v22, 5, v22
    v_xor_b32 v34, v34, v22
    v_bfe_u32 v22, v20, 2, 2
    v_lshlrev_b32 v22, 6, v22
    v_xor_b32 v34, v34, v22
    v_xor_b32 v36, 32, v34
    v_bfe_u32 v22, v20, 4, 1
    v_lshl_add_u32 v35, v22, 12, v35
    v_bfe_u32 v22, v20, 3, 1
    v_lshl_add_u32 v35, v22, 11, v35
    v_bfe_u32 v22, v20, 5, 1
    v_lshl_add_u32 v35, v22, 9, v35
    v_bfe_u32 v22, v20, 2, 1
    v_lshl_add_u32 v35, v22, 7, v35
    s_cmp_eq_u32 s59, 0
    s_cbranch_scc1 VF_30
    v_mov_b32 v1, 0
    s_waitcnt vmcnt(32)
    v_readfirstlane_b32 s56, v3
    s_nop 1
    v_mov_b32 v2, s56
    ds_write_b32 v1, v2
    s_waitcnt lgkmcnt(0)
    s_barrier
    ds_read_b32 v2, v1
    s_waitcnt lgkmcnt(0)
    v_readfirstlane_b32 s56, v2
    s_bitcmp1_b32 s56, s8
    s_cbranch_scc1 L_lost
VF_30:
    v_and_b32 v16, 15, v0
    v_lshrrev_b32 v17, 4, v0
    v_lshlrev_b32 v0, 4, v0
    v_add_u32 v2, 24576, v0
    v_and_b32 v18, 2, v16
    v_mov_b32 v1, 0x4444
    v_mov_b32 v7, 0xeeee
    v_cmp_eq_u32 vcc, 2, v18
    s_nop 1
    v_cndmask_b32 v1, v1, v7, vcc
    v_mov_b32 v14, 0
    v_mov_b32 v7, 0x7f800000
    v_cndmask_b32 v14, v14, v7, vcc
    v_mul_u32_u24 v3, 1088, v17
    v_lshl_add_u32 v3, v16, 2, v3
    v_add_u32 v3, 16384, v3
    v_lshrrev_b32 v18, 2, v16
    v_mul_u32_u24 v4, 1088, v18
    v_and_b32 v18, 1, v16
    v_mul_u32_u24 v18, 544, v18
    v_add_u32 v4, v4, v18
    v_bfe_u32 v18, v16, 1, 1
    v_mul_u32_u24 v18, 128, v18
    v_add_u32 v4, v4, v18
    v_lshl_add_u32 v4, v17, 4, v4
    v_add_u32 v4, 16384, v4
    v_lshlrev_b32 v5, 14, v17
    v_lshrrev_b32 v18, 3, v16
    v_lshl_add_u32 v5, v18, 13, v5
    v_bfe_u32 v18, v16, 2, 1
    v_lshl_add_u32 v5, v18, 11, v5
    v_and_b32 v18, 3, v16
    v_lshl_add_u32 v5, v18, 4, v5
    v_lshlrev_b32 v6, 4, v17
    v_lshl_add_u32 v6, v16, 2, v6
    v_mov_b32 v7, 0x40000000
    v_cmp_gt_u32 vcc, 4, v16
    s_nop 1
    v_cndmask_b32 v6, v7, v6, vcc
    v_mov_b32 v8, 0
    v_mov_b32 v7, 0x3f80
    v_cmp_eq_u32 vcc, 0, v16
    s_nop 1
    v_cndmask_b32 v8, v8, v7, vcc
    v_mov_b32 v7, 1.0
    v_cmp_eq_u32 vcc, 1, v16
    s_nop 1
    v_cndmask_b32 v8, v8, v7, vcc
    v_mov_b32 v9, 0
    v_mov_b32 v7, 0x3f80
    v_cmp_eq_u32 vcc, 4, v16
    s_nop 1
    v_cndmask_b32 v9, v9, v7, vcc
    v_mov_b32 v7, 1.0
    v_cmp_eq_u32 vcc, 5, v16
    s_nop 1
    v_cndmask_b32 v9, v9, v7, vcc
    v_mov_b32 v10, 0
    v_mov_b32 v7, 0x3f80
    v_cmp_eq_u32 vcc, 8, v16
    s_nop 1
    v_cndmask_b32 v10, v10, v7, vcc
    v_mov_b32 v7, 1.0
    v_cmp_eq_u32 vcc, 9, v16
    s_nop 1
    v_cndmask_b32 v10, v10, v7, vcc
    v_mov_b32 v11, 0
    v_mov_b32 v7, 0x3f80
    v_cmp_eq_u32 vcc, 12, v16
    s_nop 1
    v_cndmask_b32 v11, v11, v7, vcc
    v_mov_b32 v7, 1.0
    v_cmp_eq_u32 vcc, 13, v16
    s_nop 1
    v_cndmask_b32 v11, v11, v7, vcc
    s_mov_b32 s9, 0
    s_mov_b32 s10, 51380224
    s_lshl_b32 s20, s8, 13
    s_add_u32 s11, s20, 16777216
    s_add_u32 s12, s20, 33554432
    s_add_u32 s13, s20, 17301504
    s_add_u32 s16, s20, 50331648
    s_lshr_b32 s20, s8, 4
    s_lshl_b32 s14, s20, 10
    s_and_b32 s20, s8, 3
    s_lshl_b32 s20, s20, 8
    s_add_u32 s14, s14, s20
    s_and_b32 s20, s8, 12
    s_lshl_b32 s20, s20, 4
    s_add_u32 s14, s14, s20
    s_add_u32 s14, s14, 50331648
    s_add_u32 s15, s14, 4096
    s_lshr_b32 s20, s8, 3
    s_lshl_b32 s17, s20, 11
    s_and_b32 s20, s8, 6
    s_lshl_b32 s20, s20, 5
    s_add_u32 s17, s17, s20
    s_and_b32 s20, s8, 1
    s_lshl_b32 s20, s20, 9
    s_add_u32 s17, s17, s20
    s_add_u32 s17, s17, 51380224
    s_mov_b32 s19, 4194304
    s_mov_b32 s99, 31
    s_mov_b32 s21, 0
    s_mov_b32 s60, 0
    s_add_u32 s61, s17, 16384
    s_sub_u32 s18, s17, 524288
    s_mov_b32 s96, 0
    s_mov_b32 s56, 0x3e0293ee
    s_mov_b32 s57, 0x3e0293ee
    s_mov_b32 s58, 0x3f803f80
    s_mov_b32 s59, 0x3f803f80
    s_waitcnt vmcnt(24)
    ds_read_b64_tr_b16 v[192:193], v35 offset:18432
    ds_read_b64_tr_b16 v[194:195], v35 offset:18688
    ds_read_b64_tr_b16 v[196:197], v35 offset:19456
    ds_read_b64_tr_b16 v[198:199], v35 offset:19712
    ds_read_b64_tr_b16 v[208:209], v35 offset:18464
    ds_read_b64_tr_b16 v[210:211], v35 offset:18720
    ds_read_b64_tr_b16 v[212:213], v35 offset:19488
    ds_read_b64_tr_b16 v[214:215], v35 offset:19744
    ds_read_b64_tr_b16 v[224:225], v35 offset:18496
    ds_read_b64_tr_b16 v[226:227], v35 offset:18752
    ds_read_b64_tr_b16 v[228:229], v35 offset:19520
    ds_read_b64_tr_b16 v[230:231], v35 offset:19776
    ds_read_b64_tr_b16 v[240:241], v35 offset:18528
    ds_read_b64_tr_b16 v[242:243], v35 offset:18784
    ds_read_b64_tr_b16 v[244:245], v35 offset:19552
    ds_read_b64_tr_b16 v[246:247], v35 offset:19808
    s_waitcnt lgkmcnt(0)
    s_mov_b32 m0, 43008
    s_add_u32 s20, s48, 524288
    buffer_load_dwordx4 v32, s[32:35], s20 offen lds
    s_mov_b32 m0, 44032
    s_add_u32 s20, s48, 557056
    buffer_load_dwordx4 v32, s[32:35], s20 offen lds
    s_mov_b32 m0, 45056
    s_add_u32 s20, s48, 589824
    buffer_load_dwordx4 v32, s[32:35], s20 offen lds
    s_mov_b32 m0, 46080
    s_add_u32 s20, s48, 622592
    buffer_load_dwordx4 v32, s[32:35], s20 offen lds
    s_mov_b32 m0, 47104
    s_add_u32 s20, s48, 1048576
    buffer_load_dwordx4 v32, s[36:39], s20 offen lds
    s_mov_b32 m0, 48128
    s_add_u32 s20, s48, 1081344
    buffer_load_dwordx4 v32, s[36:39], s20 offen lds
    s_mov_b32 m0, 49152
    s_add_u32 s20, s48, 1114112
    buffer_load_dwordx4 v32, s[36:39], s20 offen lds
    s_mov_b32 m0, 50176
    s_add_u32 s20, s48, 1146880
    buffer_load_dwordx4 v32, s[36:39], s20 offen lds
    s_waitcnt vmcnt(24)
    ds_read_b64_tr_b16 v[200:201], v35 offset:26624
    ds_read_b64_tr_b16 v[202:203], v35 offset:26880
    ds_read_b64_tr_b16 v[204:205], v35 offset:27648
    ds_read_b64_tr_b16 v[206:207], v35 offset:27904
    ds_read_b64_tr_b16 v[216:217], v35 offset:26656
    ds_read_b64_tr_b16 v[218:219], v35 offset:26912
    ds_read_b64_tr_b16 v[220:221], v35 offset:27680
    ds_read_b64_tr_b16 v[222:223], v35 offset:27936
    ds_read_b64_tr_b16 v[232:233], v35 offset:26688
    ds_read_b64_tr_b16 v[234:235], v35 offset:26944
    ds_read_b64_tr_b16 v[236:237], v35 offset:27712
    ds_read_b64_tr_b16 v[238:239], v35 offset:27968
    ds_read_b64_tr_b16 v[248:249], v35 offset:26720
    ds_read_b64_tr_b16 v[250:251], v35 offset:26976
    ds_read_b64_tr_b16 v[252:253], v35 offset:27744
    ds_read_b64_tr_b16 v[254:255], v35 offset:28000
    s_waitcnt lgkmcnt(0)
    s_mov_b32 m0, 51200
    s_add_u32 s20, s48, 1048576
    buffer_load_dwordx4 v32, s[40:43], s20 offen lds
    s_mov_b32 m0, 52224
    s_add_u32 s20, s48, 1081344
    buffer_load_dwordx4 v32, s[40:43], s20 offen lds
    s_mov_b32 m0, 53248
    s_add_u32 s20, s48, 1114112
    buffer_load_dwordx4 v32, s[40:43], s20 offen lds
    s_mov_b32 m0, 54272
    s_add_u32 s20, s48, 1146880
    buffer_load_dwordx4 v32, s[40:43], s20 offen lds
    s_mov_b32 m0, 55296
    s_add_u32 s20, s48, 1572864
    buffer_load_dwordx4 v32, s[36:39], s20 offen lds
    s_mov_b32 m0, 56320
    s_add_u32 s20, s48, 1605632
    buffer_load_dwordx4 v32, s[36:39], s20 offen lds
    s_mov_b32 m0, 57344
    s_add_u32 s20, s48, 1638400
    buffer_load_dwordx4 v32, s[36:39], s20 offen lds
    s_mov_b32 m0, 58368
    s_add_u32 s20, s48, 1671168
    buffer_load_dwordx4 v32, s[36:39], s20 offen lds
    s_waitcnt vmcnt(28)
    s_barrier
    ds_read_b64_tr_b16 a[0:1], v34 offset:0
    ds_read_b64_tr_b16 a[2:3], v34 offset:256
    ds_read_b64_tr_b16 a[4:5], v34 offset:2048
    ds_read_b64_tr_b16 a[6:7], v34 offset:2304
    ds_read_b64_tr_b16 a[8:9], v36 offset:0
    ds_read_b64_tr_b16 a[10:11], v36 offset:256
    ds_read_b64_tr_b16 a[12:13], v36 offset:2048
    ds_read_b64_tr_b16 a[14:15], v36 offset:2304
    s_waitcnt lgkmcnt(0)
    s_waitcnt vmcnt(24)
    s_barrier
    ds_read_b64_tr_b16 a[128:129], v34 offset:4096
    ds_read_b64_tr_b16 a[130:131], v34 offset:4352
    ds_read_b64_tr_b16 a[132:133], v34 offset:6144
    ds_read_b64_tr_b16 a[134:135], v34 offset:6400
    ds_read_b64_tr_b16 a[136:137], v36 offset:4096
    ds_read_b64_tr_b16 a[138:139], v36 offset:4352
    ds_read_b64_tr_b16 a[140:141], v36 offset:6144
    ds_read_b64_tr_b16 a[142:143], v36 offset:6400
    s_mov_b32 m0, 24576
    s_add_u32 s20, s48, 1572864
    buffer_load_dwordx4 v32, s[40:43], s20 offen lds
    s_mov_b32 m0, 25600
    s_add_u32 s20, s48, 1605632
    buffer_load_dwordx4 v32, s[40:43], s20 offen lds
    s_mov_b32 m0, 26624
    s_add_u32 s20, s48, 1638400
    buffer_load_dwordx4 v32, s[40:43], s20 offen lds
    s_mov_b32 m0, 27648
    s_add_u32 s20, s48, 1671168
    buffer_load_dwordx4 v32, s[40:43], s20 offen lds
    s_waitcnt lgkmcnt(0)
    s_waitcnt vmcnt(24)
    s_barrier
    ds_read_b64_tr_b16 a[16:17], v34 offset:8192
    ds_read_b64_tr_b16 a[18:19], v34 offset:8448
    ds_read_b64_tr_b16 a[20:21], v34 offset:10240
    ds_read_b64_tr_b16 a[22:23], v34 offset:10496
    ds_read_b64_tr_b16 a[24:25], v36 offset:8192
    ds_read_b64_tr_b16 a[26:27], v36 offset:8448
    ds_read_b64_tr_b16 a[28:29], v36 offset:10240
    ds_read_b64_tr_b16 a[30:31], v36 offset:10496
    s_mov_b32 m0, 28672
    s_add_u32 s20, s48, 1572864
    buffer_load_dwordx4 v32, s[32:35], s20 offen lds
    s_mov_b32 m0, 29696
    s_add_u32 s20, s48, 1605632
    buffer_load_dwordx4 v32, s[32:35], s20 offen lds
    s_mov_b32 m0, 30720
    s_add_u32 s20, s48, 1638400
    buffer_load_dwordx4 v32, s[32:35], s20 offen lds
    s_mov_b32 m0, 31744
    s_add_u32 s20, s48, 1671168
    buffer_load_dwordx4 v32, s[32:35], s20 offen lds
    s_waitcnt lgkmcnt(0)
    s_waitcnt vmcnt(24)
    s_barrier
    ds_read_b64_tr_b16 a[144:145], v34 offset:12288
    ds_read_b64_tr_b16 a[146:147], v34 offset:12544
    ds_read_b64_tr_b16 a[148:149], v34 offset:14336
    ds_read_b64_tr_b16 a[150:151], v34 offset:14592
    ds_read_b64_tr_b16 a[152:153], v36 offset:12288
    ds_read_b64_tr_b16 a[154:155], v36 offset:12544
    ds_read_b64_tr_b16 a[156:157], v36 offset:14336
    ds_read_b64_tr_b16 a[158:159], v36 offset:14592
    s_mov_b32 m0, 32768
    s_add_u32 s20, s48, 2097152
    buffer_load_dwordx4 v32, s[36:39], s20 offen lds
    s_mov_b32 m0, 33792
    s_add_u32 s20, s48, 2129920
    buffer_load_dwordx4 v32, s[36:39], s20 offen lds
    s_mov_b32 m0, 34816
    s_add_u32 s20, s48, 2162688
    buffer_load_dwordx4 v32, s[36:39], s20 offen lds
    s_mov_b32 m0, 35840
    s_add_u32 s20, s48, 2195456
    buffer_load_dwordx4 v32, s[36:39], s20 offen lds
    s_waitcnt lgkmcnt(0)
    s_waitcnt vmcnt(24)
    s_barrier
    ds_read_b64_tr_b16 v[128:129], v34 offset:18432
    ds_read_b64_tr_b16 v[130:131], v34 offset:18688
    ds_read_b64_tr_b16 v[132:133], v34 offset:20480
    ds_read_b64_tr_b16 v[134:135], v34 offset:20736
    ds_read_b64_tr_b16 v[136:137], v36 offset:18432
    ds_read_b64_tr_b16 v[138:139], v36 offset:18688
    ds_read_b64_tr_b16 v[140:141], v36 offset:20480
    ds_read_b64_tr_b16 v[142:143], v36 offset:20736
    s_mov_b32 m0, 36864
    s_add_u32 s20, s48, 2097152
    buffer_load_dwordx4 v32, s[40:43], s20 offen lds
    s_mov_b32 m0, 37888
    s_add_u32 s20, s48, 2129920
    buffer_load_dwordx4 v32, s[40:43], s20 offen lds
    s_mov_b32 m0, 38912
    s_add_u32 s20, s48, 2162688
    buffer_load_dwordx4 v32, s[40:43], s20 offen lds
    s_mov_b32 m0, 39936
    s_add_u32 s20, s48, 2195456
    buffer_load_dwordx4 v32, s[40:43], s20 offen lds
    s_waitcnt lgkmcnt(0)
    ds_write_b128 v2, v[128:131] offset:16384
    ds_write_b128 v2, v[132:135] offset:17408
    s_waitcnt vmcnt(24)
    s_barrier
    ds_read_b64_tr_b16 a[32:33], v34 offset:22528
    ds_read_b64_tr_b16 a[34:35], v34 offset:22784
    ds_read_b64_tr_b16 a[36:37], v34 offset:24576
    ds_read_b64_tr_b16 a[38:39], v34 offset:24832
    ds_read_b64_tr_b16 a[40:41], v36 offset:22528
    ds_read_b64_tr_b16 a[42:43], v36 offset:22784
    ds_read_b64_tr_b16 a[44:45], v36 offset:24576
    ds_read_b64_tr_b16 a[46:47], v36 offset:24832
    s_mov_b32 m0, 43008
    s_add_u32 s20, s48, 2621440
    buffer_load_dwordx4 v32, s[36:39], s20 offen lds
    s_mov_b32 m0, 44032
    s_add_u32 s20, s48, 2654208
    buffer_load_dwordx4 v32, s[36:39], s20 offen lds
    s_mov_b32 m0, 45056
    s_add_u32 s20, s48, 2686976
    buffer_load_dwordx4 v32, s[36:39], s20 offen lds
    s_mov_b32 m0, 46080
    s_add_u32 s20, s48, 2719744
    buffer_load_dwordx4 v32, s[36:39], s20 offen lds
    s_waitcnt lgkmcnt(0)
    s_waitcnt vmcnt(24)
    s_barrier
    ds_read_b64_tr_b16 a[160:161], v34 offset:26624
    ds_read_b64_tr_b16 a[162:163], v34 offset:26880
    ds_read_b64_tr_b16 a[164:165], v34 offset:28672
    ds_read_b64_tr_b16 a[166:167], v34 offset:28928
    ds_read_b64_tr_b16 a[168:169], v36 offset:26624
    ds_read_b64_tr_b16 a[170:171], v36 offset:26880
    ds_read_b64_tr_b16 a[172:173], v36 offset:28672
    ds_read_b64_tr_b16 a[174:175], v36 offset:28928
    s_mov_b32 m0, 47104
    s_add_u32 s20, s48, 2621440
    buffer_load_dwordx4 v32, s[40:43], s20 offen lds
    s_mov_b32 m0, 48128
    s_add_u32 s20, s48, 2654208
    buffer_load_dwordx4 v32, s[40:43], s20 offen lds
    s_mov_b32 m0, 49152
    s_add_u32 s20, s48, 2686976
    buffer_load_dwordx4 v32, s[40:43], s20 offen lds
    s_mov_b32 m0, 50176
    s_add_u32 s20, s48, 2719744
    buffer_load_dwordx4 v32, s[40:43], s20 offen lds
    s_waitcnt lgkmcnt(0)
    s_waitcnt vmcnt(24)
    s_barrier
    ds_read_b64_tr_b16 a[48:49], v34 offset:30720
    ds_read_b64_tr_b16 a[50:51], v34 offset:30976
    ds_read_b64_tr_b16 a[52:53], v34 offset:32768
    ds_read_b64_tr_b16 a[54:55], v34 offset:33024
    ds_read_b64_tr_b16 a[56:57], v36 offset:30720
    ds_read_b64_tr_b16 a[58:59], v36 offset:30976
    ds_read_b64_tr_b16 a[60:61], v36 offset:32768
    ds_read_b64_tr_b16 a[62:63], v36 offset:33024
    s_mov_b32 m0, 51200
    s_add_u32 s20, s48, 2621440
    buffer_load_dwordx4 v32, s[32:35], s20 offen lds
    s_mov_b32 m0, 52224
    s_add_u32 s20, s48, 2654208
    buffer_load_dwordx4 v32, s[32:35], s20 offen lds
    s_mov_b32 m0, 53248
    s_add_u32 s20, s48, 2686976
    buffer_load_dwordx4 v32, s[32:35], s20 offen lds
    s_mov_b32 m0, 54272
    s_add_u32 s20, s48, 2719744
    buffer_load_dwordx4 v32, s[32:35], s20 offen lds
    s_waitcnt lgkmcnt(0)
    s_waitcnt vmcnt(24)
    s_barrier
    ds_read_b64_tr_b16 a[176:177], v34 offset:0
    ds_read_b64_tr_b16 a[178:179], v34 offset:256
    ds_read_b64_tr_b16 a[180:181], v34 offset:2048
    ds_read_b64_tr_b16 a[182:183], v34 offset:2304
    ds_read_b64_tr_b16 a[184:185], v36 offset:0
    ds_read_b64_tr_b16 a[186:187], v36 offset:256
    ds_read_b64_tr_b16 a[188:189], v36 offset:2048
    ds_read_b64_tr_b16 a[190:191], v36 offset:2304
    s_mov_b32 m0, 55296
    s_add_u32 s20, s48, 3145728
    buffer_load_dwordx4 v32, s[36:39], s20 offen lds
    s_mov_b32 m0, 56320
    s_add_u32 s20, s48, 3178496
    buffer_load_dwordx4 v32, s[36:39], s20 offen lds
    s_mov_b32 m0, 57344
    s_add_u32 s20, s48, 3211264
    buffer_load_dwordx4 v32, s[36:39], s20 offen lds
    s_mov_b32 m0, 58368
    s_add_u32 s20, s48, 3244032
    buffer_load_dwordx4 v32, s[36:39], s20 offen lds
    s_waitcnt lgkmcnt(0)
    s_waitcnt vmcnt(24)
    s_barrier
    ds_read_b64_tr_b16 v[144:145], v34 offset:4096
    ds_read_b64_tr_b16 v[146:147], v34 offset:4352
    ds_read_b64_tr_b16 v[148:149], v34 offset:6144
    ds_read_b64_tr_b16 v[150:151], v34 offset:6400
    ds_read_b64_tr_b16 v[152:153], v36 offset:4096
    ds_read_b64_tr_b16 v[154:155], v36 offset:4352
    ds_read_b64_tr_b16 v[156:157], v36 offset:6144
    ds_read_b64_tr_b16 v[158:159], v36 offset:6400
    v_and_b32 v21, 3, v20
    v_lshrrev_b32 v22, 4, v20
    v_and_b32 v23, 1, v22
    v_lshlrev_b32 v23, 10, v23
    v_lshrrev_b32 v22, 1, v22
    v_lshl_add_u32 v23, v22, 6, v23
    v_lshl_add_u32 v23, v21, 1, v23
    s_and_b32 s20, s8, 6
    s_lshl_b32 s20, s20, 10
    s_lshr_b32 s100, s8, 3
    s_lshl_b32 s100, s100, 8
    s_add_u32 s20, s20, s100
    s_and_b32 s100, s8, 1
    s_lshl_b32 s100, s100, 4
    s_add_u32 s20, s20, s100
    s_add_u32 s20, s20, 0
    v_add_u32 v23, s20, v23
    global_load_ushort v24, v23, s[50:51]
    global_load_ushort v25, v23, s[50:51] offset:32
    v_mov_b32 v22, 128
    global_load_dwordx4 v[40:43], v22, s[64:65] sc1
    s_mov_b32 m0, 24576
    s_add_u32 s20, s48, 3145728
    buffer_load_dwordx4 v32, s[40:43], s20 offen lds
    s_mov_b32 m0, 25600
    s_add_u32 s20, s48, 3178496
    buffer_load_dwordx4 v32, s[40:43], s20 offen lds
    s_mov_b32 m0, 26624
    s_add_u32 s20, s48, 3211264
    buffer_load_dwordx4 v32, s[40:43], s20 offen lds
    s_mov_b32 m0, 27648
    s_add_u32 s20, s48, 3244032
    buffer_load_dwordx4 v32, s[40:43], s20 offen lds
    s_waitcnt lgkmcnt(0)
    s_waitcnt vmcnt(27)
    s_barrier
    ds_read_b64_tr_b16 a[64:65], v34 offset:8192
    ds_read_b64_tr_b16 a[66:67], v34 offset:8448
    ds_read_b64_tr_b16 a[68:69], v34 offset:10240
    ds_read_b64_tr_b16 a[70:71], v34 offset:10496
    ds_read_b64_tr_b16 a[72:73], v36 offset:8192
    ds_read_b64_tr_b16 a[74:75], v36 offset:8448
    ds_read_b64_tr_b16 a[76:77], v36 offset:10240
    ds_read_b64_tr_b16 a[78:79], v36 offset:10496
    s_mov_b32 m0, 28672
    s_add_u32 s20, s48, 3670016
    buffer_load_dwordx4 v32, s[36:39], s20 offen lds
    s_mov_b32 m0, 29696
    s_add_u32 s20, s48, 3702784
    buffer_load_dwordx4 v32, s[36:39], s20 offen lds
    s_mov_b32 m0, 30720
    s_add_u32 s20, s48, 3735552
    buffer_load_dwordx4 v32, s[36:39], s20 offen lds
    s_mov_b32 m0, 31744
    s_add_u32 s20, s48, 3768320
    buffer_load_dwordx4 v32, s[36:39], s20 offen lds
    s_waitcnt lgkmcnt(0)
    s_waitcnt vmcnt(27)
    s_barrier
    ds_read_b64_tr_b16 a[192:193], v34 offset:12288
    ds_read_b64_tr_b16 a[194:195], v34 offset:12544
    ds_read_b64_tr_b16 a[196:197], v34 offset:14336
    ds_read_b64_tr_b16 a[198:199], v34 offset:14592
    ds_read_b64_tr_b16 a[200:201], v36 offset:12288
    ds_read_b64_tr_b16 a[202:203], v36 offset:12544
    ds_read_b64_tr_b16 a[204:205], v36 offset:14336
    ds_read_b64_tr_b16 a[206:207], v36 offset:14592
    s_mov_b32 m0, 32768
    s_add_u32 s20, s48, 3670016
    buffer_load_dwordx4 v32, s[40:43], s20 offen lds
    s_mov_b32 m0, 33792
    s_add_u32 s20, s48, 3702784
    buffer_load_dwordx4 v32, s[40:43], s20 offen lds
    s_mov_b32 m0, 34816
    s_add_u32 s20, s48, 3735552
    buffer_load_dwordx4 v32, s[40:43], s20 offen lds
    s_mov_b32 m0, 35840
    s_add_u32 s20, s48, 3768320
    buffer_load_dwordx4 v32, s[40:43], s20 offen lds
    s_waitcnt lgkmcnt(0)
    s_waitcnt vmcnt(27)
    s_barrier
    ds_read_b64_tr_b16 a[80:81], v34 offset:18432
    ds_read_b64_tr_b16 a[82:83], v34 offset:18688
    ds_read_b64_tr_b16 a[84:85], v34 offset:20480
    ds_read_b64_tr_b16 a[86:87], v34 offset:20736
    ds_read_b64_tr_b16 a[88:89], v36 offset:18432
    ds_read_b64_tr_b16 a[90:91], v36 offset:18688
    ds_read_b64_tr_b16 a[92:93], v36 offset:20480
    ds_read_b64_tr_b16 a[94:95], v36 offset:20736
    s_mov_b32 m0, 36864
    s_add_u32 s20, s48, 3670016
    buffer_load_dwordx4 v32, s[32:35], s20 offen lds
    s_mov_b32 m0, 37888
    s_add_u32 s20, s48, 3702784
    buffer_load_dwordx4 v32, s[32:35], s20 offen lds
    s_mov_b32 m0, 38912
    s_add_u32 s20, s48, 3735552
    buffer_load_dwordx4 v32, s[32:35], s20 offen lds
    s_mov_b32 m0, 39936
    s_add_u32 s20, s48, 3768320
    buffer_load_dwordx4 v32, s[32:35], s20 offen lds
    s_waitcnt lgkmcnt(0)
    s_waitcnt vmcnt(27)
    s_barrier
    ds_read_b64_tr_b16 a[208:209], v34 offset:22528
    ds_read_b64_tr_b16 a[210:211], v34 offset:22784
    ds_read_b64_tr_b16 a[212:213], v34 offset:24576
    ds_read_b64_tr_b16 a[214:215], v34 offset:24832
    ds_read_b64_tr_b16 a[216:217], v36 offset:22528
    ds_read_b64_tr_b16 a[218:219], v36 offset:22784
    ds_read_b64_tr_b16 a[220:221], v36 offset:24576
    ds_read_b64_tr_b16 a[222:223], v36 offset:24832
    s_mov_b32 m0, 43008
    s_add_u32 s20, s49, 128
    buffer_load_dwordx4 v33, s[44:47], s20 offen lds
    s_mov_b32 m0, 44032
    s_add_u32 s20, s49, 8320
    buffer_load_dwordx4 v33, s[44:47], s20 offen lds
    s_mov_b32 m0, 45056
    s_add_u32 s20, s49, 16512
    buffer_load_dwordx4 v33, s[44:47], s20 offen lds
    s_mov_b32 m0, 46080
    s_add_u32 s20, s49, 24704
    buffer_load_dwordx4 v33, s[44:47], s20 offen lds
    s_waitcnt lgkmcnt(0)
    s_waitcnt vmcnt(27)
    s_barrier
    ds_read_b64_tr_b16 v[160:161], v34 offset:26624
    ds_read_b64_tr_b16 v[162:163], v34 offset:26880
    ds_read_b64_tr_b16 v[164:165], v34 offset:28672
    ds_read_b64_tr_b16 v[166:167], v34 offset:28928
    ds_read_b64_tr_b16 v[168:169], v36 offset:26624
    ds_read_b64_tr_b16 v[170:171], v36 offset:26880
    ds_read_b64_tr_b16 v[172:173], v36 offset:28672
    ds_read_b64_tr_b16 v[174:175], v36 offset:28928
    s_mov_b32 m0, 47104
    s_add_u32 s20, s49, 32896
    buffer_load_dwordx4 v33, s[44:47], s20 offen lds
    s_mov_b32 m0, 48128
    s_add_u32 s20, s49, 41088
    buffer_load_dwordx4 v33, s[44:47], s20 offen lds
    s_mov_b32 m0, 49152
    s_add_u32 s20, s49, 49280
    buffer_load_dwordx4 v33, s[44:47], s20 offen lds
    s_mov_b32 m0, 50176
    s_add_u32 s20, s49, 57472
    buffer_load_dwordx4 v33, s[44:47], s20 offen lds
    s_waitcnt lgkmcnt(0)
    s_waitcnt vmcnt(27)
    s_barrier
    ds_read_b64_tr_b16 a[96:97], v34 offset:30720
    ds_read_b64_tr_b16 a[98:99], v34 offset:30976
    ds_read_b64_tr_b16 a[100:101], v34 offset:32768
    ds_read_b64_tr_b16 a[102:103], v34 offset:33024
    ds_read_b64_tr_b16 a[104:105], v36 offset:30720
    ds_read_b64_tr_b16 a[106:107], v36 offset:30976
    ds_read_b64_tr_b16 a[108:109], v36 offset:32768
    ds_read_b64_tr_b16 a[110:111], v36 offset:33024
    s_mov_b32 m0, 51200
    s_add_u32 s20, s49, 65664
    buffer_load_dwordx4 v33, s[44:47], s20 offen lds
    s_mov_b32 m0, 52224
    s_add_u32 s20, s49, 73856
    buffer_load_dwordx4 v33, s[44:47], s20 offen lds
    s_mov_b32 m0, 53248
    s_add_u32 s20, s49, 82048
    buffer_load_dwordx4 v33, s[44:47], s20 offen lds
    s_mov_b32 m0, 54272
    s_add_u32 s20, s49, 90240
    buffer_load_dwordx4 v33, s[44:47], s20 offen lds
    s_waitcnt lgkmcnt(0)
    s_waitcnt vmcnt(24)
    s_barrier
    ds_read_b64_tr_b16 a[224:225], v34 offset:0
    ds_read_b64_tr_b16 a[226:227], v34 offset:256
    ds_read_b64_tr_b16 a[228:229], v34 offset:2048
    ds_read_b64_tr_b16 a[230:231], v34 offset:2304
    ds_read_b64_tr_b16 a[232:233], v36 offset:0
    ds_read_b64_tr_b16 a[234:235], v36 offset:256
    ds_read_b64_tr_b16 a[236:237], v36 offset:2048
    ds_read_b64_tr_b16 a[238:239], v36 offset:2304
    s_mov_b32 m0, 55296
    s_add_u32 s20, s49, 98432
    buffer_load_dwordx4 v33, s[44:47], s20 offen lds
    s_mov_b32 m0, 56320
    s_add_u32 s20, s49, 106624
    buffer_load_dwordx4 v33, s[44:47], s20 offen lds
    s_mov_b32 m0, 57344
    s_add_u32 s20, s49, 114816
    buffer_load_dwordx4 v33, s[44:47], s20 offen lds
    s_mov_b32 m0, 58368
    s_add_u32 s20, s49, 123008
    buffer_load_dwordx4 v33, s[44:47], s20 offen lds
    s_waitcnt lgkmcnt(0)
    s_waitcnt vmcnt(24)
    s_barrier
    ds_read_b64_tr_b16 a[112:113], v34 offset:4096
    ds_read_b64_tr_b16 a[114:115], v34 offset:4352
    ds_read_b64_tr_b16 a[116:117], v34 offset:6144
    ds_read_b64_tr_b16 a[118:119], v34 offset:6400
    ds_read_b64_tr_b16 a[120:121], v36 offset:4096
    ds_read_b64_tr_b16 a[122:123], v36 offset:4352
    ds_read_b64_tr_b16 a[124:125], v36 offset:6144
    ds_read_b64_tr_b16 a[126:127], v36 offset:6400
    s_waitcnt vmcnt(32)
RR_29_c0:
    v_readfirstlane_b32 s100, v40
    v_readfirstlane_b32 s101, v41
    v_readfirstlane_b32 s97, v42
    s_cmp_ge_u32 s101, 8
    s_cselect_b32 s100, s100, 0
    s_cmp_eq_u32 s100, -1
    s_cbranch_scc1 RR_29_d0
    global_load_dwordx4 v[40:43], v22, s[64:65] sc1
    s_sub_u32 s19, s19, 1
    s_cbranch_scc1 L_end
    s_waitcnt vmcnt(0)
    s_branch RR_29_c0
RR_29_d0:
    v_lshl_or_b32 v15, v25, 16, v24
    buffer_store_dword v15, v6, s[4:7], s17 offen sc1
    s_add_u32 s17, s17, 8192
    s_mov_b32 m0, 24576
    s_add_u32 s20, s48, 0
    buffer_load_dwordx4 v32, s[32:35], s20 offen lds
    s_mov_b32 m0, 25600
    s_add_u32 s20, s48, 32768
    buffer_load_dwordx4 v32, s[32:35], s20 offen lds
    s_mov_b32 m0, 26624
    s_add_u32 s20, s48, 65536
    buffer_load_dwordx4 v32, s[32:35], s20 offen lds
    s_mov_b32 m0, 27648
    s_add_u32 s20, s48, 98304
    buffer_load_dwordx4 v32, s[32:35], s20 offen lds
    s_waitcnt lgkmcnt(0)
    s_waitcnt vmcnt(25)
    s_barrier
    ds_read_b64_tr_b16 a[240:241], v34 offset:8192
    ds_read_b64_tr_b16 a[242:243], v34 offset:8448
    ds_read_b64_tr_b16 a[244:245], v34 offset:10240
    ds_read_b64_tr_b16 a[246:247], v34 offset:10496
    ds_read_b64_tr_b16 a[248:249], v36 offset:8192
    ds_read_b64_tr_b16 a[250:251], v36 offset:8448
    ds_read_b64_tr_b16 a[252:253], v36 offset:10240
    ds_read_b64_tr_b16 a[254:255], v36 offset:10496
    s_mov_b32 m0, 28672
    s_add_u32 s20, s48, 1048576
    buffer_load_dwordx4 v32, s[32:35], s20 offen lds
    s_mov_b32 m0, 29696
    s_add_u32 s20, s48, 1081344
    buffer_load_dwordx4 v32, s[32:35], s20 offen lds
    s_mov_b32 m0, 30720
    s_add_u32 s20, s48, 1114112
    buffer_load_dwordx4 v32, s[32:35], s20 offen lds
    s_mov_b32 m0, 31744
    s_add_u32 s20, s48, 1146880
    buffer_load_dwordx4 v32, s[32:35], s20 offen lds
    buffer_load_dword v28, v6, s[4:7], s98 offen sc1
    s_waitcnt lgkmcnt(0)
    s_waitcnt vmcnt(26)
    s_barrier
    ds_read_b64_tr_b16 v[176:177], v34 offset:12288
    ds_read_b64_tr_b16 v[178:179], v34 offset:12544
    ds_read_b64_tr_b16 v[180:181], v34 offset:14336
    ds_read_b64_tr_b16 v[182:183], v34 offset:14592
    ds_read_b64_tr_b16 v[184:185], v36 offset:12288
    ds_read_b64_tr_b16 v[186:187], v36 offset:12544
    ds_read_b64_tr_b16 v[188:189], v36 offset:14336
    ds_read_b64_tr_b16 v[190:191], v36 offset:14592
    s_mov_b32 m0, 32768
    s_add_u32 s20, s48, 2097152
    buffer_load_dwordx4 v32, s[32:35], s20 offen lds
    s_mov_b32 m0, 33792
    s_add_u32 s20, s48, 2129920
    buffer_load_dwordx4 v32, s[32:35], s20 offen lds
    s_mov_b32 m0, 34816
    s_add_u32 s20, s48, 2162688
    buffer_load_dwordx4 v32, s[32:35], s20 offen lds
    s_mov_b32 m0, 35840
    s_add_u32 s20, s48, 2195456
    buffer_load_dwordx4 v32, s[32:35], s20 offen lds
    s_waitcnt lgkmcnt(0)
    s_waitcnt vmcnt(22)
    s_barrier
    ds_read_b64_tr_b16 v[64:65], v35 offset:18432
    ds_read_b64_tr_b16 v[66:67], v35 offset:18688
    ds_read_b64_tr_b16 v[68:69], v35 offset:19456
    ds_read_b64_tr_b16 v[70:71], v35 offset:19712
    ds_read_b64_tr_b16 v[80:81], v35 offset:18464
    ds_read_b64_tr_b16 v[82:83], v35 offset:18720
    ds_read_b64_tr_b16 v[84:85], v35 offset:19488
    ds_read_b64_tr_b16 v[86:87], v35 offset:19744
    ds_read_b64_tr_b16 v[96:97], v35 offset:18496
    ds_read_b64_tr_b16 v[98:99], v35 offset:18752
    ds_read_b64_tr_b16 v[100:101], v35 offset:19520
    ds_read_b64_tr_b16 v[102:103], v35 offset:19776
    ds_read_b64_tr_b16 v[112:113], v35 offset:18528
    ds_read_b64_tr_b16 v[114:115], v35 offset:18784
    ds_read_b64_tr_b16 v[116:117], v35 offset:19552
    ds_read_b64_tr_b16 v[118:119], v35 offset:19808
    s_mov_b32 m0, 36864
    s_add_u32 s20, s48, 3145728
    buffer_load_dwordx4 v32, s[32:35], s20 offen lds
    s_mov_b32 m0, 37888
    s_add_u32 s20, s48, 3178496
    buffer_load_dwordx4 v32, s[32:35], s20 offen lds
    s_mov_b32 m0, 38912
    s_add_u32 s20, s48, 3211264
    buffer_load_dwordx4 v32, s[32:35], s20 offen lds
    s_mov_b32 m0, 39936
    s_add_u32 s20, s48, 3244032
    buffer_load_dwordx4 v32, s[32:35], s20 offen lds
    s_waitcnt lgkmcnt(0)
    s_waitcnt vmcnt(18)
    ds_read_b64_tr_b16 v[72:73], v35 offset:26624
    ds_read_b64_tr_b16 v[74:75], v35 offset:26880
    ds_read_b64_tr_b16 v[76:77], v35 offset:27648
    ds_read_b64_tr_b16 v[78:79], v35 offset:27904
    ds_read_b64_tr_b16 v[88:89], v35 offset:26656
    ds_read_b64_tr_b16 v[90:91], v35 offset:26912
    ds_read_b64_tr_b16 v[92:93], v35 offset:27680
    ds_read_b64_tr_b16 v[94:95], v35 offset:27936
    ds_read_b64_tr_b16 v[104:105], v35 offset:26688
    ds_read_b64_tr_b16 v[106:107], v35 offset:26944
    ds_read_b64_tr_b16 v[108:109], v35 offset:27712
    ds_read_b64_tr_b16 v[110:111], v35 offset:27968
    ds_read_b64_tr_b16 v[120:121], v35 offset:26720
    ds_read_b64_tr_b16 v[122:123], v35 offset:26976
    ds_read_b64_tr_b16 v[124:125], v35 offset:27744
    ds_read_b64_tr_b16 v[126:127], v35 offset:28000
    v_lshlrev_b32 v30, 1, v0
    s_add_u32 s20, s16, 0
    buffer_load_dword v7, v30, s[4:7], s20 offen sc1
    s_add_u32 s20, s16, 262144
    buffer_load_dword v7, v30, s[4:7], s20 offen sc1
    s_add_u32 s20, s10, 8192
    buffer_load_dword v7, v30, s[4:7], s20 offen sc1
    s_add_u32 s20, s10, 16384
    buffer_load_dword v7, v30, s[4:7], s20 offen sc1
    s_add_u32 s20, s10, 24576
    buffer_load_dword v7, v30, s[4:7], s20 offen sc1
    s_getpc_b64 s[54:55]
RR_29_pc0:
    v_lshlrev_b32 v30, 3, v0
    v_min_u32 v30, 5632, v30
    global_load_dword v7, v30, s[54:55]
    s_waitcnt lgkmcnt(0)
    ds_write_b128 v2, v[64:67] offset:18432
    ds_write_b128 v2, v[68:71] offset:19456
    ds_write_b128 v2, v[72:75] offset:20480
    ds_write_b128 v2, v[76:79] offset:21504
    ds_write_b128 v2, v[80:83] offset:22528
    ds_write_b128 v2, v[84:87] offset:23552
    ds_write_b128 v2, v[88:91] offset:24576
    ds_write_b128 v2, v[92:95] offset:25600
    ds_write_b128 v2, v[96:99] offset:26624
    ds_write_b128 v2, v[100:103] offset:27648
    ds_write_b128 v2, v[104:107] offset:28672
    ds_write_b128 v2, v[108:111] offset:29696
    ds_write_b128 v2, v[112:115] offset:30720
    ds_write_b128 v2, v[116:119] offset:31744
    ds_write_b128 v2, v[120:123] offset:32768
    ds_write_b128 v2, v[124:127] offset:33792
    s_waitcnt lgkmcnt(0)
    s_waitcnt vmcnt(19)
    s_barrier
    ds_read_b64_tr_b16 v[64:65], v34 offset:0
    ds_read_b64_tr_b16 v[66:67], v34 offset:256
    ds_read_b64_tr_b16 v[68:69], v34 offset:2048
    ds_read_b64_tr_b16 v[70:71], v34 offset:2304
    ds_read_b64_tr_b16 v[72:73], v36 offset:0
    ds_read_b64_tr_b16 v[74:75], v36 offset:256
    ds_read_b64_tr_b16 v[76:77], v36 offset:2048
    ds_read_b64_tr_b16 v[78:79], v36 offset:2304
    buffer_load_dword v13, v6, s[4:7], s98 offen sc1
    s_waitcnt lgkmcnt(0)
    s_waitcnt vmcnt(16)
    s_barrier
    ds_read_b64_tr_b16 v[80:81], v34 offset:4096
    ds_read_b64_tr_b16 v[82:83], v34 offset:4352
    ds_read_b64_tr_b16 v[84:85], v34 offset:6144
    ds_read_b64_tr_b16 v[86:87], v34 offset:6400
    ds_read_b64_tr_b16 v[88:89], v36 offset:4096
    ds_read_b64_tr_b16 v[90:91], v36 offset:4352
    ds_read_b64_tr_b16 v[92:93], v36 offset:6144
    ds_read_b64_tr_b16 v[94:95], v36 offset:6400
    s_waitcnt lgkmcnt(0)
    s_waitcnt vmcnt(11)
    s_barrier
    ds_read_b64_tr_b16 v[96:97], v34 offset:8192
    ds_read_b64_tr_b16 v[98:99], v34 offset:8448
    ds_read_b64_tr_b16 v[100:101], v34 offset:10240
    ds_read_b64_tr_b16 v[102:103], v34 offset:10496
    ds_read_b64_tr_b16 v[104:105], v36 offset:8192
    ds_read_b64_tr_b16 v[106:107], v36 offset:8448
    ds_read_b64_tr_b16 v[108:109], v36 offset:10240
    ds_read_b64_tr_b16 v[110:111], v36 offset:10496
    v_readlane_b32 s100, v28, 0
    s_lshl_b32 s100, s100, 2
    s_add_u32 s100, s100, 0
    s_mov_b32 s96, s100
    v_readlane_b32 s100, v28, 1
    s_lshl_b32 s100, s100, 2
    s_add_u32 s100, s100, 1
    s_min_u32 s96, s96, s100
    v_readlane_b32 s100, v28, 2
    s_lshl_b32 s100, s100, 2
    s_add_u32 s100, s100, 2
    s_min_u32 s96, s96, s100
    v_readlane_b32 s100, v28, 3
    s_lshl_b32 s100, s100, 2
    s_add_u32 s100, s100, 3
    s_min_u32 s96, s96, s100
    s_cmp_ge_u32 s96, 64
    s_cselect_b32 s96, 128, s96
    s_cmp_lt_u32 s96, 2
    s_cselect_b32 s100, 0x40000000, 0
    v_lshlrev_b32 v30, 1, v0
    v_add_u32 v30, s100, v30
    buffer_load_dword v7, v30, s[4:7], s11 offen
    buffer_load_dword v7, v30, s[4:7], s12 offen
    s_add_u32 s20, s11, 262144
    buffer_load_dword v7, v30, s[4:7], s20 offen
    s_waitcnt lgkmcnt(0)
    s_waitcnt vmcnt(10)
    s_barrier
    ds_read_b64_tr_b16 v[112:113], v34 offset:12288
    ds_read_b64_tr_b16 v[114:115], v34 offset:12544
    ds_read_b64_tr_b16 v[116:117], v34 offset:14336
    ds_read_b64_tr_b16 v[118:119], v34 offset:14592
    ds_read_b64_tr_b16 v[120:121], v36 offset:12288
    ds_read_b64_tr_b16 v[122:123], v36 offset:12544
    ds_read_b64_tr_b16 v[124:125], v36 offset:14336
    ds_read_b64_tr_b16 v[126:127], v36 offset:14592
    s_mov_b32 s20, 1
    s_cmp_lt_u32 s20, s96
    s_cbranch_scc1 R0s_r0_ok
    s_waitcnt vmcnt(0)
    v_readlane_b32 s100, v13, 0
    s_lshl_b32 s100, s100, 2
    s_add_u32 s100, s100, 0
    s_mov_b32 s96, s100
    v_readlane_b32 s100, v13, 1
    s_lshl_b32 s100, s100, 2
    s_add_u32 s100, s100, 1
    s_min_u32 s96, s96, s100
    v_readlane_b32 s100, v13, 2
    s_lshl_b32 s100, s100, 2
    s_add_u32 s100, s100, 2
    s_min_u32 s96, s96, s100
    v_readlane_b32 s100, v13, 3
    s_lshl_b32 s100, s100, 2
    s_add_u32 s100, s100, 3
    s_min_u32 s96, s96, s100
    s_cmp_ge_u32 s96, 64
    s_cselect_b32 s96, 128, s96
    s_cmp_lt_u32 s20, s96
    s_cbranch_scc1 R0s_r0_w
R0s_r0:
    buffer_load_dword v7, v6, s[4:7], s98 offen sc1
    s_sub_u32 s19, s19, 1
    s_cbranch_scc1 R0s_r0_to
    s_waitcnt vmcnt(0)
    v_readlane_b32 s100, v7, 0
    s_lshl_b32 s100, s100, 2
    s_add_u32 s100, s100, 0
    s_mov_b32 s96, s100
    v_readlane_b32 s100, v7, 1
    s_lshl_b32 s100, s100, 2
    s_add_u32 s100, s100, 1
    s_min_u32 s96, s96, s100
    v_readlane_b32 s100, v7, 2
    s_lshl_b32 s100, s100, 2
    s_add_u32 s100, s100, 2
    s_min_u32 s96, s96, s100
    v_readlane_b32 s100, v7, 3
    s_lshl_b32 s100, s100, 2
    s_add_u32 s100, s100, 3
    s_min_u32 s96, s96, s100
    s_cmp_ge_u32 s96, 64
    s_cselect_b32 s96, 128, s96
    s_cmp_lt_u32 s20, s96
    s_cbranch_scc1 R0s_r0_w
    s_sleep 8
    s_branch R0s_r0
R0s_r0_to:
    s_mov_b32 s19, 0
    s_mov_b32 s96, 128
    s_waitcnt vmcnt(0)
    s_branch R0s_r0_w
R0s_r0_w:
    v_lshlrev_b32 v30, 1, v0
    buffer_load_dword v7, v30, s[4:7], s11 offen
    buffer_load_dword v7, v30, s[4:7], s12 offen
    s_add_u32 s20, s11, 262144
    buffer_load_dword v7, v30, s[4:7], s20 offen
R0s_r0_ok:
    s_mov_b32 m0, 8192
    s_nop 0
    buffer_load_dwordx4 v0, s[4:7], s11 offen offset:0 nt lds
    buffer_load_dwordx4 v0, s[4:7], s11 offen offset:1024 nt lds
    s_add_u32 s11, s11, 262144
    buffer_load_dwordx4 v[56:59], v0, s[4:7], s10 offen offset:0 sc1
    buffer_load_dwordx4 v[56:59], v0, s[4:7], s10 offen offset:0 sc1
    s_waitcnt lgkmcnt(0)
    s_barrier
    ds_write_b128 v2, v[64:67] offset:0
    ds_write_b128 v2, v[68:71] offset:1024
    ds_write_b128 v2, v[72:75] offset:2048
    ds_write_b128 v2, v[76:79] offset:3072
    ds_write_b128 v2, v[80:83] offset:4096
    ds_write_b128 v2, v[84:87] offset:5120
    ds_write_b128 v2, v[88:91] offset:6144
    ds_write_b128 v2, v[92:95] offset:7168
    ds_write_b128 v2, v[96:99] offset:8192
    ds_write_b128 v2, v[100:103] offset:9216
    ds_write_b128 v2, v[104:107] offset:10240
    ds_write_b128 v2, v[108:111] offset:11264
    ds_write_b128 v2, v[112:115] offset:12288
    ds_write_b128 v2, v[116:119] offset:13312
    ds_write_b128 v2, v[120:123] offset:14336
    ds_write_b128 v2, v[124:127] offset:15360
    s_cmp_lg_u32 s97, 0
    s_cbranch_scc1 RR_29_s0
    v_mov_b64 v[16:17], 0
    v_mov_b64 v[18:19], 0
    v_mov_b64 v[20:21], 0
    v_mov_b64 v[22:23], 0
    v_mov_b64 v[24:25], 0
    v_mov_b64 v[26:27], 0
    v_mov_b64 v[28:29], 0
    v_mov_b64 v[30:31], 0
    v_mov_b64 v[32:33], 0
    v_mov_b64 v[34:35], 0
    v_mov_b64 v[36:37], 0
    v_mov_b64 v[38:39], 0
    s_branch R0f_top
.p2align 6
    s_nop 0
R0f_pe:
    buffer_load_dwordx4 v[56:59], v0, s[4:7], s10 offen offset:0 sc1
    s_sub_u32 s99, s99, 1
    s_cbranch_scc1 R0f_pe_to
R0f_top:
    s_waitcnt vmcnt(1)
    v_fma_f32 v7, v56, v57, v58
    v_cmp_u_f32 vcc, v7, v59
    ds_write_b128 v0, v[56:59] offset:0
    s_cbranch_vccnz R0f_pe
R0f_pe_go:
    v_smfmac_f32_16x16x64_bf16 v[16:19], v[56:59], v[64:71], v1
    buffer_load_dwordx4 v[60:63], v0, s[4:7], s10 offen offset:1024 sc1
    v_smfmac_f32_16x16x64_bf16 v[20:23], v[56:59], v[72:79], v1
    v_smfmac_f32_16x16x64_bf16 v[24:27], v[56:59], a[0:7], v1
    s_waitcnt lgkmcnt(0)
    s_barrier
    ds_read_b128 v[48:51], v0 offset:2048
    v_smfmac_f32_16x16x64_bf16 v[28:31], v[56:59], a[8:15], v1
    ds_read_b128 v[52:55], v0 offset:4096
    v_smfmac_f32_16x16x64_bf16 v[32:35], v[56:59], a[128:135], v1
    v_smfmac_f32_16x16x64_bf16 v[36:39], v[56:59], a[136:143], v1
    s_waitcnt lgkmcnt(1)
    v_smfmac_f32_16x16x64_bf16 v[16:19], v[48:51], v[80:87], v1
    buffer_load_dwordx4 v[40:43], v0, s[4:7], s12 offen offset:0 nt
    v_smfmac_f32_16x16x64_bf16 v[20:23], v[48:51], v[88:95], v1
    buffer_load_dwordx4 v[44:47], v0, s[4:7], s12 offen offset:1024 nt
    ds_read_b128 v[80:83], v0 offset:8192
    v_smfmac_f32_16x16x64_bf16 v[24:27], v[48:51], a[32:39], v1
    s_waitcnt vmcnt(3)
    ds_read_b128 v[56:59], v0 offset:6144
    v_smfmac_f32_16x16x64_bf16 v[28:31], v[48:51], a[40:47], v1
    ds_read_b128 v[84:87], v0 offset:9216
    s_waitcnt lgkmcnt(3)
    v_smfmac_f32_16x16x64_bf16 v[16:19], v[52:55], v[96:103], v1
    ds_read_b128 v[88:91], v0 offset:10240
    v_mov_b32 v12, -1
    v_smfmac_f32_16x16x64_bf16 v[20:23], v[52:55], v[104:111], v1
    v_smfmac_f32_16x16x64_bf16 v[24:27], v[52:55], a[64:71], v1
    s_waitcnt lgkmcnt(2)
    v_smfmac_f32_16x16x64_bf16 v[28:31], v[52:55], a[72:79], v1
    s_waitcnt vmcnt(2)
    ds_write_b128 v0, v[60:63] offset:1024
    v_smfmac_f32_16x16x64_bf16 v[16:19], v[56:59], v[112:119], v1
    v_fma_f32 v7, v60, v61, v62
    v_smfmac_f32_16x16x64_bf16 v[20:23], v[56:59], v[120:127], v1
    buffer_store_dword v12, v6, s[4:7], s61 offen
    v_cmp_u_f32 vcc, v7, v63
    v_smfmac_f32_16x16x64_bf16 v[24:27], v[56:59], a[96:103], v1
    v_smfmac_f32_16x16x64_bf16 v[28:31], v[56:59], a[104:111], v1
    s_cbranch_vccnz R0f_po
R0f_po_ok:
    v_smfmac_f32_16x16x64_bf16 v[32:35], v[56:59], a[224:231], v1
    s_waitcnt lgkmcnt(0)
    s_barrier
    ds_read_b128 v[48:51], v0 offset:3072
    v_smfmac_f32_16x16x64_bf16 v[36:39], v[56:59], a[232:239], v1
    buffer_store_dword v15, v6, s[4:7], s18 offen sc1
    ds_read_b128 v[56:59], v0 offset:5120
    v_smfmac_f32_16x16x64_bf16 v[16:19], v[60:63], v[128:135], v1
    ds_read_b128 v[52:55], v0 offset:7168
    s_add_u32 s20, s9, 2
    v_smfmac_f32_16x16x64_bf16 v[20:23], v[60:63], v[136:143], v1
    s_cmp_lt_u32 s20, s96
    v_smfmac_f32_16x16x64_bf16 v[24:27], v[60:63], a[16:23], v1
    s_cbranch_scc0 R0f_rd
R0f_rd_ok:
    v_smfmac_f32_16x16x64_bf16 v[28:31], v[60:63], a[24:31], v1
    s_waitcnt lgkmcnt(2)
    ds_read_b128 v[92:95], v0 offset:11264
    v_lshlrev_b32 v7, 3, v0
    v_smfmac_f32_16x16x64_bf16 v[16:19], v[48:51], v[144:151], v1
    buffer_load_dword v7, v7, s[4:7], s13 offen
    ds_read_b128 v[96:99], v0 offset:12288
    v_smfmac_f32_16x16x64_bf16 v[20:23], v[48:51], v[152:159], v1
    s_waitcnt lgkmcnt(3)
    ds_read_b128 v[100:103], v0 offset:13312
    v_smfmac_f32_16x16x64_bf16 v[16:19], v[56:59], v[160:167], v1
    ds_read_b128 v[104:107], v0 offset:14336
    v_smfmac_f32_16x16x64_bf16 v[20:23], v[56:59], v[168:175], v1
    s_waitcnt lgkmcnt(4)
    ds_read_b128 v[108:111], v0 offset:15360
    v_smfmac_f32_16x16x64_bf16 v[16:19], v[52:55], v[176:183], v1
    v_smfmac_f32_16x16x64_bf16 v[20:23], v[52:55], v[184:191], v1
    v_smfmac_f32_16x16x64_bf16 v[24:27], v[48:51], a[48:55], v1
    ds_read_b128 v[120:123], v2 offset:32768
    v_add_f32 v16, v16, v18
    v_smfmac_f32_16x16x64_bf16 v[28:31], v[48:51], a[56:63], v1
    ds_read_b128 v[124:127], v2 offset:33792
    v_add_f32 v17, v17, v19
    v_smfmac_f32_16x16x64_bf16 v[24:27], v[56:59], a[80:87], v1
    buffer_load_dword v7, v6, s[4:7], s98 offen sc1
    v_add_f32 v20, v20, v22
    v_smfmac_f32_16x16x64_bf16 v[28:31], v[56:59], a[88:95], v1
    v_add_f32 v21, v21, v23
    v_smfmac_f32_16x16x64_bf16 v[24:27], v[52:55], a[112:119], v1
    v_cvt_pk_bf16_f32 v18, v16, v20
    v_smfmac_f32_16x16x64_bf16 v[28:31], v[52:55], a[120:127], v1
    v_cvt_pk_bf16_f32 v19, v17, v21
    v_smfmac_f32_16x16x64_bf16 v[32:35], v[48:51], a[176:183], v1
    ds_write2_b32 v3, v18, v19 offset0:0 offset1:136
    v_add_f32 v24, v24, v26
    v_smfmac_f32_16x16x64_bf16 v[36:39], v[48:51], a[184:191], v1
    ds_read_b128 v[48:51], v0 offset:2048
    v_add_f32 v25, v25, v27
    v_add_f32 v28, v28, v30
    v_add_f32 v29, v29, v31
    v_cvt_pk_bf16_f32 v128, v24, v28
    v_cvt_pk_bf16_f32 v129, v25, v29
    v_smfmac_f32_16x16x64_bf16 v[32:35], v[52:55], a[240:247], v1
    ds_write2_b32 v3, v128, v129 offset0:64 offset1:200
    v_smfmac_f32_16x16x64_bf16 v[36:39], v[52:55], a[248:255], v1
    ds_read_b128 v[52:55], v0 offset:4096
    v_smfmac_f32_16x16x64_bf16 v[32:35], v[60:63], a[144:151], v1
    v_smfmac_f32_16x16x64_bf16 v[36:39], v[60:63], a[152:159], v1
    v_smfmac_f32_16x16x64_bf16 v[32:35], v[56:59], a[208:215], v1
    s_waitcnt lgkmcnt(1)
    s_barrier
    ds_read_b128 v[64:67], v4 offset:0
    v_smfmac_f32_16x16x64_bf16 v[36:39], v[56:59], a[216:223], v1
    ds_read_b128 v[68:71], v4 offset:64
    ds_read_b128 v[112:115], v4 offset:256
    v_smfmac_f32_16x16x64_bf16 v[32:35], v[48:51], a[160:167], v1
    ds_read_b128 v[116:119], v4 offset:320
    ds_read_b128 v[72:75], v4 offset:128
    s_waitcnt lgkmcnt(5)
    ds_read_b128 v[76:79], v4 offset:192
    s_waitcnt lgkmcnt(5)
    v_mfma_f32_16x16x32_bf16 v[16:19], v[80:83], v[64:67], 0
    buffer_load_dwordx4 v0, s[4:7], s11 offen offset:0 nt lds
    v_mfma_f32_16x16x32_bf16 v[20:23], v[96:99], v[64:67], 0
    buffer_load_dwordx4 v0, s[4:7], s11 offen offset:1024 nt lds
    s_waitcnt lgkmcnt(4)
    v_mfma_f32_16x16x32_bf16 v[16:19], v[84:87], v[68:71], v[16:19]
    v_mov_b64 v[56:57], s[58:59]
    v_mov_b64 v[58:59], s[58:59]
    v_mfma_f32_16x16x32_bf16 v[20:23], v[100:103], v[68:71], v[20:23]
    s_waitcnt lgkmcnt(2)
    v_mfma_f32_16x16x32_bf16 v[24:27], v[112:115], v[64:67], 0
    v_mfma_f32_16x16x32_bf16 v[24:27], v[116:119], v[68:71], v[24:27]
    s_waitcnt lgkmcnt(1)
    v_mfma_f32_16x16x32_bf16 v[16:19], v[88:91], v[72:75], v[16:19]
    ds_read_b128 v[80:83], v2 offset:22528
    v_mfma_f32_16x16x32_bf16 v[20:23], v[104:107], v[72:75], v[20:23]
    s_waitcnt lgkmcnt(1)
    ds_read_b128 v[84:87], v2 offset:23552
    v_mfma_f32_16x16x32_bf16 v[16:19], v[92:95], v[76:79], v[16:19]
    ds_read_b128 v[64:67], v2 offset:18432
    v_add_f32_dpp v24, v26, v24 quad_perm:[2,3,0,1] row_mask:0xf bank_mask:0xf
    v_add_f32_dpp v25, v27, v25 quad_perm:[2,3,0,1] row_mask:0xf bank_mask:0xf
    v_mfma_f32_16x16x32_bf16 v[20:23], v[108:111], v[76:79], v[20:23]
    ds_read_b128 v[68:71], v2 offset:19456
    v_max_f32 v132, v24, v25
    v_smfmac_f32_16x16x64_bf16 v[36:39], v[48:51], a[168:175], v1
    ds_read_b128 v[88:91], v2 offset:24576
    ds_read_b128 v[72:75], v2 offset:20480
    v_max3_f32 v132, v132, v16, v17
    v_max3_f32 v132, v132, v18, v19
    v_max3_f32 v134, v132, v20, v21
    v_max3_f32 v132, v134, v22, v23
    v_max3_f32 v133, v134, v22, v23
    v_smfmac_f32_16x16x64_bf16 v[32:35], v[52:55], a[192:199], v1
    ds_read_b128 v[92:95], v2 offset:25600
    ds_read_b128 v[96:99], v2 offset:26624
    v_permlane16_swap_b32 v132, v133
    v_max_f32 v134, v132, v133
    v_max_f32 v135, v132, v133
    v_smfmac_f32_16x16x64_bf16 v[36:39], v[52:55], a[200:207], v1
    ds_read_b128 v[100:103], v2 offset:27648
    v_permlane32_swap_b32 v134, v135
    v_max_f32 v132, v134, v135
    v_fma_f32 v132, v132, s56, v14
    v_pk_fma_f32 v[24:25], v[24:25], s[56:57], v[132:133] op_sel_hi:[1,1,0] neg_lo:[0,0,1] neg_hi:[0,0,1]
    v_pk_fma_f32 v[16:17], v[16:17], s[56:57], v[132:133] op_sel_hi:[1,1,0] neg_lo:[0,0,1] neg_hi:[0,0,1]
    v_pk_fma_f32 v[18:19], v[18:19], s[56:57], v[132:133] op_sel_hi:[1,1,0] neg_lo:[0,0,1] neg_hi:[0,0,1]
    v_pk_fma_f32 v[20:21], v[20:21], s[56:57], v[132:133] op_sel_hi:[1,1,0] neg_lo:[0,0,1] neg_hi:[0,0,1]
    v_pk_fma_f32 v[22:23], v[22:23], s[56:57], v[132:133] op_sel_hi:[1,1,0] neg_lo:[0,0,1] neg_hi:[0,0,1]
    v_pk_add_f32 v[32:33], v[32:33], v[34:35]
    v_pk_add_f32 v[36:37], v[36:37], v[38:39]
    v_cvt_pk_bf16_f32 v130, v32, v33
    v_cvt_pk_bf16_f32 v131, v36, v37
    v_exp_f32 v24, v24
    v_exp_f32 v25, v25
    v_exp_f32 v16, v16
    v_cvt_pk_bf16_f32 v12, v24, v25
    v_exp_f32 v17, v17
    v_exp_f32 v18, v18
    v_mov_b32_dpp v13, v12 quad_perm:[2,3,0,1] row_mask:0xf bank_mask:0xf
    v_exp_f32 v19, v19
    v_cvt_pk_bf16_f32 v28, v16, v17
    v_mfma_f32_16x16x16_bf16 v[60:63], v[56:57], v[12:13], 0
    ds_read_b128 v[76:79], v2 offset:21504
    v_exp_f32 v20, v20
    v_cvt_pk_bf16_f32 v29, v18, v19
    v_mfma_f32_16x16x16_bf16 v[48:51], v[130:131], v[12:13], 0
    s_waitcnt vmcnt(6)
    v_exp_f32 v21, v21
    v_exp_f32 v22, v22
    v_exp_f32 v23, v23
    v_cvt_pk_bf16_f32 v30, v20, v21
    v_cvt_pk_bf16_f32 v31, v22, v23
    v_mov_b32_dpp v16, v28 quad_perm:[2,3,0,1] row_mask:0xf bank_mask:0xf
    v_mov_b32_dpp v17, v29 quad_perm:[2,3,0,1] row_mask:0xf bank_mask:0xf
    v_mfma_f32_16x16x32_bf16 v[60:63], v[56:59], v[28:31], v[60:63]
    v_mov_b32_dpp v18, v30 quad_perm:[2,3,0,1] row_mask:0xf bank_mask:0xf
    v_mov_b32_dpp v19, v31 quad_perm:[2,3,0,1] row_mask:0xf bank_mask:0xf
    v_mfma_f32_16x16x32_bf16 v[48:51], v[40:43], v[28:31], v[48:51]
    v_mov_b64 v[24:25], 0
    v_mov_b64 v[26:27], 0
    v_mfma_f32_16x16x32_bf16 v[48:51], v[44:47], v[16:19], v[48:51]
    v_rcp_f32_dpp v132, v60 quad_perm:[0,1,0,1] row_mask:0xf bank_mask:0xf
    v_mov_b64 v[20:21], 0
    v_mov_b64 v[22:23], 0
    v_mov_b64 v[16:17], 0
    v_mov_b64 v[18:19], 0
    v_mov_b64 v[28:29], 0
    v_pk_mul_f32 v[48:49], v[48:49], v[132:133] op_sel_hi:[1,0]
    v_pk_mul_f32 v[50:51], v[50:51], v[132:133] op_sel_hi:[1,0]
    v_cvt_pk_bf16_f32 v134, v48, v49
    v_cvt_pk_bf16_f32 v135, v50, v51
    ds_write_b64 v0, v[134:135] offset:22016
    v_mov_b64 v[30:31], 0
    v_mov_b64 v[48:49], 0
    v_mov_b64 v[50:51], 0
    v_mov_b64 v[32:33], 0
    v_mov_b64 v[34:35], 0
    v_mov_b64 v[36:37], 0
    v_mov_b64 v[38:39], 0
    v_mov_b64 v[52:53], 0
    v_mov_b64 v[54:55], 0
    s_add_u32 s11, s11, 262144
    s_add_u32 s12, s12, 262144
    s_add_u32 s9, s9, 1
    s_waitcnt lgkmcnt(0)
    s_barrier
    ds_read_b128 v[56:59], v0 offset:22016
    ds_read_b128 v[60:63], v0 offset:23040
    s_add_u32 s10, s10, 8192
    s_and_b32 s10, s10, 0xffff7fff
    s_add_u32 s13, s13, 262144
    s_add_u32 s18, s18, 8192
    s_xor_b32 s61, s17, 16384
    s_waitcnt lgkmcnt(1)
    v_smfmac_f32_16x16x64_bf16 v[16:19], v[56:59], v[192:199], v1
    v_smfmac_f32_16x16x64_bf16 v[20:23], v[56:59], v[208:215], v1
    s_waitcnt lgkmcnt(0)
    v_smfmac_f32_16x16x64_bf16 v[16:19], v[60:63], v[200:207], v1
    ds_read_b128 v[104:107], v2 offset:28672
    v_smfmac_f32_16x16x64_bf16 v[20:23], v[60:63], v[216:223], v1
    ds_read_b128 v[108:111], v2 offset:29696
    v_smfmac_f32_16x16x64_bf16 v[24:27], v[56:59], v[224:231], v1
    ds_read_b128 v[112:115], v2 offset:30720
    v_add_f32 v16, v16, v18
    v_smfmac_f32_16x16x64_bf16 v[24:27], v[60:63], v[232:239], v1
    ds_read_b128 v[116:119], v2 offset:31744
    v_add_f32 v20, v20, v22
    v_smfmac_f32_16x16x64_bf16 v[28:31], v[56:59], v[240:247], v1
    v_add_f32 v17, v17, v19
    v_smfmac_f32_16x16x64_bf16 v[28:31], v[60:63], v[248:255], v1
    v_add_f32 v21, v21, v23
    v_smfmac_f32_16x16x64_bf16 v[32:35], v[56:59], v[64:71], v1
    v_cvt_pk_bf16_f32 v16, v16, v20
    v_bfi_b32 v16, 1, s21, v16
    v_cvt_pk_bf16_f32 v17, v17, v21
    v_add_f32 v24, v24, v26
    v_add_f32 v25, v25, v27
    v_add_f32 v28, v28, v30
    v_add_f32 v29, v29, v31
    v_cvt_pk_bf16_f32 v18, v24, v28
    v_cvt_pk_bf16_f32 v19, v25, v29
    v_smfmac_f32_16x16x64_bf16 v[32:35], v[60:63], v[72:79], v1
    buffer_store_dwordx4 v[16:19], v5, s[4:7], s14 offen
    v_smfmac_f32_16x16x64_bf16 v[36:39], v[56:59], v[80:87], v1
    v_smfmac_f32_16x16x64_bf16 v[36:39], v[60:63], v[88:95], v1
    s_waitcnt lgkmcnt(0)
    v_add_f32 v32, v32, v34
    v_smfmac_f32_16x16x64_bf16 v[48:51], v[56:59], v[96:103], v1
    v_add_f32 v33, v33, v35
    v_smfmac_f32_16x16x64_bf16 v[48:51], v[60:63], v[104:111], v1
    v_add_f32 v36, v36, v38
    v_smfmac_f32_16x16x64_bf16 v[52:55], v[56:59], v[112:119], v1
    v_add_f32 v37, v37, v39
    v_smfmac_f32_16x16x64_bf16 v[52:55], v[60:63], v[120:127], v1
    v_cvt_pk_bf16_f32 v32, v32, v36
    v_bfi_b32 v32, 1, s21, v32
    v_cvt_pk_bf16_f32 v33, v33, v37
    v_add_f32 v48, v48, v50
    v_add_f32 v49, v49, v51
    s_nop 1
    v_add_f32 v52, v52, v54
    v_add_f32 v53, v53, v55
    v_cvt_pk_bf16_f32 v34, v48, v52
    v_cvt_pk_bf16_f32 v35, v49, v53
    buffer_store_dwordx4 v[32:35], v5, s[4:7], s15 offen
    v_mov_b64 v[16:17], 0
    v_mov_b64 v[18:19], 0
    v_mov_b64 v[20:21], 0
    v_mov_b64 v[22:23], 0
    v_mov_b64 v[24:25], 0
    v_mov_b64 v[26:27], 0
    v_mov_b64 v[28:29], 0
    v_mov_b64 v[30:31], 0
    v_mov_b64 v[32:33], 0
    v_mov_b64 v[34:35], 0
    v_mov_b64 v[36:37], 0
    v_mov_b64 v[38:39], 0
    ds_read_b128 v[64:67], v2 offset:0
    ds_read_b128 v[68:71], v2 offset:1024
    ds_read_b128 v[72:75], v2 offset:2048
    ds_read_b128 v[76:79], v2 offset:3072
    ds_read_b128 v[80:83], v2 offset:4096
    ds_read_b128 v[84:87], v2 offset:5120
    s_waitcnt vmcnt(1)
    buffer_load_dwordx4 v[56:59], v0, s[4:7], s16 offen offset:0 sc1
    buffer_load_dwordx4 v[60:63], v0, s[4:7], s16 offen offset:1024 sc1
    ds_read_b128 v[88:91], v2 offset:6144
    ds_read_b128 v[92:95], v2 offset:7168
    ds_read_b128 v[96:99], v2 offset:8192
    ds_read_b128 v[100:103], v2 offset:9216
    s_waitcnt lgkmcnt(0)
    buffer_load_dwordx4 v[40:43], v0, s[4:7], s16 offen offset:0 sc1
    buffer_load_dwordx4 v[44:47], v0, s[4:7], s16 offen offset:1024 sc1
    ds_read_b128 v[104:107], v2 offset:10240
    ds_read_b128 v[108:111], v2 offset:11264
    s_waitcnt vmcnt(3)
    v_mfma_f32_16x16x32_bf16 v[48:51], v[8:11], v[56:59], 0
    s_waitcnt vmcnt(2)
    v_mfma_f32_16x16x32_bf16 v[48:51], v[8:11], v[60:63], v[48:51]
    v_and_b32 v13, 1, v56
    v_and_b32 v12, 1, v60
    v_add_u32 v12, v13, v12
    v_cmp_ne_u32 vcc, s60, v12
    s_nop 2
    v_add_f32_dpp v48, v48, v48 row_ror:4 row_mask:0xf bank_mask:0xf
    v_add_f32_dpp v49, v49, v49 row_ror:4 row_mask:0xf bank_mask:0xf
    s_cbranch_vccnz R0f_p1
    v_add_f32_dpp v48, v48, v48 row_ror:8 row_mask:0xf bank_mask:0xf
    v_add_f32_dpp v49, v49, v49 row_ror:8 row_mask:0xf bank_mask:0xf
    v_cvt_pk_bf16_f32 v15, v48, v49
    buffer_store_dword v15, v6, s[4:7], s17 offen
R0f_p1_ok:
    s_cmp_eq_u32 s9, 63
    s_cbranch_scc1 R0f_fin
    s_xor_b32 s14, s14, 262144
    s_xor_b32 s15, s15, 262144
    s_add_u32 s17, s17, 8192
    s_and_b32 s17, s17, 0xffff7fff
    s_xor_b32 s16, s16, 262144
    s_min_u32 s99, s19, 31
    s_and_b32 s60, s9, 2
    s_lshr_b32 s21, s60, 1
    ds_read_b128 v[112:115], v2 offset:12288
    ds_read_b128 v[116:119], v2 offset:13312
    s_waitcnt lgkmcnt(0)
    buffer_load_dwordx4 v[56:59], v0, s[4:7], s10 offen offset:0 sc1
    ds_read_b128 v[120:123], v2 offset:14336
    ds_read_b128 v[124:127], v2 offset:15360
    ds_read_b128 v[128:131], v2 offset:16384
    ds_read_b128 v[132:135], v2 offset:17408
    s_waitcnt lgkmcnt(0)
    buffer_load_dwordx4 v[56:59], v0, s[4:7], s10 offen offset:0 sc1
    s_cmp_eq_u32 s96, 128
    s_cbranch_scc1 R0f_top
    v_readlane_b32 s100, v7, 0
    s_lshl_b32 s100, s100, 2
    s_add_u32 s100, s100, 0
    s_mov_b32 s96, s100
    v_readlane_b32 s100, v7, 1
    s_lshl_b32 s100, s100, 2
    s_add_u32 s100, s100, 1
    s_min_u32 s96, s96, s100
    v_readlane_b32 s100, v7, 2
    s_lshl_b32 s100, s100, 2
    s_add_u32 s100, s100, 2
    s_min_u32 s96, s96, s100
    v_readlane_b32 s100, v7, 3
    s_lshl_b32 s100, s100, 2
    s_add_u32 s100, s100, 3
    s_min_u32 s96, s96, s100
    s_cmp_ge_u32 s96, 64
    s_cselect_b32 s96, 128, s96
    s_branch R0f_top
R0f_pe_to:
    s_mov_b32 s99, 31
    s_waitcnt vmcnt(0)
    v_max3_u32 v7, v56, v57, v58
    v_max_u32 v7, v7, v59
    v_cmp_eq_u32 vcc, -1, v7
    ds_write_b128 v0, v[56:59] offset:0
    s_cbranch_vccz R0f_pe_go
    s_sub_u32 s19, s19, 32
    s_cbranch_scc0 R0f_pe
    s_mov_b32 s19, 0
    s_mov_b32 s99, 0
    s_branch R0f_pe_go
R0f_po:
    buffer_load_dwordx4 v[60:63], v0, s[4:7], s10 offen offset:1024 sc1
    s_sub_u32 s19, s19, 1
    s_cbranch_scc1 R0f_po_to
    s_waitcnt vmcnt(0)
    ds_write_b128 v0, v[60:63] offset:1024
    v_max3_u32 v7, v60, v61, v62
    v_max_u32 v7, v7, v63
    v_cmp_eq_u32 vcc, -1, v7
    s_cbranch_vccnz R0f_po
    s_branch R0f_po_ok
R0f_po_to:
    s_mov_b32 s19, 0
    s_waitcnt vmcnt(0)
    ds_write_b128 v0, v[60:63] offset:1024
    s_branch R0f_po_ok
R0f_rd:
    buffer_load_dword v7, v6, s[4:7], s98 offen sc1
    s_sub_u32 s19, s19, 1
    s_cbranch_scc1 R0f_rd_to
    s_waitcnt vmcnt(0)
    v_readlane_b32 s100, v7, 0
    s_lshl_b32 s100, s100, 2
    s_add_u32 s100, s100, 0
    s_mov_b32 s96, s100
    v_readlane_b32 s100, v7, 1
    s_lshl_b32 s100, s100, 2
    s_add_u32 s100, s100, 1
    s_min_u32 s96, s96, s100
    v_readlane_b32 s100, v7, 2
    s_lshl_b32 s100, s100, 2
    s_add_u32 s100, s100, 2
    s_min_u32 s96, s96, s100
    v_readlane_b32 s100, v7, 3
    s_lshl_b32 s100, s100, 2
    s_add_u32 s100, s100, 3
    s_min_u32 s96, s96, s100
    s_cmp_ge_u32 s96, 64
    s_cselect_b32 s96, 128, s96
    s_cmp_lt_u32 s20, s96
    s_cbranch_scc1 R0f_rd_ok
    s_sleep 8
    s_branch R0f_rd
R0f_rd_to:
    s_mov_b32 s19, 0
    s_mov_b32 s96, 128
    s_waitcnt vmcnt(0)
    s_branch R0f_rd_ok
R0f_p1:
    buffer_load_dwordx4 v[56:59], v0, s[4:7], s16 offen offset:0 sc1
    buffer_load_dwordx4 v[60:63], v0, s[4:7], s16 offen offset:1024 sc1
    s_waitcnt vmcnt(3)
    v_mfma_f32_16x16x32_bf16 v[48:51], v[8:11], v[40:43], 0
    s_waitcnt vmcnt(2)
    v_mfma_f32_16x16x32_bf16 v[48:51], v[8:11], v[44:47], v[48:51]
    v_and_b32 v13, 1, v40
    v_and_b32 v12, 1, v44
    v_add_u32 v12, v13, v12
    v_cmp_ne_u32 vcc, s60, v12
    s_nop 2
    v_add_f32_dpp v48, v48, v48 row_ror:4 row_mask:0xf bank_mask:0xf
    v_add_f32_dpp v49, v49, v49 row_ror:4 row_mask:0xf bank_mask:0xf
    s_cbranch_vccnz R0f_p1b
    v_add_f32_dpp v48, v48, v48 row_ror:8 row_mask:0xf bank_mask:0xf
    v_add_f32_dpp v49, v49, v49 row_ror:8 row_mask:0xf bank_mask:0xf
    v_cvt_pk_bf16_f32 v15, v48, v49
    buffer_store_dword v15, v6, s[4:7], s17 offen
    s_branch R0f_p1_ok
R0f_p1b:
    buffer_load_dwordx4 v[40:43], v0, s[4:7], s16 offen offset:0 sc1
    buffer_load_dwordx4 v[44:47], v0, s[4:7], s16 offen offset:1024 sc1
    s_sub_u32 s19, s19, 1
    s_cbranch_scc1 R0f_p1_to
    s_waitcnt vmcnt(3)
    v_mfma_f32_16x16x32_bf16 v[48:51], v[8:11], v[56:59], 0
    s_waitcnt vmcnt(2)
    v_mfma_f32_16x16x32_bf16 v[48:51], v[8:11], v[60:63], v[48:51]
    v_and_b32 v13, 1, v56
    v_and_b32 v12, 1, v60
    v_add_u32 v12, v13, v12
    v_cmp_ne_u32 vcc, s60, v12
    s_nop 2
    v_add_f32_dpp v48, v48, v48 row_ror:4 row_mask:0xf bank_mask:0xf
    v_add_f32_dpp v49, v49, v49 row_ror:4 row_mask:0xf bank_mask:0xf
    s_cbranch_vccnz R0f_p1
    v_add_f32_dpp v48, v48, v48 row_ror:8 row_mask:0xf bank_mask:0xf
    v_add_f32_dpp v49, v49, v49 row_ror:8 row_mask:0xf bank_mask:0xf
    v_cvt_pk_bf16_f32 v15, v48, v49
    buffer_store_dword v15, v6, s[4:7], s17 offen
    s_branch R0f_p1_ok
R0f_p1_to:
    s_mov_b32 s19, 0
    v_add_f32_dpp v48, v48, v48 row_ror:8 row_mask:0xf bank_mask:0xf
    v_add_f32_dpp v49, v49, v49 row_ror:8 row_mask:0xf bank_mask:0xf
    v_cvt_pk_bf16_f32 v15, v48, v49
    buffer_store_dword v15, v6, s[4:7], s17 offen
    s_branch R0f_p1_ok
R0f_fin:
    buffer_store_dword v15, v6, s[4:7], s18 offen sc1
    s_branch L_end
RR_29_s0:
    v_mov_b64 v[16:17], 0
    v_mov_b64 v[18:19], 0
    v_mov_b64 v[20:21], 0
    v_mov_b64 v[22:23], 0
    v_mov_b64 v[24:25], 0
    v_mov_b64 v[26:27], 0
    v_mov_b64 v[28:29], 0
    v_mov_b64 v[30:31], 0
    v_mov_b64 v[32:33], 0
    v_mov_b64 v[34:35], 0
    v_mov_b64 v[36:37], 0
    v_mov_b64 v[38:39], 0
    s_branch R0s_top
.p2align 6
    s_nop 0
R0s_pe:
    buffer_load_dwordx4 v[56:59], v0, s[4:7], s10 offen offset:0 sc1
    s_sub_u32 s99, s99, 1
    s_cbranch_scc1 R0s_pe_to
R0s_top:
    s_waitcnt vmcnt(1)
    v_fma_f32 v7, v56, v57, v58
    v_cmp_u_f32 vcc, v7, v59
    ds_write_b128 v0, v[56:59] offset:0
    s_cbranch_vccnz R0s_pe
R0s_pe_go:
    v_smfmac_f32_16x16x64_bf16 v[16:19], v[56:59], v[64:71], v1
    buffer_load_dwordx4 v[60:63], v0, s[4:7], s10 offen offset:1024 sc1
    v_smfmac_f32_16x16x64_bf16 v[20:23], v[56:59], v[72:79], v1
    v_smfmac_f32_16x16x64_bf16 v[24:27], v[56:59], a[0:7], v1
    s_waitcnt lgkmcnt(0)
    s_barrier
    ds_read_b128 v[48:51], v0 offset:2048
    v_smfmac_f32_16x16x64_bf16 v[28:31], v[56:59], a[8:15], v1
    ds_read_b128 v[52:55], v0 offset:4096
    v_smfmac_f32_16x16x64_bf16 v[32:35], v[56:59], a[128:135], v1
    v_smfmac_f32_16x16x64_bf16 v[36:39], v[56:59], a[136:143], v1
    s_waitcnt lgkmcnt(1)
    v_smfmac_f32_16x16x64_bf16 v[16:19], v[48:51], v[80:87], v1
    buffer_load_dwordx4 v[40:43], v0, s[4:7], s12 offen offset:0 nt
    v_smfmac_f32_16x16x64_bf16 v[20:23], v[48:51], v[88:95], v1
    buffer_load_dwordx4 v[44:47], v0, s[4:7], s12 offen offset:1024 nt
    ds_read_b128 v[80:83], v0 offset:8192
    v_smfmac_f32_16x16x64_bf16 v[24:27], v[48:51], a[32:39], v1
    s_waitcnt vmcnt(3)
    ds_read_b128 v[56:59], v0 offset:6144
    v_smfmac_f32_16x16x64_bf16 v[28:31], v[48:51], a[40:47], v1
    ds_read_b128 v[84:87], v0 offset:9216
    s_waitcnt lgkmcnt(3)
    v_smfmac_f32_16x16x64_bf16 v[16:19], v[52:55], v[96:103], v1
    ds_read_b128 v[88:91], v0 offset:10240
    v_mov_b32 v12, -1
    v_smfmac_f32_16x16x64_bf16 v[20:23], v[52:55], v[104:111], v1
    v_smfmac_f32_16x16x64_bf16 v[24:27], v[52:55], a[64:71], v1
    s_waitcnt lgkmcnt(2)
    v_smfmac_f32_16x16x64_bf16 v[28:31], v[52:55], a[72:79], v1
    s_waitcnt vmcnt(2)
    ds_write_b128 v0, v[60:63] offset:1024
    v_smfmac_f32_16x16x64_bf16 v[16:19], v[56:59], v[112:119], v1
    v_fma_f32 v7, v60, v61, v62
    v_smfmac_f32_16x16x64_bf16 v[20:23], v[56:59], v[120:127], v1
    buffer_store_dword v12, v6, s[4:7], s61 offen sc1
    v_cmp_u_f32 vcc, v7, v63
    v_smfmac_f32_16x16x64_bf16 v[24:27], v[56:59], a[96:103], v1
    v_smfmac_f32_16x16x64_bf16 v[28:31], v[56:59], a[104:111], v1
    s_cbranch_vccnz R0s_po
R0s_po_ok:
    v_smfmac_f32_16x16x64_bf16 v[32:35], v[56:59], a[224:231], v1
    s_waitcnt lgkmcnt(0)
    s_barrier
    ds_read_b128 v[48:51], v0 offset:3072
    v_smfmac_f32_16x16x64_bf16 v[36:39], v[56:59], a[232:239], v1
    buffer_store_dword v15, v6, s[4:7], s18 offen sc1
    ds_read_b128 v[56:59], v0 offset:5120
    v_smfmac_f32_16x16x64_bf16 v[16:19], v[60:63], v[128:135], v1
    ds_read_b128 v[52:55], v0 offset:7168
    s_add_u32 s20, s9, 2
    v_smfmac_f32_16x16x64_bf16 v[20:23], v[60:63], v[136:143], v1
    s_cmp_lt_u32 s20, s96
    v_smfmac_f32_16x16x64_bf16 v[24:27], v[60:63], a[16:23], v1
    s_cbranch_scc0 R0s_rd
R0s_rd_ok:
    v_smfmac_f32_16x16x64_bf16 v[28:31], v[60:63], a[24:31], v1
    s_waitcnt lgkmcnt(2)
    ds_read_b128 v[92:95], v0 offset:11264
    v_lshlrev_b32 v7, 3, v0
    v_smfmac_f32_16x16x64_bf16 v[16:19], v[48:51], v[144:151], v1
    buffer_load_dword v7, v7, s[4:7], s13 offen
    ds_read_b128 v[96:99], v0 offset:12288
    v_smfmac_f32_16x16x64_bf16 v[20:23], v[48:51], v[152:159], v1
    s_waitcnt lgkmcnt(3)
    ds_read_b128 v[100:103], v0 offset:13312
    v_smfmac_f32_16x16x64_bf16 v[16:19], v[56:59], v[160:167], v1
    ds_read_b128 v[104:107], v0 offset:14336
    v_smfmac_f32_16x16x64_bf16 v[20:23], v[56:59], v[168:175], v1
    s_waitcnt lgkmcnt(4)
    ds_read_b128 v[108:111], v0 offset:15360
    v_smfmac_f32_16x16x64_bf16 v[16:19], v[52:55], v[176:183], v1
    v_smfmac_f32_16x16x64_bf16 v[20:23], v[52:55], v[184:191], v1
    v_smfmac_f32_16x16x64_bf16 v[24:27], v[48:51], a[48:55], v1
    ds_read_b128 v[120:123], v2 offset:32768
    v_add_f32 v16, v16, v18
    v_smfmac_f32_16x16x64_bf16 v[28:31], v[48:51], a[56:63], v1
    ds_read_b128 v[124:127], v2 offset:33792
    v_add_f32 v17, v17, v19
    v_smfmac_f32_16x16x64_bf16 v[24:27], v[56:59], a[80:87], v1
    buffer_load_dword v7, v6, s[4:7], s98 offen sc1
    v_add_f32 v20, v20, v22
    v_smfmac_f32_16x16x64_bf16 v[28:31], v[56:59], a[88:95], v1
    v_add_f32 v21, v21, v23
    v_smfmac_f32_16x16x64_bf16 v[24:27], v[52:55], a[112:119], v1
    v_cvt_pk_bf16_f32 v18, v16, v20
    v_smfmac_f32_16x16x64_bf16 v[28:31], v[52:55], a[120:127], v1
    v_cvt_pk_bf16_f32 v19, v17, v21
    v_smfmac_f32_16x16x64_bf16 v[32:35], v[48:51], a[176:183], v1
    ds_write2_b32 v3, v18, v19 offset0:0 offset1:136
    v_add_f32 v24, v24, v26
    v_smfmac_f32_16x16x64_bf16 v[36:39], v[48:51], a[184:191], v1
    ds_read_b128 v[48:51], v0 offset:2048
    v_add_f32 v25, v25, v27
    v_add_f32 v28, v28, v30
    v_add_f32 v29, v29, v31
    v_cvt_pk_bf16_f32 v128, v24, v28
    v_cvt_pk_bf16_f32 v129, v25, v29
    v_smfmac_f32_16x16x64_bf16 v[32:35], v[52:55], a[240:247], v1
    ds_write2_b32 v3, v128, v129 offset0:64 offset1:200
    v_smfmac_f32_16x16x64_bf16 v[36:39], v[52:55], a[248:255], v1
    ds_read_b128 v[52:55], v0 offset:4096
    v_smfmac_f32_16x16x64_bf16 v[32:35], v[60:63], a[144:151], v1
    v_smfmac_f32_16x16x64_bf16 v[36:39], v[60:63], a[152:159], v1
    v_smfmac_f32_16x16x64_bf16 v[32:35], v[56:59], a[208:215], v1
    s_waitcnt lgkmcnt(1)
    s_barrier
    ds_read_b128 v[64:67], v4 offset:0
    v_smfmac_f32_16x16x64_bf16 v[36:39], v[56:59], a[216:223], v1
    ds_read_b128 v[68:71], v4 offset:64
    ds_read_b128 v[112:115], v4 offset:256
    v_smfmac_f32_16x16x64_bf16 v[32:35], v[48:51], a[160:167], v1
    ds_read_b128 v[116:119], v4 offset:320
    ds_read_b128 v[72:75], v4 offset:128
    s_waitcnt lgkmcnt(5)
    ds_read_b128 v[76:79], v4 offset:192
    s_waitcnt lgkmcnt(5)
    v_mfma_f32_16x16x32_bf16 v[16:19], v[80:83], v[64:67], 0
    buffer_load_dwordx4 v0, s[4:7], s11 offen offset:0 nt lds
    v_mfma_f32_16x16x32_bf16 v[20:23], v[96:99], v[64:67], 0
    buffer_load_dwordx4 v0, s[4:7], s11 offen offset:1024 nt lds
    s_waitcnt lgkmcnt(4)
    v_mfma_f32_16x16x32_bf16 v[16:19], v[84:87], v[68:71], v[16:19]
    v_mov_b64 v[56:57], s[58:59]
    v_mov_b64 v[58:59], s[58:59]
    v_mfma_f32_16x16x32_bf16 v[20:23], v[100:103], v[68:71], v[20:23]
    s_waitcnt lgkmcnt(2)
    v_mfma_f32_16x16x32_bf16 v[24:27], v[112:115], v[64:67], 0
    v_mfma_f32_16x16x32_bf16 v[24:27], v[116:119], v[68:71], v[24:27]
    s_waitcnt lgkmcnt(1)
    v_mfma_f32_16x16x32_bf16 v[16:19], v[88:91], v[72:75], v[16:19]
    ds_read_b128 v[80:83], v2 offset:22528
    v_mfma_f32_16x16x32_bf16 v[20:23], v[104:107], v[72:75], v[20:23]
    s_waitcnt lgkmcnt(1)
    ds_read_b128 v[84:87], v2 offset:23552
    v_mfma_f32_16x16x32_bf16 v[16:19], v[92:95], v[76:79], v[16:19]
    ds_read_b128 v[64:67], v2 offset:18432
    v_add_f32_dpp v24, v26, v24 quad_perm:[2,3,0,1] row_mask:0xf bank_mask:0xf
    v_add_f32_dpp v25, v27, v25 quad_perm:[2,3,0,1] row_mask:0xf bank_mask:0xf
    v_mfma_f32_16x16x32_bf16 v[20:23], v[108:111], v[76:79], v[20:23]
    ds_read_b128 v[68:71], v2 offset:19456
    v_max_f32 v132, v24, v25
    v_smfmac_f32_16x16x64_bf16 v[36:39], v[48:51], a[168:175], v1
    ds_read_b128 v[88:91], v2 offset:24576
    ds_read_b128 v[72:75], v2 offset:20480
    v_max3_f32 v132, v132, v16, v17
    v_max3_f32 v132, v132, v18, v19
    v_max3_f32 v134, v132, v20, v21
    v_max3_f32 v132, v134, v22, v23
    v_max3_f32 v133, v134, v22, v23
    v_smfmac_f32_16x16x64_bf16 v[32:35], v[52:55], a[192:199], v1
    ds_read_b128 v[92:95], v2 offset:25600
    ds_read_b128 v[96:99], v2 offset:26624
    v_permlane16_swap_b32 v132, v133
    v_max_f32 v134, v132, v133
    v_max_f32 v135, v132, v133
    v_smfmac_f32_16x16x64_bf16 v[36:39], v[52:55], a[200:207], v1
    ds_read_b128 v[100:103], v2 offset:27648
    v_permlane32_swap_b32 v134, v135
    v_max_f32 v132, v134, v135
    v_fma_f32 v132, v132, s56, v14
    v_pk_fma_f32 v[24:25], v[24:25], s[56:57], v[132:133] op_sel_hi:[1,1,0] neg_lo:[0,0,1] neg_hi:[0,0,1]
    v_pk_fma_f32 v[16:17], v[16:17], s[56:57], v[132:133] op_sel_hi:[1,1,0] neg_lo:[0,0,1] neg_hi:[0,0,1]
    v_pk_fma_f32 v[18:19], v[18:19], s[56:57], v[132:133] op_sel_hi:[1,1,0] neg_lo:[0,0,1] neg_hi:[0,0,1]
    v_pk_fma_f32 v[20:21], v[20:21], s[56:57], v[132:133] op_sel_hi:[1,1,0] neg_lo:[0,0,1] neg_hi:[0,0,1]
    v_pk_fma_f32 v[22:23], v[22:23], s[56:57], v[132:133] op_sel_hi:[1,1,0] neg_lo:[0,0,1] neg_hi:[0,0,1]
    v_pk_add_f32 v[32:33], v[32:33], v[34:35]
    v_pk_add_f32 v[36:37], v[36:37], v[38:39]
    v_cvt_pk_bf16_f32 v130, v32, v33
    v_cvt_pk_bf16_f32 v131, v36, v37
    v_exp_f32 v24, v24
    v_exp_f32 v25, v25
    v_exp_f32 v16, v16
    v_cvt_pk_bf16_f32 v12, v24, v25
    v_exp_f32 v17, v17
    v_exp_f32 v18, v18
    v_mov_b32_dpp v13, v12 quad_perm:[2,3,0,1] row_mask:0xf bank_mask:0xf
    v_exp_f32 v19, v19
    v_cvt_pk_bf16_f32 v28, v16, v17
    v_mfma_f32_16x16x16_bf16 v[60:63], v[56:57], v[12:13], 0
    ds_read_b128 v[76:79], v2 offset:21504
    v_exp_f32 v20, v20
    v_cvt_pk_bf16_f32 v29, v18, v19
    v_mfma_f32_16x16x16_bf16 v[48:51], v[130:131], v[12:13], 0
    s_waitcnt vmcnt(6)
    v_exp_f32 v21, v21
    v_exp_f32 v22, v22
    v_exp_f32 v23, v23
    v_cvt_pk_bf16_f32 v30, v20, v21
    v_cvt_pk_bf16_f32 v31, v22, v23
    v_mov_b32_dpp v16, v28 quad_perm:[2,3,0,1] row_mask:0xf bank_mask:0xf
    v_mov_b32_dpp v17, v29 quad_perm:[2,3,0,1] row_mask:0xf bank_mask:0xf
    v_mfma_f32_16x16x32_bf16 v[60:63], v[56:59], v[28:31], v[60:63]
    v_mov_b32_dpp v18, v30 quad_perm:[2,3,0,1] row_mask:0xf bank_mask:0xf
    v_mov_b32_dpp v19, v31 quad_perm:[2,3,0,1] row_mask:0xf bank_mask:0xf
    v_mfma_f32_16x16x32_bf16 v[48:51], v[40:43], v[28:31], v[48:51]
    v_mov_b64 v[24:25], 0
    v_mov_b64 v[26:27], 0
    v_mfma_f32_16x16x32_bf16 v[48:51], v[44:47], v[16:19], v[48:51]
    v_rcp_f32_dpp v132, v60 quad_perm:[0,1,0,1] row_mask:0xf bank_mask:0xf
    v_mov_b64 v[20:21], 0
    v_mov_b64 v[22:23], 0
    v_mov_b64 v[16:17], 0
    v_mov_b64 v[18:19], 0
    v_mov_b64 v[28:29], 0
    v_pk_mul_f32 v[48:49], v[48:49], v[132:133] op_sel_hi:[1,0]
    v_pk_mul_f32 v[50:51], v[50:51], v[132:133] op_sel_hi:[1,0]
    v_cvt_pk_bf16_f32 v134, v48, v49
    v_cvt_pk_bf16_f32 v135, v50, v51
    ds_write_b64 v0, v[134:135] offset:22016
    v_mov_b64 v[30:31], 0
    v_mov_b64 v[48:49], 0
    v_mov_b64 v[50:51], 0
    v_mov_b64 v[32:33], 0
    v_mov_b64 v[34:35], 0
    v_mov_b64 v[36:37], 0
    v_mov_b64 v[38:39], 0
    v_mov_b64 v[52:53], 0
    v_mov_b64 v[54:55], 0
    s_add_u32 s11, s11, 262144
    s_add_u32 s12, s12, 262144
    s_add_u32 s9, s9, 1
    s_waitcnt lgkmcnt(0)
    s_barrier
    ds_read_b128 v[56:59], v0 offset:22016
    ds_read_b128 v[60:63], v0 offset:23040
    s_add_u32 s10, s10, 8192
    s_and_b32 s10, s10, 0xffff7fff
    s_add_u32 s13, s13, 262144
    s_add_u32 s18, s18, 8192
    s_xor_b32 s61, s17, 16384
    s_waitcnt lgkmcnt(1)
    v_smfmac_f32_16x16x64_bf16 v[16:19], v[56:59], v[192:199], v1
    v_smfmac_f32_16x16x64_bf16 v[20:23], v[56:59], v[208:215], v1
    s_waitcnt lgkmcnt(0)
    v_smfmac_f32_16x16x64_bf16 v[16:19], v[60:63], v[200:207], v1
    ds_read_b128 v[104:107], v2 offset:28672
    v_smfmac_f32_16x16x64_bf16 v[20:23], v[60:63], v[216:223], v1
    ds_read_b128 v[108:111], v2 offset:29696
    v_smfmac_f32_16x16x64_bf16 v[24:27], v[56:59], v[224:231], v1
    ds_read_b128 v[112:115], v2 offset:30720
    v_add_f32 v16, v16, v18
    v_smfmac_f32_16x16x64_bf16 v[24:27], v[60:63], v[232:239], v1
    ds_read_b128 v[116:119], v2 offset:31744
    v_add_f32 v20, v20, v22
    v_smfmac_f32_16x16x64_bf16 v[28:31], v[56:59], v[240:247], v1
    v_add_f32 v17, v17, v19
    v_smfmac_f32_16x16x64_bf16 v[28:31], v[60:63], v[248:255], v1
    v_add_f32 v21, v21, v23
    v_smfmac_f32_16x16x64_bf16 v[32:35], v[56:59], v[64:71], v1
    v_cvt_pk_bf16_f32 v16, v16, v20
    v_bfi_b32 v16, 1, s21, v16
    v_cvt_pk_bf16_f32 v17, v17, v21
    v_add_f32 v24, v24, v26
    v_add_f32 v25, v25, v27
    v_add_f32 v28, v28, v30
    v_add_f32 v29, v29, v31
    v_cvt_pk_bf16_f32 v18, v24, v28
    v_cvt_pk_bf16_f32 v19, v25, v29
    v_smfmac_f32_16x16x64_bf16 v[32:35], v[60:63], v[72:79], v1
    buffer_store_dwordx4 v[16:19], v5, s[4:7], s14 offen sc1
    v_smfmac_f32_16x16x64_bf16 v[36:39], v[56:59], v[80:87], v1
    v_smfmac_f32_16x16x64_bf16 v[36:39], v[60:63], v[88:95], v1
    s_waitcnt lgkmcnt(0)
    v_add_f32 v32, v32, v34
    v_smfmac_f32_16x16x64_bf16 v[48:51], v[56:59], v[96:103], v1
    v_add_f32 v33, v33, v35
    v_smfmac_f32_16x16x64_bf16 v[48:51], v[60:63], v[104:111], v1
    v_add_f32 v36, v36, v38
    v_smfmac_f32_16x16x64_bf16 v[52:55], v[56:59], v[112:119], v1
    v_add_f32 v37, v37, v39
    v_smfmac_f32_16x16x64_bf16 v[52:55], v[60:63], v[120:127], v1
    v_cvt_pk_bf16_f32 v32, v32, v36
    v_bfi_b32 v32, 1, s21, v32
    v_cvt_pk_bf16_f32 v33, v33, v37
    v_add_f32 v48, v48, v50
    v_add_f32 v49, v49, v51
    s_nop 1
    v_add_f32 v52, v52, v54
    v_add_f32 v53, v53, v55
    v_cvt_pk_bf16_f32 v34, v48, v52
    v_cvt_pk_bf16_f32 v35, v49, v53
    buffer_store_dwordx4 v[32:35], v5, s[4:7], s15 offen sc1
    v_mov_b64 v[16:17], 0
    v_mov_b64 v[18:19], 0
    v_mov_b64 v[20:21], 0
    v_mov_b64 v[22:23], 0
    v_mov_b64 v[24:25], 0
    v_mov_b64 v[26:27], 0
    v_mov_b64 v[28:29], 0
    v_mov_b64 v[30:31], 0
    v_mov_b64 v[32:33], 0
    v_mov_b64 v[34:35], 0
    v_mov_b64 v[36:37], 0
    v_mov_b64 v[38:39], 0
    ds_read_b128 v[64:67], v2 offset:0
    ds_read_b128 v[68:71], v2 offset:1024
    ds_read_b128 v[72:75], v2 offset:2048
    ds_read_b128 v[76:79], v2 offset:3072
    ds_read_b128 v[80:83], v2 offset:4096
    ds_read_b128 v[84:87], v2 offset:5120
    s_waitcnt vmcnt(1)
    buffer_load_dwordx4 v[56:59], v0, s[4:7], s16 offen offset:0 sc1
    buffer_load_dwordx4 v[60:63], v0, s[4:7], s16 offen offset:1024 sc1
    ds_read_b128 v[88:91], v2 offset:6144
    ds_read_b128 v[92:95], v2 offset:7168
    ds_read_b128 v[96:99], v2 offset:8192
    ds_read_b128 v[100:103], v2 offset:9216
    s_waitcnt lgkmcnt(0)
    buffer_load_dwordx4 v[40:43], v0, s[4:7], s16 offen offset:0 sc1
    buffer_load_dwordx4 v[44:47], v0, s[4:7], s16 offen offset:1024 sc1
    ds_read_b128 v[104:107], v2 offset:10240
    ds_read_b128 v[108:111], v2 offset:11264
    s_waitcnt vmcnt(3)
    v_mfma_f32_16x16x32_bf16 v[48:51], v[8:11], v[56:59], 0
    s_waitcnt vmcnt(2)
    v_mfma_f32_16x16x32_bf16 v[48:51], v[8:11], v[60:63], v[48:51]
    v_and_b32 v13, 1, v56
    v_and_b32 v12, 1, v60
    v_add_u32 v12, v13, v12
    v_cmp_ne_u32 vcc, s60, v12
    s_nop 2
    v_add_f32_dpp v48, v48, v48 row_ror:4 row_mask:0xf bank_mask:0xf
    v_add_f32_dpp v49, v49, v49 row_ror:4 row_mask:0xf bank_mask:0xf
    s_cbranch_vccnz R0s_p1
    v_add_f32_dpp v48, v48, v48 row_ror:8 row_mask:0xf bank_mask:0xf
    v_add_f32_dpp v49, v49, v49 row_ror:8 row_mask:0xf bank_mask:0xf
    v_cvt_pk_bf16_f32 v15, v48, v49
    buffer_store_dword v15, v6, s[4:7], s17 offen sc1
R0s_p1_ok:
    s_cmp_eq_u32 s9, 63
    s_cbranch_scc1 R0s_fin
    s_xor_b32 s14, s14, 262144
    s_xor_b32 s15, s15, 262144
    s_add_u32 s17, s17, 8192
    s_and_b32 s17, s17, 0xffff7fff
    s_xor_b32 s16, s16, 262144
    s_min_u32 s99, s19, 31
    s_and_b32 s60, s9, 2
    s_lshr_b32 s21, s60, 1
    ds_read_b128 v[112:115], v2 offset:12288
    ds_read_b128 v[116:119], v2 offset:13312
    s_waitcnt lgkmcnt(0)
    buffer_load_dwordx4 v[56:59], v0, s[4:7], s10 offen offset:0 sc1
    ds_read_b128 v[120:123], v2 offset:14336
    ds_read_b128 v[124:127], v2 offset:15360
    ds_read_b128 v[128:131], v2 offset:16384
    ds_read_b128 v[132:135], v2 offset:17408
    s_waitcnt lgkmcnt(0)
    buffer_load_dwordx4 v[56:59], v0, s[4:7], s10 offen offset:0 sc1
    s_cmp_eq_u32 s96, 128
    s_cbranch_scc1 R0s_top
    v_readlane_b32 s100, v7, 0
    s_lshl_b32 s100, s100, 2
    s_add_u32 s100, s100, 0
    s_mov_b32 s96, s100
    v_readlane_b32 s100, v7, 1
    s_lshl_b32 s100, s100, 2
    s_add_u32 s100, s100, 1
    s_min_u32 s96, s96, s100
    v_readlane_b32 s100, v7, 2
    s_lshl_b32 s100, s100, 2
    s_add_u32 s100, s100, 2
    s_min_u32 s96, s96, s100
    v_readlane_b32 s100, v7, 3
    s_lshl_b32 s100, s100, 2
    s_add_u32 s100, s100, 3
    s_min_u32 s96, s96, s100
    s_cmp_ge_u32 s96, 64
    s_cselect_b32 s96, 128, s96
    s_branch R0s_top
R0s_pe_to:
    s_mov_b32 s99, 31
    s_waitcnt vmcnt(0)
    v_max3_u32 v7, v56, v57, v58
    v_max_u32 v7, v7, v59
    v_cmp_eq_u32 vcc, -1, v7
    ds_write_b128 v0, v[56:59] offset:0
    s_cbranch_vccz R0s_pe_go
    s_sub_u32 s19, s19, 32
    s_cbranch_scc0 R0s_pe
    s_mov_b32 s19, 0
    s_mov_b32 s99, 0
    s_branch R0s_pe_go
R0s_po:
    buffer_load_dwordx4 v[60:63], v0, s[4:7], s10 offen offset:1024 sc1
    s_sub_u32 s19, s19, 1
    s_cbranch_scc1 R0s_po_to
    s_waitcnt vmcnt(0)
    ds_write_b128 v0, v[60:63] offset:1024
    v_max3_u32 v7, v60, v61, v62
    v_max_u32 v7, v7, v63
    v_cmp_eq_u32 vcc, -1, v7
    s_cbranch_vccnz R0s_po
    s_branch R0s_po_ok
R0s_po_to:
    s_mov_b32 s19, 0
    s_waitcnt vmcnt(0)
    ds_write_b128 v0, v[60:63] offset:1024
    s_branch R0s_po_ok
R0s_rd:
    buffer_load_dword v7, v6, s[4:7], s98 offen sc1
    s_sub_u32 s19, s19, 1
    s_cbranch_scc1 R0s_rd_to
    s_waitcnt vmcnt(0)
    v_readlane_b32 s100, v7, 0
    s_lshl_b32 s100, s100, 2
    s_add_u32 s100, s100, 0
    s_mov_b32 s96, s100
    v_readlane_b32 s100, v7, 1
    s_lshl_b32 s100, s100, 2
    s_add_u32 s100, s100, 1
    s_min_u32 s96, s96, s100
    v_readlane_b32 s100, v7, 2
    s_lshl_b32 s100, s100, 2
    s_add_u32 s100, s100, 2
    s_min_u32 s96, s96, s100
    v_readlane_b32 s100, v7, 3
    s_lshl_b32 s100, s100, 2
    s_add_u32 s100, s100, 3
    s_min_u32 s96, s96, s100
    s_cmp_ge_u32 s96, 64
    s_cselect_b32 s96, 128, s96
    s_cmp_lt_u32 s20, s96
    s_cbranch_scc1 R0s_rd_ok
    s_sleep 8
    s_branch R0s_rd
R0s_rd_to:
    s_mov_b32 s19, 0
    s_mov_b32 s96, 128
    s_waitcnt vmcnt(0)
    s_branch R0s_rd_ok
R0s_p1:
    buffer_load_dwordx4 v[56:59], v0, s[4:7], s16 offen offset:0 sc1
    buffer_load_dwordx4 v[60:63], v0, s[4:7], s16 offen offset:1024 sc1
    s_waitcnt vmcnt(3)
    v_mfma_f32_16x16x32_bf16 v[48:51], v[8:11], v[40:43], 0
    s_waitcnt vmcnt(2)
    v_mfma_f32_16x16x32_bf16 v[48:51], v[8:11], v[44:47], v[48:51]
    v_and_b32 v13, 1, v40
    v_and_b32 v12, 1, v44
    v_add_u32 v12, v13, v12
    v_cmp_ne_u32 vcc, s60, v12
    s_nop 2
    v_add_f32_dpp v48, v48, v48 row_ror:4 row_mask:0xf bank_mask:0xf
    v_add_f32_dpp v49, v49, v49 row_ror:4 row_mask:0xf bank_mask:0xf
    s_cbranch_vccnz R0s_p1b
    v_add_f32_dpp v48, v48, v48 row_ror:8 row_mask:0xf bank_mask:0xf
    v_add_f32_dpp v49, v49, v49 row_ror:8 row_mask:0xf bank_mask:0xf
    v_cvt_pk_bf16_f32 v15, v48, v49
    buffer_store_dword v15, v6, s[4:7], s17 offen sc1
    s_branch R0s_p1_ok
R0s_p1b:
    buffer_load_dwordx4 v[40:43], v0, s[4:7], s16 offen offset:0 sc1
    buffer_load_dwordx4 v[44:47], v0, s[4:7], s16 offen offset:1024 sc1
    s_sub_u32 s19, s19, 1
    s_cbranch_scc1 R0s_p1_to
    s_waitcnt vmcnt(3)
    v_mfma_f32_16x16x32_bf16 v[48:51], v[8:11], v[56:59], 0
    s_waitcnt vmcnt(2)
    v_mfma_f32_16x16x32_bf16 v[48:51], v[8:11], v[60:63], v[48:51]
    v_and_b32 v13, 1, v56
    v_and_b32 v12, 1, v60
    v_add_u32 v12, v13, v12
    v_cmp_ne_u32 vcc, s60, v12
    s_nop 2
    v_add_f32_dpp v48, v48, v48 row_ror:4 row_mask:0xf bank_mask:0xf
    v_add_f32_dpp v49, v49, v49 row_ror:4 row_mask:0xf bank_mask:0xf
    s_cbranch_vccnz R0s_p1
    v_add_f32_dpp v48, v48, v48 row_ror:8 row_mask:0xf bank_mask:0xf
    v_add_f32_dpp v49, v49, v49 row_ror:8 row_mask:0xf bank_mask:0xf
    v_cvt_pk_bf16_f32 v15, v48, v49
    buffer_store_dword v15, v6, s[4:7], s17 offen sc1
    s_branch R0s_p1_ok
R0s_p1_to:
    s_mov_b32 s19, 0
    v_add_f32_dpp v48, v48, v48 row_ror:8 row_mask:0xf bank_mask:0xf
    v_add_f32_dpp v49, v49, v49 row_ror:8 row_mask:0xf bank_mask:0xf
    v_cvt_pk_bf16_f32 v15, v48, v49
    buffer_store_dword v15, v6, s[4:7], s17 offen sc1
    s_branch R0s_p1_ok
R0s_fin:
    buffer_store_dword v15, v6, s[4:7], s18 offen sc1
    s_branch L_end
RR_29_w1:
    v_mov_b32 v20, v0
    v_lshrrev_b32 v32, 4, v20
    v_lshlrev_b32 v32, 13, v32
    v_and_b32 v21, 15, v20
    v_lshrrev_b32 v22, 5, v20
    v_lshlrev_b32 v22, 1, v22
    v_xor_b32 v21, v21, v22
    v_xor_b32 v21, 4, v21
    v_lshl_add_u32 v32, v21, 4, v32
    v_and_b32 v21, 3, v20
    s_lshl_b32 s48, s8, 8
    s_mov_b32 m0, 59392
    s_add_u32 s20, s48, 131072
    buffer_load_dwordx4 v32, s[36:39], s20 offen lds
    s_mov_b32 m0, 60416
    s_add_u32 s20, s48, 163840
    buffer_load_dwordx4 v32, s[36:39], s20 offen lds
    s_mov_b32 m0, 61440
    s_add_u32 s20, s48, 196608
    buffer_load_dwordx4 v32, s[36:39], s20 offen lds
    s_mov_b32 m0, 62464
    s_add_u32 s20, s48, 229376
    buffer_load_dwordx4 v32, s[36:39], s20 offen lds
    s_mov_b32 m0, 63488
    s_add_u32 s20, s48, 131072
    buffer_load_dwordx4 v32, s[40:43], s20 offen lds
    s_mov_b32 m0, 64512
    s_add_u32 s20, s48, 163840
    buffer_load_dwordx4 v32, s[40:43], s20 offen lds
    s_mov_b32 m0, 65536
    s_add_u32 s20, s48, 196608
    buffer_load_dwordx4 v32, s[40:43], s20 offen lds
    s_mov_b32 m0, 66560
    s_add_u32 s20, s48, 229376
    buffer_load_dwordx4 v32, s[40:43], s20 offen lds
    s_mov_b32 m0, 67584
    s_add_u32 s20, s48, 655360
    buffer_load_dwordx4 v32, s[36:39], s20 offen lds
    s_mov_b32 m0, 68608
    s_add_u32 s20, s48, 688128
    buffer_load_dwordx4 v32, s[36:39], s20 offen lds
    s_mov_b32 m0, 69632
    s_add_u32 s20, s48, 720896
    buffer_load_dwordx4 v32, s[36:39], s20 offen lds
    s_mov_b32 m0, 70656
    s_add_u32 s20, s48, 753664
    buffer_load_dwordx4 v32, s[36:39], s20 offen lds
    s_mov_b32 m0, 71680
    s_add_u32 s20, s48, 655360
    buffer_load_dwordx4 v32, s[40:43], s20 offen lds
    s_mov_b32 m0, 72704
    s_add_u32 s20, s48, 688128
    buffer_load_dwordx4 v32, s[40:43], s20 offen lds
    s_mov_b32 m0, 73728
    s_add_u32 s20, s48, 720896
    buffer_load_dwordx4 v32, s[40:43], s20 offen lds
    s_mov_b32 m0, 74752
    s_add_u32 s20, s48, 753664
    buffer_load_dwordx4 v32, s[40:43], s20 offen lds
    v_lshlrev_b32 v34, 3, v21
    v_add_u32 v35, 59392, v34
    v_add_u32 v34, 24640, v34
    v_bfe_u32 v22, v20, 2, 2
    v_mul_u32_u24 v22, 34816, v22
    v_add_u32 v34, v34, v22
    v_lshrrev_b32 v22, 4, v20
    v_lshl_add_u32 v34, v22, 9, v34
    v_bfe_u32 v22, v20, 4, 1
    v_lshlrev_b32 v22, 5, v22
    v_xor_b32 v34, v34, v22
    v_bfe_u32 v22, v20, 2, 2
    v_lshlrev_b32 v22, 6, v22
    v_xor_b32 v34, v34, v22
    v_xor_b32 v36, 32, v34
    v_bfe_u32 v22, v20, 4, 1
    v_lshl_add_u32 v35, v22, 12, v35
    v_bfe_u32 v22, v20, 3, 1
    v_lshl_add_u32 v35, v22, 11, v35
    v_bfe_u32 v22, v20, 5, 1
    v_lshl_add_u32 v35, v22, 9, v35
    v_bfe_u32 v22, v20, 2, 1
    v_lshl_add_u32 v35, v22, 7, v35
    s_cmp_eq_u32 s59, 0
    s_cbranch_scc1 VF_31
    v_mov_b32 v1, 0
    s_barrier
    ds_read_b32 v2, v1
    s_waitcnt lgkmcnt(0)
    v_readfirstlane_b32 s56, v2
    s_bitcmp1_b32 s56, s8
    s_cbranch_scc1 L_lost
VF_31:
    v_and_b32 v16, 15, v0
    v_lshrrev_b32 v17, 4, v0
    v_lshlrev_b32 v0, 4, v0
    v_add_u32 v2, 59392, v0
    v_and_b32 v18, 2, v16
    v_mov_b32 v1, 0x4444
    v_mov_b32 v7, 0xeeee
    v_cmp_eq_u32 vcc, 2, v18
    s_nop 1
    v_cndmask_b32 v1, v1, v7, vcc
    v_mov_b32 v14, 0
    v_mov_b32 v7, 0x7f800000
    v_cndmask_b32 v14, v14, v7, vcc
    v_mul_u32_u24 v3, 1088, v17
    v_lshl_add_u32 v3, v16, 2, v3
    v_add_u32 v3, 16448, v3
    v_lshrrev_b32 v18, 2, v16
    v_mul_u32_u24 v4, 1088, v18
    v_and_b32 v18, 1, v16
    v_mul_u32_u24 v18, 544, v18
    v_add_u32 v4, v4, v18
    v_bfe_u32 v18, v16, 1, 1
    v_mul_u32_u24 v18, 128, v18
    v_add_u32 v4, v4, v18
    v_lshl_add_u32 v4, v17, 4, v4
    v_add_u32 v4, 16384, v4
    v_lshlrev_b32 v5, 14, v17
    v_lshrrev_b32 v18, 3, v16
    v_lshl_add_u32 v5, v18, 13, v5
    v_bfe_u32 v18, v16, 2, 1
    v_lshl_add_u32 v5, v18, 11, v5
    v_and_b32 v18, 3, v16
    v_lshl_add_u32 v5, v18, 4, v5
    v_lshlrev_b32 v6, 4, v17
    v_lshl_add_u32 v6, v16, 2, v6
    v_mov_b32 v7, 0x40000000
    v_cmp_gt_u32 vcc, 4, v16
    s_nop 1
    v_cndmask_b32 v6, v7, v6, vcc
    v_mov_b32 v8, 0
    v_mov_b32 v7, 0x3f80
    v_cmp_eq_u32 vcc, 0, v16
    s_nop 1
    v_cndmask_b32 v8, v8, v7, vcc
    v_mov_b32 v7, 1.0
    v_cmp_eq_u32 vcc, 1, v16
    s_nop 1
    v_cndmask_b32 v8, v8, v7, vcc
    v_mov_b32 v9, 0
    v_mov_b32 v7, 0x3f80
    v_cmp_eq_u32 vcc, 4, v16
    s_nop 1
    v_cndmask_b32 v9, v9, v7, vcc
    v_mov_b32 v7, 1.0
    v_cmp_eq_u32 vcc, 5, v16
    s_nop 1
    v_cndmask_b32 v9, v9, v7, vcc
    v_mov_b32 v10, 0
    v_mov_b32 v7, 0x3f80
    v_cmp_eq_u32 vcc, 8, v16
    s_nop 1
    v_cndmask_b32 v10, v10, v7, vcc
    v_mov_b32 v7, 1.0
    v_cmp_eq_u32 vcc, 9, v16
    s_nop 1
    v_cndmask_b32 v10, v10, v7, vcc
    v_mov_b32 v11, 0
    v_mov_b32 v7, 0x3f80
    v_cmp_eq_u32 vcc, 12, v16
    s_nop 1
    v_cndmask_b32 v11, v11, v7, vcc
    v_mov_b32 v7, 1.0
    v_cmp_eq_u32 vcc, 13, v16
    s_nop 1
    v_cndmask_b32 v11, v11, v7, vcc
    s_mov_b32 s9, 0
    s_mov_b32 s10, 51382272
    s_lshl_b32 s20, s8, 13
    s_add_u32 s11, s20, 16779264
    s_add_u32 s12, s20, 33556480
    s_add_u32 s13, s20, 17305600
    s_add_u32 s16, s20, 50333696
    s_lshr_b32 s20, s8, 4
    s_lshl_b32 s14, s20, 10
    s_and_b32 s20, s8, 3
    s_lshl_b32 s20, s20, 8
    s_add_u32 s14, s14, s20
    s_and_b32 s20, s8, 12
    s_lshl_b32 s20, s20, 4
    s_add_u32 s14, s14, s20
    s_add_u32 s14, s14, 50397184
    s_add_u32 s15, s14, 4096
    s_lshr_b32 s20, s8, 3
    s_lshl_b32 s17, s20, 11
    s_and_b32 s20, s8, 6
    s_lshl_b32 s20, s20, 5
    s_add_u32 s17, s17, s20
    s_and_b32 s20, s8, 1
    s_lshl_b32 s20, s20, 9
    s_add_u32 s17, s17, s20
    s_add_u32 s17, s17, 51380480
    s_mov_b32 s19, 4194304
    s_mov_b32 s99, 31
    s_mov_b32 s21, 0
    s_mov_b32 s60, 0
    s_add_u32 s61, s17, 16384
    s_sub_u32 s18, s17, 524288
    s_mov_b32 s96, 0
    s_mov_b32 s56, 0x3e0293ee
    s_mov_b32 s57, 0x3e0293ee
    s_mov_b32 s58, 0x3f803f80
    s_mov_b32 s59, 0x3f803f80
    s_waitcnt vmcnt(24)
    ds_read_b64_tr_b16 v[192:193], v35 offset:18432
    ds_read_b64_tr_b16 v[194:195], v35 offset:18688
    ds_read_b64_tr_b16 v[196:197], v35 offset:19456
    ds_read_b64_tr_b16 v[198:199], v35 offset:19712
    ds_read_b64_tr_b16 v[208:209], v35 offset:18464
    ds_read_b64_tr_b16 v[210:211], v35 offset:18720
    ds_read_b64_tr_b16 v[212:213], v35 offset:19488
    ds_read_b64_tr_b16 v[214:215], v35 offset:19744
    ds_read_b64_tr_b16 v[224:225], v35 offset:18496
    ds_read_b64_tr_b16 v[226:227], v35 offset:18752
    ds_read_b64_tr_b16 v[228:229], v35 offset:19520
    ds_read_b64_tr_b16 v[230:231], v35 offset:19776
    ds_read_b64_tr_b16 v[240:241], v35 offset:18528
    ds_read_b64_tr_b16 v[242:243], v35 offset:18784
    ds_read_b64_tr_b16 v[244:245], v35 offset:19552
    ds_read_b64_tr_b16 v[246:247], v35 offset:19808
    s_waitcnt lgkmcnt(0)
    s_mov_b32 m0, 77824
    s_add_u32 s20, s48, 655360
    buffer_load_dwordx4 v32, s[32:35], s20 offen lds
    s_mov_b32 m0, 78848
    s_add_u32 s20, s48, 688128
    buffer_load_dwordx4 v32, s[32:35], s20 offen lds
    s_mov_b32 m0, 79872
    s_add_u32 s20, s48, 720896
    buffer_load_dwordx4 v32, s[32:35], s20 offen lds
    s_mov_b32 m0, 80896
    s_add_u32 s20, s48, 753664
    buffer_load_dwordx4 v32, s[32:35], s20 offen lds
    s_mov_b32 m0, 81920
    s_add_u32 s20, s48, 1179648
    buffer_load_dwordx4 v32, s[36:39], s20 offen lds
    s_mov_b32 m0, 82944
    s_add_u32 s20, s48, 1212416
    buffer_load_dwordx4 v32, s[36:39], s20 offen lds
    s_mov_b32 m0, 83968
    s_add_u32 s20, s48, 1245184
    buffer_load_dwordx4 v32, s[36:39], s20 offen lds
    s_mov_b32 m0, 84992
    s_add_u32 s20, s48, 1277952
    buffer_load_dwordx4 v32, s[36:39], s20 offen lds
    s_waitcnt vmcnt(24)
    ds_read_b64_tr_b16 v[200:201], v35 offset:26624
    ds_read_b64_tr_b16 v[202:203], v35 offset:26880
    ds_read_b64_tr_b16 v[204:205], v35 offset:27648
    ds_read_b64_tr_b16 v[206:207], v35 offset:27904
    ds_read_b64_tr_b16 v[216:217], v35 offset:26656
    ds_read_b64_tr_b16 v[218:219], v35 offset:26912
    ds_read_b64_tr_b16 v[220:221], v35 offset:27680
    ds_read_b64_tr_b16 v[222:223], v35 offset:27936
    ds_read_b64_tr_b16 v[232:233], v35 offset:26688
    ds_read_b64_tr_b16 v[234:235], v35 offset:26944
    ds_read_b64_tr_b16 v[236:237], v35 offset:27712
    ds_read_b64_tr_b16 v[238:239], v35 offset:27968
    ds_read_b64_tr_b16 v[248:249], v35 offset:26720
    ds_read_b64_tr_b16 v[250:251], v35 offset:26976
    ds_read_b64_tr_b16 v[252:253], v35 offset:27744
    ds_read_b64_tr_b16 v[254:255], v35 offset:28000
    s_waitcnt lgkmcnt(0)
    s_mov_b32 m0, 86016
    s_add_u32 s20, s48, 1179648
    buffer_load_dwordx4 v32, s[40:43], s20 offen lds
    s_mov_b32 m0, 87040
    s_add_u32 s20, s48, 1212416
    buffer_load_dwordx4 v32, s[40:43], s20 offen lds
    s_mov_b32 m0, 88064
    s_add_u32 s20, s48, 1245184
    buffer_load_dwordx4 v32, s[40:43], s20 offen lds
    s_mov_b32 m0, 89088
    s_add_u32 s20, s48, 1277952
    buffer_load_dwordx4 v32, s[40:43], s20 offen lds
    s_mov_b32 m0, 90112
    s_add_u32 s20, s48, 1703936
    buffer_load_dwordx4 v32, s[36:39], s20 offen lds
    s_mov_b32 m0, 91136
    s_add_u32 s20, s48, 1736704
    buffer_load_dwordx4 v32, s[36:39], s20 offen lds
    s_mov_b32 m0, 92160
    s_add_u32 s20, s48, 1769472
    buffer_load_dwordx4 v32, s[36:39], s20 offen lds
    s_mov_b32 m0, 93184
    s_add_u32 s20, s48, 1802240
    buffer_load_dwordx4 v32, s[36:39], s20 offen lds
    s_waitcnt vmcnt(28)
    s_barrier
    ds_read_b64_tr_b16 a[0:1], v34 offset:0
    ds_read_b64_tr_b16 a[2:3], v34 offset:256
    ds_read_b64_tr_b16 a[4:5], v34 offset:2048
    ds_read_b64_tr_b16 a[6:7], v34 offset:2304
    ds_read_b64_tr_b16 a[8:9], v36 offset:0
    ds_read_b64_tr_b16 a[10:11], v36 offset:256
    ds_read_b64_tr_b16 a[12:13], v36 offset:2048
    ds_read_b64_tr_b16 a[14:15], v36 offset:2304
    s_waitcnt lgkmcnt(0)
    s_waitcnt vmcnt(24)
    s_barrier
    ds_read_b64_tr_b16 a[128:129], v34 offset:4096
    ds_read_b64_tr_b16 a[130:131], v34 offset:4352
    ds_read_b64_tr_b16 a[132:133], v34 offset:6144
    ds_read_b64_tr_b16 a[134:135], v34 offset:6400
    ds_read_b64_tr_b16 a[136:137], v36 offset:4096
    ds_read_b64_tr_b16 a[138:139], v36 offset:4352
    ds_read_b64_tr_b16 a[140:141], v36 offset:6144
    ds_read_b64_tr_b16 a[142:143], v36 offset:6400
    s_mov_b32 m0, 59392
    s_add_u32 s20, s48, 1703936
    buffer_load_dwordx4 v32, s[40:43], s20 offen lds
    s_mov_b32 m0, 60416
    s_add_u32 s20, s48, 1736704
    buffer_load_dwordx4 v32, s[40:43], s20 offen lds
    s_mov_b32 m0, 61440
    s_add_u32 s20, s48, 1769472
    buffer_load_dwordx4 v32, s[40:43], s20 offen lds
    s_mov_b32 m0, 62464
    s_add_u32 s20, s48, 1802240
    buffer_load_dwordx4 v32, s[40:43], s20 offen lds
    s_waitcnt lgkmcnt(0)
    s_waitcnt vmcnt(24)
    s_barrier
    ds_read_b64_tr_b16 a[16:17], v34 offset:8192
    ds_read_b64_tr_b16 a[18:19], v34 offset:8448
    ds_read_b64_tr_b16 a[20:21], v34 offset:10240
    ds_read_b64_tr_b16 a[22:23], v34 offset:10496
    ds_read_b64_tr_b16 a[24:25], v36 offset:8192
    ds_read_b64_tr_b16 a[26:27], v36 offset:8448
    ds_read_b64_tr_b16 a[28:29], v36 offset:10240
    ds_read_b64_tr_b16 a[30:31], v36 offset:10496
    s_mov_b32 m0, 63488
    s_add_u32 s20, s48, 1703936
    buffer_load_dwordx4 v32, s[32:35], s20 offen lds
    s_mov_b32 m0, 64512
    s_add_u32 s20, s48, 1736704
    buffer_load_dwordx4 v32, s[32:35], s20 offen lds
    s_mov_b32 m0, 65536
    s_add_u32 s20, s48, 1769472
    buffer_load_dwordx4 v32, s[32:35], s20 offen lds
    s_mov_b32 m0, 66560
    s_add_u32 s20, s48, 1802240
    buffer_load_dwordx4 v32, s[32:35], s20 offen lds
    s_waitcnt lgkmcnt(0)
    s_waitcnt vmcnt(24)
    s_barrier
    ds_read_b64_tr_b16 a[144:145], v34 offset:12288
    ds_read_b64_tr_b16 a[146:147], v34 offset:12544
    ds_read_b64_tr_b16 a[148:149], v34 offset:14336
    ds_read_b64_tr_b16 a[150:151], v34 offset:14592
    ds_read_b64_tr_b16 a[152:153], v36 offset:12288
    ds_read_b64_tr_b16 a[154:155], v36 offset:12544
    ds_read_b64_tr_b16 a[156:157], v36 offset:14336
    ds_read_b64_tr_b16 a[158:159], v36 offset:14592
    s_mov_b32 m0, 67584
    s_add_u32 s20, s48, 2228224
    buffer_load_dwordx4 v32, s[36:39], s20 offen lds
    s_mov_b32 m0, 68608
    s_add_u32 s20, s48, 2260992
    buffer_load_dwordx4 v32, s[36:39], s20 offen lds
    s_mov_b32 m0, 69632
    s_add_u32 s20, s48, 2293760
    buffer_load_dwordx4 v32, s[36:39], s20 offen lds
    s_mov_b32 m0, 70656
    s_add_u32 s20, s48, 2326528
    buffer_load_dwordx4 v32, s[36:39], s20 offen lds
    s_waitcnt lgkmcnt(0)
    s_waitcnt vmcnt(24)
    s_barrier
    ds_read_b64_tr_b16 v[176:177], v34 offset:18432
    ds_read_b64_tr_b16 v[178:179], v34 offset:18688
    ds_read_b64_tr_b16 v[180:181], v34 offset:20480
    ds_read_b64_tr_b16 v[182:183], v34 offset:20736
    ds_read_b64_tr_b16 v[184:185], v36 offset:18432
    ds_read_b64_tr_b16 v[186:187], v36 offset:18688
    ds_read_b64_tr_b16 v[188:189], v36 offset:20480
    ds_read_b64_tr_b16 v[190:191], v36 offset:20736
    s_mov_b32 m0, 71680
    s_add_u32 s20, s48, 2228224
    buffer_load_dwordx4 v32, s[40:43], s20 offen lds
    s_mov_b32 m0, 72704
    s_add_u32 s20, s48, 2260992
    buffer_load_dwordx4 v32, s[40:43], s20 offen lds
    s_mov_b32 m0, 73728
    s_add_u32 s20, s48, 2293760
    buffer_load_dwordx4 v32, s[40:43], s20 offen lds
    s_mov_b32 m0, 74752
    s_add_u32 s20, s48, 2326528
    buffer_load_dwordx4 v32, s[40:43], s20 offen lds
    s_waitcnt lgkmcnt(0)
    s_waitcnt vmcnt(24)
    s_barrier
    ds_read_b64_tr_b16 a[32:33], v34 offset:22528
    ds_read_b64_tr_b16 a[34:35], v34 offset:22784
    ds_read_b64_tr_b16 a[36:37], v34 offset:24576
    ds_read_b64_tr_b16 a[38:39], v34 offset:24832
    ds_read_b64_tr_b16 a[40:41], v36 offset:22528
    ds_read_b64_tr_b16 a[42:43], v36 offset:22784
    ds_read_b64_tr_b16 a[44:45], v36 offset:24576
    ds_read_b64_tr_b16 a[46:47], v36 offset:24832
    s_mov_b32 m0, 77824
    s_add_u32 s20, s48, 2752512
    buffer_load_dwordx4 v32, s[36:39], s20 offen lds
    s_mov_b32 m0, 78848
    s_add_u32 s20, s48, 2785280
    buffer_load_dwordx4 v32, s[36:39], s20 offen lds
    s_mov_b32 m0, 79872
    s_add_u32 s20, s48, 2818048
    buffer_load_dwordx4 v32, s[36:39], s20 offen lds
    s_mov_b32 m0, 80896
    s_add_u32 s20, s48, 2850816
    buffer_load_dwordx4 v32, s[36:39], s20 offen lds
    s_waitcnt lgkmcnt(0)
    s_waitcnt vmcnt(24)
    s_barrier
    ds_read_b64_tr_b16 a[160:161], v34 offset:26624
    ds_read_b64_tr_b16 a[162:163], v34 offset:26880
    ds_read_b64_tr_b16 a[164:165], v34 offset:28672
    ds_read_b64_tr_b16 a[166:167], v34 offset:28928
    ds_read_b64_tr_b16 a[168:169], v36 offset:26624
    ds_read_b64_tr_b16 a[170:171], v36 offset:26880
    ds_read_b64_tr_b16 a[172:173], v36 offset:28672
    ds_read_b64_tr_b16 a[174:175], v36 offset:28928
    s_mov_b32 m0, 81920
    s_add_u32 s20, s48, 2752512
    buffer_load_dwordx4 v32, s[40:43], s20 offen lds
    s_mov_b32 m0, 82944
    s_add_u32 s20, s48, 2785280
    buffer_load_dwordx4 v32, s[40:43], s20 offen lds
    s_mov_b32 m0, 83968
    s_add_u32 s20, s48, 2818048
    buffer_load_dwordx4 v32, s[40:43], s20 offen lds
    s_mov_b32 m0, 84992
    s_add_u32 s20, s48, 2850816
    buffer_load_dwordx4 v32, s[40:43], s20 offen lds
    s_waitcnt lgkmcnt(0)
    s_waitcnt vmcnt(24)
    s_barrier
    ds_read_b64_tr_b16 a[48:49], v34 offset:30720
    ds_read_b64_tr_b16 a[50:51], v34 offset:30976
    ds_read_b64_tr_b16 a[52:53], v34 offset:32768
    ds_read_b64_tr_b16 a[54:55], v34 offset:33024
    ds_read_b64_tr_b16 a[56:57], v36 offset:30720
    ds_read_b64_tr_b16 a[58:59], v36 offset:30976
    ds_read_b64_tr_b16 a[60:61], v36 offset:32768
    ds_read_b64_tr_b16 a[62:63], v36 offset:33024
    s_mov_b32 m0, 86016
    s_add_u32 s20, s48, 2752512
    buffer_load_dwordx4 v32, s[32:35], s20 offen lds
    s_mov_b32 m0, 87040
    s_add_u32 s20, s48, 2785280
    buffer_load_dwordx4 v32, s[32:35], s20 offen lds
    s_mov_b32 m0, 88064
    s_add_u32 s20, s48, 2818048
    buffer_load_dwordx4 v32, s[32:35], s20 offen lds
    s_mov_b32 m0, 89088
    s_add_u32 s20, s48, 2850816
    buffer_load_dwordx4 v32, s[32:35], s20 offen lds
    s_waitcnt lgkmcnt(0)
    s_waitcnt vmcnt(24)
    s_barrier
    ds_read_b64_tr_b16 a[176:177], v34 offset:0
    ds_read_b64_tr_b16 a[178:179], v34 offset:256
    ds_read_b64_tr_b16 a[180:181], v34 offset:2048
    ds_read_b64_tr_b16 a[182:183], v34 offset:2304
    ds_read_b64_tr_b16 a[184:185], v36 offset:0
    ds_read_b64_tr_b16 a[186:187], v36 offset:256
    ds_read_b64_tr_b16 a[188:189], v36 offset:2048
    ds_read_b64_tr_b16 a[190:191], v36 offset:2304
    s_mov_b32 m0, 90112
    s_add_u32 s20, s48, 3276800
    buffer_load_dwordx4 v32, s[36:39], s20 offen lds
    s_mov_b32 m0, 91136
    s_add_u32 s20, s48, 3309568
    buffer_load_dwordx4 v32, s[36:39], s20 offen lds
    s_mov_b32 m0, 92160
    s_add_u32 s20, s48, 3342336
    buffer_load_dwordx4 v32, s[36:39], s20 offen lds
    s_mov_b32 m0, 93184
    s_add_u32 s20, s48, 3375104
    buffer_load_dwordx4 v32, s[36:39], s20 offen lds
    s_waitcnt lgkmcnt(0)
    s_waitcnt vmcnt(24)
    s_barrier
    ds_read_b64_tr_b16 v[128:129], v34 offset:4096
    ds_read_b64_tr_b16 v[130:131], v34 offset:4352
    ds_read_b64_tr_b16 v[132:133], v34 offset:6144
    ds_read_b64_tr_b16 v[134:135], v34 offset:6400
    ds_read_b64_tr_b16 v[136:137], v36 offset:4096
    ds_read_b64_tr_b16 v[138:139], v36 offset:4352
    ds_read_b64_tr_b16 v[140:141], v36 offset:6144
    ds_read_b64_tr_b16 v[142:143], v36 offset:6400
    v_and_b32 v21, 3, v20
    v_lshrrev_b32 v22, 4, v20
    v_and_b32 v23, 1, v22
    v_lshlrev_b32 v23, 10, v23
    v_lshrrev_b32 v22, 1, v22
    v_lshl_add_u32 v23, v22, 6, v23
    v_lshl_add_u32 v23, v21, 1, v23
    s_and_b32 s20, s8, 6
    s_lshl_b32 s20, s20, 10
    s_lshr_b32 s100, s8, 3
    s_lshl_b32 s100, s100, 8
    s_add_u32 s20, s20, s100
    s_and_b32 s100, s8, 1
    s_lshl_b32 s100, s100, 4
    s_add_u32 s20, s20, s100
    s_add_u32 s20, s20, 8
    v_add_u32 v23, s20, v23
    global_load_ushort v24, v23, s[50:51]
    global_load_ushort v25, v23, s[50:51] offset:32
    v_mov_b32 v22, 128
    global_load_dwordx4 v[40:43], v22, s[64:65] sc1
    s_mov_b32 m0, 59392
    s_add_u32 s20, s48, 3276800
    buffer_load_dwordx4 v32, s[40:43], s20 offen lds
    s_mov_b32 m0, 60416
    s_add_u32 s20, s48, 3309568
    buffer_load_dwordx4 v32, s[40:43], s20 offen lds
    s_mov_b32 m0, 61440
    s_add_u32 s20, s48, 3342336
    buffer_load_dwordx4 v32, s[40:43], s20 offen lds
    s_mov_b32 m0, 62464
    s_add_u32 s20, s48, 3375104
    buffer_load_dwordx4 v32, s[40:43], s20 offen lds
    s_waitcnt lgkmcnt(0)
    ds_write_b128 v2, v[128:131] offset:16384
    ds_write_b128 v2, v[132:135] offset:17408
    s_waitcnt vmcnt(27)
    s_barrier
    ds_read_b64_tr_b16 a[64:65], v34 offset:8192
    ds_read_b64_tr_b16 a[66:67], v34 offset:8448
    ds_read_b64_tr_b16 a[68:69], v34 offset:10240
    ds_read_b64_tr_b16 a[70:71], v34 offset:10496
    ds_read_b64_tr_b16 a[72:73], v36 offset:8192
    ds_read_b64_tr_b16 a[74:75], v36 offset:8448
    ds_read_b64_tr_b16 a[76:77], v36 offset:10240
    ds_read_b64_tr_b16 a[78:79], v36 offset:10496
    s_mov_b32 m0, 63488
    s_add_u32 s20, s48, 3801088
    buffer_load_dwordx4 v32, s[36:39], s20 offen lds
    s_mov_b32 m0, 64512
    s_add_u32 s20, s48, 3833856
    buffer_load_dwordx4 v32, s[36:39], s20 offen lds
    s_mov_b32 m0, 65536
    s_add_u32 s20, s48, 3866624
    buffer_load_dwordx4 v32, s[36:39], s20 offen lds
    s_mov_b32 m0, 66560
    s_add_u32 s20, s48, 3899392
    buffer_load_dwordx4 v32, s[36:39], s20 offen lds
    s_waitcnt lgkmcnt(0)
    s_waitcnt vmcnt(27)
    s_barrier
    ds_read_b64_tr_b16 a[192:193], v34 offset:12288
    ds_read_b64_tr_b16 a[194:195], v34 offset:12544
    ds_read_b64_tr_b16 a[196:197], v34 offset:14336
    ds_read_b64_tr_b16 a[198:199], v34 offset:14592
    ds_read_b64_tr_b16 a[200:201], v36 offset:12288
    ds_read_b64_tr_b16 a[202:203], v36 offset:12544
    ds_read_b64_tr_b16 a[204:205], v36 offset:14336
    ds_read_b64_tr_b16 a[206:207], v36 offset:14592
    s_mov_b32 m0, 67584
    s_add_u32 s20, s48, 3801088
    buffer_load_dwordx4 v32, s[40:43], s20 offen lds
    s_mov_b32 m0, 68608
    s_add_u32 s20, s48, 3833856
    buffer_load_dwordx4 v32, s[40:43], s20 offen lds
    s_mov_b32 m0, 69632
    s_add_u32 s20, s48, 3866624
    buffer_load_dwordx4 v32, s[40:43], s20 offen lds
    s_mov_b32 m0, 70656
    s_add_u32 s20, s48, 3899392
    buffer_load_dwordx4 v32, s[40:43], s20 offen lds
    s_waitcnt lgkmcnt(0)
    s_waitcnt vmcnt(27)
    s_barrier
    ds_read_b64_tr_b16 a[80:81], v34 offset:18432
    ds_read_b64_tr_b16 a[82:83], v34 offset:18688
    ds_read_b64_tr_b16 a[84:85], v34 offset:20480
    ds_read_b64_tr_b16 a[86:87], v34 offset:20736
    ds_read_b64_tr_b16 a[88:89], v36 offset:18432
    ds_read_b64_tr_b16 a[90:91], v36 offset:18688
    ds_read_b64_tr_b16 a[92:93], v36 offset:20480
    ds_read_b64_tr_b16 a[94:95], v36 offset:20736
    s_mov_b32 m0, 71680
    s_add_u32 s20, s48, 3801088
    buffer_load_dwordx4 v32, s[32:35], s20 offen lds
    s_mov_b32 m0, 72704
    s_add_u32 s20, s48, 3833856
    buffer_load_dwordx4 v32, s[32:35], s20 offen lds
    s_mov_b32 m0, 73728
    s_add_u32 s20, s48, 3866624
    buffer_load_dwordx4 v32, s[32:35], s20 offen lds
    s_mov_b32 m0, 74752
    s_add_u32 s20, s48, 3899392
    buffer_load_dwordx4 v32, s[32:35], s20 offen lds
    s_waitcnt lgkmcnt(0)
    s_waitcnt vmcnt(27)
    s_barrier
    ds_read_b64_tr_b16 a[208:209], v34 offset:22528
    ds_read_b64_tr_b16 a[210:211], v34 offset:22784
    ds_read_b64_tr_b16 a[212:213], v34 offset:24576
    ds_read_b64_tr_b16 a[214:215], v34 offset:24832
    ds_read_b64_tr_b16 a[216:217], v36 offset:22528
    ds_read_b64_tr_b16 a[218:219], v36 offset:22784
    ds_read_b64_tr_b16 a[220:221], v36 offset:24576
    ds_read_b64_tr_b16 a[222:223], v36 offset:24832
    s_mov_b32 m0, 77824
    s_add_u32 s20, s49, 128
    buffer_load_dwordx4 v33, s[44:47], s20 offen lds
    s_mov_b32 m0, 78848
    s_add_u32 s20, s49, 8320
    buffer_load_dwordx4 v33, s[44:47], s20 offen lds
    s_mov_b32 m0, 79872
    s_add_u32 s20, s49, 16512
    buffer_load_dwordx4 v33, s[44:47], s20 offen lds
    s_mov_b32 m0, 80896
    s_add_u32 s20, s49, 24704
    buffer_load_dwordx4 v33, s[44:47], s20 offen lds
    s_waitcnt lgkmcnt(0)
    s_waitcnt vmcnt(27)
    s_barrier
    ds_read_b64_tr_b16 v[144:145], v34 offset:26624
    ds_read_b64_tr_b16 v[146:147], v34 offset:26880
    ds_read_b64_tr_b16 v[148:149], v34 offset:28672
    ds_read_b64_tr_b16 v[150:151], v34 offset:28928
    ds_read_b64_tr_b16 v[152:153], v36 offset:26624
    ds_read_b64_tr_b16 v[154:155], v36 offset:26880
    ds_read_b64_tr_b16 v[156:157], v36 offset:28672
    ds_read_b64_tr_b16 v[158:159], v36 offset:28928
    s_mov_b32 m0, 81920
    s_add_u32 s20, s49, 32896
    buffer_load_dwordx4 v33, s[44:47], s20 offen lds
    s_mov_b32 m0, 82944
    s_add_u32 s20, s49, 41088
    buffer_load_dwordx4 v33, s[44:47], s20 offen lds
    s_mov_b32 m0, 83968
    s_add_u32 s20, s49, 49280
    buffer_load_dwordx4 v33, s[44:47], s20 offen lds
    s_mov_b32 m0, 84992
    s_add_u32 s20, s49, 57472
    buffer_load_dwordx4 v33, s[44:47], s20 offen lds
    s_waitcnt lgkmcnt(0)
    s_waitcnt vmcnt(27)
    s_barrier
    ds_read_b64_tr_b16 a[96:97], v34 offset:30720
    ds_read_b64_tr_b16 a[98:99], v34 offset:30976
    ds_read_b64_tr_b16 a[100:101], v34 offset:32768
    ds_read_b64_tr_b16 a[102:103], v34 offset:33024
    ds_read_b64_tr_b16 a[104:105], v36 offset:30720
    ds_read_b64_tr_b16 a[106:107], v36 offset:30976
    ds_read_b64_tr_b16 a[108:109], v36 offset:32768
    ds_read_b64_tr_b16 a[110:111], v36 offset:33024
    s_mov_b32 m0, 86016
    s_add_u32 s20, s49, 65664
    buffer_load_dwordx4 v33, s[44:47], s20 offen lds
    s_mov_b32 m0, 87040
    s_add_u32 s20, s49, 73856
    buffer_load_dwordx4 v33, s[44:47], s20 offen lds
    s_mov_b32 m0, 88064
    s_add_u32 s20, s49, 82048
    buffer_load_dwordx4 v33, s[44:47], s20 offen lds
    s_mov_b32 m0, 89088
    s_add_u32 s20, s49, 90240
    buffer_load_dwordx4 v33, s[44:47], s20 offen lds
    s_waitcnt lgkmcnt(0)
    s_waitcnt vmcnt(24)
    s_barrier
    ds_read_b64_tr_b16 a[224:225], v34 offset:0
    ds_read_b64_tr_b16 a[226:227], v34 offset:256
    ds_read_b64_tr_b16 a[228:229], v34 offset:2048
    ds_read_b64_tr_b16 a[230:231], v34 offset:2304
    ds_read_b64_tr_b16 a[232:233], v36 offset:0
    ds_read_b64_tr_b16 a[234:235], v36 offset:256
    ds_read_b64_tr_b16 a[236:237], v36 offset:2048
    ds_read_b64_tr_b16 a[238:239], v36 offset:2304
    s_mov_b32 m0, 90112
    s_add_u32 s20, s49, 98432
    buffer_load_dwordx4 v33, s[44:47], s20 offen lds
    s_mov_b32 m0, 91136
    s_add_u32 s20, s49, 106624
    buffer_load_dwordx4 v33, s[44:47], s20 offen lds
    s_mov_b32 m0, 92160
    s_add_u32 s20, s49, 114816
    buffer_load_dwordx4 v33, s[44:47], s20 offen lds
    s_mov_b32 m0, 93184
    s_add_u32 s20, s49, 123008
    buffer_load_dwordx4 v33, s[44:47], s20 offen lds
    s_waitcnt lgkmcnt(0)
    s_waitcnt vmcnt(24)
    s_barrier
    ds_read_b64_tr_b16 a[112:113], v34 offset:4096
    ds_read_b64_tr_b16 a[114:115], v34 offset:4352
    ds_read_b64_tr_b16 a[116:117], v34 offset:6144
    ds_read_b64_tr_b16 a[118:119], v34 offset:6400
    ds_read_b64_tr_b16 a[120:121], v36 offset:4096
    ds_read_b64_tr_b16 a[122:123], v36 offset:4352
    ds_read_b64_tr_b16 a[124:125], v36 offset:6144
    ds_read_b64_tr_b16 a[126:127], v36 offset:6400
    s_waitcnt vmcnt(32)
RR_29_c1:
    v_readfirstlane_b32 s100, v40
    v_readfirstlane_b32 s101, v41
    v_readfirstlane_b32 s97, v42
    s_cmp_ge_u32 s101, 8
    s_cselect_b32 s100, s100, 0
    s_cmp_eq_u32 s100, -1
    s_cbranch_scc1 RR_29_d1
    global_load_dwordx4 v[40:43], v22, s[64:65] sc1
    s_sub_u32 s19, s19, 1
    s_cbranch_scc1 L_end
    s_waitcnt vmcnt(0)
    s_branch RR_29_c1
RR_29_d1:
    v_lshl_or_b32 v15, v25, 16, v24
    buffer_store_dword v15, v6, s[4:7], s17 offen sc1
    s_add_u32 s17, s17, 8192
    s_mov_b32 m0, 59392
    s_add_u32 s20, s48, 131072
    buffer_load_dwordx4 v32, s[32:35], s20 offen lds
    s_mov_b32 m0, 60416
    s_add_u32 s20, s48, 163840
    buffer_load_dwordx4 v32, s[32:35], s20 offen lds
    s_mov_b32 m0, 61440
    s_add_u32 s20, s48, 196608
    buffer_load_dwordx4 v32, s[32:35], s20 offen lds
    s_mov_b32 m0, 62464
    s_add_u32 s20, s48, 229376
    buffer_load_dwordx4 v32, s[32:35], s20 offen lds
    s_waitcnt lgkmcnt(0)
    s_waitcnt vmcnt(25)
    s_barrier
    ds_read_b64_tr_b16 a[240:241], v34 offset:8192
    ds_read_b64_tr_b16 a[242:243], v34 offset:8448
    ds_read_b64_tr_b16 a[244:245], v34 offset:10240
    ds_read_b64_tr_b16 a[246:247], v34 offset:10496
    ds_read_b64_tr_b16 a[248:249], v36 offset:8192
    ds_read_b64_tr_b16 a[250:251], v36 offset:8448
    ds_read_b64_tr_b16 a[252:253], v36 offset:10240
    ds_read_b64_tr_b16 a[254:255], v36 offset:10496
    s_mov_b32 m0, 63488
    s_add_u32 s20, s48, 1179648
    buffer_load_dwordx4 v32, s[32:35], s20 offen lds
    s_mov_b32 m0, 64512
    s_add_u32 s20, s48, 1212416
    buffer_load_dwordx4 v32, s[32:35], s20 offen lds
    s_mov_b32 m0, 65536
    s_add_u32 s20, s48, 1245184
    buffer_load_dwordx4 v32, s[32:35], s20 offen lds
    s_mov_b32 m0, 66560
    s_add_u32 s20, s48, 1277952
    buffer_load_dwordx4 v32, s[32:35], s20 offen lds
    buffer_load_dword v28, v6, s[4:7], s98 offen sc1
    s_waitcnt lgkmcnt(0)
    s_waitcnt vmcnt(26)
    s_barrier
    ds_read_b64_tr_b16 v[160:161], v34 offset:12288
    ds_read_b64_tr_b16 v[162:163], v34 offset:12544
    ds_read_b64_tr_b16 v[164:165], v34 offset:14336
    ds_read_b64_tr_b16 v[166:167], v34 offset:14592
    ds_read_b64_tr_b16 v[168:169], v36 offset:12288
    ds_read_b64_tr_b16 v[170:171], v36 offset:12544
    ds_read_b64_tr_b16 v[172:173], v36 offset:14336
    ds_read_b64_tr_b16 v[174:175], v36 offset:14592
    s_mov_b32 m0, 67584
    s_add_u32 s20, s48, 2228224
    buffer_load_dwordx4 v32, s[32:35], s20 offen lds
    s_mov_b32 m0, 68608
    s_add_u32 s20, s48, 2260992
    buffer_load_dwordx4 v32, s[32:35], s20 offen lds
    s_mov_b32 m0, 69632
    s_add_u32 s20, s48, 2293760
    buffer_load_dwordx4 v32, s[32:35], s20 offen lds
    s_mov_b32 m0, 70656
    s_add_u32 s20, s48, 2326528
    buffer_load_dwordx4 v32, s[32:35], s20 offen lds
    s_waitcnt lgkmcnt(0)
    s_waitcnt vmcnt(22)
    s_barrier
    ds_read_b64_tr_b16 v[64:65], v35 offset:18432
    ds_read_b64_tr_b16 v[66:67], v35 offset:18688
    ds_read_b64_tr_b16 v[68:69], v35 offset:19456
    ds_read_b64_tr_b16 v[70:71], v35 offset:19712
    ds_read_b64_tr_b16 v[80:81], v35 offset:18464
    ds_read_b64_tr_b16 v[82:83], v35 offset:18720
    ds_read_b64_tr_b16 v[84:85], v35 offset:19488
    ds_read_b64_tr_b16 v[86:87], v35 offset:19744
    ds_read_b64_tr_b16 v[96:97], v35 offset:18496
    ds_read_b64_tr_b16 v[98:99], v35 offset:18752
    ds_read_b64_tr_b16 v[100:101], v35 offset:19520
    ds_read_b64_tr_b16 v[102:103], v35 offset:19776
    ds_read_b64_tr_b16 v[112:113], v35 offset:18528
    ds_read_b64_tr_b16 v[114:115], v35 offset:18784
    ds_read_b64_tr_b16 v[116:117], v35 offset:19552
    ds_read_b64_tr_b16 v[118:119], v35 offset:19808
    s_mov_b32 m0, 71680
    s_add_u32 s20, s48, 3276800
    buffer_load_dwordx4 v32, s[32:35], s20 offen lds
    s_mov_b32 m0, 72704
    s_add_u32 s20, s48, 3309568
    buffer_load_dwordx4 v32, s[32:35], s20 offen lds
    s_mov_b32 m0, 73728
    s_add_u32 s20, s48, 3342336
    buffer_load_dwordx4 v32, s[32:35], s20 offen lds
    s_mov_b32 m0, 74752
    s_add_u32 s20, s48, 3375104
    buffer_load_dwordx4 v32, s[32:35], s20 offen lds
    s_waitcnt lgkmcnt(0)
    s_waitcnt vmcnt(18)
    ds_read_b64_tr_b16 v[72:73], v35 offset:26624
    ds_read_b64_tr_b16 v[74:75], v35 offset:26880
    ds_read_b64_tr_b16 v[76:77], v35 offset:27648
    ds_read_b64_tr_b16 v[78:79], v35 offset:27904
    ds_read_b64_tr_b16 v[88:89], v35 offset:26656
    ds_read_b64_tr_b16 v[90:91], v35 offset:26912
    ds_read_b64_tr_b16 v[92:93], v35 offset:27680
    ds_read_b64_tr_b16 v[94:95], v35 offset:27936
    ds_read_b64_tr_b16 v[104:105], v35 offset:26688
    ds_read_b64_tr_b16 v[106:107], v35 offset:26944
    ds_read_b64_tr_b16 v[108:109], v35 offset:27712
    ds_read_b64_tr_b16 v[110:111], v35 offset:27968
    ds_read_b64_tr_b16 v[120:121], v35 offset:26720
    ds_read_b64_tr_b16 v[122:123], v35 offset:26976
    ds_read_b64_tr_b16 v[124:125], v35 offset:27744
    ds_read_b64_tr_b16 v[126:127], v35 offset:28000
    v_lshlrev_b32 v30, 1, v0
    s_add_u32 s20, s16, 0
    buffer_load_dword v7, v30, s[4:7], s20 offen sc1
    s_add_u32 s20, s16, 262144
    buffer_load_dword v7, v30, s[4:7], s20 offen sc1
    s_add_u32 s20, s10, 8192
    buffer_load_dword v7, v30, s[4:7], s20 offen sc1
    s_add_u32 s20, s10, 16384
    buffer_load_dword v7, v30, s[4:7], s20 offen sc1
    s_add_u32 s20, s10, 24576
    buffer_load_dword v7, v30, s[4:7], s20 offen sc1
    s_getpc_b64 s[54:55]
RR_29_pc1:
    v_lshlrev_b32 v30, 3, v0
    v_min_u32 v30, 5632, v30
    global_load_dword v7, v30, s[54:55]
    s_waitcnt lgkmcnt(0)
    ds_write_b128 v2, v[64:67] offset:18432
    ds_write_b128 v2, v[68:71] offset:19456
    ds_write_b128 v2, v[72:75] offset:20480
    ds_write_b128 v2, v[76:79] offset:21504
    ds_write_b128 v2, v[80:83] offset:22528
    ds_write_b128 v2, v[84:87] offset:23552
    ds_write_b128 v2, v[88:91] offset:24576
    ds_write_b128 v2, v[92:95] offset:25600
    ds_write_b128 v2, v[96:99] offset:26624
    ds_write_b128 v2, v[100:103] offset:27648
    ds_write_b128 v2, v[104:107] offset:28672
    ds_write_b128 v2, v[108:111] offset:29696
    ds_write_b128 v2, v[112:115] offset:30720
    ds_write_b128 v2, v[116:119] offset:31744
    ds_write_b128 v2, v[120:123] offset:32768
    ds_write_b128 v2, v[124:127] offset:33792
    s_waitcnt lgkmcnt(0)
    s_waitcnt vmcnt(19)
    s_barrier
    ds_read_b64_tr_b16 v[112:113], v34 offset:0
    ds_read_b64_tr_b16 v[114:115], v34 offset:256
    ds_read_b64_tr_b16 v[116:117], v34 offset:2048
    ds_read_b64_tr_b16 v[118:119], v34 offset:2304
    ds_read_b64_tr_b16 v[120:121], v36 offset:0
    ds_read_b64_tr_b16 v[122:123], v36 offset:256
    ds_read_b64_tr_b16 v[124:125], v36 offset:2048
    ds_read_b64_tr_b16 v[126:127], v36 offset:2304
    buffer_load_dword v13, v6, s[4:7], s98 offen sc1
    s_waitcnt lgkmcnt(0)
    s_waitcnt vmcnt(16)
    s_barrier
    ds_read_b64_tr_b16 v[64:65], v34 offset:4096
    ds_read_b64_tr_b16 v[66:67], v34 offset:4352
    ds_read_b64_tr_b16 v[68:69], v34 offset:6144
    ds_read_b64_tr_b16 v[70:71], v34 offset:6400
    ds_read_b64_tr_b16 v[72:73], v36 offset:4096
    ds_read_b64_tr_b16 v[74:75], v36 offset:4352
    ds_read_b64_tr_b16 v[76:77], v36 offset:6144
    ds_read_b64_tr_b16 v[78:79], v36 offset:6400
    s_waitcnt lgkmcnt(0)
    s_waitcnt vmcnt(11)
    s_barrier
    ds_read_b64_tr_b16 v[80:81], v34 offset:8192
    ds_read_b64_tr_b16 v[82:83], v34 offset:8448
    ds_read_b64_tr_b16 v[84:85], v34 offset:10240
    ds_read_b64_tr_b16 v[86:87], v34 offset:10496
    ds_read_b64_tr_b16 v[88:89], v36 offset:8192
    ds_read_b64_tr_b16 v[90:91], v36 offset:8448
    ds_read_b64_tr_b16 v[92:93], v36 offset:10240
    ds_read_b64_tr_b16 v[94:95], v36 offset:10496
    v_readlane_b32 s100, v28, 0
    s_lshl_b32 s100, s100, 2
    s_add_u32 s100, s100, 0
    s_mov_b32 s96, s100
    v_readlane_b32 s100, v28, 1
    s_lshl_b32 s100, s100, 2
    s_add_u32 s100, s100, 1
    s_min_u32 s96, s96, s100
    v_readlane_b32 s100, v28, 2
    s_lshl_b32 s100, s100, 2
    s_add_u32 s100, s100, 2
    s_min_u32 s96, s96, s100
    v_readlane_b32 s100, v28, 3
    s_lshl_b32 s100, s100, 2
    s_add_u32 s100, s100, 3
    s_min_u32 s96, s96, s100
    s_cmp_ge_u32 s96, 64
    s_cselect_b32 s96, 128, s96
    s_cmp_lt_u32 s96, 2
    s_cselect_b32 s100, 0x40000000, 0
    v_lshlrev_b32 v30, 1, v0
    v_add_u32 v30, s100, v30
    buffer_load_dword v7, v30, s[4:7], s11 offen
    buffer_load_dword v7, v30, s[4:7], s12 offen
    s_add_u32 s20, s11, 262144
    buffer_load_dword v7, v30, s[4:7], s20 offen
    s_waitcnt lgkmcnt(0)
    s_waitcnt vmcnt(10)
    s_barrier
    ds_read_b64_tr_b16 v[96:97], v34 offset:12288
    ds_read_b64_tr_b16 v[98:99], v34 offset:12544
    ds_read_b64_tr_b16 v[100:101], v34 offset:14336
    ds_read_b64_tr_b16 v[102:103], v34 offset:14592
    ds_read_b64_tr_b16 v[104:105], v36 offset:12288
    ds_read_b64_tr_b16 v[106:107], v36 offset:12544
    ds_read_b64_tr_b16 v[108:109], v36 offset:14336
    ds_read_b64_tr_b16 v[110:111], v36 offset:14592
    s_mov_b32 s20, 1
    s_cmp_lt_u32 s20, s96
    s_cbranch_scc1 R1s_r0_ok
    s_waitcnt vmcnt(0)
    v_readlane_b32 s100, v13, 0
    s_lshl_b32 s100, s100, 2
    s_add_u32 s100, s100, 0
    s_mov_b32 s96, s100
    v_readlane_b32 s100, v13, 1
    s_lshl_b32 s100, s100, 2
    s_add_u32 s100, s100, 1
    s_min_u32 s96, s96, s100
    v_readlane_b32 s100, v13, 2
    s_lshl_b32 s100, s100, 2
    s_add_u32 s100, s100, 2
    s_min_u32 s96, s96, s100
    v_readlane_b32 s100, v13, 3
    s_lshl_b32 s100, s100, 2
    s_add_u32 s100, s100, 3
    s_min_u32 s96, s96, s100
    s_cmp_ge_u32 s96, 64
    s_cselect_b32 s96, 128, s96
    s_cmp_lt_u32 s20, s96
    s_cbranch_scc1 R1s_r0_w
R1s_r0:
    buffer_load_dword v7, v6, s[4:7], s98 offen sc1
    s_sub_u32 s19, s19, 1
    s_cbranch_scc1 R1s_r0_to
    s_waitcnt vmcnt(0)
    v_readlane_b32 s100, v7, 0
    s_lshl_b32 s100, s100, 2
    s_add_u32 s100, s100, 0
    s_mov_b32 s96, s100
    v_readlane_b32 s100, v7, 1
    s_lshl_b32 s100, s100, 2
    s_add_u32 s100, s100, 1
    s_min_u32 s96, s96, s100
    v_readlane_b32 s100, v7, 2
    s_lshl_b32 s100, s100, 2
    s_add_u32 s100, s100, 2
    s_min_u32 s96, s96, s100
    v_readlane_b32 s100, v7, 3
    s_lshl_b32 s100, s100, 2
    s_add_u32 s100, s100, 3
    s_min_u32 s96, s96, s100
    s_cmp_ge_u32 s96, 64
    s_cselect_b32 s96, 128, s96
    s_cmp_lt_u32 s20, s96
    s_cbranch_scc1 R1s_r0_w
    s_sleep 8
    s_branch R1s_r0
R1s_r0_to:
    s_mov_b32 s19, 0
    s_mov_b32 s96, 128
    s_waitcnt vmcnt(0)
    s_branch R1s_r0_w
R1s_r0_w:
    v_lshlrev_b32 v30, 1, v0
    buffer_load_dword v7, v30, s[4:7], s11 offen
    buffer_load_dword v7, v30, s[4:7], s12 offen
    s_add_u32 s20, s11, 262144
    buffer_load_dword v7, v30, s[4:7], s20 offen
R1s_r0_ok:
    s_mov_b32 m0, 10240
    s_nop 0
    buffer_load_dwordx4 v0, s[4:7], s11 offen offset:0 nt lds
    buffer_load_dwordx4 v0, s[4:7], s11 offen offset:1024 nt lds
    s_add_u32 s11, s11, 262144
    buffer_load_dwordx4 v[56:59], v0, s[4:7], s10 offen offset:0 sc1
    buffer_load_dwordx4 v[56:59], v0, s[4:7], s10 offen offset:0 sc1
    s_waitcnt lgkmcnt(0)
    s_barrier
    ds_write_b128 v2, v[64:67] offset:0
    ds_write_b128 v2, v[68:71] offset:1024
    ds_write_b128 v2, v[72:75] offset:2048
    ds_write_b128 v2, v[76:79] offset:3072
    ds_write_b128 v2, v[80:83] offset:4096
    ds_write_b128 v2, v[84:87] offset:5120
    ds_write_b128 v2, v[88:91] offset:6144
    ds_write_b128 v2, v[92:95] offset:7168
    ds_write_b128 v2, v[96:99] offset:8192
    ds_write_b128 v2, v[100:103] offset:9216
    ds_write_b128 v2, v[104:107] offset:10240
    ds_write_b128 v2, v[108:111] offset:11264
    ds_write_b128 v2, v[112:115] offset:12288
    ds_write_b128 v2, v[116:119] offset:13312
    ds_write_b128 v2, v[120:123] offset:14336
    ds_write_b128 v2, v[124:127] offset:15360
    s_cmp_lg_u32 s97, 0
    s_cbranch_scc1 RR_29_s1
    v_mov_b64 v[16:17], 0
    v_mov_b64 v[18:19], 0
    v_mov_b64 v[20:21], 0
    v_mov_b64 v[22:23], 0
    v_mov_b64 v[24:25], 0
    v_mov_b64 v[26:27], 0
    v_mov_b64 v[28:29], 0
    v_mov_b64 v[30:31], 0
    v_mov_b64 v[32:33], 0
    v_mov_b64 v[34:35], 0
    v_mov_b64 v[36:37], 0
    v_mov_b64 v[38:39], 0
    s_branch R1f_top
.p2align 6
    s_nop 0
R1f_pe:
    buffer_load_dwordx4 v[56:59], v0, s[4:7], s10 offen offset:0 sc1
    s_sub_u32 s99, s99, 1
    s_cbranch_scc1 R1f_pe_to
R1f_top:
    s_waitcnt vmcnt(1)
    v_fma_f32 v7, v56, v57, v58
    v_cmp_u_f32 vcc, v7, v59
    ds_write_b128 v0, v[56:59] offset:2048
    s_cbranch_vccnz R1f_pe
R1f_pe_go:
    v_smfmac_f32_16x16x64_bf16 v[16:19], v[56:59], v[64:71], v1
    buffer_load_dwordx4 v[60:63], v0, s[4:7], s10 offen offset:1024 sc1
    v_smfmac_f32_16x16x64_bf16 v[20:23], v[56:59], v[72:79], v1
    v_smfmac_f32_16x16x64_bf16 v[24:27], v[56:59], a[32:39], v1
    s_waitcnt lgkmcnt(0)
    s_barrier
    ds_read_b128 v[48:51], v0 offset:4096
    v_smfmac_f32_16x16x64_bf16 v[28:31], v[56:59], a[40:47], v1
    ds_read_b128 v[52:55], v0 offset:6144
    v_smfmac_f32_16x16x64_bf16 v[32:35], v[56:59], a[160:167], v1
    v_smfmac_f32_16x16x64_bf16 v[36:39], v[56:59], a[168:175], v1
    s_waitcnt lgkmcnt(1)
    v_smfmac_f32_16x16x64_bf16 v[16:19], v[48:51], v[80:87], v1
    v_smfmac_f32_16x16x64_bf16 v[20:23], v[48:51], v[88:95], v1
    ds_read_b128 v[80:83], v0 offset:8192
    v_smfmac_f32_16x16x64_bf16 v[24:27], v[48:51], a[64:71], v1
    s_waitcnt vmcnt(1)
    ds_read_b128 v[56:59], v0 offset:0
    buffer_load_dwordx4 v[40:43], v0, s[4:7], s12 offen offset:0 nt
    v_smfmac_f32_16x16x64_bf16 v[28:31], v[48:51], a[72:79], v1
    buffer_load_dwordx4 v[44:47], v0, s[4:7], s12 offen offset:1024 nt
    ds_read_b128 v[84:87], v0 offset:9216
    s_waitcnt lgkmcnt(3)
    v_smfmac_f32_16x16x64_bf16 v[16:19], v[52:55], v[96:103], v1
    ds_read_b128 v[88:91], v0 offset:10240
    v_mov_b32 v12, -1
    v_smfmac_f32_16x16x64_bf16 v[20:23], v[52:55], v[104:111], v1
    v_smfmac_f32_16x16x64_bf16 v[24:27], v[52:55], a[96:103], v1
    s_waitcnt lgkmcnt(2)
    v_smfmac_f32_16x16x64_bf16 v[28:31], v[52:55], a[104:111], v1
    s_waitcnt vmcnt(2)
    ds_write_b128 v0, v[60:63] offset:3072
    v_smfmac_f32_16x16x64_bf16 v[16:19], v[56:59], v[112:119], v1
    v_fma_f32 v7, v60, v61, v62
    v_smfmac_f32_16x16x64_bf16 v[20:23], v[56:59], v[120:127], v1
    v_cmp_u_f32 vcc, v7, v63
    v_smfmac_f32_16x16x64_bf16 v[24:27], v[56:59], a[0:7], v1
    buffer_store_dword v12, v6, s[4:7], s61 offen
    v_smfmac_f32_16x16x64_bf16 v[28:31], v[56:59], a[8:15], v1
    s_cbranch_vccnz R1f_po
R1f_po_ok:
    v_smfmac_f32_16x16x64_bf16 v[32:35], v[56:59], a[128:135], v1
    s_waitcnt lgkmcnt(0)
    s_barrier
    ds_read_b128 v[48:51], v0 offset:5120
    v_smfmac_f32_16x16x64_bf16 v[36:39], v[56:59], a[136:143], v1
    ds_read_b128 v[56:59], v0 offset:7168
    v_smfmac_f32_16x16x64_bf16 v[16:19], v[60:63], v[128:135], v1
    buffer_store_dword v15, v6, s[4:7], s18 offen sc1
    ds_read_b128 v[52:55], v0 offset:1024
    v_smfmac_f32_16x16x64_bf16 v[20:23], v[60:63], v[136:143], v1
    v_smfmac_f32_16x16x64_bf16 v[24:27], v[60:63], a[48:55], v1
    v_smfmac_f32_16x16x64_bf16 v[28:31], v[60:63], a[56:63], v1
    s_waitcnt lgkmcnt(2)
    ds_read_b128 v[92:95], v0 offset:11264
    v_smfmac_f32_16x16x64_bf16 v[16:19], v[48:51], v[144:151], v1
    ds_read_b128 v[96:99], v0 offset:12288
    v_smfmac_f32_16x16x64_bf16 v[20:23], v[48:51], v[152:159], v1
    s_waitcnt lgkmcnt(3)
    ds_read_b128 v[100:103], v0 offset:13312
    v_smfmac_f32_16x16x64_bf16 v[16:19], v[56:59], v[160:167], v1
    ds_read_b128 v[104:107], v0 offset:14336
    v_smfmac_f32_16x16x64_bf16 v[20:23], v[56:59], v[168:175], v1
    s_waitcnt lgkmcnt(4)
    ds_read_b128 v[108:111], v0 offset:15360
    v_smfmac_f32_16x16x64_bf16 v[16:19], v[52:55], v[176:183], v1
    v_smfmac_f32_16x16x64_bf16 v[20:23], v[52:55], v[184:191], v1
    v_smfmac_f32_16x16x64_bf16 v[24:27], v[48:51], a[80:87], v1
    ds_read_b128 v[120:123], v2 offset:32768
    v_add_f32 v16, v16, v18
    v_smfmac_f32_16x16x64_bf16 v[28:31], v[48:51], a[88:95], v1
    ds_read_b128 v[124:127], v2 offset:33792
    v_add_f32 v17, v17, v19
    v_smfmac_f32_16x16x64_bf16 v[24:27], v[56:59], a[112:119], v1
    v_add_f32 v20, v20, v22
    v_smfmac_f32_16x16x64_bf16 v[28:31], v[56:59], a[120:127], v1
    v_add_f32 v21, v21, v23
    v_smfmac_f32_16x16x64_bf16 v[24:27], v[52:55], a[16:23], v1
    v_cvt_pk_bf16_f32 v18, v16, v20
    v_smfmac_f32_16x16x64_bf16 v[28:31], v[52:55], a[24:31], v1
    v_cvt_pk_bf16_f32 v19, v17, v21
    v_smfmac_f32_16x16x64_bf16 v[32:35], v[48:51], a[208:215], v1
    ds_write2_b32 v3, v18, v19 offset0:0 offset1:136
    v_add_f32 v24, v24, v26
    v_smfmac_f32_16x16x64_bf16 v[36:39], v[48:51], a[216:223], v1
    ds_read_b128 v[48:51], v0 offset:4096
    v_add_f32 v25, v25, v27
    v_add_f32 v28, v28, v30
    v_add_f32 v29, v29, v31
    v_cvt_pk_bf16_f32 v128, v24, v28
    v_cvt_pk_bf16_f32 v129, v25, v29
    v_smfmac_f32_16x16x64_bf16 v[32:35], v[52:55], a[144:151], v1
    ds_write2_b32 v3, v128, v129 offset0:64 offset1:200
    v_smfmac_f32_16x16x64_bf16 v[36:39], v[52:55], a[152:159], v1
    ds_read_b128 v[52:55], v0 offset:6144
    v_smfmac_f32_16x16x64_bf16 v[32:35], v[60:63], a[176:183], v1
    v_smfmac_f32_16x16x64_bf16 v[36:39], v[60:63], a[184:191], v1
    v_smfmac_f32_16x16x64_bf16 v[32:35], v[56:59], a[240:247], v1
    s_waitcnt lgkmcnt(1)
    s_barrier
    ds_read_b128 v[64:67], v4 offset:0
    v_smfmac_f32_16x16x64_bf16 v[36:39], v[56:59], a[248:255], v1
    ds_read_b128 v[68:71], v4 offset:64
    ds_read_b128 v[112:115], v4 offset:256
    v_smfmac_f32_16x16x64_bf16 v[32:35], v[48:51], a[192:199], v1
    ds_read_b128 v[116:119], v4 offset:320
    ds_read_b128 v[72:75], v4 offset:128
    s_waitcnt lgkmcnt(5)
    ds_read_b128 v[76:79], v4 offset:192
    s_waitcnt lgkmcnt(5)
    v_mfma_f32_16x16x32_bf16 v[16:19], v[80:83], v[64:67], 0
    v_mfma_f32_16x16x32_bf16 v[20:23], v[96:99], v[64:67], 0
    s_waitcnt lgkmcnt(4)
    v_mfma_f32_16x16x32_bf16 v[16:19], v[84:87], v[68:71], v[16:19]
    buffer_load_dwordx4 v0, s[4:7], s11 offen offset:0 nt lds
    v_mov_b64 v[56:57], s[58:59]
    v_mov_b64 v[58:59], s[58:59]
    v_mfma_f32_16x16x32_bf16 v[20:23], v[100:103], v[68:71], v[20:23]
    buffer_load_dwordx4 v0, s[4:7], s11 offen offset:1024 nt lds
    s_waitcnt lgkmcnt(2)
    v_mfma_f32_16x16x32_bf16 v[24:27], v[112:115], v[64:67], 0
    v_mfma_f32_16x16x32_bf16 v[24:27], v[116:119], v[68:71], v[24:27]
    s_waitcnt lgkmcnt(1)
    v_mfma_f32_16x16x32_bf16 v[16:19], v[88:91], v[72:75], v[16:19]
    ds_read_b128 v[80:83], v2 offset:22528
    v_mfma_f32_16x16x32_bf16 v[20:23], v[104:107], v[72:75], v[20:23]
    s_waitcnt lgkmcnt(1)
    ds_read_b128 v[84:87], v2 offset:23552
    v_mfma_f32_16x16x32_bf16 v[16:19], v[92:95], v[76:79], v[16:19]
    ds_read_b128 v[64:67], v2 offset:18432
    v_add_f32_dpp v24, v26, v24 quad_perm:[2,3,0,1] row_mask:0xf bank_mask:0xf
    v_add_f32_dpp v25, v27, v25 quad_perm:[2,3,0,1] row_mask:0xf bank_mask:0xf
    v_mfma_f32_16x16x32_bf16 v[20:23], v[108:111], v[76:79], v[20:23]
    ds_read_b128 v[68:71], v2 offset:19456
    v_max_f32 v132, v24, v25
    v_smfmac_f32_16x16x64_bf16 v[36:39], v[48:51], a[200:207], v1
    ds_read_b128 v[88:91], v2 offset:24576
    ds_read_b128 v[72:75], v2 offset:20480
    v_max3_f32 v132, v132, v16, v17
    v_max3_f32 v132, v132, v18, v19
    v_max3_f32 v134, v132, v20, v21
    v_max3_f32 v132, v134, v22, v23
    v_max3_f32 v133, v134, v22, v23
    v_smfmac_f32_16x16x64_bf16 v[32:35], v[52:55], a[224:231], v1
    ds_read_b128 v[92:95], v2 offset:25600
    ds_read_b128 v[96:99], v2 offset:26624
    v_permlane16_swap_b32 v132, v133
    v_max_f32 v134, v132, v133
    v_max_f32 v135, v132, v133
    v_smfmac_f32_16x16x64_bf16 v[36:39], v[52:55], a[232:239], v1
    ds_read_b128 v[100:103], v2 offset:27648
    v_permlane32_swap_b32 v134, v135
    v_max_f32 v132, v134, v135
    v_fma_f32 v132, v132, s56, v14
    v_pk_fma_f32 v[24:25], v[24:25], s[56:57], v[132:133] op_sel_hi:[1,1,0] neg_lo:[0,0,1] neg_hi:[0,0,1]
    v_pk_fma_f32 v[16:17], v[16:17], s[56:57], v[132:133] op_sel_hi:[1,1,0] neg_lo:[0,0,1] neg_hi:[0,0,1]
    v_pk_fma_f32 v[18:19], v[18:19], s[56:57], v[132:133] op_sel_hi:[1,1,0] neg_lo:[0,0,1] neg_hi:[0,0,1]
    v_pk_fma_f32 v[20:21], v[20:21], s[56:57], v[132:133] op_sel_hi:[1,1,0] neg_lo:[0,0,1] neg_hi:[0,0,1]
    v_pk_fma_f32 v[22:23], v[22:23], s[56:57], v[132:133] op_sel_hi:[1,1,0] neg_lo:[0,0,1] neg_hi:[0,0,1]
    v_pk_add_f32 v[32:33], v[32:33], v[34:35]
    v_pk_add_f32 v[36:37], v[36:37], v[38:39]
    v_cvt_pk_bf16_f32 v130, v32, v33
    v_cvt_pk_bf16_f32 v131, v36, v37
    v_exp_f32 v24, v24
    v_exp_f32 v25, v25
    v_exp_f32 v16, v16
    v_cvt_pk_bf16_f32 v12, v24, v25
    v_exp_f32 v17, v17
    v_exp_f32 v18, v18
    v_mov_b32_dpp v13, v12 quad_perm:[2,3,0,1] row_mask:0xf bank_mask:0xf
    v_exp_f32 v19, v19
    v_cvt_pk_bf16_f32 v28, v16, v17
    v_mfma_f32_16x16x16_bf16 v[60:63], v[56:57], v[12:13], 0
    ds_read_b128 v[76:79], v2 offset:21504
    v_exp_f32 v20, v20
    v_cvt_pk_bf16_f32 v29, v18, v19
    v_mfma_f32_16x16x16_bf16 v[48:51], v[130:131], v[12:13], 0
    s_waitcnt vmcnt(4)
    v_exp_f32 v21, v21
    v_exp_f32 v22, v22
    v_exp_f32 v23, v23
    v_cvt_pk_bf16_f32 v30, v20, v21
    v_cvt_pk_bf16_f32 v31, v22, v23
    v_mov_b32_dpp v16, v28 quad_perm:[2,3,0,1] row_mask:0xf bank_mask:0xf
    v_mov_b32_dpp v17, v29 quad_perm:[2,3,0,1] row_mask:0xf bank_mask:0xf
    v_mfma_f32_16x16x32_bf16 v[60:63], v[56:59], v[28:31], v[60:63]
    v_mov_b32_dpp v18, v30 quad_perm:[2,3,0,1] row_mask:0xf bank_mask:0xf
    v_mov_b32_dpp v19, v31 quad_perm:[2,3,0,1] row_mask:0xf bank_mask:0xf
    v_mfma_f32_16x16x32_bf16 v[48:51], v[40:43], v[28:31], v[48:51]
    v_mov_b64 v[24:25], 0
    v_mov_b64 v[26:27], 0
    v_mfma_f32_16x16x32_bf16 v[48:51], v[44:47], v[16:19], v[48:51]
    v_rcp_f32_dpp v132, v60 quad_perm:[0,1,0,1] row_mask:0xf bank_mask:0xf
    v_mov_b64 v[20:21], 0
    v_mov_b64 v[22:23], 0
    v_mov_b64 v[16:17], 0
    v_mov_b64 v[18:19], 0
    v_mov_b64 v[28:29], 0
    v_pk_mul_f32 v[48:49], v[48:49], v[132:133] op_sel_hi:[1,0]
    v_pk_mul_f32 v[50:51], v[50:51], v[132:133] op_sel_hi:[1,0]
    v_cvt_pk_bf16_f32 v134, v48, v49
    v_cvt_pk_bf16_f32 v135, v50, v51
    ds_write_b64 v0, v[134:135] offset:22024
    v_mov_b64 v[30:31], 0
    v_mov_b64 v[48:49], 0
    v_mov_b64 v[50:51], 0
    v_mov_b64 v[32:33], 0
    v_mov_b64 v[34:35], 0
    v_mov_b64 v[36:37], 0
    v_mov_b64 v[38:39], 0
    v_mov_b64 v[52:53], 0
    v_mov_b64 v[54:55], 0
    s_add_u32 s11, s11, 262144
    s_add_u32 s12, s12, 262144
    s_add_u32 s9, s9, 1
    s_waitcnt lgkmcnt(0)
    s_barrier
    ds_read_b128 v[56:59], v0 offset:22016
    ds_read_b128 v[60:63], v0 offset:23040
    s_add_u32 s10, s10, 8192
    s_and_b32 s10, s10, 0xffff7fff
    s_add_u32 s13, s13, 262144
    s_add_u32 s18, s18, 8192
    s_xor_b32 s61, s17, 16384
    s_waitcnt lgkmcnt(1)
    v_smfmac_f32_16x16x64_bf16 v[16:19], v[56:59], v[192:199], v1
    v_smfmac_f32_16x16x64_bf16 v[20:23], v[56:59], v[208:215], v1
    s_waitcnt lgkmcnt(0)
    v_smfmac_f32_16x16x64_bf16 v[16:19], v[60:63], v[200:207], v1
    ds_read_b128 v[104:107], v2 offset:28672
    v_smfmac_f32_16x16x64_bf16 v[20:23], v[60:63], v[216:223], v1
    ds_read_b128 v[108:111], v2 offset:29696
    v_smfmac_f32_16x16x64_bf16 v[24:27], v[56:59], v[224:231], v1
    ds_read_b128 v[112:115], v2 offset:30720
    v_add_f32 v16, v16, v18
    v_smfmac_f32_16x16x64_bf16 v[24:27], v[60:63], v[232:239], v1
    ds_read_b128 v[116:119], v2 offset:31744
    v_add_f32 v20, v20, v22
    v_smfmac_f32_16x16x64_bf16 v[28:31], v[56:59], v[240:247], v1
    v_add_f32 v17, v17, v19
    v_smfmac_f32_16x16x64_bf16 v[28:31], v[60:63], v[248:255], v1
    v_add_f32 v21, v21, v23
    v_smfmac_f32_16x16x64_bf16 v[32:35], v[56:59], v[64:71], v1
    v_cvt_pk_bf16_f32 v16, v16, v20
    v_bfi_b32 v16, 1, s21, v16
    v_cvt_pk_bf16_f32 v17, v17, v21
    v_add_f32 v24, v24, v26
    v_add_f32 v25, v25, v27
    v_add_f32 v28, v28, v30
    v_add_f32 v29, v29, v31
    v_cvt_pk_bf16_f32 v18, v24, v28
    v_cvt_pk_bf16_f32 v19, v25, v29
    v_smfmac_f32_16x16x64_bf16 v[32:35], v[60:63], v[72:79], v1
    buffer_store_dwordx4 v[16:19], v5, s[4:7], s14 offen
    v_smfmac_f32_16x16x64_bf16 v[36:39], v[56:59], v[80:87], v1
    v_smfmac_f32_16x16x64_bf16 v[36:39], v[60:63], v[88:95], v1
    s_waitcnt lgkmcnt(0)
    v_add_f32 v32, v32, v34
    v_smfmac_f32_16x16x64_bf16 v[48:51], v[56:59], v[96:103], v1
    v_add_f32 v33, v33, v35
    v_smfmac_f32_16x16x64_bf16 v[48:51], v[60:63], v[104:111], v1
    v_add_f32 v36, v36, v38
    v_smfmac_f32_16x16x64_bf16 v[52:55], v[56:59], v[112:119], v1
    v_add_f32 v37, v37, v39
    v_smfmac_f32_16x16x64_bf16 v[52:55], v[60:63], v[120:127], v1
    v_cvt_pk_bf16_f32 v32, v32, v36
    v_bfi_b32 v32, 1, s21, v32
    v_cvt_pk_bf16_f32 v33, v33, v37
    v_add_f32 v48, v48, v50
    v_add_f32 v49, v49, v51
    s_nop 1
    v_add_f32 v52, v52, v54
    v_add_f32 v53, v53, v55
    v_cvt_pk_bf16_f32 v34, v48, v52
    v_cvt_pk_bf16_f32 v35, v49, v53
    buffer_store_dwordx4 v[32:35], v5, s[4:7], s15 offen
    v_mov_b64 v[16:17], 0
    v_mov_b64 v[18:19], 0
    v_mov_b64 v[20:21], 0
    v_mov_b64 v[22:23], 0
    v_mov_b64 v[24:25], 0
    v_mov_b64 v[26:27], 0
    v_mov_b64 v[28:29], 0
    v_mov_b64 v[30:31], 0
    v_mov_b64 v[32:33], 0
    v_mov_b64 v[34:35], 0
    v_mov_b64 v[36:37], 0
    v_mov_b64 v[38:39], 0
    ds_read_b128 v[64:67], v2 offset:0
    ds_read_b128 v[68:71], v2 offset:1024
    ds_read_b128 v[72:75], v2 offset:2048
    ds_read_b128 v[76:79], v2 offset:3072
    ds_read_b128 v[80:83], v2 offset:4096
    ds_read_b128 v[84:87], v2 offset:5120
    s_waitcnt vmcnt(1)
    buffer_load_dwordx4 v[56:59], v0, s[4:7], s16 offen offset:0 sc1
    buffer_load_dwordx4 v[60:63], v0, s[4:7], s16 offen offset:1024 sc1
    ds_read_b128 v[88:91], v2 offset:6144
    ds_read_b128 v[92:95], v2 offset:7168
    ds_read_b128 v[96:99], v2 offset:8192
    ds_read_b128 v[100:103], v2 offset:9216
    s_waitcnt lgkmcnt(0)
    buffer_load_dwordx4 v[40:43], v0, s[4:7], s16 offen offset:0 sc1
    buffer_load_dwordx4 v[44:47], v0, s[4:7], s16 offen offset:1024 sc1
    ds_read_b128 v[104:107], v2 offset:10240
    ds_read_b128 v[108:111], v2 offset:11264
    s_waitcnt vmcnt(3)
    v_mfma_f32_16x16x32_bf16 v[48:51], v[8:11], v[56:59], 0
    s_waitcnt vmcnt(2)
    v_mfma_f32_16x16x32_bf16 v[48:51], v[8:11], v[60:63], v[48:51]
    v_and_b32 v13, 1, v56
    v_and_b32 v12, 1, v60
    v_add_u32 v12, v13, v12
    v_cmp_ne_u32 vcc, s60, v12
    s_nop 2
    v_add_f32_dpp v48, v48, v48 row_ror:4 row_mask:0xf bank_mask:0xf
    v_add_f32_dpp v49, v49, v49 row_ror:4 row_mask:0xf bank_mask:0xf
    s_cbranch_vccnz R1f_p1
    v_add_f32_dpp v48, v48, v48 row_ror:8 row_mask:0xf bank_mask:0xf
    v_add_f32_dpp v49, v49, v49 row_ror:8 row_mask:0xf bank_mask:0xf
    v_cvt_pk_bf16_f32 v15, v48, v49
    buffer_store_dword v15, v6, s[4:7], s17 offen
R1f_p1_ok:
    s_cmp_eq_u32 s9, 63
    s_cbranch_scc1 R1f_fin
    s_xor_b32 s14, s14, 262144
    s_xor_b32 s15, s15, 262144
    s_add_u32 s17, s17, 8192
    s_and_b32 s17, s17, 0xffff7fff
    s_xor_b32 s16, s16, 262144
    s_min_u32 s99, s19, 31
    s_and_b32 s60, s9, 2
    s_lshr_b32 s21, s60, 1
    ds_read_b128 v[112:115], v2 offset:12288
    ds_read_b128 v[116:119], v2 offset:13312
    s_waitcnt lgkmcnt(0)
    buffer_load_dwordx4 v[56:59], v0, s[4:7], s10 offen offset:0 sc1
    ds_read_b128 v[120:123], v2 offset:14336
    ds_read_b128 v[124:127], v2 offset:15360
    ds_read_b128 v[128:131], v2 offset:16384
    ds_read_b128 v[132:135], v2 offset:17408
    s_waitcnt lgkmcnt(0)
    buffer_load_dwordx4 v[56:59], v0, s[4:7], s10 offen offset:0 sc1
    s_branch R1f_top
R1f_pe_to:
    s_mov_b32 s99, 31
    s_waitcnt vmcnt(0)
    v_max3_u32 v7, v56, v57, v58
    v_max_u32 v7, v7, v59
    v_cmp_eq_u32 vcc, -1, v7
    ds_write_b128 v0, v[56:59] offset:2048
    s_cbranch_vccz R1f_pe_go
    s_sub_u32 s19, s19, 32
    s_cbranch_scc0 R1f_pe
    s_mov_b32 s19, 0
    s_mov_b32 s99, 0
    s_branch R1f_pe_go
R1f_po:
    buffer_load_dwordx4 v[60:63], v0, s[4:7], s10 offen offset:1024 sc1
    s_sub_u32 s19, s19, 1
    s_cbranch_scc1 R1f_po_to
    s_waitcnt vmcnt(0)
    ds_write_b128 v0, v[60:63] offset:3072
    v_max3_u32 v7, v60, v61, v62
    v_max_u32 v7, v7, v63
    v_cmp_eq_u32 vcc, -1, v7
    s_cbranch_vccnz R1f_po
    s_branch R1f_po_ok
R1f_po_to:
    s_mov_b32 s19, 0
    s_waitcnt vmcnt(0)
    ds_write_b128 v0, v[60:63] offset:3072
    s_branch R1f_po_ok
R1f_p1:
    buffer_load_dwordx4 v[56:59], v0, s[4:7], s16 offen offset:0 sc1
    buffer_load_dwordx4 v[60:63], v0, s[4:7], s16 offen offset:1024 sc1
    s_waitcnt vmcnt(3)
    v_mfma_f32_16x16x32_bf16 v[48:51], v[8:11], v[40:43], 0
    s_waitcnt vmcnt(2)
    v_mfma_f32_16x16x32_bf16 v[48:51], v[8:11], v[44:47], v[48:51]
    v_and_b32 v13, 1, v40
    v_and_b32 v12, 1, v44
    v_add_u32 v12, v13, v12
    v_cmp_ne_u32 vcc, s60, v12
    s_nop 2
    v_add_f32_dpp v48, v48, v48 row_ror:4 row_mask:0xf bank_mask:0xf
    v_add_f32_dpp v49, v49, v49 row_ror:4 row_mask:0xf bank_mask:0xf
    s_cbranch_vccnz R1f_p1b
    v_add_f32_dpp v48, v48, v48 row_ror:8 row_mask:0xf bank_mask:0xf
    v_add_f32_dpp v49, v49, v49 row_ror:8 row_mask:0xf bank_mask:0xf
    v_cvt_pk_bf16_f32 v15, v48, v49
    buffer_store_dword v15, v6, s[4:7], s17 offen
    s_branch R1f_p1_ok
R1f_p1b:
    buffer_load_dwordx4 v[40:43], v0, s[4:7], s16 offen offset:0 sc1
    buffer_load_dwordx4 v[44:47], v0, s[4:7], s16 offen offset:1024 sc1
    s_sub_u32 s19, s19, 1
    s_cbranch_scc1 R1f_p1_to
    s_waitcnt vmcnt(3)
    v_mfma_f32_16x16x32_bf16 v[48:51], v[8:11], v[56:59], 0
    s_waitcnt vmcnt(2)
    v_mfma_f32_16x16x32_bf16 v[48:51], v[8:11], v[60:63], v[48:51]
    v_and_b32 v13, 1, v56
    v_and_b32 v12, 1, v60
    v_add_u32 v12, v13, v12
    v_cmp_ne_u32 vcc, s60, v12
    s_nop 2
    v_add_f32_dpp v48, v48, v48 row_ror:4 row_mask:0xf bank_mask:0xf
    v_add_f32_dpp v49, v49, v49 row_ror:4 row_mask:0xf bank_mask:0xf
    s_cbranch_vccnz R1f_p1
    v_add_f32_dpp v48, v48, v48 row_ror:8 row_mask:0xf bank_mask:0xf
    v_add_f32_dpp v49, v49, v49 row_ror:8 row_mask:0xf bank_mask:0xf
    v_cvt_pk_bf16_f32 v15, v48, v49
    buffer_store_dword v15, v6, s[4:7], s17 offen
    s_branch R1f_p1_ok
R1f_p1_to:
    s_mov_b32 s19, 0
    v_add_f32_dpp v48, v48, v48 row_ror:8 row_mask:0xf bank_mask:0xf
    v_add_f32_dpp v49, v49, v49 row_ror:8 row_mask:0xf bank_mask:0xf
    v_cvt_pk_bf16_f32 v15, v48, v49
    buffer_store_dword v15, v6, s[4:7], s17 offen
    s_branch R1f_p1_ok
R1f_fin:
    buffer_store_dword v15, v6, s[4:7], s18 offen sc1
    s_branch L_end
RR_29_s1:
    v_mov_b64 v[16:17], 0
    v_mov_b64 v[18:19], 0
    v_mov_b64 v[20:21], 0
    v_mov_b64 v[22:23], 0
    v_mov_b64 v[24:25], 0
    v_mov_b64 v[26:27], 0
    v_mov_b64 v[28:29], 0
    v_mov_b64 v[30:31], 0
    v_mov_b64 v[32:33], 0
    v_mov_b64 v[34:35], 0
    v_mov_b64 v[36:37], 0
    v_mov_b64 v[38:39], 0
    s_branch R1s_top
.p2align 6
    s_nop 0
R1s_pe:
    buffer_load_dwordx4 v[56:59], v0, s[4:7], s10 offen offset:0 sc1
    s_sub_u32 s99, s99, 1
    s_cbranch_scc1 R1s_pe_to
R1s_top:
    s_waitcnt vmcnt(1)
    v_fma_f32 v7, v56, v57, v58
    v_cmp_u_f32 vcc, v7, v59
    ds_write_b128 v0, v[56:59] offset:2048
    s_cbranch_vccnz R1s_pe
R1s_pe_go:
    v_smfmac_f32_16x16x64_bf16 v[16:19], v[56:59], v[64:71], v1
    buffer_load_dwordx4 v[60:63], v0, s[4:7], s10 offen offset:1024 sc1
    v_smfmac_f32_16x16x64_bf16 v[20:23], v[56:59], v[72:79], v1
    v_smfmac_f32_16x16x64_bf16 v[24:27], v[56:59], a[32:39], v1
    s_waitcnt lgkmcnt(0)
    s_barrier
    ds_read_b128 v[48:51], v0 offset:4096
    v_smfmac_f32_16x16x64_bf16 v[28:31], v[56:59], a[40:47], v1
    ds_read_b128 v[52:55], v0 offset:6144
    v_smfmac_f32_16x16x64_bf16 v[32:35], v[56:59], a[160:167], v1
    v_smfmac_f32_16x16x64_bf16 v[36:39], v[56:59], a[168:175], v1
    s_waitcnt lgkmcnt(1)
    v_smfmac_f32_16x16x64_bf16 v[16:19], v[48:51], v[80:87], v1
    v_smfmac_f32_16x16x64_bf16 v[20:23], v[48:51], v[88:95], v1
    ds_read_b128 v[80:83], v0 offset:8192
    v_smfmac_f32_16x16x64_bf16 v[24:27], v[48:51], a[64:71], v1
    s_waitcnt vmcnt(1)
    ds_read_b128 v[56:59], v0 offset:0
    buffer_load_dwordx4 v[40:43], v0, s[4:7], s12 offen offset:0 nt
    v_smfmac_f32_16x16x64_bf16 v[28:31], v[48:51], a[72:79], v1
    buffer_load_dwordx4 v[44:47], v0, s[4:7], s12 offen offset:1024 nt
    ds_read_b128 v[84:87], v0 offset:9216
    s_waitcnt lgkmcnt(3)
    v_smfmac_f32_16x16x64_bf16 v[16:19], v[52:55], v[96:103], v1
    ds_read_b128 v[88:91], v0 offset:10240
    v_mov_b32 v12, -1
    v_smfmac_f32_16x16x64_bf16 v[20:23], v[52:55], v[104:111], v1
    v_smfmac_f32_16x16x64_bf16 v[24:27], v[52:55], a[96:103], v1
    s_waitcnt lgkmcnt(2)
    v_smfmac_f32_16x16x64_bf16 v[28:31], v[52:55], a[104:111], v1
    s_waitcnt vmcnt(2)
    ds_write_b128 v0, v[60:63] offset:3072
    v_smfmac_f32_16x16x64_bf16 v[16:19], v[56:59], v[112:119], v1
    v_fma_f32 v7, v60, v61, v62
    v_smfmac_f32_16x16x64_bf16 v[20:23], v[56:59], v[120:127], v1
    v_cmp_u_f32 vcc, v7, v63
    v_smfmac_f32_16x16x64_bf16 v[24:27], v[56:59], a[0:7], v1
    buffer_store_dword v12, v6, s[4:7], s61 offen sc1
    v_smfmac_f32_16x16x64_bf16 v[28:31], v[56:59], a[8:15], v1
    s_cbranch_vccnz R1s_po
R1s_po_ok:
    v_smfmac_f32_16x16x64_bf16 v[32:35], v[56:59], a[128:135], v1
    s_waitcnt lgkmcnt(0)
    s_barrier
    ds_read_b128 v[48:51], v0 offset:5120
    v_smfmac_f32_16x16x64_bf16 v[36:39], v[56:59], a[136:143], v1
    ds_read_b128 v[56:59], v0 offset:7168
    v_smfmac_f32_16x16x64_bf16 v[16:19], v[60:63], v[128:135], v1
    buffer_store_dword v15, v6, s[4:7], s18 offen sc1
    ds_read_b128 v[52:55], v0 offset:1024
    v_smfmac_f32_16x16x64_bf16 v[20:23], v[60:63], v[136:143], v1
    v_smfmac_f32_16x16x64_bf16 v[24:27], v[60:63], a[48:55], v1
    v_smfmac_f32_16x16x64_bf16 v[28:31], v[60:63], a[56:63], v1
    s_waitcnt lgkmcnt(2)
    ds_read_b128 v[92:95], v0 offset:11264
    v_smfmac_f32_16x16x64_bf16 v[16:19], v[48:51], v[144:151], v1
    ds_read_b128 v[96:99], v0 offset:12288
    v_smfmac_f32_16x16x64_bf16 v[20:23], v[48:51], v[152:159], v1
    s_waitcnt lgkmcnt(3)
    ds_read_b128 v[100:103], v0 offset:13312
    v_smfmac_f32_16x16x64_bf16 v[16:19], v[56:59], v[160:167], v1
    ds_read_b128 v[104:107], v0 offset:14336
    v_smfmac_f32_16x16x64_bf16 v[20:23], v[56:59], v[168:175], v1
    s_waitcnt lgkmcnt(4)
    ds_read_b128 v[108:111], v0 offset:15360
    v_smfmac_f32_16x16x64_bf16 v[16:19], v[52:55], v[176:183], v1
    v_smfmac_f32_16x16x64_bf16 v[20:23], v[52:55], v[184:191], v1
    v_smfmac_f32_16x16x64_bf16 v[24:27], v[48:51], a[80:87], v1
    ds_read_b128 v[120:123], v2 offset:32768
    v_add_f32 v16, v16, v18
    v_smfmac_f32_16x16x64_bf16 v[28:31], v[48:51], a[88:95], v1
    ds_read_b128 v[124:127], v2 offset:33792
    v_add_f32 v17, v17, v19
    v_smfmac_f32_16x16x64_bf16 v[24:27], v[56:59], a[112:119], v1
    v_add_f32 v20, v20, v22
    v_smfmac_f32_16x16x64_bf16 v[28:31], v[56:59], a[120:127], v1
    v_add_f32 v21, v21, v23
    v_smfmac_f32_16x16x64_bf16 v[24:27], v[52:55], a[16:23], v1
    v_cvt_pk_bf16_f32 v18, v16, v20
    v_smfmac_f32_16x16x64_bf16 v[28:31], v[52:55], a[24:31], v1
    v_cvt_pk_bf16_f32 v19, v17, v21
    v_smfmac_f32_16x16x64_bf16 v[32:35], v[48:51], a[208:215], v1
    ds_write2_b32 v3, v18, v19 offset0:0 offset1:136
    v_add_f32 v24, v24, v26
    v_smfmac_f32_16x16x64_bf16 v[36:39], v[48:51], a[216:223], v1
    ds_read_b128 v[48:51], v0 offset:4096
    v_add_f32 v25, v25, v27
    v_add_f32 v28, v28, v30
    v_add_f32 v29, v29, v31
    v_cvt_pk_bf16_f32 v128, v24, v28
    v_cvt_pk_bf16_f32 v129, v25, v29
    v_smfmac_f32_16x16x64_bf16 v[32:35], v[52:55], a[144:151], v1
    ds_write2_b32 v3, v128, v129 offset0:64 offset1:200
    v_smfmac_f32_16x16x64_bf16 v[36:39], v[52:55], a[152:159], v1
    ds_read_b128 v[52:55], v0 offset:6144
    v_smfmac_f32_16x16x64_bf16 v[32:35], v[60:63], a[176:183], v1
    v_smfmac_f32_16x16x64_bf16 v[36:39], v[60:63], a[184:191], v1
    v_smfmac_f32_16x16x64_bf16 v[32:35], v[56:59], a[240:247], v1
    s_waitcnt lgkmcnt(1)
    s_barrier
    ds_read_b128 v[64:67], v4 offset:0
    v_smfmac_f32_16x16x64_bf16 v[36:39], v[56:59], a[248:255], v1
    ds_read_b128 v[68:71], v4 offset:64
    ds_read_b128 v[112:115], v4 offset:256
    v_smfmac_f32_16x16x64_bf16 v[32:35], v[48:51], a[192:199], v1
    ds_read_b128 v[116:119], v4 offset:320
    ds_read_b128 v[72:75], v4 offset:128
    s_waitcnt lgkmcnt(5)
    ds_read_b128 v[76:79], v4 offset:192
    s_waitcnt lgkmcnt(5)
    v_mfma_f32_16x16x32_bf16 v[16:19], v[80:83], v[64:67], 0
    v_mfma_f32_16x16x32_bf16 v[20:23], v[96:99], v[64:67], 0
    s_waitcnt lgkmcnt(4)
    v_mfma_f32_16x16x32_bf16 v[16:19], v[84:87], v[68:71], v[16:19]
    buffer_load_dwordx4 v0, s[4:7], s11 offen offset:0 nt lds
    v_mov_b64 v[56:57], s[58:59]
    v_mov_b64 v[58:59], s[58:59]
    v_mfma_f32_16x16x32_bf16 v[20:23], v[100:103], v[68:71], v[20:23]
    buffer_load_dwordx4 v0, s[4:7], s11 offen offset:1024 nt lds
    s_waitcnt lgkmcnt(2)
    v_mfma_f32_16x16x32_bf16 v[24:27], v[112:115], v[64:67], 0
    v_mfma_f32_16x16x32_bf16 v[24:27], v[116:119], v[68:71], v[24:27]
    s_waitcnt lgkmcnt(1)
    v_mfma_f32_16x16x32_bf16 v[16:19], v[88:91], v[72:75], v[16:19]
    ds_read_b128 v[80:83], v2 offset:22528
    v_mfma_f32_16x16x32_bf16 v[20:23], v[104:107], v[72:75], v[20:23]
    s_waitcnt lgkmcnt(1)
    ds_read_b128 v[84:87], v2 offset:23552
    v_mfma_f32_16x16x32_bf16 v[16:19], v[92:95], v[76:79], v[16:19]
    ds_read_b128 v[64:67], v2 offset:18432
    v_add_f32_dpp v24, v26, v24 quad_perm:[2,3,0,1] row_mask:0xf bank_mask:0xf
    v_add_f32_dpp v25, v27, v25 quad_perm:[2,3,0,1] row_mask:0xf bank_mask:0xf
    v_mfma_f32_16x16x32_bf16 v[20:23], v[108:111], v[76:79], v[20:23]
    ds_read_b128 v[68:71], v2 offset:19456
    v_max_f32 v132, v24, v25
    v_smfmac_f32_16x16x64_bf16 v[36:39], v[48:51], a[200:207], v1
    ds_read_b128 v[88:91], v2 offset:24576
    ds_read_b128 v[72:75], v2 offset:20480
    v_max3_f32 v132, v132, v16, v17
    v_max3_f32 v132, v132, v18, v19
    v_max3_f32 v134, v132, v20, v21
    v_max3_f32 v132, v134, v22, v23
    v_max3_f32 v133, v134, v22, v23
    v_smfmac_f32_16x16x64_bf16 v[32:35], v[52:55], a[224:231], v1
    ds_read_b128 v[92:95], v2 offset:25600
    ds_read_b128 v[96:99], v2 offset:26624
    v_permlane16_swap_b32 v132, v133
    v_max_f32 v134, v132, v133
    v_max_f32 v135, v132, v133
    v_smfmac_f32_16x16x64_bf16 v[36:39], v[52:55], a[232:239], v1
    ds_read_b128 v[100:103], v2 offset:27648
    v_permlane32_swap_b32 v134, v135
    v_max_f32 v132, v134, v135
    v_fma_f32 v132, v132, s56, v14
    v_pk_fma_f32 v[24:25], v[24:25], s[56:57], v[132:133] op_sel_hi:[1,1,0] neg_lo:[0,0,1] neg_hi:[0,0,1]
    v_pk_fma_f32 v[16:17], v[16:17], s[56:57], v[132:133] op_sel_hi:[1,1,0] neg_lo:[0,0,1] neg_hi:[0,0,1]
    v_pk_fma_f32 v[18:19], v[18:19], s[56:57], v[132:133] op_sel_hi:[1,1,0] neg_lo:[0,0,1] neg_hi:[0,0,1]
    v_pk_fma_f32 v[20:21], v[20:21], s[56:57], v[132:133] op_sel_hi:[1,1,0] neg_lo:[0,0,1] neg_hi:[0,0,1]
    v_pk_fma_f32 v[22:23], v[22:23], s[56:57], v[132:133] op_sel_hi:[1,1,0] neg_lo:[0,0,1] neg_hi:[0,0,1]
    v_pk_add_f32 v[32:33], v[32:33], v[34:35]
    v_pk_add_f32 v[36:37], v[36:37], v[38:39]
    v_cvt_pk_bf16_f32 v130, v32, v33
    v_cvt_pk_bf16_f32 v131, v36, v37
    v_exp_f32 v24, v24
    v_exp_f32 v25, v25
    v_exp_f32 v16, v16
    v_cvt_pk_bf16_f32 v12, v24, v25
    v_exp_f32 v17, v17
    v_exp_f32 v18, v18
    v_mov_b32_dpp v13, v12 quad_perm:[2,3,0,1] row_mask:0xf bank_mask:0xf
    v_exp_f32 v19, v19
    v_cvt_pk_bf16_f32 v28, v16, v17
    v_mfma_f32_16x16x16_bf16 v[60:63], v[56:57], v[12:13], 0
    ds_read_b128 v[76:79], v2 offset:21504
    v_exp_f32 v20, v20
    v_cvt_pk_bf16_f32 v29, v18, v19
    v_mfma_f32_16x16x16_bf16 v[48:51], v[130:131], v[12:13], 0
    s_waitcnt vmcnt(4)
    v_exp_f32 v21, v21
    v_exp_f32 v22, v22
    v_exp_f32 v23, v23
    v_cvt_pk_bf16_f32 v30, v20, v21
    v_cvt_pk_bf16_f32 v31, v22, v23
    v_mov_b32_dpp v16, v28 quad_perm:[2,3,0,1] row_mask:0xf bank_mask:0xf
    v_mov_b32_dpp v17, v29 quad_perm:[2,3,0,1] row_mask:0xf bank_mask:0xf
    v_mfma_f32_16x16x32_bf16 v[60:63], v[56:59], v[28:31], v[60:63]
    v_mov_b32_dpp v18, v30 quad_perm:[2,3,0,1] row_mask:0xf bank_mask:0xf
    v_mov_b32_dpp v19, v31 quad_perm:[2,3,0,1] row_mask:0xf bank_mask:0xf
    v_mfma_f32_16x16x32_bf16 v[48:51], v[40:43], v[28:31], v[48:51]
    v_mov_b64 v[24:25], 0
    v_mov_b64 v[26:27], 0
    v_mfma_f32_16x16x32_bf16 v[48:51], v[44:47], v[16:19], v[48:51]
    v_rcp_f32_dpp v132, v60 quad_perm:[0,1,0,1] row_mask:0xf bank_mask:0xf
    v_mov_b64 v[20:21], 0
    v_mov_b64 v[22:23], 0
    v_mov_b64 v[16:17], 0
    v_mov_b64 v[18:19], 0
    v_mov_b64 v[28:29], 0
    v_pk_mul_f32 v[48:49], v[48:49], v[132:133] op_sel_hi:[1,0]
    v_pk_mul_f32 v[50:51], v[50:51], v[132:133] op_sel_hi:[1,0]
    v_cvt_pk_bf16_f32 v134, v48, v49
    v_cvt_pk_bf16_f32 v135, v50, v51
    ds_write_b64 v0, v[134:135] offset:22024
    v_mov_b64 v[30:31], 0
    v_mov_b64 v[48:49], 0
    v_mov_b64 v[50:51], 0
    v_mov_b64 v[32:33], 0
    v_mov_b64 v[34:35], 0
    v_mov_b64 v[36:37], 0
    v_mov_b64 v[38:39], 0
    v_mov_b64 v[52:53], 0
    v_mov_b64 v[54:55], 0
    s_add_u32 s11, s11, 262144
    s_add_u32 s12, s12, 262144
    s_add_u32 s9, s9, 1
    s_waitcnt lgkmcnt(0)
    s_barrier
    ds_read_b128 v[56:59], v0 offset:22016
    ds_read_b128 v[60:63], v0 offset:23040
    s_add_u32 s10, s10, 8192
    s_and_b32 s10, s10, 0xffff7fff
    s_add_u32 s13, s13, 262144
    s_add_u32 s18, s18, 8192
    s_xor_b32 s61, s17, 16384
    s_waitcnt lgkmcnt(1)
    v_smfmac_f32_16x16x64_bf16 v[16:19], v[56:59], v[192:199], v1
    v_smfmac_f32_16x16x64_bf16 v[20:23], v[56:59], v[208:215], v1
    s_waitcnt lgkmcnt(0)
    v_smfmac_f32_16x16x64_bf16 v[16:19], v[60:63], v[200:207], v1
    ds_read_b128 v[104:107], v2 offset:28672
    v_smfmac_f32_16x16x64_bf16 v[20:23], v[60:63], v[216:223], v1
    ds_read_b128 v[108:111], v2 offset:29696
    v_smfmac_f32_16x16x64_bf16 v[24:27], v[56:59], v[224:231], v1
    ds_read_b128 v[112:115], v2 offset:30720
    v_add_f32 v16, v16, v18
    v_smfmac_f32_16x16x64_bf16 v[24:27], v[60:63], v[232:239], v1
    ds_read_b128 v[116:119], v2 offset:31744
    v_add_f32 v20, v20, v22
    v_smfmac_f32_16x16x64_bf16 v[28:31], v[56:59], v[240:247], v1
    v_add_f32 v17, v17, v19
    v_smfmac_f32_16x16x64_bf16 v[28:31], v[60:63], v[248:255], v1
    v_add_f32 v21, v21, v23
    v_smfmac_f32_16x16x64_bf16 v[32:35], v[56:59], v[64:71], v1
    v_cvt_pk_bf16_f32 v16, v16, v20
    v_bfi_b32 v16, 1, s21, v16
    v_cvt_pk_bf16_f32 v17, v17, v21
    v_add_f32 v24, v24, v26
    v_add_f32 v25, v25, v27
    v_add_f32 v28, v28, v30
    v_add_f32 v29, v29, v31
    v_cvt_pk_bf16_f32 v18, v24, v28
    v_cvt_pk_bf16_f32 v19, v25, v29
    v_smfmac_f32_16x16x64_bf16 v[32:35], v[60:63], v[72:79], v1
    buffer_store_dwordx4 v[16:19], v5, s[4:7], s14 offen sc1
    v_smfmac_f32_16x16x64_bf16 v[36:39], v[56:59], v[80:87], v1
    v_smfmac_f32_16x16x64_bf16 v[36:39], v[60:63], v[88:95], v1
    s_waitcnt lgkmcnt(0)
    v_add_f32 v32, v32, v34
    v_smfmac_f32_16x16x64_bf16 v[48:51], v[56:59], v[96:103], v1
    v_add_f32 v33, v33, v35
    v_smfmac_f32_16x16x64_bf16 v[48:51], v[60:63], v[104:111], v1
    v_add_f32 v36, v36, v38
    v_smfmac_f32_16x16x64_bf16 v[52:55], v[56:59], v[112:119], v1
    v_add_f32 v37, v37, v39
    v_smfmac_f32_16x16x64_bf16 v[52:55], v[60:63], v[120:127], v1
    v_cvt_pk_bf16_f32 v32, v32, v36
    v_bfi_b32 v32, 1, s21, v32
    v_cvt_pk_bf16_f32 v33, v33, v37
    v_add_f32 v48, v48, v50
    v_add_f32 v49, v49, v51
    s_nop 1
    v_add_f32 v52, v52, v54
    v_add_f32 v53, v53, v55
    v_cvt_pk_bf16_f32 v34, v48, v52
    v_cvt_pk_bf16_f32 v35, v49, v53
    buffer_store_dwordx4 v[32:35], v5, s[4:7], s15 offen sc1
    v_mov_b64 v[16:17], 0
    v_mov_b64 v[18:19], 0
    v_mov_b64 v[20:21], 0
    v_mov_b64 v[22:23], 0
    v_mov_b64 v[24:25], 0
    v_mov_b64 v[26:27], 0
    v_mov_b64 v[28:29], 0
    v_mov_b64 v[30:31], 0
    v_mov_b64 v[32:33], 0
    v_mov_b64 v[34:35], 0
    v_mov_b64 v[36:37], 0
    v_mov_b64 v[38:39], 0
    ds_read_b128 v[64:67], v2 offset:0
    ds_read_b128 v[68:71], v2 offset:1024
    ds_read_b128 v[72:75], v2 offset:2048
    ds_read_b128 v[76:79], v2 offset:3072
    ds_read_b128 v[80:83], v2 offset:4096
    ds_read_b128 v[84:87], v2 offset:5120
    s_waitcnt vmcnt(1)
    buffer_load_dwordx4 v[56:59], v0, s[4:7], s16 offen offset:0 sc1
    buffer_load_dwordx4 v[60:63], v0, s[4:7], s16 offen offset:1024 sc1
    ds_read_b128 v[88:91], v2 offset:6144
    ds_read_b128 v[92:95], v2 offset:7168
    ds_read_b128 v[96:99], v2 offset:8192
    ds_read_b128 v[100:103], v2 offset:9216
    s_waitcnt lgkmcnt(0)
    buffer_load_dwordx4 v[40:43], v0, s[4:7], s16 offen offset:0 sc1
    buffer_load_dwordx4 v[44:47], v0, s[4:7], s16 offen offset:1024 sc1
    ds_read_b128 v[104:107], v2 offset:10240
    ds_read_b128 v[108:111], v2 offset:11264
    s_waitcnt vmcnt(3)
    v_mfma_f32_16x16x32_bf16 v[48:51], v[8:11], v[56:59], 0
    s_waitcnt vmcnt(2)
    v_mfma_f32_16x16x32_bf16 v[48:51], v[8:11], v[60:63], v[48:51]
    v_and_b32 v13, 1, v56
    v_and_b32 v12, 1, v60
    v_add_u32 v12, v13, v12
    v_cmp_ne_u32 vcc, s60, v12
    s_nop 2
    v_add_f32_dpp v48, v48, v48 row_ror:4 row_mask:0xf bank_mask:0xf
    v_add_f32_dpp v49, v49, v49 row_ror:4 row_mask:0xf bank_mask:0xf
    s_cbranch_vccnz R1s_p1
    v_add_f32_dpp v48, v48, v48 row_ror:8 row_mask:0xf bank_mask:0xf
    v_add_f32_dpp v49, v49, v49 row_ror:8 row_mask:0xf bank_mask:0xf
    v_cvt_pk_bf16_f32 v15, v48, v49
    buffer_store_dword v15, v6, s[4:7], s17 offen sc1
R1s_p1_ok:
    s_cmp_eq_u32 s9, 63
    s_cbranch_scc1 R1s_fin
    s_xor_b32 s14, s14, 262144
    s_xor_b32 s15, s15, 262144
    s_add_u32 s17, s17, 8192
    s_and_b32 s17, s17, 0xffff7fff
    s_xor_b32 s16, s16, 262144
    s_min_u32 s99, s19, 31
    s_and_b32 s60, s9, 2
    s_lshr_b32 s21, s60, 1
    ds_read_b128 v[112:115], v2 offset:12288
    ds_read_b128 v[116:119], v2 offset:13312
    s_waitcnt lgkmcnt(0)
    buffer_load_dwordx4 v[56:59], v0, s[4:7], s10 offen offset:0 sc1
    ds_read_b128 v[120:123], v2 offset:14336
    ds_read_b128 v[124:127], v2 offset:15360
    ds_read_b128 v[128:131], v2 offset:16384
    ds_read_b128 v[132:135], v2 offset:17408
    s_waitcnt lgkmcnt(0)
    buffer_load_dwordx4 v[56:59], v0, s[4:7], s10 offen offset:0 sc1
    s_branch R1s_top
R1s_pe_to:
    s_mov_b32 s99, 31
    s_waitcnt vmcnt(0)
    v_max3_u32 v7, v56, v57, v58
    v_max_u32 v7, v7, v59
    v_cmp_eq_u32 vcc, -1, v7
    ds_write_b128 v0, v[56:59] offset:2048
    s_cbranch_vccz R1s_pe_go
    s_sub_u32 s19, s19, 32
    s_cbranch_scc0 R1s_pe
    s_mov_b32 s19, 0
    s_mov_b32 s99, 0
    s_branch R1s_pe_go
R1s_po:
    buffer_load_dwordx4 v[60:63], v0, s[4:7], s10 offen offset:1024 sc1
    s_sub_u32 s19, s19, 1
    s_cbranch_scc1 R1s_po_to
    s_waitcnt vmcnt(0)
    ds_write_b128 v0, v[60:63] offset:3072
    v_max3_u32 v7, v60, v61, v62
    v_max_u32 v7, v7, v63
    v_cmp_eq_u32 vcc, -1, v7
    s_cbranch_vccnz R1s_po
    s_branch R1s_po_ok
R1s_po_to:
    s_mov_b32 s19, 0
    s_waitcnt vmcnt(0)
    ds_write_b128 v0, v[60:63] offset:3072
    s_branch R1s_po_ok
R1s_p1:
    buffer_load_dwordx4 v[56:59], v0, s[4:7], s16 offen offset:0 sc1
    buffer_load_dwordx4 v[60:63], v0, s[4:7], s16 offen offset:1024 sc1
    s_waitcnt vmcnt(3)
    v_mfma_f32_16x16x32_bf16 v[48:51], v[8:11], v[40:43], 0
    s_waitcnt vmcnt(2)
    v_mfma_f32_16x16x32_bf16 v[48:51], v[8:11], v[44:47], v[48:51]
    v_and_b32 v13, 1, v40
    v_and_b32 v12, 1, v44
    v_add_u32 v12, v13, v12
    v_cmp_ne_u32 vcc, s60, v12
    s_nop 2
    v_add_f32_dpp v48, v48, v48 row_ror:4 row_mask:0xf bank_mask:0xf
    v_add_f32_dpp v49, v49, v49 row_ror:4 row_mask:0xf bank_mask:0xf
    s_cbranch_vccnz R1s_p1b
    v_add_f32_dpp v48, v48, v48 row_ror:8 row_mask:0xf bank_mask:0xf
    v_add_f32_dpp v49, v49, v49 row_ror:8 row_mask:0xf bank_mask:0xf
    v_cvt_pk_bf16_f32 v15, v48, v49
    buffer_store_dword v15, v6, s[4:7], s17 offen sc1
    s_branch R1s_p1_ok
R1s_p1b:
    buffer_load_dwordx4 v[40:43], v0, s[4:7], s16 offen offset:0 sc1
    buffer_load_dwordx4 v[44:47], v0, s[4:7], s16 offen offset:1024 sc1
    s_sub_u32 s19, s19, 1
    s_cbranch_scc1 R1s_p1_to
    s_waitcnt vmcnt(3)
    v_mfma_f32_16x16x32_bf16 v[48:51], v[8:11], v[56:59], 0
    s_waitcnt vmcnt(2)
    v_mfma_f32_16x16x32_bf16 v[48:51], v[8:11], v[60:63], v[48:51]
    v_and_b32 v13, 1, v56
    v_and_b32 v12, 1, v60
    v_add_u32 v12, v13, v12
    v_cmp_ne_u32 vcc, s60, v12
    s_nop 2
    v_add_f32_dpp v48, v48, v48 row_ror:4 row_mask:0xf bank_mask:0xf
    v_add_f32_dpp v49, v49, v49 row_ror:4 row_mask:0xf bank_mask:0xf
    s_cbranch_vccnz R1s_p1
    v_add_f32_dpp v48, v48, v48 row_ror:8 row_mask:0xf bank_mask:0xf
    v_add_f32_dpp v49, v49, v49 row_ror:8 row_mask:0xf bank_mask:0xf
    v_cvt_pk_bf16_f32 v15, v48, v49
    buffer_store_dword v15, v6, s[4:7], s17 offen sc1
    s_branch R1s_p1_ok
R1s_p1_to:
    s_mov_b32 s19, 0
    v_add_f32_dpp v48, v48, v48 row_ror:8 row_mask:0xf bank_mask:0xf
    v_add_f32_dpp v49, v49, v49 row_ror:8 row_mask:0xf bank_mask:0xf
    v_cvt_pk_bf16_f32 v15, v48, v49
    buffer_store_dword v15, v6, s[4:7], s17 offen sc1
    s_branch R1s_p1_ok
R1s_fin:
    buffer_store_dword v15, v6, s[4:7], s18 offen sc1
    s_branch L_end
RR_29_w2:
    v_mov_b32 v20, v0
    v_lshrrev_b32 v32, 4, v20
    v_lshlrev_b32 v32, 13, v32
    v_and_b32 v21, 15, v20
    v_lshrrev_b32 v22, 5, v20
    v_lshlrev_b32 v22, 1, v22
    v_xor_b32 v21, v21, v22
    v_xor_b32 v21, 8, v21
    v_lshl_add_u32 v32, v21, 4, v32
    v_and_b32 v21, 3, v20
    s_lshl_b32 s48, s8, 8
    s_mov_b32 m0, 94208
    s_add_u32 s20, s48, 262144
    buffer_load_dwordx4 v32, s[36:39], s20 offen lds
    s_mov_b32 m0, 95232
    s_add_u32 s20, s48, 294912
    buffer_load_dwordx4 v32, s[36:39], s20 offen lds
    s_mov_b32 m0, 96256
    s_add_u32 s20, s48, 327680
    buffer_load_dwordx4 v32, s[36:39], s20 offen lds
    s_mov_b32 m0, 97280
    s_add_u32 s20, s48, 360448
    buffer_load_dwordx4 v32, s[36:39], s20 offen lds
    s_mov_b32 m0, 98304
    s_add_u32 s20, s48, 262144
    buffer_load_dwordx4 v32, s[40:43], s20 offen lds
    s_mov_b32 m0, 99328
    s_add_u32 s20, s48, 294912
    buffer_load_dwordx4 v32, s[40:43], s20 offen lds
    s_mov_b32 m0, 100352
    s_add_u32 s20, s48, 327680
    buffer_load_dwordx4 v32, s[40:43], s20 offen lds
    s_mov_b32 m0, 101376
    s_add_u32 s20, s48, 360448
    buffer_load_dwordx4 v32, s[40:43], s20 offen lds
    s_mov_b32 m0, 102400
    s_add_u32 s20, s48, 786432
    buffer_load_dwordx4 v32, s[36:39], s20 offen lds
    s_mov_b32 m0, 103424
    s_add_u32 s20, s48, 819200
    buffer_load_dwordx4 v32, s[36:39], s20 offen lds
    s_mov_b32 m0, 104448
    s_add_u32 s20, s48, 851968
    buffer_load_dwordx4 v32, s[36:39], s20 offen lds
    s_mov_b32 m0, 105472
    s_add_u32 s20, s48, 884736
    buffer_load_dwordx4 v32, s[36:39], s20 offen lds
    s_mov_b32 m0, 106496
    s_add_u32 s20, s48, 786432
    buffer_load_dwordx4 v32, s[40:43], s20 offen lds
    s_mov_b32 m0, 107520
    s_add_u32 s20, s48, 819200
    buffer_load_dwordx4 v32, s[40:43], s20 offen lds
    s_mov_b32 m0, 108544
    s_add_u32 s20, s48, 851968
    buffer_load_dwordx4 v32, s[40:43], s20 offen lds
    s_mov_b32 m0, 109568
    s_add_u32 s20, s48, 884736
    buffer_load_dwordx4 v32, s[40:43], s20 offen lds
    v_lshlrev_b32 v34, 3, v21
    v_add_u32 v35, 94208, v34
    v_add_u32 v34, 24704, v34
    v_bfe_u32 v22, v20, 2, 2
    v_mul_u32_u24 v22, 34816, v22
    v_add_u32 v34, v34, v22
    v_lshrrev_b32 v22, 4, v20
    v_lshl_add_u32 v34, v22, 9, v34
    v_bfe_u32 v22, v20, 4, 1
    v_lshlrev_b32 v22, 5, v22
    v_xor_b32 v34, v34, v22
    v_bfe_u32 v22, v20, 2, 2
    v_lshlrev_b32 v22, 6, v22
    v_xor_b32 v34, v34, v22
    v_xor_b32 v36, 32, v34
    v_bfe_u32 v22, v20, 4, 1
    v_lshl_add_u32 v35, v22, 12, v35
    v_bfe_u32 v22, v20, 3, 1
    v_lshl_add_u32 v35, v22, 11, v35
    v_bfe_u32 v22, v20, 5, 1
    v_lshl_add_u32 v35, v22, 9, v35
    v_bfe_u32 v22, v20, 2, 1
    v_lshl_add_u32 v35, v22, 7, v35
    s_cmp_eq_u32 s59, 0
    s_cbranch_scc1 VF_32
    v_mov_b32 v1, 0
    s_barrier
    ds_read_b32 v2, v1
    s_waitcnt lgkmcnt(0)
    v_readfirstlane_b32 s56, v2
    s_bitcmp1_b32 s56, s8
    s_cbranch_scc1 L_lost
VF_32:
    v_and_b32 v16, 15, v0
    v_lshrrev_b32 v17, 4, v0
    v_lshlrev_b32 v0, 4, v0
    v_add_u32 v2, 94208, v0
    v_and_b32 v18, 2, v16
    v_mov_b32 v1, 0x4444
    v_mov_b32 v7, 0xeeee
    v_cmp_eq_u32 vcc, 2, v18
    s_nop 1
    v_cndmask_b32 v1, v1, v7, vcc
    v_mov_b32 v14, 0
    v_mov_b32 v7, 0x7f800000
    v_cndmask_b32 v14, v14, v7, vcc
    v_mul_u32_u24 v3, 1088, v17
    v_lshl_add_u32 v3, v16, 2, v3
    v_add_u32 v3, 16512, v3
    v_lshrrev_b32 v18, 2, v16
    v_mul_u32_u24 v4, 1088, v18
    v_and_b32 v18, 1, v16
    v_mul_u32_u24 v18, 544, v18
    v_add_u32 v4, v4, v18
    v_bfe_u32 v18, v16, 1, 1
    v_mul_u32_u24 v18, 128, v18
    v_add_u32 v4, v4, v18
    v_lshl_add_u32 v4, v17, 4, v4
    v_add_u32 v4, 16384, v4
    v_lshlrev_b32 v5, 14, v17
    v_lshrrev_b32 v18, 3, v16
    v_lshl_add_u32 v5, v18, 13, v5
    v_bfe_u32 v18, v16, 2, 1
    v_lshl_add_u32 v5, v18, 11, v5
    v_and_b32 v18, 3, v16
    v_lshl_add_u32 v5, v18, 4, v5
    v_lshlrev_b32 v6, 4, v17
    v_lshl_add_u32 v6, v16, 2, v6
    v_mov_b32 v7, 0x40000000
    v_cmp_gt_u32 vcc, 4, v16
    s_nop 1
    v_cndmask_b32 v6, v7, v6, vcc
    v_mov_b32 v8, 0
    v_mov_b32 v7, 0x3f80
    v_cmp_eq_u32 vcc, 0, v16
    s_nop 1
    v_cndmask_b32 v8, v8, v7, vcc
    v_mov_b32 v7, 1.0
    v_cmp_eq_u32 vcc, 1, v16
    s_nop 1
    v_cndmask_b32 v8, v8, v7, vcc
    v_mov_b32 v9, 0
    v_mov_b32 v7, 0x3f80
    v_cmp_eq_u32 vcc, 4, v16
    s_nop 1
    v_cndmask_b32 v9, v9, v7, vcc
    v_mov_b32 v7, 1.0
    v_cmp_eq_u32 vcc, 5, v16
    s_nop 1
    v_cndmask_b32 v9, v9, v7, vcc
    v_mov_b32 v10, 0
    v_mov_b32 v7, 0x3f80
    v_cmp_eq_u32 vcc, 8, v16
    s_nop 1
    v_cndmask_b32 v10, v10, v7, vcc
    v_mov_b32 v7, 1.0
    v_cmp_eq_u32 vcc, 9, v16
    s_nop 1
    v_cndmask_b32 v10, v10, v7, vcc
    v_mov_b32 v11, 0
    v_mov_b32 v7, 0x3f80
    v_cmp_eq_u32 vcc, 12, v16
    s_nop 1
    v_cndmask_b32 v11, v11, v7, vcc
    v_mov_b32 v7, 1.0
    v_cmp_eq_u32 vcc, 13, v16
    s_nop 1
    v_cndmask_b32 v11, v11, v7, vcc
    s_mov_b32 s9, 0
    s_mov_b32 s10, 51384320
    s_lshl_b32 s20, s8, 13
    s_add_u32 s11, s20, 16781312
    s_add_u32 s12, s20, 33558528
    s_add_u32 s13, s20, 33816576
    s_add_u32 s16, s20, 50335744
    s_lshr_b32 s20, s8, 4
    s_lshl_b32 s14, s20, 10
    s_and_b32 s20, s8, 3
    s_lshl_b32 s20, s20, 8
    s_add_u32 s14, s14, s20
    s_and_b32 s20, s8, 12
    s_lshl_b32 s20, s20, 4
    s_add_u32 s14, s14, s20
    s_add_u32 s14, s14, 50462720
    s_add_u32 s15, s14, 4096
    s_lshr_b32 s20, s8, 3
    s_lshl_b32 s17, s20, 11
    s_and_b32 s20, s8, 6
    s_lshl_b32 s20, s20, 5
    s_add_u32 s17, s17, s20
    s_and_b32 s20, s8, 1
    s_lshl_b32 s20, s20, 9
    s_add_u32 s17, s17, s20
    s_add_u32 s17, s17, 51381248
    s_mov_b32 s19, 4194304
    s_mov_b32 s99, 31
    s_mov_b32 s21, 0
    s_mov_b32 s60, 0
    s_add_u32 s61, s17, 16384
    s_sub_u32 s18, s17, 524288
    s_mov_b32 s96, 0
    s_mov_b32 s56, 0x3e0293ee
    s_mov_b32 s57, 0x3e0293ee
    s_mov_b32 s58, 0x3f803f80
    s_mov_b32 s59, 0x3f803f80
    s_waitcnt vmcnt(24)
    ds_read_b64_tr_b16 v[192:193], v35 offset:18432
    ds_read_b64_tr_b16 v[194:195], v35 offset:18688
    ds_read_b64_tr_b16 v[196:197], v35 offset:19456
    ds_read_b64_tr_b16 v[198:199], v35 offset:19712
    ds_read_b64_tr_b16 v[208:209], v35 offset:18464
    ds_read_b64_tr_b16 v[210:211], v35 offset:18720
    ds_read_b64_tr_b16 v[212:213], v35 offset:19488
    ds_read_b64_tr_b16 v[214:215], v35 offset:19744
    ds_read_b64_tr_b16 v[224:225], v35 offset:18496
    ds_read_b64_tr_b16 v[226:227], v35 offset:18752
    ds_read_b64_tr_b16 v[228:229], v35 offset:19520
    ds_read_b64_tr_b16 v[230:231], v35 offset:19776
    ds_read_b64_tr_b16 v[240:241], v35 offset:18528
    ds_read_b64_tr_b16 v[242:243], v35 offset:18784
    ds_read_b64_tr_b16 v[244:245], v35 offset:19552
    ds_read_b64_tr_b16 v[246:247], v35 offset:19808
    s_waitcnt lgkmcnt(0)
    s_mov_b32 m0, 112640
    s_add_u32 s20, s48, 786432
    buffer_load_dwordx4 v32, s[32:35], s20 offen lds
    s_mov_b32 m0, 113664
    s_add_u32 s20, s48, 819200
    buffer_load_dwordx4 v32, s[32:35], s20 offen lds
    s_mov_b32 m0, 114688
    s_add_u32 s20, s48, 851968
    buffer_load_dwordx4 v32, s[32:35], s20 offen lds
    s_mov_b32 m0, 115712
    s_add_u32 s20, s48, 884736
    buffer_load_dwordx4 v32, s[32:35], s20 offen lds
    s_mov_b32 m0, 116736
    s_add_u32 s20, s48, 1310720
    buffer_load_dwordx4 v32, s[36:39], s20 offen lds
    s_mov_b32 m0, 117760
    s_add_u32 s20, s48, 1343488
    buffer_load_dwordx4 v32, s[36:39], s20 offen lds
    s_mov_b32 m0, 118784
    s_add_u32 s20, s48, 1376256
    buffer_load_dwordx4 v32, s[36:39], s20 offen lds
    s_mov_b32 m0, 119808
    s_add_u32 s20, s48, 1409024
    buffer_load_dwordx4 v32, s[36:39], s20 offen lds
    s_waitcnt vmcnt(24)
    ds_read_b64_tr_b16 v[200:201], v35 offset:26624
    ds_read_b64_tr_b16 v[202:203], v35 offset:26880
    ds_read_b64_tr_b16 v[204:205], v35 offset:27648
    ds_read_b64_tr_b16 v[206:207], v35 offset:27904
    ds_read_b64_tr_b16 v[216:217], v35 offset:26656
    ds_read_b64_tr_b16 v[218:219], v35 offset:26912
    ds_read_b64_tr_b16 v[220:221], v35 offset:27680
    ds_read_b64_tr_b16 v[222:223], v35 offset:27936
    ds_read_b64_tr_b16 v[232:233], v35 offset:26688
    ds_read_b64_tr_b16 v[234:235], v35 offset:26944
    ds_read_b64_tr_b16 v[236:237], v35 offset:27712
    ds_read_b64_tr_b16 v[238:239], v35 offset:27968
    ds_read_b64_tr_b16 v[248:249], v35 offset:26720
    ds_read_b64_tr_b16 v[250:251], v35 offset:26976
    ds_read_b64_tr_b16 v[252:253], v35 offset:27744
    ds_read_b64_tr_b16 v[254:255], v35 offset:28000
    s_waitcnt lgkmcnt(0)
    s_mov_b32 m0, 120832
    s_add_u32 s20, s48, 1310720
    buffer_load_dwordx4 v32, s[40:43], s20 offen lds
    s_mov_b32 m0, 121856
    s_add_u32 s20, s48, 1343488
    buffer_load_dwordx4 v32, s[40:43], s20 offen lds
    s_mov_b32 m0, 122880
    s_add_u32 s20, s48, 1376256
    buffer_load_dwordx4 v32, s[40:43], s20 offen lds
    s_mov_b32 m0, 123904
    s_add_u32 s20, s48, 1409024
    buffer_load_dwordx4 v32, s[40:43], s20 offen lds
    s_mov_b32 m0, 124928
    s_add_u32 s20, s48, 1835008
    buffer_load_dwordx4 v32, s[36:39], s20 offen lds
    s_mov_b32 m0, 125952
    s_add_u32 s20, s48, 1867776
    buffer_load_dwordx4 v32, s[36:39], s20 offen lds
    s_mov_b32 m0, 126976
    s_add_u32 s20, s48, 1900544
    buffer_load_dwordx4 v32, s[36:39], s20 offen lds
    s_mov_b32 m0, 128000
    s_add_u32 s20, s48, 1933312
    buffer_load_dwordx4 v32, s[36:39], s20 offen lds
    s_waitcnt vmcnt(28)
    s_barrier
    ds_read_b64_tr_b16 a[0:1], v34 offset:0
    ds_read_b64_tr_b16 a[2:3], v34 offset:256
    ds_read_b64_tr_b16 a[4:5], v34 offset:2048
    ds_read_b64_tr_b16 a[6:7], v34 offset:2304
    ds_read_b64_tr_b16 a[8:9], v36 offset:0
    ds_read_b64_tr_b16 a[10:11], v36 offset:256
    ds_read_b64_tr_b16 a[12:13], v36 offset:2048
    ds_read_b64_tr_b16 a[14:15], v36 offset:2304
    s_waitcnt lgkmcnt(0)
    s_waitcnt vmcnt(24)
    s_barrier
    ds_read_b64_tr_b16 a[128:129], v34 offset:4096
    ds_read_b64_tr_b16 a[130:131], v34 offset:4352
    ds_read_b64_tr_b16 a[132:133], v34 offset:6144
    ds_read_b64_tr_b16 a[134:135], v34 offset:6400
    ds_read_b64_tr_b16 a[136:137], v36 offset:4096
    ds_read_b64_tr_b16 a[138:139], v36 offset:4352
    ds_read_b64_tr_b16 a[140:141], v36 offset:6144
    ds_read_b64_tr_b16 a[142:143], v36 offset:6400
    s_mov_b32 m0, 94208
    s_add_u32 s20, s48, 1835008
    buffer_load_dwordx4 v32, s[40:43], s20 offen lds
    s_mov_b32 m0, 95232
    s_add_u32 s20, s48, 1867776
    buffer_load_dwordx4 v32, s[40:43], s20 offen lds
    s_mov_b32 m0, 96256
    s_add_u32 s20, s48, 1900544
    buffer_load_dwordx4 v32, s[40:43], s20 offen lds
    s_mov_b32 m0, 97280
    s_add_u32 s20, s48, 1933312
    buffer_load_dwordx4 v32, s[40:43], s20 offen lds
    s_waitcnt lgkmcnt(0)
    s_waitcnt vmcnt(24)
    s_barrier
    ds_read_b64_tr_b16 a[16:17], v34 offset:8192
    ds_read_b64_tr_b16 a[18:19], v34 offset:8448
    ds_read_b64_tr_b16 a[20:21], v34 offset:10240
    ds_read_b64_tr_b16 a[22:23], v34 offset:10496
    ds_read_b64_tr_b16 a[24:25], v36 offset:8192
    ds_read_b64_tr_b16 a[26:27], v36 offset:8448
    ds_read_b64_tr_b16 a[28:29], v36 offset:10240
    ds_read_b64_tr_b16 a[30:31], v36 offset:10496
    s_mov_b32 m0, 98304
    s_add_u32 s20, s48, 1835008
    buffer_load_dwordx4 v32, s[32:35], s20 offen lds
    s_mov_b32 m0, 99328
    s_add_u32 s20, s48, 1867776
    buffer_load_dwordx4 v32, s[32:35], s20 offen lds
    s_mov_b32 m0, 100352
    s_add_u32 s20, s48, 1900544
    buffer_load_dwordx4 v32, s[32:35], s20 offen lds
    s_mov_b32 m0, 101376
    s_add_u32 s20, s48, 1933312
    buffer_load_dwordx4 v32, s[32:35], s20 offen lds
    s_waitcnt lgkmcnt(0)
    s_waitcnt vmcnt(24)
    s_barrier
    ds_read_b64_tr_b16 a[144:145], v34 offset:12288
    ds_read_b64_tr_b16 a[146:147], v34 offset:12544
    ds_read_b64_tr_b16 a[148:149], v34 offset:14336
    ds_read_b64_tr_b16 a[150:151], v34 offset:14592
    ds_read_b64_tr_b16 a[152:153], v36 offset:12288
    ds_read_b64_tr_b16 a[154:155], v36 offset:12544
    ds_read_b64_tr_b16 a[156:157], v36 offset:14336
    ds_read_b64_tr_b16 a[158:159], v36 offset:14592
    s_mov_b32 m0, 102400
    s_add_u32 s20, s48, 2359296
    buffer_load_dwordx4 v32, s[36:39], s20 offen lds
    s_mov_b32 m0, 103424
    s_add_u32 s20, s48, 2392064
    buffer_load_dwordx4 v32, s[36:39], s20 offen lds
    s_mov_b32 m0, 104448
    s_add_u32 s20, s48, 2424832
    buffer_load_dwordx4 v32, s[36:39], s20 offen lds
    s_mov_b32 m0, 105472
    s_add_u32 s20, s48, 2457600
    buffer_load_dwordx4 v32, s[36:39], s20 offen lds
    s_waitcnt lgkmcnt(0)
    s_waitcnt vmcnt(24)
    s_barrier
    ds_read_b64_tr_b16 v[160:161], v34 offset:18432
    ds_read_b64_tr_b16 v[162:163], v34 offset:18688
    ds_read_b64_tr_b16 v[164:165], v34 offset:20480
    ds_read_b64_tr_b16 v[166:167], v34 offset:20736
    ds_read_b64_tr_b16 v[168:169], v36 offset:18432
    ds_read_b64_tr_b16 v[170:171], v36 offset:18688
    ds_read_b64_tr_b16 v[172:173], v36 offset:20480
    ds_read_b64_tr_b16 v[174:175], v36 offset:20736
    s_mov_b32 m0, 106496
    s_add_u32 s20, s48, 2359296
    buffer_load_dwordx4 v32, s[40:43], s20 offen lds
    s_mov_b32 m0, 107520
    s_add_u32 s20, s48, 2392064
    buffer_load_dwordx4 v32, s[40:43], s20 offen lds
    s_mov_b32 m0, 108544
    s_add_u32 s20, s48, 2424832
    buffer_load_dwordx4 v32, s[40:43], s20 offen lds
    s_mov_b32 m0, 109568
    s_add_u32 s20, s48, 2457600
    buffer_load_dwordx4 v32, s[40:43], s20 offen lds
    s_waitcnt lgkmcnt(0)
    s_waitcnt vmcnt(24)
    s_barrier
    ds_read_b64_tr_b16 a[32:33], v34 offset:22528
    ds_read_b64_tr_b16 a[34:35], v34 offset:22784
    ds_read_b64_tr_b16 a[36:37], v34 offset:24576
    ds_read_b64_tr_b16 a[38:39], v34 offset:24832
    ds_read_b64_tr_b16 a[40:41], v36 offset:22528
    ds_read_b64_tr_b16 a[42:43], v36 offset:22784
    ds_read_b64_tr_b16 a[44:45], v36 offset:24576
    ds_read_b64_tr_b16 a[46:47], v36 offset:24832
    s_mov_b32 m0, 112640
    s_add_u32 s20, s48, 2883584
    buffer_load_dwordx4 v32, s[36:39], s20 offen lds
    s_mov_b32 m0, 113664
    s_add_u32 s20, s48, 2916352
    buffer_load_dwordx4 v32, s[36:39], s20 offen lds
    s_mov_b32 m0, 114688
    s_add_u32 s20, s48, 2949120
    buffer_load_dwordx4 v32, s[36:39], s20 offen lds
    s_mov_b32 m0, 115712
    s_add_u32 s20, s48, 2981888
    buffer_load_dwordx4 v32, s[36:39], s20 offen lds
    s_waitcnt lgkmcnt(0)
    s_waitcnt vmcnt(24)
    s_barrier
    ds_read_b64_tr_b16 a[160:161], v34 offset:26624
    ds_read_b64_tr_b16 a[162:163], v34 offset:26880
    ds_read_b64_tr_b16 a[164:165], v34 offset:28672
    ds_read_b64_tr_b16 a[166:167], v34 offset:28928
    ds_read_b64_tr_b16 a[168:169], v36 offset:26624
    ds_read_b64_tr_b16 a[170:171], v36 offset:26880
    ds_read_b64_tr_b16 a[172:173], v36 offset:28672
    ds_read_b64_tr_b16 a[174:175], v36 offset:28928
    s_mov_b32 m0, 116736
    s_add_u32 s20, s48, 2883584
    buffer_load_dwordx4 v32, s[40:43], s20 offen lds
    s_mov_b32 m0, 117760
    s_add_u32 s20, s48, 2916352
    buffer_load_dwordx4 v32, s[40:43], s20 offen lds
    s_mov_b32 m0, 118784
    s_add_u32 s20, s48, 2949120
    buffer_load_dwordx4 v32, s[40:43], s20 offen lds
    s_mov_b32 m0, 119808
    s_add_u32 s20, s48, 2981888
    buffer_load_dwordx4 v32, s[40:43], s20 offen lds
    s_waitcnt lgkmcnt(0)
    s_waitcnt vmcnt(24)
    s_barrier
    ds_read_b64_tr_b16 a[48:49], v34 offset:30720
    ds_read_b64_tr_b16 a[50:51], v34 offset:30976
    ds_read_b64_tr_b16 a[52:53], v34 offset:32768
    ds_read_b64_tr_b16 a[54:55], v34 offset:33024
    ds_read_b64_tr_b16 a[56:57], v36 offset:30720
    ds_read_b64_tr_b16 a[58:59], v36 offset:30976
    ds_read_b64_tr_b16 a[60:61], v36 offset:32768
    ds_read_b64_tr_b16 a[62:63], v36 offset:33024
    s_mov_b32 m0, 120832
    s_add_u32 s20, s48, 2883584
    buffer_load_dwordx4 v32, s[32:35], s20 offen lds
    s_mov_b32 m0, 121856
    s_add_u32 s20, s48, 2916352
    buffer_load_dwordx4 v32, s[32:35], s20 offen lds
    s_mov_b32 m0, 122880
    s_add_u32 s20, s48, 2949120
    buffer_load_dwordx4 v32, s[32:35], s20 offen lds
    s_mov_b32 m0, 123904
    s_add_u32 s20, s48, 2981888
    buffer_load_dwordx4 v32, s[32:35], s20 offen lds
    s_waitcnt lgkmcnt(0)
    s_waitcnt vmcnt(24)
    s_barrier
    ds_read_b64_tr_b16 a[176:177], v34 offset:0
    ds_read_b64_tr_b16 a[178:179], v34 offset:256
    ds_read_b64_tr_b16 a[180:181], v34 offset:2048
    ds_read_b64_tr_b16 a[182:183], v34 offset:2304
    ds_read_b64_tr_b16 a[184:185], v36 offset:0
    ds_read_b64_tr_b16 a[186:187], v36 offset:256
    ds_read_b64_tr_b16 a[188:189], v36 offset:2048
    ds_read_b64_tr_b16 a[190:191], v36 offset:2304
    s_mov_b32 m0, 124928
    s_add_u32 s20, s48, 3407872
    buffer_load_dwordx4 v32, s[36:39], s20 offen lds
    s_mov_b32 m0, 125952
    s_add_u32 s20, s48, 3440640
    buffer_load_dwordx4 v32, s[36:39], s20 offen lds
    s_mov_b32 m0, 126976
    s_add_u32 s20, s48, 3473408
    buffer_load_dwordx4 v32, s[36:39], s20 offen lds
    s_mov_b32 m0, 128000
    s_add_u32 s20, s48, 3506176
    buffer_load_dwordx4 v32, s[36:39], s20 offen lds
    s_waitcnt lgkmcnt(0)
    s_waitcnt vmcnt(24)
    s_barrier
    ds_read_b64_tr_b16 v[176:177], v34 offset:4096
    ds_read_b64_tr_b16 v[178:179], v34 offset:4352
    ds_read_b64_tr_b16 v[180:181], v34 offset:6144
    ds_read_b64_tr_b16 v[182:183], v34 offset:6400
    ds_read_b64_tr_b16 v[184:185], v36 offset:4096
    ds_read_b64_tr_b16 v[186:187], v36 offset:4352
    ds_read_b64_tr_b16 v[188:189], v36 offset:6144
    ds_read_b64_tr_b16 v[190:191], v36 offset:6400
    v_and_b32 v21, 3, v20
    v_lshrrev_b32 v22, 4, v20
    v_and_b32 v23, 1, v22
    v_lshlrev_b32 v23, 10, v23
    v_lshrrev_b32 v22, 1, v22
    v_lshl_add_u32 v23, v22, 6, v23
    v_lshl_add_u32 v23, v21, 1, v23
    s_and_b32 s20, s8, 6
    s_lshl_b32 s20, s20, 10
    s_lshr_b32 s100, s8, 3
    s_lshl_b32 s100, s100, 8
    s_add_u32 s20, s20, s100
    s_and_b32 s100, s8, 1
    s_lshl_b32 s100, s100, 4
    s_add_u32 s20, s20, s100
    s_add_u32 s20, s20, 128
    v_add_u32 v23, s20, v23
    global_load_ushort v24, v23, s[50:51]
    global_load_ushort v25, v23, s[50:51] offset:32
    v_mov_b32 v22, 128
    global_load_dwordx4 v[40:43], v22, s[64:65] sc1
    s_mov_b32 m0, 94208
    s_add_u32 s20, s48, 3407872
    buffer_load_dwordx4 v32, s[40:43], s20 offen lds
    s_mov_b32 m0, 95232
    s_add_u32 s20, s48, 3440640
    buffer_load_dwordx4 v32, s[40:43], s20 offen lds
    s_mov_b32 m0, 96256
    s_add_u32 s20, s48, 3473408
    buffer_load_dwordx4 v32, s[40:43], s20 offen lds
    s_mov_b32 m0, 97280
    s_add_u32 s20, s48, 3506176
    buffer_load_dwordx4 v32, s[40:43], s20 offen lds
    s_waitcnt lgkmcnt(0)
    s_waitcnt vmcnt(27)
    s_barrier
    ds_read_b64_tr_b16 a[64:65], v34 offset:8192
    ds_read_b64_tr_b16 a[66:67], v34 offset:8448
    ds_read_b64_tr_b16 a[68:69], v34 offset:10240
    ds_read_b64_tr_b16 a[70:71], v34 offset:10496
    ds_read_b64_tr_b16 a[72:73], v36 offset:8192
    ds_read_b64_tr_b16 a[74:75], v36 offset:8448
    ds_read_b64_tr_b16 a[76:77], v36 offset:10240
    ds_read_b64_tr_b16 a[78:79], v36 offset:10496
    s_mov_b32 m0, 98304
    s_add_u32 s20, s48, 3932160
    buffer_load_dwordx4 v32, s[36:39], s20 offen lds
    s_mov_b32 m0, 99328
    s_add_u32 s20, s48, 3964928
    buffer_load_dwordx4 v32, s[36:39], s20 offen lds
    s_mov_b32 m0, 100352
    s_add_u32 s20, s48, 3997696
    buffer_load_dwordx4 v32, s[36:39], s20 offen lds
    s_mov_b32 m0, 101376
    s_add_u32 s20, s48, 4030464
    buffer_load_dwordx4 v32, s[36:39], s20 offen lds
    s_waitcnt lgkmcnt(0)
    s_waitcnt vmcnt(27)
    s_barrier
    ds_read_b64_tr_b16 a[192:193], v34 offset:12288
    ds_read_b64_tr_b16 a[194:195], v34 offset:12544
    ds_read_b64_tr_b16 a[196:197], v34 offset:14336
    ds_read_b64_tr_b16 a[198:199], v34 offset:14592
    ds_read_b64_tr_b16 a[200:201], v36 offset:12288
    ds_read_b64_tr_b16 a[202:203], v36 offset:12544
    ds_read_b64_tr_b16 a[204:205], v36 offset:14336
    ds_read_b64_tr_b16 a[206:207], v36 offset:14592
    s_mov_b32 m0, 102400
    s_add_u32 s20, s48, 3932160
    buffer_load_dwordx4 v32, s[40:43], s20 offen lds
    s_mov_b32 m0, 103424
    s_add_u32 s20, s48, 3964928
    buffer_load_dwordx4 v32, s[40:43], s20 offen lds
    s_mov_b32 m0, 104448
    s_add_u32 s20, s48, 3997696
    buffer_load_dwordx4 v32, s[40:43], s20 offen lds
    s_mov_b32 m0, 105472
    s_add_u32 s20, s48, 4030464
    buffer_load_dwordx4 v32, s[40:43], s20 offen lds
    s_waitcnt lgkmcnt(0)
    s_waitcnt vmcnt(27)
    s_barrier
    ds_read_b64_tr_b16 a[80:81], v34 offset:18432
    ds_read_b64_tr_b16 a[82:83], v34 offset:18688
    ds_read_b64_tr_b16 a[84:85], v34 offset:20480
    ds_read_b64_tr_b16 a[86:87], v34 offset:20736
    ds_read_b64_tr_b16 a[88:89], v36 offset:18432
    ds_read_b64_tr_b16 a[90:91], v36 offset:18688
    ds_read_b64_tr_b16 a[92:93], v36 offset:20480
    ds_read_b64_tr_b16 a[94:95], v36 offset:20736
    s_mov_b32 m0, 106496
    s_add_u32 s20, s48, 3932160
    buffer_load_dwordx4 v32, s[32:35], s20 offen lds
    s_mov_b32 m0, 107520
    s_add_u32 s20, s48, 3964928
    buffer_load_dwordx4 v32, s[32:35], s20 offen lds
    s_mov_b32 m0, 108544
    s_add_u32 s20, s48, 3997696
    buffer_load_dwordx4 v32, s[32:35], s20 offen lds
    s_mov_b32 m0, 109568
    s_add_u32 s20, s48, 4030464
    buffer_load_dwordx4 v32, s[32:35], s20 offen lds
    s_waitcnt lgkmcnt(0)
    s_waitcnt vmcnt(27)
    s_barrier
    ds_read_b64_tr_b16 a[208:209], v34 offset:22528
    ds_read_b64_tr_b16 a[210:211], v34 offset:22784
    ds_read_b64_tr_b16 a[212:213], v34 offset:24576
    ds_read_b64_tr_b16 a[214:215], v34 offset:24832
    ds_read_b64_tr_b16 a[216:217], v36 offset:22528
    ds_read_b64_tr_b16 a[218:219], v36 offset:22784
    ds_read_b64_tr_b16 a[220:221], v36 offset:24576
    ds_read_b64_tr_b16 a[222:223], v36 offset:24832
    s_mov_b32 m0, 112640
    s_add_u32 s20, s49, 128
    buffer_load_dwordx4 v33, s[44:47], s20 offen lds
    s_mov_b32 m0, 113664
    s_add_u32 s20, s49, 8320
    buffer_load_dwordx4 v33, s[44:47], s20 offen lds
    s_mov_b32 m0, 114688
    s_add_u32 s20, s49, 16512
    buffer_load_dwordx4 v33, s[44:47], s20 offen lds
    s_mov_b32 m0, 115712
    s_add_u32 s20, s49, 24704
    buffer_load_dwordx4 v33, s[44:47], s20 offen lds
    s_waitcnt lgkmcnt(0)
    s_waitcnt vmcnt(27)
    s_barrier
    ds_read_b64_tr_b16 v[128:129], v34 offset:26624
    ds_read_b64_tr_b16 v[130:131], v34 offset:26880
    ds_read_b64_tr_b16 v[132:133], v34 offset:28672
    ds_read_b64_tr_b16 v[134:135], v34 offset:28928
    ds_read_b64_tr_b16 v[136:137], v36 offset:26624
    ds_read_b64_tr_b16 v[138:139], v36 offset:26880
    ds_read_b64_tr_b16 v[140:141], v36 offset:28672
    ds_read_b64_tr_b16 v[142:143], v36 offset:28928
    s_mov_b32 m0, 116736
    s_add_u32 s20, s49, 32896
    buffer_load_dwordx4 v33, s[44:47], s20 offen lds
    s_mov_b32 m0, 117760
    s_add_u32 s20, s49, 41088
    buffer_load_dwordx4 v33, s[44:47], s20 offen lds
    s_mov_b32 m0, 118784
    s_add_u32 s20, s49, 49280
    buffer_load_dwordx4 v33, s[44:47], s20 offen lds
    s_mov_b32 m0, 119808
    s_add_u32 s20, s49, 57472
    buffer_load_dwordx4 v33, s[44:47], s20 offen lds
    s_waitcnt lgkmcnt(0)
    ds_write_b128 v2, v[128:131] offset:16384
    ds_write_b128 v2, v[132:135] offset:17408
    s_waitcnt vmcnt(27)
    s_barrier
    ds_read_b64_tr_b16 a[96:97], v34 offset:30720
    ds_read_b64_tr_b16 a[98:99], v34 offset:30976
    ds_read_b64_tr_b16 a[100:101], v34 offset:32768
    ds_read_b64_tr_b16 a[102:103], v34 offset:33024
    ds_read_b64_tr_b16 a[104:105], v36 offset:30720
    ds_read_b64_tr_b16 a[106:107], v36 offset:30976
    ds_read_b64_tr_b16 a[108:109], v36 offset:32768
    ds_read_b64_tr_b16 a[110:111], v36 offset:33024
    s_mov_b32 m0, 120832
    s_add_u32 s20, s49, 65664
    buffer_load_dwordx4 v33, s[44:47], s20 offen lds
    s_mov_b32 m0, 121856
    s_add_u32 s20, s49, 73856
    buffer_load_dwordx4 v33, s[44:47], s20 offen lds
    s_mov_b32 m0, 122880
    s_add_u32 s20, s49, 82048
    buffer_load_dwordx4 v33, s[44:47], s20 offen lds
    s_mov_b32 m0, 123904
    s_add_u32 s20, s49, 90240
    buffer_load_dwordx4 v33, s[44:47], s20 offen lds
    s_waitcnt lgkmcnt(0)
    s_waitcnt vmcnt(24)
    s_barrier
    ds_read_b64_tr_b16 a[224:225], v34 offset:0
    ds_read_b64_tr_b16 a[226:227], v34 offset:256
    ds_read_b64_tr_b16 a[228:229], v34 offset:2048
    ds_read_b64_tr_b16 a[230:231], v34 offset:2304
    ds_read_b64_tr_b16 a[232:233], v36 offset:0
    ds_read_b64_tr_b16 a[234:235], v36 offset:256
    ds_read_b64_tr_b16 a[236:237], v36 offset:2048
    ds_read_b64_tr_b16 a[238:239], v36 offset:2304
    s_mov_b32 m0, 124928
    s_add_u32 s20, s49, 98432
    buffer_load_dwordx4 v33, s[44:47], s20 offen lds
    s_mov_b32 m0, 125952
    s_add_u32 s20, s49, 106624
    buffer_load_dwordx4 v33, s[44:47], s20 offen lds
    s_mov_b32 m0, 126976
    s_add_u32 s20, s49, 114816
    buffer_load_dwordx4 v33, s[44:47], s20 offen lds
    s_mov_b32 m0, 128000
    s_add_u32 s20, s49, 123008
    buffer_load_dwordx4 v33, s[44:47], s20 offen lds
    s_waitcnt lgkmcnt(0)
    s_waitcnt vmcnt(24)
    s_barrier
    ds_read_b64_tr_b16 a[112:113], v34 offset:4096
    ds_read_b64_tr_b16 a[114:115], v34 offset:4352
    ds_read_b64_tr_b16 a[116:117], v34 offset:6144
    ds_read_b64_tr_b16 a[118:119], v34 offset:6400
    ds_read_b64_tr_b16 a[120:121], v36 offset:4096
    ds_read_b64_tr_b16 a[122:123], v36 offset:4352
    ds_read_b64_tr_b16 a[124:125], v36 offset:6144
    ds_read_b64_tr_b16 a[126:127], v36 offset:6400
    s_waitcnt vmcnt(32)
RR_29_c2:
    v_readfirstlane_b32 s100, v40
    v_readfirstlane_b32 s101, v41
    v_readfirstlane_b32 s97, v42
    s_cmp_ge_u32 s101, 8
    s_cselect_b32 s100, s100, 0
    s_cmp_eq_u32 s100, -1
    s_cbranch_scc1 RR_29_d2
    global_load_dwordx4 v[40:43], v22, s[64:65] sc1
    s_sub_u32 s19, s19, 1
    s_cbranch_scc1 L_end
    s_waitcnt vmcnt(0)
    s_branch RR_29_c2
RR_29_d2:
    v_lshl_or_b32 v15, v25, 16, v24
    buffer_store_dword v15, v6, s[4:7], s17 offen sc1
    s_add_u32 s17, s17, 8192
    s_mov_b32 m0, 94208
    s_add_u32 s20, s48, 262144
    buffer_load_dwordx4 v32, s[32:35], s20 offen lds
    s_mov_b32 m0, 95232
    s_add_u32 s20, s48, 294912
    buffer_load_dwordx4 v32, s[32:35], s20 offen lds
    s_mov_b32 m0, 96256
    s_add_u32 s20, s48, 327680
    buffer_load_dwordx4 v32, s[32:35], s20 offen lds
    s_mov_b32 m0, 97280
    s_add_u32 s20, s48, 360448
    buffer_load_dwordx4 v32, s[32:35], s20 offen lds
    s_waitcnt lgkmcnt(0)
    s_waitcnt vmcnt(25)
    s_barrier
    ds_read_b64_tr_b16 a[240:241], v34 offset:8192
    ds_read_b64_tr_b16 a[242:243], v34 offset:8448
    ds_read_b64_tr_b16 a[244:245], v34 offset:10240
    ds_read_b64_tr_b16 a[246:247], v34 offset:10496
    ds_read_b64_tr_b16 a[248:249], v36 offset:8192
    ds_read_b64_tr_b16 a[250:251], v36 offset:8448
    ds_read_b64_tr_b16 a[252:253], v36 offset:10240
    ds_read_b64_tr_b16 a[254:255], v36 offset:10496
    s_mov_b32 m0, 98304
    s_add_u32 s20, s48, 1310720
    buffer_load_dwordx4 v32, s[32:35], s20 offen lds
    s_mov_b32 m0, 99328
    s_add_u32 s20, s48, 1343488
    buffer_load_dwordx4 v32, s[32:35], s20 offen lds
    s_mov_b32 m0, 100352
    s_add_u32 s20, s48, 1376256
    buffer_load_dwordx4 v32, s[32:35], s20 offen lds
    s_mov_b32 m0, 101376
    s_add_u32 s20, s48, 1409024
    buffer_load_dwordx4 v32, s[32:35], s20 offen lds
    buffer_load_dword v28, v6, s[4:7], s98 offen sc1
    s_waitcnt lgkmcnt(0)
    s_waitcnt vmcnt(26)
    s_barrier
    ds_read_b64_tr_b16 v[144:145], v34 offset:12288
    ds_read_b64_tr_b16 v[146:147], v34 offset:12544
    ds_read_b64_tr_b16 v[148:149], v34 offset:14336
    ds_read_b64_tr_b16 v[150:151], v34 offset:14592
    ds_read_b64_tr_b16 v[152:153], v36 offset:12288
    ds_read_b64_tr_b16 v[154:155], v36 offset:12544
    ds_read_b64_tr_b16 v[156:157], v36 offset:14336
    ds_read_b64_tr_b16 v[158:159], v36 offset:14592
    s_mov_b32 m0, 102400
    s_add_u32 s20, s48, 2359296
    buffer_load_dwordx4 v32, s[32:35], s20 offen lds
    s_mov_b32 m0, 103424
    s_add_u32 s20, s48, 2392064
    buffer_load_dwordx4 v32, s[32:35], s20 offen lds
    s_mov_b32 m0, 104448
    s_add_u32 s20, s48, 2424832
    buffer_load_dwordx4 v32, s[32:35], s20 offen lds
    s_mov_b32 m0, 105472
    s_add_u32 s20, s48, 2457600
    buffer_load_dwordx4 v32, s[32:35], s20 offen lds
    s_waitcnt lgkmcnt(0)
    s_waitcnt vmcnt(22)
    s_barrier
    ds_read_b64_tr_b16 v[64:65], v35 offset:18432
    ds_read_b64_tr_b16 v[66:67], v35 offset:18688
    ds_read_b64_tr_b16 v[68:69], v35 offset:19456
    ds_read_b64_tr_b16 v[70:71], v35 offset:19712
    ds_read_b64_tr_b16 v[80:81], v35 offset:18464
    ds_read_b64_tr_b16 v[82:83], v35 offset:18720
    ds_read_b64_tr_b16 v[84:85], v35 offset:19488
    ds_read_b64_tr_b16 v[86:87], v35 offset:19744
    ds_read_b64_tr_b16 v[96:97], v35 offset:18496
    ds_read_b64_tr_b16 v[98:99], v35 offset:18752
    ds_read_b64_tr_b16 v[100:101], v35 offset:19520
    ds_read_b64_tr_b16 v[102:103], v35 offset:19776
    ds_read_b64_tr_b16 v[112:113], v35 offset:18528
    ds_read_b64_tr_b16 v[114:115], v35 offset:18784
    ds_read_b64_tr_b16 v[116:117], v35 offset:19552
    ds_read_b64_tr_b16 v[118:119], v35 offset:19808
    s_mov_b32 m0, 106496
    s_add_u32 s20, s48, 3407872
    buffer_load_dwordx4 v32, s[32:35], s20 offen lds
    s_mov_b32 m0, 107520
    s_add_u32 s20, s48, 3440640
    buffer_load_dwordx4 v32, s[32:35], s20 offen lds
    s_mov_b32 m0, 108544
    s_add_u32 s20, s48, 3473408
    buffer_load_dwordx4 v32, s[32:35], s20 offen lds
    s_mov_b32 m0, 109568
    s_add_u32 s20, s48, 3506176
    buffer_load_dwordx4 v32, s[32:35], s20 offen lds
    s_waitcnt lgkmcnt(0)
    s_waitcnt vmcnt(18)
    ds_read_b64_tr_b16 v[72:73], v35 offset:26624
    ds_read_b64_tr_b16 v[74:75], v35 offset:26880
    ds_read_b64_tr_b16 v[76:77], v35 offset:27648
    ds_read_b64_tr_b16 v[78:79], v35 offset:27904
    ds_read_b64_tr_b16 v[88:89], v35 offset:26656
    ds_read_b64_tr_b16 v[90:91], v35 offset:26912
    ds_read_b64_tr_b16 v[92:93], v35 offset:27680
    ds_read_b64_tr_b16 v[94:95], v35 offset:27936
    ds_read_b64_tr_b16 v[104:105], v35 offset:26688
    ds_read_b64_tr_b16 v[106:107], v35 offset:26944
    ds_read_b64_tr_b16 v[108:109], v35 offset:27712
    ds_read_b64_tr_b16 v[110:111], v35 offset:27968
    ds_read_b64_tr_b16 v[120:121], v35 offset:26720
    ds_read_b64_tr_b16 v[122:123], v35 offset:26976
    ds_read_b64_tr_b16 v[124:125], v35 offset:27744
    ds_read_b64_tr_b16 v[126:127], v35 offset:28000
    v_lshlrev_b32 v30, 1, v0
    s_add_u32 s20, s16, 0
    buffer_load_dword v7, v30, s[4:7], s20 offen sc1
    s_add_u32 s20, s16, 262144
    buffer_load_dword v7, v30, s[4:7], s20 offen sc1
    s_add_u32 s20, s10, 8192
    buffer_load_dword v7, v30, s[4:7], s20 offen sc1
    s_add_u32 s20, s10, 16384
    buffer_load_dword v7, v30, s[4:7], s20 offen sc1
    s_add_u32 s20, s10, 24576
    buffer_load_dword v7, v30, s[4:7], s20 offen sc1
    s_getpc_b64 s[54:55]
RR_29_pc2:
    v_lshlrev_b32 v30, 3, v0
    v_min_u32 v30, 5632, v30
    global_load_dword v7, v30, s[54:55]
    s_waitcnt lgkmcnt(0)
    ds_write_b128 v2, v[64:67] offset:18432
    ds_write_b128 v2, v[68:71] offset:19456
    ds_write_b128 v2, v[72:75] offset:20480
    ds_write_b128 v2, v[76:79] offset:21504
    ds_write_b128 v2, v[80:83] offset:22528
    ds_write_b128 v2, v[84:87] offset:23552
    ds_write_b128 v2, v[88:91] offset:24576
    ds_write_b128 v2, v[92:95] offset:25600
    ds_write_b128 v2, v[96:99] offset:26624
    ds_write_b128 v2, v[100:103] offset:27648
    ds_write_b128 v2, v[104:107] offset:28672
    ds_write_b128 v2, v[108:111] offset:29696
    ds_write_b128 v2, v[112:115] offset:30720
    ds_write_b128 v2, v[116:119] offset:31744
    ds_write_b128 v2, v[120:123] offset:32768
    ds_write_b128 v2, v[124:127] offset:33792
    s_waitcnt lgkmcnt(0)
    s_waitcnt vmcnt(19)
    s_barrier
    ds_read_b64_tr_b16 v[96:97], v34 offset:0
    ds_read_b64_tr_b16 v[98:99], v34 offset:256
    ds_read_b64_tr_b16 v[100:101], v34 offset:2048
    ds_read_b64_tr_b16 v[102:103], v34 offset:2304
    ds_read_b64_tr_b16 v[104:105], v36 offset:0
    ds_read_b64_tr_b16 v[106:107], v36 offset:256
    ds_read_b64_tr_b16 v[108:109], v36 offset:2048
    ds_read_b64_tr_b16 v[110:111], v36 offset:2304
    buffer_load_dword v13, v6, s[4:7], s98 offen sc1
    s_waitcnt lgkmcnt(0)
    s_waitcnt vmcnt(16)
    s_barrier
    ds_read_b64_tr_b16 v[112:113], v34 offset:4096
    ds_read_b64_tr_b16 v[114:115], v34 offset:4352
    ds_read_b64_tr_b16 v[116:117], v34 offset:6144
    ds_read_b64_tr_b16 v[118:119], v34 offset:6400
    ds_read_b64_tr_b16 v[120:121], v36 offset:4096
    ds_read_b64_tr_b16 v[122:123], v36 offset:4352
    ds_read_b64_tr_b16 v[124:125], v36 offset:6144
    ds_read_b64_tr_b16 v[126:127], v36 offset:6400
    s_waitcnt lgkmcnt(0)
    s_waitcnt vmcnt(11)
    s_barrier
    ds_read_b64_tr_b16 v[64:65], v34 offset:8192
    ds_read_b64_tr_b16 v[66:67], v34 offset:8448
    ds_read_b64_tr_b16 v[68:69], v34 offset:10240
    ds_read_b64_tr_b16 v[70:71], v34 offset:10496
    ds_read_b64_tr_b16 v[72:73], v36 offset:8192
    ds_read_b64_tr_b16 v[74:75], v36 offset:8448
    ds_read_b64_tr_b16 v[76:77], v36 offset:10240
    ds_read_b64_tr_b16 v[78:79], v36 offset:10496
    v_readlane_b32 s100, v28, 0
    s_lshl_b32 s100, s100, 2
    s_add_u32 s100, s100, 0
    s_mov_b32 s96, s100
    v_readlane_b32 s100, v28, 1
    s_lshl_b32 s100, s100, 2
    s_add_u32 s100, s100, 1
    s_min_u32 s96, s96, s100
    v_readlane_b32 s100, v28, 2
    s_lshl_b32 s100, s100, 2
    s_add_u32 s100, s100, 2
    s_min_u32 s96, s96, s100
    v_readlane_b32 s100, v28, 3
    s_lshl_b32 s100, s100, 2
    s_add_u32 s100, s100, 3
    s_min_u32 s96, s96, s100
    s_cmp_ge_u32 s96, 64
    s_cselect_b32 s96, 128, s96
    s_cmp_lt_u32 s96, 2
    s_cselect_b32 s100, 0x40000000, 0
    v_lshlrev_b32 v30, 1, v0
    v_add_u32 v30, s100, v30
    buffer_load_dword v7, v30, s[4:7], s11 offen
    buffer_load_dword v7, v30, s[4:7], s12 offen
    s_add_u32 s20, s11, 262144
    buffer_load_dword v7, v30, s[4:7], s20 offen
    s_waitcnt lgkmcnt(0)
    s_waitcnt vmcnt(10)
    s_barrier
    ds_read_b64_tr_b16 v[80:81], v34 offset:12288
    ds_read_b64_tr_b16 v[82:83], v34 offset:12544
    ds_read_b64_tr_b16 v[84:85], v34 offset:14336
    ds_read_b64_tr_b16 v[86:87], v34 offset:14592
    ds_read_b64_tr_b16 v[88:89], v36 offset:12288
    ds_read_b64_tr_b16 v[90:91], v36 offset:12544
    ds_read_b64_tr_b16 v[92:93], v36 offset:14336
    ds_read_b64_tr_b16 v[94:95], v36 offset:14592
    s_mov_b32 s20, 1
    s_cmp_lt_u32 s20, s96
    s_cbranch_scc1 R2s_r0_ok
    s_waitcnt vmcnt(0)
    v_readlane_b32 s100, v13, 0
    s_lshl_b32 s100, s100, 2
    s_add_u32 s100, s100, 0
    s_mov_b32 s96, s100
    v_readlane_b32 s100, v13, 1
    s_lshl_b32 s100, s100, 2
    s_add_u32 s100, s100, 1
    s_min_u32 s96, s96, s100
    v_readlane_b32 s100, v13, 2
    s_lshl_b32 s100, s100, 2
    s_add_u32 s100, s100, 2
    s_min_u32 s96, s96, s100
    v_readlane_b32 s100, v13, 3
    s_lshl_b32 s100, s100, 2
    s_add_u32 s100, s100, 3
    s_min_u32 s96, s96, s100
    s_cmp_ge_u32 s96, 64
    s_cselect_b32 s96, 128, s96
    s_cmp_lt_u32 s20, s96
    s_cbranch_scc1 R2s_r0_w
R2s_r0:
    buffer_load_dword v7, v6, s[4:7], s98 offen sc1
    s_sub_u32 s19, s19, 1
    s_cbranch_scc1 R2s_r0_to
    s_waitcnt vmcnt(0)
    v_readlane_b32 s100, v7, 0
    s_lshl_b32 s100, s100, 2
    s_add_u32 s100, s100, 0
    s_mov_b32 s96, s100
    v_readlane_b32 s100, v7, 1
    s_lshl_b32 s100, s100, 2
    s_add_u32 s100, s100, 1
    s_min_u32 s96, s96, s100
    v_readlane_b32 s100, v7, 2
    s_lshl_b32 s100, s100, 2
    s_add_u32 s100, s100, 2
    s_min_u32 s96, s96, s100
    v_readlane_b32 s100, v7, 3
    s_lshl_b32 s100, s100, 2
    s_add_u32 s100, s100, 3
    s_min_u32 s96, s96, s100
    s_cmp_ge_u32 s96, 64
    s_cselect_b32 s96, 128, s96
    s_cmp_lt_u32 s20, s96
    s_cbranch_scc1 R2s_r0_w
    s_sleep 8
    s_branch R2s_r0
R2s_r0_to:
    s_mov_b32 s19, 0
    s_mov_b32 s96, 128
    s_waitcnt vmcnt(0)
    s_branch R2s_r0_w
R2s_r0_w:
    v_lshlrev_b32 v30, 1, v0
    buffer_load_dword v7, v30, s[4:7], s11 offen
    buffer_load_dword v7, v30, s[4:7], s12 offen
    s_add_u32 s20, s11, 262144
    buffer_load_dword v7, v30, s[4:7], s20 offen
R2s_r0_ok:
    s_mov_b32 m0, 12288
    s_nop 0
    buffer_load_dwordx4 v0, s[4:7], s11 offen offset:0 nt lds
    buffer_load_dwordx4 v0, s[4:7], s11 offen offset:1024 nt lds
    s_add_u32 s11, s11, 262144
    buffer_load_dwordx4 v[56:59], v0, s[4:7], s10 offen offset:0 sc1
    buffer_load_dwordx4 v[56:59], v0, s[4:7], s10 offen offset:0 sc1
    s_waitcnt lgkmcnt(0)
    s_barrier
    ds_write_b128 v2, v[64:67] offset:0
    ds_write_b128 v2, v[68:71] offset:1024
    ds_write_b128 v2, v[72:75] offset:2048
    ds_write_b128 v2, v[76:79] offset:3072
    ds_write_b128 v2, v[80:83] offset:4096
    ds_write_b128 v2, v[84:87] offset:5120
    ds_write_b128 v2, v[88:91] offset:6144
    ds_write_b128 v2, v[92:95] offset:7168
    ds_write_b128 v2, v[96:99] offset:8192
    ds_write_b128 v2, v[100:103] offset:9216
    ds_write_b128 v2, v[104:107] offset:10240
    ds_write_b128 v2, v[108:111] offset:11264
    ds_write_b128 v2, v[112:115] offset:12288
    ds_write_b128 v2, v[116:119] offset:13312
    ds_write_b128 v2, v[120:123] offset:14336
    ds_write_b128 v2, v[124:127] offset:15360
    s_cmp_lg_u32 s97, 0
    s_cbranch_scc1 RR_29_s2
    v_mov_b64 v[16:17], 0
    v_mov_b64 v[18:19], 0
    v_mov_b64 v[20:21], 0
    v_mov_b64 v[22:23], 0
    v_mov_b64 v[24:25], 0
    v_mov_b64 v[26:27], 0
    v_mov_b64 v[28:29], 0
    v_mov_b64 v[30:31], 0
    v_mov_b64 v[32:33], 0
    v_mov_b64 v[34:35], 0
    v_mov_b64 v[36:37], 0
    v_mov_b64 v[38:39], 0
    s_branch R2f_top
.p2align 6
    s_nop 0
R2f_pe:
    buffer_load_dwordx4 v[56:59], v0, s[4:7], s10 offen offset:0 sc1
    s_sub_u32 s99, s99, 1
    s_cbranch_scc1 R2f_pe_to
R2f_top:
    s_waitcnt vmcnt(1)
    v_fma_f32 v7, v56, v57, v58
    v_cmp_u_f32 vcc, v7, v59
    ds_write_b128 v0, v[56:59] offset:4096
    s_cbranch_vccnz R2f_pe
R2f_pe_go:
    v_smfmac_f32_16x16x64_bf16 v[16:19], v[56:59], v[64:71], v1
    buffer_load_dwordx4 v[60:63], v0, s[4:7], s10 offen offset:1024 sc1
    v_smfmac_f32_16x16x64_bf16 v[20:23], v[56:59], v[72:79], v1
    v_smfmac_f32_16x16x64_bf16 v[24:27], v[56:59], a[64:71], v1
    s_waitcnt lgkmcnt(0)
    s_barrier
    ds_read_b128 v[48:51], v0 offset:6144
    v_smfmac_f32_16x16x64_bf16 v[28:31], v[56:59], a[72:79], v1
    ds_read_b128 v[52:55], v0 offset:0
    v_smfmac_f32_16x16x64_bf16 v[32:35], v[56:59], a[192:199], v1
    v_smfmac_f32_16x16x64_bf16 v[36:39], v[56:59], a[200:207], v1
    s_waitcnt lgkmcnt(1)
    v_smfmac_f32_16x16x64_bf16 v[16:19], v[48:51], v[80:87], v1
    v_smfmac_f32_16x16x64_bf16 v[20:23], v[48:51], v[88:95], v1
    ds_read_b128 v[80:83], v0 offset:8192
    v_smfmac_f32_16x16x64_bf16 v[24:27], v[48:51], a[96:103], v1
    s_waitcnt vmcnt(1)
    ds_read_b128 v[56:59], v0 offset:2048
    v_smfmac_f32_16x16x64_bf16 v[28:31], v[48:51], a[104:111], v1
    ds_read_b128 v[84:87], v0 offset:9216
    s_waitcnt lgkmcnt(3)
    v_smfmac_f32_16x16x64_bf16 v[16:19], v[52:55], v[96:103], v1
    buffer_load_dwordx4 v[40:43], v0, s[4:7], s12 offen offset:0 nt
    ds_read_b128 v[88:91], v0 offset:10240
    v_mov_b32 v12, -1
    v_smfmac_f32_16x16x64_bf16 v[20:23], v[52:55], v[104:111], v1
    buffer_load_dwordx4 v[44:47], v0, s[4:7], s12 offen offset:1024 nt
    v_smfmac_f32_16x16x64_bf16 v[24:27], v[52:55], a[0:7], v1
    s_waitcnt lgkmcnt(2)
    v_smfmac_f32_16x16x64_bf16 v[28:31], v[52:55], a[8:15], v1
    s_waitcnt vmcnt(2)
    ds_write_b128 v0, v[60:63] offset:5120
    v_smfmac_f32_16x16x64_bf16 v[16:19], v[56:59], v[112:119], v1
    v_fma_f32 v7, v60, v61, v62
    v_smfmac_f32_16x16x64_bf16 v[20:23], v[56:59], v[120:127], v1
    v_cmp_u_f32 vcc, v7, v63
    v_smfmac_f32_16x16x64_bf16 v[24:27], v[56:59], a[32:39], v1
    v_smfmac_f32_16x16x64_bf16 v[28:31], v[56:59], a[40:47], v1
    buffer_store_dword v12, v6, s[4:7], s61 offen
    s_cbranch_vccnz R2f_po
R2f_po_ok:
    v_smfmac_f32_16x16x64_bf16 v[32:35], v[56:59], a[160:167], v1
    s_waitcnt lgkmcnt(0)
    s_barrier
    ds_read_b128 v[48:51], v0 offset:7168
    v_smfmac_f32_16x16x64_bf16 v[36:39], v[56:59], a[168:175], v1
    ds_read_b128 v[56:59], v0 offset:1024
    v_smfmac_f32_16x16x64_bf16 v[16:19], v[60:63], v[128:135], v1
    ds_read_b128 v[52:55], v0 offset:3072
    s_add_u32 s20, s9, 2
    v_smfmac_f32_16x16x64_bf16 v[20:23], v[60:63], v[136:143], v1
    buffer_store_dword v15, v6, s[4:7], s18 offen sc1
    s_cmp_lt_u32 s20, s96
    v_smfmac_f32_16x16x64_bf16 v[24:27], v[60:63], a[80:87], v1
    s_cbranch_scc0 R2f_rd
R2f_rd_ok:
    v_smfmac_f32_16x16x64_bf16 v[28:31], v[60:63], a[88:95], v1
    s_waitcnt lgkmcnt(2)
    ds_read_b128 v[92:95], v0 offset:11264
    v_lshlrev_b32 v7, 3, v0
    v_smfmac_f32_16x16x64_bf16 v[16:19], v[48:51], v[144:151], v1
    ds_read_b128 v[96:99], v0 offset:12288
    v_smfmac_f32_16x16x64_bf16 v[20:23], v[48:51], v[152:159], v1
    s_waitcnt lgkmcnt(3)
    ds_read_b128 v[100:103], v0 offset:13312
    v_smfmac_f32_16x16x64_bf16 v[16:19], v[56:59], v[160:167], v1
    ds_read_b128 v[104:107], v0 offset:14336
    v_smfmac_f32_16x16x64_bf16 v[20:23], v[56:59], v[168:175], v1
    s_waitcnt lgkmcnt(4)
    ds_read_b128 v[108:111], v0 offset:15360
    v_smfmac_f32_16x16x64_bf16 v[16:19], v[52:55], v[176:183], v1
    buffer_load_dword v7, v7, s[4:7], s13 offen
    v_smfmac_f32_16x16x64_bf16 v[20:23], v[52:55], v[184:191], v1
    v_smfmac_f32_16x16x64_bf16 v[24:27], v[48:51], a[112:119], v1
    ds_read_b128 v[120:123], v2 offset:32768
    v_add_f32 v16, v16, v18
    v_smfmac_f32_16x16x64_bf16 v[28:31], v[48:51], a[120:127], v1
    ds_read_b128 v[124:127], v2 offset:33792
    v_add_f32 v17, v17, v19
    v_smfmac_f32_16x16x64_bf16 v[24:27], v[56:59], a[16:23], v1
    v_add_f32 v20, v20, v22
    v_smfmac_f32_16x16x64_bf16 v[28:31], v[56:59], a[24:31], v1
    v_add_f32 v21, v21, v23
    v_smfmac_f32_16x16x64_bf16 v[24:27], v[52:55], a[48:55], v1
    buffer_load_dword v7, v6, s[4:7], s98 offen sc1
    v_cvt_pk_bf16_f32 v18, v16, v20
    v_smfmac_f32_16x16x64_bf16 v[28:31], v[52:55], a[56:63], v1
    v_cvt_pk_bf16_f32 v19, v17, v21
    v_smfmac_f32_16x16x64_bf16 v[32:35], v[48:51], a[240:247], v1
    ds_write2_b32 v3, v18, v19 offset0:0 offset1:136
    v_add_f32 v24, v24, v26
    v_smfmac_f32_16x16x64_bf16 v[36:39], v[48:51], a[248:255], v1
    ds_read_b128 v[48:51], v0 offset:6144
    v_add_f32 v25, v25, v27
    v_add_f32 v28, v28, v30
    v_add_f32 v29, v29, v31
    v_cvt_pk_bf16_f32 v128, v24, v28
    v_cvt_pk_bf16_f32 v129, v25, v29
    v_smfmac_f32_16x16x64_bf16 v[32:35], v[52:55], a[176:183], v1
    ds_write2_b32 v3, v128, v129 offset0:64 offset1:200
    v_smfmac_f32_16x16x64_bf16 v[36:39], v[52:55], a[184:191], v1
    ds_read_b128 v[52:55], v0 offset:0
    v_smfmac_f32_16x16x64_bf16 v[32:35], v[60:63], a[208:215], v1
    v_smfmac_f32_16x16x64_bf16 v[36:39], v[60:63], a[216:223], v1
    v_smfmac_f32_16x16x64_bf16 v[32:35], v[56:59], a[144:151], v1
    s_waitcnt lgkmcnt(1)
    s_barrier
    ds_read_b128 v[64:67], v4 offset:0
    v_smfmac_f32_16x16x64_bf16 v[36:39], v[56:59], a[152:159], v1
    ds_read_b128 v[68:71], v4 offset:64
    ds_read_b128 v[112:115], v4 offset:256
    v_smfmac_f32_16x16x64_bf16 v[32:35], v[48:51], a[224:231], v1
    ds_read_b128 v[116:119], v4 offset:320
    ds_read_b128 v[72:75], v4 offset:128
    s_waitcnt lgkmcnt(5)
    ds_read_b128 v[76:79], v4 offset:192
    s_waitcnt lgkmcnt(5)
    v_mfma_f32_16x16x32_bf16 v[16:19], v[80:83], v[64:67], 0
    v_mfma_f32_16x16x32_bf16 v[20:23], v[96:99], v[64:67], 0
    s_waitcnt lgkmcnt(4)
    v_mfma_f32_16x16x32_bf16 v[16:19], v[84:87], v[68:71], v[16:19]
    v_mov_b64 v[56:57], s[58:59]
    v_mov_b64 v[58:59], s[58:59]
    v_mfma_f32_16x16x32_bf16 v[20:23], v[100:103], v[68:71], v[20:23]
    s_waitcnt lgkmcnt(2)
    v_mfma_f32_16x16x32_bf16 v[24:27], v[112:115], v[64:67], 0
    buffer_load_dwordx4 v0, s[4:7], s11 offen offset:0 nt lds
    v_mfma_f32_16x16x32_bf16 v[24:27], v[116:119], v[68:71], v[24:27]
    buffer_load_dwordx4 v0, s[4:7], s11 offen offset:1024 nt lds
    s_waitcnt lgkmcnt(1)
    v_mfma_f32_16x16x32_bf16 v[16:19], v[88:91], v[72:75], v[16:19]
    ds_read_b128 v[80:83], v2 offset:22528
    v_mfma_f32_16x16x32_bf16 v[20:23], v[104:107], v[72:75], v[20:23]
    s_waitcnt lgkmcnt(1)
    ds_read_b128 v[84:87], v2 offset:23552
    v_mfma_f32_16x16x32_bf16 v[16:19], v[92:95], v[76:79], v[16:19]
    ds_read_b128 v[64:67], v2 offset:18432
    v_add_f32_dpp v24, v26, v24 quad_perm:[2,3,0,1] row_mask:0xf bank_mask:0xf
    v_add_f32_dpp v25, v27, v25 quad_perm:[2,3,0,1] row_mask:0xf bank_mask:0xf
    v_mfma_f32_16x16x32_bf16 v[20:23], v[108:111], v[76:79], v[20:23]
    ds_read_b128 v[68:71], v2 offset:19456
    v_max_f32 v132, v24, v25
    v_smfmac_f32_16x16x64_bf16 v[36:39], v[48:51], a[232:239], v1
    ds_read_b128 v[88:91], v2 offset:24576
    ds_read_b128 v[72:75], v2 offset:20480
    v_max3_f32 v132, v132, v16, v17
    v_max3_f32 v132, v132, v18, v19
    v_max3_f32 v134, v132, v20, v21
    v_max3_f32 v132, v134, v22, v23
    v_max3_f32 v133, v134, v22, v23
    v_smfmac_f32_16x16x64_bf16 v[32:35], v[52:55], a[128:135], v1
    ds_read_b128 v[92:95], v2 offset:25600
    ds_read_b128 v[96:99], v2 offset:26624
    v_permlane16_swap_b32 v132, v133
    v_max_f32 v134, v132, v133
    v_max_f32 v135, v132, v133
    v_smfmac_f32_16x16x64_bf16 v[36:39], v[52:55], a[136:143], v1
    ds_read_b128 v[100:103], v2 offset:27648
    v_permlane32_swap_b32 v134, v135
    v_max_f32 v132, v134, v135
    v_fma_f32 v132, v132, s56, v14
    v_pk_fma_f32 v[24:25], v[24:25], s[56:57], v[132:133] op_sel_hi:[1,1,0] neg_lo:[0,0,1] neg_hi:[0,0,1]
    v_pk_fma_f32 v[16:17], v[16:17], s[56:57], v[132:133] op_sel_hi:[1,1,0] neg_lo:[0,0,1] neg_hi:[0,0,1]
    v_pk_fma_f32 v[18:19], v[18:19], s[56:57], v[132:133] op_sel_hi:[1,1,0] neg_lo:[0,0,1] neg_hi:[0,0,1]
    v_pk_fma_f32 v[20:21], v[20:21], s[56:57], v[132:133] op_sel_hi:[1,1,0] neg_lo:[0,0,1] neg_hi:[0,0,1]
    v_pk_fma_f32 v[22:23], v[22:23], s[56:57], v[132:133] op_sel_hi:[1,1,0] neg_lo:[0,0,1] neg_hi:[0,0,1]
    v_pk_add_f32 v[32:33], v[32:33], v[34:35]
    v_pk_add_f32 v[36:37], v[36:37], v[38:39]
    v_cvt_pk_bf16_f32 v130, v32, v33
    v_cvt_pk_bf16_f32 v131, v36, v37
    v_exp_f32 v24, v24
    v_exp_f32 v25, v25
    v_exp_f32 v16, v16
    v_cvt_pk_bf16_f32 v12, v24, v25
    v_exp_f32 v17, v17
    v_exp_f32 v18, v18
    v_mov_b32_dpp v13, v12 quad_perm:[2,3,0,1] row_mask:0xf bank_mask:0xf
    v_exp_f32 v19, v19
    v_cvt_pk_bf16_f32 v28, v16, v17
    v_mfma_f32_16x16x16_bf16 v[60:63], v[56:57], v[12:13], 0
    ds_read_b128 v[76:79], v2 offset:21504
    v_exp_f32 v20, v20
    v_cvt_pk_bf16_f32 v29, v18, v19
    v_mfma_f32_16x16x16_bf16 v[48:51], v[130:131], v[12:13], 0
    s_waitcnt vmcnt(6)
    v_exp_f32 v21, v21
    v_exp_f32 v22, v22
    v_exp_f32 v23, v23
    v_cvt_pk_bf16_f32 v30, v20, v21
    v_cvt_pk_bf16_f32 v31, v22, v23
    v_mov_b32_dpp v16, v28 quad_perm:[2,3,0,1] row_mask:0xf bank_mask:0xf
    v_mov_b32_dpp v17, v29 quad_perm:[2,3,0,1] row_mask:0xf bank_mask:0xf
    v_mfma_f32_16x16x32_bf16 v[60:63], v[56:59], v[28:31], v[60:63]
    v_mov_b32_dpp v18, v30 quad_perm:[2,3,0,1] row_mask:0xf bank_mask:0xf
    v_mov_b32_dpp v19, v31 quad_perm:[2,3,0,1] row_mask:0xf bank_mask:0xf
    v_mfma_f32_16x16x32_bf16 v[48:51], v[40:43], v[28:31], v[48:51]
    v_mov_b64 v[24:25], 0
    v_mov_b64 v[26:27], 0
    v_mfma_f32_16x16x32_bf16 v[48:51], v[44:47], v[16:19], v[48:51]
    v_rcp_f32_dpp v132, v60 quad_perm:[0,1,0,1] row_mask:0xf bank_mask:0xf
    v_mov_b64 v[20:21], 0
    v_mov_b64 v[22:23], 0
    v_mov_b64 v[16:17], 0
    v_mov_b64 v[18:19], 0
    v_mov_b64 v[28:29], 0
    v_pk_mul_f32 v[48:49], v[48:49], v[132:133] op_sel_hi:[1,0]
    v_pk_mul_f32 v[50:51], v[50:51], v[132:133] op_sel_hi:[1,0]
    v_cvt_pk_bf16_f32 v134, v48, v49
    v_cvt_pk_bf16_f32 v135, v50, v51
    ds_write_b64 v0, v[134:135] offset:23040
    v_mov_b64 v[30:31], 0
    v_mov_b64 v[48:49], 0
    v_mov_b64 v[50:51], 0
    v_mov_b64 v[32:33], 0
    v_mov_b64 v[34:35], 0
    v_mov_b64 v[36:37], 0
    v_mov_b64 v[38:39], 0
    v_mov_b64 v[52:53], 0
    v_mov_b64 v[54:55], 0
    s_add_u32 s11, s11, 262144
    s_add_u32 s12, s12, 262144
    s_add_u32 s9, s9, 1
    s_waitcnt lgkmcnt(0)
    s_barrier
    ds_read_b128 v[56:59], v0 offset:22016
    ds_read_b128 v[60:63], v0 offset:23040
    s_add_u32 s10, s10, 8192
    s_and_b32 s10, s10, 0xffff7fff
    s_add_u32 s13, s13, 262144
    s_add_u32 s18, s18, 8192
    s_xor_b32 s61, s17, 16384
    s_waitcnt lgkmcnt(1)
    v_smfmac_f32_16x16x64_bf16 v[16:19], v[56:59], v[192:199], v1
    v_smfmac_f32_16x16x64_bf16 v[20:23], v[56:59], v[208:215], v1
    s_waitcnt lgkmcnt(0)
    v_smfmac_f32_16x16x64_bf16 v[16:19], v[60:63], v[200:207], v1
    ds_read_b128 v[104:107], v2 offset:28672
    v_smfmac_f32_16x16x64_bf16 v[20:23], v[60:63], v[216:223], v1
    ds_read_b128 v[108:111], v2 offset:29696
    v_smfmac_f32_16x16x64_bf16 v[24:27], v[56:59], v[224:231], v1
    ds_read_b128 v[112:115], v2 offset:30720
    v_add_f32 v16, v16, v18
    v_smfmac_f32_16x16x64_bf16 v[24:27], v[60:63], v[232:239], v1
    ds_read_b128 v[116:119], v2 offset:31744
    v_add_f32 v20, v20, v22
    v_smfmac_f32_16x16x64_bf16 v[28:31], v[56:59], v[240:247], v1
    v_add_f32 v17, v17, v19
    v_smfmac_f32_16x16x64_bf16 v[28:31], v[60:63], v[248:255], v1
    v_add_f32 v21, v21, v23
    v_smfmac_f32_16x16x64_bf16 v[32:35], v[56:59], v[64:71], v1
    v_cvt_pk_bf16_f32 v16, v16, v20
    v_bfi_b32 v16, 1, s21, v16
    v_cvt_pk_bf16_f32 v17, v17, v21
    v_add_f32 v24, v24, v26
    v_add_f32 v25, v25, v27
    v_add_f32 v28, v28, v30
    v_add_f32 v29, v29, v31
    v_cvt_pk_bf16_f32 v18, v24, v28
    v_cvt_pk_bf16_f32 v19, v25, v29
    v_smfmac_f32_16x16x64_bf16 v[32:35], v[60:63], v[72:79], v1
    buffer_store_dwordx4 v[16:19], v5, s[4:7], s14 offen
    v_smfmac_f32_16x16x64_bf16 v[36:39], v[56:59], v[80:87], v1
    v_smfmac_f32_16x16x64_bf16 v[36:39], v[60:63], v[88:95], v1
    s_waitcnt lgkmcnt(0)
    v_add_f32 v32, v32, v34
    v_smfmac_f32_16x16x64_bf16 v[48:51], v[56:59], v[96:103], v1
    v_add_f32 v33, v33, v35
    v_smfmac_f32_16x16x64_bf16 v[48:51], v[60:63], v[104:111], v1
    v_add_f32 v36, v36, v38
    v_smfmac_f32_16x16x64_bf16 v[52:55], v[56:59], v[112:119], v1
    v_add_f32 v37, v37, v39
    v_smfmac_f32_16x16x64_bf16 v[52:55], v[60:63], v[120:127], v1
    v_cvt_pk_bf16_f32 v32, v32, v36
    v_bfi_b32 v32, 1, s21, v32
    v_cvt_pk_bf16_f32 v33, v33, v37
    v_add_f32 v48, v48, v50
    v_add_f32 v49, v49, v51
    s_nop 1
    v_add_f32 v52, v52, v54
    v_add_f32 v53, v53, v55
    v_cvt_pk_bf16_f32 v34, v48, v52
    v_cvt_pk_bf16_f32 v35, v49, v53
    buffer_store_dwordx4 v[32:35], v5, s[4:7], s15 offen
    v_mov_b64 v[16:17], 0
    v_mov_b64 v[18:19], 0
    v_mov_b64 v[20:21], 0
    v_mov_b64 v[22:23], 0
    v_mov_b64 v[24:25], 0
    v_mov_b64 v[26:27], 0
    v_mov_b64 v[28:29], 0
    v_mov_b64 v[30:31], 0
    v_mov_b64 v[32:33], 0
    v_mov_b64 v[34:35], 0
    v_mov_b64 v[36:37], 0
    v_mov_b64 v[38:39], 0
    ds_read_b128 v[64:67], v2 offset:0
    ds_read_b128 v[68:71], v2 offset:1024
    ds_read_b128 v[72:75], v2 offset:2048
    ds_read_b128 v[76:79], v2 offset:3072
    ds_read_b128 v[80:83], v2 offset:4096
    ds_read_b128 v[84:87], v2 offset:5120
    ds_read_b128 v[88:91], v2 offset:6144
    ds_read_b128 v[92:95], v2 offset:7168
    s_waitcnt vmcnt(0)
    buffer_load_dwordx4 v[56:59], v0, s[4:7], s16 offen offset:0 sc1
    buffer_load_dwordx4 v[60:63], v0, s[4:7], s16 offen offset:1024 sc1
    ds_read_b128 v[96:99], v2 offset:8192
    ds_read_b128 v[100:103], v2 offset:9216
    ds_read_b128 v[104:107], v2 offset:10240
    ds_read_b128 v[108:111], v2 offset:11264
    ds_read_b128 v[112:115], v2 offset:12288
    ds_read_b128 v[116:119], v2 offset:13312
    s_waitcnt lgkmcnt(0)
    buffer_load_dwordx4 v[40:43], v0, s[4:7], s16 offen offset:0 sc1
    buffer_load_dwordx4 v[44:47], v0, s[4:7], s16 offen offset:1024 sc1
    s_waitcnt vmcnt(3)
    v_mfma_f32_16x16x32_bf16 v[48:51], v[8:11], v[56:59], 0
    s_waitcnt vmcnt(2)
    v_mfma_f32_16x16x32_bf16 v[48:51], v[8:11], v[60:63], v[48:51]
    v_and_b32 v13, 1, v56
    v_and_b32 v12, 1, v60
    v_add_u32 v12, v13, v12
    v_cmp_ne_u32 vcc, s60, v12
    s_nop 2
    v_add_f32_dpp v48, v48, v48 row_ror:4 row_mask:0xf bank_mask:0xf
    v_add_f32_dpp v49, v49, v49 row_ror:4 row_mask:0xf bank_mask:0xf
    s_cbranch_vccnz R2f_p1
    v_add_f32_dpp v48, v48, v48 row_ror:8 row_mask:0xf bank_mask:0xf
    v_add_f32_dpp v49, v49, v49 row_ror:8 row_mask:0xf bank_mask:0xf
    v_cvt_pk_bf16_f32 v15, v48, v49
    buffer_store_dword v15, v6, s[4:7], s17 offen
R2f_p1_ok:
    buffer_load_dwordx4 v[56:59], v0, s[4:7], s10 offen offset:0 sc1
    s_cmp_eq_u32 s9, 63
    s_cbranch_scc1 R2f_fin
    s_xor_b32 s14, s14, 262144
    s_xor_b32 s15, s15, 262144
    s_add_u32 s17, s17, 8192
    s_and_b32 s17, s17, 0xffff7fff
    s_xor_b32 s16, s16, 262144
    s_min_u32 s99, s19, 31
    s_and_b32 s60, s9, 2
    s_lshr_b32 s21, s60, 1
    ds_read_b128 v[120:123], v2 offset:14336
    ds_read_b128 v[124:127], v2 offset:15360
    ds_read_b128 v[128:131], v2 offset:16384
    ds_read_b128 v[132:135], v2 offset:17408
    s_waitcnt lgkmcnt(0)
    buffer_load_dwordx4 v[56:59], v0, s[4:7], s10 offen offset:0 sc1
    s_cmp_eq_u32 s96, 128
    s_cbranch_scc1 R2f_top
    v_readlane_b32 s100, v7, 0
    s_lshl_b32 s100, s100, 2
    s_add_u32 s100, s100, 0
    s_mov_b32 s96, s100
    v_readlane_b32 s100, v7, 1
    s_lshl_b32 s100, s100, 2
    s_add_u32 s100, s100, 1
    s_min_u32 s96, s96, s100
    v_readlane_b32 s100, v7, 2
    s_lshl_b32 s100, s100, 2
    s_add_u32 s100, s100, 2
    s_min_u32 s96, s96, s100
    v_readlane_b32 s100, v7, 3
    s_lshl_b32 s100, s100, 2
    s_add_u32 s100, s100, 3
    s_min_u32 s96, s96, s100
    s_cmp_ge_u32 s96, 64
    s_cselect_b32 s96, 128, s96
    s_branch R2f_top
R2f_pe_to:
    s_mov_b32 s99, 31
    s_waitcnt vmcnt(0)
    v_max3_u32 v7, v56, v57, v58
    v_max_u32 v7, v7, v59
    v_cmp_eq_u32 vcc, -1, v7
    ds_write_b128 v0, v[56:59] offset:4096
    s_cbranch_vccz R2f_pe_go
    s_sub_u32 s19, s19, 32
    s_cbranch_scc0 R2f_pe
    s_mov_b32 s19, 0
    s_mov_b32 s99, 0
    s_branch R2f_pe_go
R2f_po:
    buffer_load_dwordx4 v[60:63], v0, s[4:7], s10 offen offset:1024 sc1
    s_sub_u32 s19, s19, 1
    s_cbranch_scc1 R2f_po_to
    s_waitcnt vmcnt(0)
    ds_write_b128 v0, v[60:63] offset:5120
    v_max3_u32 v7, v60, v61, v62
    v_max_u32 v7, v7, v63
    v_cmp_eq_u32 vcc, -1, v7
    s_cbranch_vccnz R2f_po
    s_branch R2f_po_ok
R2f_po_to:
    s_mov_b32 s19, 0
    s_waitcnt vmcnt(0)
    ds_write_b128 v0, v[60:63] offset:5120
    s_branch R2f_po_ok
R2f_rd:
    buffer_load_dword v7, v6, s[4:7], s98 offen sc1
    s_sub_u32 s19, s19, 1
    s_cbranch_scc1 R2f_rd_to
    s_waitcnt vmcnt(0)
    v_readlane_b32 s100, v7, 0
    s_lshl_b32 s100, s100, 2
    s_add_u32 s100, s100, 0
    s_mov_b32 s96, s100
    v_readlane_b32 s100, v7, 1
    s_lshl_b32 s100, s100, 2
    s_add_u32 s100, s100, 1
    s_min_u32 s96, s96, s100
    v_readlane_b32 s100, v7, 2
    s_lshl_b32 s100, s100, 2
    s_add_u32 s100, s100, 2
    s_min_u32 s96, s96, s100
    v_readlane_b32 s100, v7, 3
    s_lshl_b32 s100, s100, 2
    s_add_u32 s100, s100, 3
    s_min_u32 s96, s96, s100
    s_cmp_ge_u32 s96, 64
    s_cselect_b32 s96, 128, s96
    s_cmp_lt_u32 s20, s96
    s_cbranch_scc1 R2f_rd_ok
    s_sleep 8
    s_branch R2f_rd
R2f_rd_to:
    s_mov_b32 s19, 0
    s_mov_b32 s96, 128
    s_waitcnt vmcnt(0)
    s_branch R2f_rd_ok
R2f_p1:
    buffer_load_dwordx4 v[56:59], v0, s[4:7], s16 offen offset:0 sc1
    buffer_load_dwordx4 v[60:63], v0, s[4:7], s16 offen offset:1024 sc1
    s_waitcnt vmcnt(3)
    v_mfma_f32_16x16x32_bf16 v[48:51], v[8:11], v[40:43], 0
    s_waitcnt vmcnt(2)
    v_mfma_f32_16x16x32_bf16 v[48:51], v[8:11], v[44:47], v[48:51]
    v_and_b32 v13, 1, v40
    v_and_b32 v12, 1, v44
    v_add_u32 v12, v13, v12
    v_cmp_ne_u32 vcc, s60, v12
    s_nop 2
    v_add_f32_dpp v48, v48, v48 row_ror:4 row_mask:0xf bank_mask:0xf
    v_add_f32_dpp v49, v49, v49 row_ror:4 row_mask:0xf bank_mask:0xf
    s_cbranch_vccnz R2f_p1b
    v_add_f32_dpp v48, v48, v48 row_ror:8 row_mask:0xf bank_mask:0xf
    v_add_f32_dpp v49, v49, v49 row_ror:8 row_mask:0xf bank_mask:0xf
    v_cvt_pk_bf16_f32 v15, v48, v49
    buffer_store_dword v15, v6, s[4:7], s17 offen
    s_branch R2f_p1_ok
R2f_p1b:
    buffer_load_dwordx4 v[40:43], v0, s[4:7], s16 offen offset:0 sc1
    buffer_load_dwordx4 v[44:47], v0, s[4:7], s16 offen offset:1024 sc1
    s_sub_u32 s19, s19, 1
    s_cbranch_scc1 R2f_p1_to
    s_waitcnt vmcnt(3)
    v_mfma_f32_16x16x32_bf16 v[48:51], v[8:11], v[56:59], 0
    s_waitcnt vmcnt(2)
    v_mfma_f32_16x16x32_bf16 v[48:51], v[8:11], v[60:63], v[48:51]
    v_and_b32 v13, 1, v56
    v_and_b32 v12, 1, v60
    v_add_u32 v12, v13, v12
    v_cmp_ne_u32 vcc, s60, v12
    s_nop 2
    v_add_f32_dpp v48, v48, v48 row_ror:4 row_mask:0xf bank_mask:0xf
    v_add_f32_dpp v49, v49, v49 row_ror:4 row_mask:0xf bank_mask:0xf
    s_cbranch_vccnz R2f_p1
    v_add_f32_dpp v48, v48, v48 row_ror:8 row_mask:0xf bank_mask:0xf
    v_add_f32_dpp v49, v49, v49 row_ror:8 row_mask:0xf bank_mask:0xf
    v_cvt_pk_bf16_f32 v15, v48, v49
    buffer_store_dword v15, v6, s[4:7], s17 offen
    s_branch R2f_p1_ok
R2f_p1_to:
    s_mov_b32 s19, 0
    v_add_f32_dpp v48, v48, v48 row_ror:8 row_mask:0xf bank_mask:0xf
    v_add_f32_dpp v49, v49, v49 row_ror:8 row_mask:0xf bank_mask:0xf
    v_cvt_pk_bf16_f32 v15, v48, v49
    buffer_store_dword v15, v6, s[4:7], s17 offen
    s_branch R2f_p1_ok
R2f_fin:
    buffer_store_dword v15, v6, s[4:7], s18 offen sc1
    s_branch L_end
RR_29_s2:
    v_mov_b64 v[16:17], 0
    v_mov_b64 v[18:19], 0
    v_mov_b64 v[20:21], 0
    v_mov_b64 v[22:23], 0
    v_mov_b64 v[24:25], 0
    v_mov_b64 v[26:27], 0
    v_mov_b64 v[28:29], 0
    v_mov_b64 v[30:31], 0
    v_mov_b64 v[32:33], 0
    v_mov_b64 v[34:35], 0
    v_mov_b64 v[36:37], 0
    v_mov_b64 v[38:39], 0
    s_branch R2s_top
.p2align 6
    s_nop 0
R2s_pe:
    buffer_load_dwordx4 v[56:59], v0, s[4:7], s10 offen offset:0 sc1
    s_sub_u32 s99, s99, 1
    s_cbranch_scc1 R2s_pe_to
R2s_top:
    s_waitcnt vmcnt(1)
    v_fma_f32 v7, v56, v57, v58
    v_cmp_u_f32 vcc, v7, v59
    ds_write_b128 v0, v[56:59] offset:4096
    s_cbranch_vccnz R2s_pe
R2s_pe_go:
    v_smfmac_f32_16x16x64_bf16 v[16:19], v[56:59], v[64:71], v1
    buffer_load_dwordx4 v[60:63], v0, s[4:7], s10 offen offset:1024 sc1
    v_smfmac_f32_16x16x64_bf16 v[20:23], v[56:59], v[72:79], v1
    v_smfmac_f32_16x16x64_bf16 v[24:27], v[56:59], a[64:71], v1
    s_waitcnt lgkmcnt(0)
    s_barrier
    ds_read_b128 v[48:51], v0 offset:6144
    v_smfmac_f32_16x16x64_bf16 v[28:31], v[56:59], a[72:79], v1
    ds_read_b128 v[52:55], v0 offset:0
    v_smfmac_f32_16x16x64_bf16 v[32:35], v[56:59], a[192:199], v1
    v_smfmac_f32_16x16x64_bf16 v[36:39], v[56:59], a[200:207], v1
    s_waitcnt lgkmcnt(1)
    v_smfmac_f32_16x16x64_bf16 v[16:19], v[48:51], v[80:87], v1
    v_smfmac_f32_16x16x64_bf16 v[20:23], v[48:51], v[88:95], v1
    ds_read_b128 v[80:83], v0 offset:8192
    v_smfmac_f32_16x16x64_bf16 v[24:27], v[48:51], a[96:103], v1
    s_waitcnt vmcnt(1)
    ds_read_b128 v[56:59], v0 offset:2048
    v_smfmac_f32_16x16x64_bf16 v[28:31], v[48:51], a[104:111], v1
    ds_read_b128 v[84:87], v0 offset:9216
    s_waitcnt lgkmcnt(3)
    v_smfmac_f32_16x16x64_bf16 v[16:19], v[52:55], v[96:103], v1
    buffer_load_dwordx4 v[40:43], v0, s[4:7], s12 offen offset:0 nt
    ds_read_b128 v[88:91], v0 offset:10240
    v_mov_b32 v12, -1
    v_smfmac_f32_16x16x64_bf16 v[20:23], v[52:55], v[104:111], v1
    buffer_load_dwordx4 v[44:47], v0, s[4:7], s12 offen offset:1024 nt
    v_smfmac_f32_16x16x64_bf16 v[24:27], v[52:55], a[0:7], v1
    s_waitcnt lgkmcnt(2)
    v_smfmac_f32_16x16x64_bf16 v[28:31], v[52:55], a[8:15], v1
    s_waitcnt vmcnt(2)
    ds_write_b128 v0, v[60:63] offset:5120
    v_smfmac_f32_16x16x64_bf16 v[16:19], v[56:59], v[112:119], v1
    v_fma_f32 v7, v60, v61, v62
    v_smfmac_f32_16x16x64_bf16 v[20:23], v[56:59], v[120:127], v1
    v_cmp_u_f32 vcc, v7, v63
    v_smfmac_f32_16x16x64_bf16 v[24:27], v[56:59], a[32:39], v1
    v_smfmac_f32_16x16x64_bf16 v[28:31], v[56:59], a[40:47], v1
    buffer_store_dword v12, v6, s[4:7], s61 offen sc1
    s_cbranch_vccnz R2s_po
R2s_po_ok:
    v_smfmac_f32_16x16x64_bf16 v[32:35], v[56:59], a[160:167], v1
    s_waitcnt lgkmcnt(0)
    s_barrier
    ds_read_b128 v[48:51], v0 offset:7168
    v_smfmac_f32_16x16x64_bf16 v[36:39], v[56:59], a[168:175], v1
    ds_read_b128 v[56:59], v0 offset:1024
    v_smfmac_f32_16x16x64_bf16 v[16:19], v[60:63], v[128:135], v1
    ds_read_b128 v[52:55], v0 offset:3072
    s_add_u32 s20, s9, 2
    v_smfmac_f32_16x16x64_bf16 v[20:23], v[60:63], v[136:143], v1
    buffer_store_dword v15, v6, s[4:7], s18 offen sc1
    s_cmp_lt_u32 s20, s96
    v_smfmac_f32_16x16x64_bf16 v[24:27], v[60:63], a[80:87], v1
    s_cbranch_scc0 R2s_rd
R2s_rd_ok:
    v_smfmac_f32_16x16x64_bf16 v[28:31], v[60:63], a[88:95], v1
    s_waitcnt lgkmcnt(2)
    ds_read_b128 v[92:95], v0 offset:11264
    v_lshlrev_b32 v7, 3, v0
    v_smfmac_f32_16x16x64_bf16 v[16:19], v[48:51], v[144:151], v1
    ds_read_b128 v[96:99], v0 offset:12288
    v_smfmac_f32_16x16x64_bf16 v[20:23], v[48:51], v[152:159], v1
    s_waitcnt lgkmcnt(3)
    ds_read_b128 v[100:103], v0 offset:13312
    v_smfmac_f32_16x16x64_bf16 v[16:19], v[56:59], v[160:167], v1
    ds_read_b128 v[104:107], v0 offset:14336
    v_smfmac_f32_16x16x64_bf16 v[20:23], v[56:59], v[168:175], v1
    s_waitcnt lgkmcnt(4)
    ds_read_b128 v[108:111], v0 offset:15360
    v_smfmac_f32_16x16x64_bf16 v[16:19], v[52:55], v[176:183], v1
    buffer_load_dword v7, v7, s[4:7], s13 offen
    v_smfmac_f32_16x16x64_bf16 v[20:23], v[52:55], v[184:191], v1
    v_smfmac_f32_16x16x64_bf16 v[24:27], v[48:51], a[112:119], v1
    ds_read_b128 v[120:123], v2 offset:32768
    v_add_f32 v16, v16, v18
    v_smfmac_f32_16x16x64_bf16 v[28:31], v[48:51], a[120:127], v1
    ds_read_b128 v[124:127], v2 offset:33792
    v_add_f32 v17, v17, v19
    v_smfmac_f32_16x16x64_bf16 v[24:27], v[56:59], a[16:23], v1
    v_add_f32 v20, v20, v22
    v_smfmac_f32_16x16x64_bf16 v[28:31], v[56:59], a[24:31], v1
    v_add_f32 v21, v21, v23
    v_smfmac_f32_16x16x64_bf16 v[24:27], v[52:55], a[48:55], v1
    buffer_load_dword v7, v6, s[4:7], s98 offen sc1
    v_cvt_pk_bf16_f32 v18, v16, v20
    v_smfmac_f32_16x16x64_bf16 v[28:31], v[52:55], a[56:63], v1
    v_cvt_pk_bf16_f32 v19, v17, v21
    v_smfmac_f32_16x16x64_bf16 v[32:35], v[48:51], a[240:247], v1
    ds_write2_b32 v3, v18, v19 offset0:0 offset1:136
    v_add_f32 v24, v24, v26
    v_smfmac_f32_16x16x64_bf16 v[36:39], v[48:51], a[248:255], v1
    ds_read_b128 v[48:51], v0 offset:6144
    v_add_f32 v25, v25, v27
    v_add_f32 v28, v28, v30
    v_add_f32 v29, v29, v31
    v_cvt_pk_bf16_f32 v128, v24, v28
    v_cvt_pk_bf16_f32 v129, v25, v29
    v_smfmac_f32_16x16x64_bf16 v[32:35], v[52:55], a[176:183], v1
    ds_write2_b32 v3, v128, v129 offset0:64 offset1:200
    v_smfmac_f32_16x16x64_bf16 v[36:39], v[52:55], a[184:191], v1
    ds_read_b128 v[52:55], v0 offset:0
    v_smfmac_f32_16x16x64_bf16 v[32:35], v[60:63], a[208:215], v1
    v_smfmac_f32_16x16x64_bf16 v[36:39], v[60:63], a[216:223], v1
    v_smfmac_f32_16x16x64_bf16 v[32:35], v[56:59], a[144:151], v1
    s_waitcnt lgkmcnt(1)
    s_barrier
    ds_read_b128 v[64:67], v4 offset:0
    v_smfmac_f32_16x16x64_bf16 v[36:39], v[56:59], a[152:159], v1
    ds_read_b128 v[68:71], v4 offset:64
    ds_read_b128 v[112:115], v4 offset:256
    v_smfmac_f32_16x16x64_bf16 v[32:35], v[48:51], a[224:231], v1
    ds_read_b128 v[116:119], v4 offset:320
    ds_read_b128 v[72:75], v4 offset:128
    s_waitcnt lgkmcnt(5)
    ds_read_b128 v[76:79], v4 offset:192
    s_waitcnt lgkmcnt(5)
    v_mfma_f32_16x16x32_bf16 v[16:19], v[80:83], v[64:67], 0
    v_mfma_f32_16x16x32_bf16 v[20:23], v[96:99], v[64:67], 0
    s_waitcnt lgkmcnt(4)
    v_mfma_f32_16x16x32_bf16 v[16:19], v[84:87], v[68:71], v[16:19]
    v_mov_b64 v[56:57], s[58:59]
    v_mov_b64 v[58:59], s[58:59]
    v_mfma_f32_16x16x32_bf16 v[20:23], v[100:103], v[68:71], v[20:23]
    s_waitcnt lgkmcnt(2)
    v_mfma_f32_16x16x32_bf16 v[24:27], v[112:115], v[64:67], 0
    buffer_load_dwordx4 v0, s[4:7], s11 offen offset:0 nt lds
    v_mfma_f32_16x16x32_bf16 v[24:27], v[116:119], v[68:71], v[24:27]
    buffer_load_dwordx4 v0, s[4:7], s11 offen offset:1024 nt lds
    s_waitcnt lgkmcnt(1)
    v_mfma_f32_16x16x32_bf16 v[16:19], v[88:91], v[72:75], v[16:19]
    ds_read_b128 v[80:83], v2 offset:22528
    v_mfma_f32_16x16x32_bf16 v[20:23], v[104:107], v[72:75], v[20:23]
    s_waitcnt lgkmcnt(1)
    ds_read_b128 v[84:87], v2 offset:23552
    v_mfma_f32_16x16x32_bf16 v[16:19], v[92:95], v[76:79], v[16:19]
    ds_read_b128 v[64:67], v2 offset:18432
    v_add_f32_dpp v24, v26, v24 quad_perm:[2,3,0,1] row_mask:0xf bank_mask:0xf
    v_add_f32_dpp v25, v27, v25 quad_perm:[2,3,0,1] row_mask:0xf bank_mask:0xf
    v_mfma_f32_16x16x32_bf16 v[20:23], v[108:111], v[76:79], v[20:23]
    ds_read_b128 v[68:71], v2 offset:19456
    v_max_f32 v132, v24, v25
    v_smfmac_f32_16x16x64_bf16 v[36:39], v[48:51], a[232:239], v1
    ds_read_b128 v[88:91], v2 offset:24576
    ds_read_b128 v[72:75], v2 offset:20480
    v_max3_f32 v132, v132, v16, v17
    v_max3_f32 v132, v132, v18, v19
    v_max3_f32 v134, v132, v20, v21
    v_max3_f32 v132, v134, v22, v23
    v_max3_f32 v133, v134, v22, v23
    v_smfmac_f32_16x16x64_bf16 v[32:35], v[52:55], a[128:135], v1
    ds_read_b128 v[92:95], v2 offset:25600
    ds_read_b128 v[96:99], v2 offset:26624
    v_permlane16_swap_b32 v132, v133
    v_max_f32 v134, v132, v133
    v_max_f32 v135, v132, v133
    v_smfmac_f32_16x16x64_bf16 v[36:39], v[52:55], a[136:143], v1
    ds_read_b128 v[100:103], v2 offset:27648
    v_permlane32_swap_b32 v134, v135
    v_max_f32 v132, v134, v135
    v_fma_f32 v132, v132, s56, v14
    v_pk_fma_f32 v[24:25], v[24:25], s[56:57], v[132:133] op_sel_hi:[1,1,0] neg_lo:[0,0,1] neg_hi:[0,0,1]
    v_pk_fma_f32 v[16:17], v[16:17], s[56:57], v[132:133] op_sel_hi:[1,1,0] neg_lo:[0,0,1] neg_hi:[0,0,1]
    v_pk_fma_f32 v[18:19], v[18:19], s[56:57], v[132:133] op_sel_hi:[1,1,0] neg_lo:[0,0,1] neg_hi:[0,0,1]
    v_pk_fma_f32 v[20:21], v[20:21], s[56:57], v[132:133] op_sel_hi:[1,1,0] neg_lo:[0,0,1] neg_hi:[0,0,1]
    v_pk_fma_f32 v[22:23], v[22:23], s[56:57], v[132:133] op_sel_hi:[1,1,0] neg_lo:[0,0,1] neg_hi:[0,0,1]
    v_pk_add_f32 v[32:33], v[32:33], v[34:35]
    v_pk_add_f32 v[36:37], v[36:37], v[38:39]
    v_cvt_pk_bf16_f32 v130, v32, v33
    v_cvt_pk_bf16_f32 v131, v36, v37
    v_exp_f32 v24, v24
    v_exp_f32 v25, v25
    v_exp_f32 v16, v16
    v_cvt_pk_bf16_f32 v12, v24, v25
    v_exp_f32 v17, v17
    v_exp_f32 v18, v18
    v_mov_b32_dpp v13, v12 quad_perm:[2,3,0,1] row_mask:0xf bank_mask:0xf
    v_exp_f32 v19, v19
    v_cvt_pk_bf16_f32 v28, v16, v17
    v_mfma_f32_16x16x16_bf16 v[60:63], v[56:57], v[12:13], 0
    ds_read_b128 v[76:79], v2 offset:21504
    v_exp_f32 v20, v20
    v_cvt_pk_bf16_f32 v29, v18, v19
    v_mfma_f32_16x16x16_bf16 v[48:51], v[130:131], v[12:13], 0
    s_waitcnt vmcnt(6)
    v_exp_f32 v21, v21
    v_exp_f32 v22, v22
    v_exp_f32 v23, v23
    v_cvt_pk_bf16_f32 v30, v20, v21
    v_cvt_pk_bf16_f32 v31, v22, v23
    v_mov_b32_dpp v16, v28 quad_perm:[2,3,0,1] row_mask:0xf bank_mask:0xf
    v_mov_b32_dpp v17, v29 quad_perm:[2,3,0,1] row_mask:0xf bank_mask:0xf
    v_mfma_f32_16x16x32_bf16 v[60:63], v[56:59], v[28:31], v[60:63]
    v_mov_b32_dpp v18, v30 quad_perm:[2,3,0,1] row_mask:0xf bank_mask:0xf
    v_mov_b32_dpp v19, v31 quad_perm:[2,3,0,1] row_mask:0xf bank_mask:0xf
    v_mfma_f32_16x16x32_bf16 v[48:51], v[40:43], v[28:31], v[48:51]
    v_mov_b64 v[24:25], 0
    v_mov_b64 v[26:27], 0
    v_mfma_f32_16x16x32_bf16 v[48:51], v[44:47], v[16:19], v[48:51]
    v_rcp_f32_dpp v132, v60 quad_perm:[0,1,0,1] row_mask:0xf bank_mask:0xf
    v_mov_b64 v[20:21], 0
    v_mov_b64 v[22:23], 0
    v_mov_b64 v[16:17], 0
    v_mov_b64 v[18:19], 0
    v_mov_b64 v[28:29], 0
    v_pk_mul_f32 v[48:49], v[48:49], v[132:133] op_sel_hi:[1,0]
    v_pk_mul_f32 v[50:51], v[50:51], v[132:133] op_sel_hi:[1,0]
    v_cvt_pk_bf16_f32 v134, v48, v49
    v_cvt_pk_bf16_f32 v135, v50, v51
    ds_write_b64 v0, v[134:135] offset:23040
    v_mov_b64 v[30:31], 0
    v_mov_b64 v[48:49], 0
    v_mov_b64 v[50:51], 0
    v_mov_b64 v[32:33], 0
    v_mov_b64 v[34:35], 0
    v_mov_b64 v[36:37], 0
    v_mov_b64 v[38:39], 0
    v_mov_b64 v[52:53], 0
    v_mov_b64 v[54:55], 0
    s_add_u32 s11, s11, 262144
    s_add_u32 s12, s12, 262144
    s_add_u32 s9, s9, 1
    s_waitcnt lgkmcnt(0)
    s_barrier
    ds_read_b128 v[56:59], v0 offset:22016
    ds_read_b128 v[60:63], v0 offset:23040
    s_add_u32 s10, s10, 8192
    s_and_b32 s10, s10, 0xffff7fff
    s_add_u32 s13, s13, 262144
    s_add_u32 s18, s18, 8192
    s_xor_b32 s61, s17, 16384
    s_waitcnt lgkmcnt(1)
    v_smfmac_f32_16x16x64_bf16 v[16:19], v[56:59], v[192:199], v1
    v_smfmac_f32_16x16x64_bf16 v[20:23], v[56:59], v[208:215], v1
    s_waitcnt lgkmcnt(0)
    v_smfmac_f32_16x16x64_bf16 v[16:19], v[60:63], v[200:207], v1
    ds_read_b128 v[104:107], v2 offset:28672
    v_smfmac_f32_16x16x64_bf16 v[20:23], v[60:63], v[216:223], v1
    ds_read_b128 v[108:111], v2 offset:29696
    v_smfmac_f32_16x16x64_bf16 v[24:27], v[56:59], v[224:231], v1
    ds_read_b128 v[112:115], v2 offset:30720
    v_add_f32 v16, v16, v18
    v_smfmac_f32_16x16x64_bf16 v[24:27], v[60:63], v[232:239], v1
    ds_read_b128 v[116:119], v2 offset:31744
    v_add_f32 v20, v20, v22
    v_smfmac_f32_16x16x64_bf16 v[28:31], v[56:59], v[240:247], v1
    v_add_f32 v17, v17, v19
    v_smfmac_f32_16x16x64_bf16 v[28:31], v[60:63], v[248:255], v1
    v_add_f32 v21, v21, v23
    v_smfmac_f32_16x16x64_bf16 v[32:35], v[56:59], v[64:71], v1
    v_cvt_pk_bf16_f32 v16, v16, v20
    v_bfi_b32 v16, 1, s21, v16
    v_cvt_pk_bf16_f32 v17, v17, v21
    v_add_f32 v24, v24, v26
    v_add_f32 v25, v25, v27
    v_add_f32 v28, v28, v30
    v_add_f32 v29, v29, v31
    v_cvt_pk_bf16_f32 v18, v24, v28
    v_cvt_pk_bf16_f32 v19, v25, v29
    v_smfmac_f32_16x16x64_bf16 v[32:35], v[60:63], v[72:79], v1
    buffer_store_dwordx4 v[16:19], v5, s[4:7], s14 offen sc1
    v_smfmac_f32_16x16x64_bf16 v[36:39], v[56:59], v[80:87], v1
    v_smfmac_f32_16x16x64_bf16 v[36:39], v[60:63], v[88:95], v1
    s_waitcnt lgkmcnt(0)
    v_add_f32 v32, v32, v34
    v_smfmac_f32_16x16x64_bf16 v[48:51], v[56:59], v[96:103], v1
    v_add_f32 v33, v33, v35
    v_smfmac_f32_16x16x64_bf16 v[48:51], v[60:63], v[104:111], v1
    v_add_f32 v36, v36, v38
    v_smfmac_f32_16x16x64_bf16 v[52:55], v[56:59], v[112:119], v1
    v_add_f32 v37, v37, v39
    v_smfmac_f32_16x16x64_bf16 v[52:55], v[60:63], v[120:127], v1
    v_cvt_pk_bf16_f32 v32, v32, v36
    v_bfi_b32 v32, 1, s21, v32
    v_cvt_pk_bf16_f32 v33, v33, v37
    v_add_f32 v48, v48, v50
    v_add_f32 v49, v49, v51
    s_nop 1
    v_add_f32 v52, v52, v54
    v_add_f32 v53, v53, v55
    v_cvt_pk_bf16_f32 v34, v48, v52
    v_cvt_pk_bf16_f32 v35, v49, v53
    buffer_store_dwordx4 v[32:35], v5, s[4:7], s15 offen sc1
    v_mov_b64 v[16:17], 0
    v_mov_b64 v[18:19], 0
    v_mov_b64 v[20:21], 0
    v_mov_b64 v[22:23], 0
    v_mov_b64 v[24:25], 0
    v_mov_b64 v[26:27], 0
    v_mov_b64 v[28:29], 0
    v_mov_b64 v[30:31], 0
    v_mov_b64 v[32:33], 0
    v_mov_b64 v[34:35], 0
    v_mov_b64 v[36:37], 0
    v_mov_b64 v[38:39], 0
    ds_read_b128 v[64:67], v2 offset:0
    ds_read_b128 v[68:71], v2 offset:1024
    ds_read_b128 v[72:75], v2 offset:2048
    ds_read_b128 v[76:79], v2 offset:3072
    ds_read_b128 v[80:83], v2 offset:4096
    ds_read_b128 v[84:87], v2 offset:5120
    ds_read_b128 v[88:91], v2 offset:6144
    ds_read_b128 v[92:95], v2 offset:7168
    s_waitcnt vmcnt(0)
    buffer_load_dwordx4 v[56:59], v0, s[4:7], s16 offen offset:0 sc1
    buffer_load_dwordx4 v[60:63], v0, s[4:7], s16 offen offset:1024 sc1
    ds_read_b128 v[96:99], v2 offset:8192
    ds_read_b128 v[100:103], v2 offset:9216
    ds_read_b128 v[104:107], v2 offset:10240
    ds_read_b128 v[108:111], v2 offset:11264
    ds_read_b128 v[112:115], v2 offset:12288
    ds_read_b128 v[116:119], v2 offset:13312
    s_waitcnt lgkmcnt(0)
    buffer_load_dwordx4 v[40:43], v0, s[4:7], s16 offen offset:0 sc1
    buffer_load_dwordx4 v[44:47], v0, s[4:7], s16 offen offset:1024 sc1
    s_waitcnt vmcnt(3)
    v_mfma_f32_16x16x32_bf16 v[48:51], v[8:11], v[56:59], 0
    s_waitcnt vmcnt(2)
    v_mfma_f32_16x16x32_bf16 v[48:51], v[8:11], v[60:63], v[48:51]
    v_and_b32 v13, 1, v56
    v_and_b32 v12, 1, v60
    v_add_u32 v12, v13, v12
    v_cmp_ne_u32 vcc, s60, v12
    s_nop 2
    v_add_f32_dpp v48, v48, v48 row_ror:4 row_mask:0xf bank_mask:0xf
    v_add_f32_dpp v49, v49, v49 row_ror:4 row_mask:0xf bank_mask:0xf
    s_cbranch_vccnz R2s_p1
    v_add_f32_dpp v48, v48, v48 row_ror:8 row_mask:0xf bank_mask:0xf
    v_add_f32_dpp v49, v49, v49 row_ror:8 row_mask:0xf bank_mask:0xf
    v_cvt_pk_bf16_f32 v15, v48, v49
    buffer_store_dword v15, v6, s[4:7], s17 offen sc1
R2s_p1_ok:
    buffer_load_dwordx4 v[56:59], v0, s[4:7], s10 offen offset:0 sc1
    s_cmp_eq_u32 s9, 63
    s_cbranch_scc1 R2s_fin
    s_xor_b32 s14, s14, 262144
    s_xor_b32 s15, s15, 262144
    s_add_u32 s17, s17, 8192
    s_and_b32 s17, s17, 0xffff7fff
    s_xor_b32 s16, s16, 262144
    s_min_u32 s99, s19, 31
    s_and_b32 s60, s9, 2
    s_lshr_b32 s21, s60, 1
    ds_read_b128 v[120:123], v2 offset:14336
    ds_read_b128 v[124:127], v2 offset:15360
    ds_read_b128 v[128:131], v2 offset:16384
    ds_read_b128 v[132:135], v2 offset:17408
    s_waitcnt lgkmcnt(0)
    buffer_load_dwordx4 v[56:59], v0, s[4:7], s10 offen offset:0 sc1
    s_cmp_eq_u32 s96, 128
    s_cbranch_scc1 R2s_top
    v_readlane_b32 s100, v7, 0
    s_lshl_b32 s100, s100, 2
    s_add_u32 s100, s100, 0
    s_mov_b32 s96, s100
    v_readlane_b32 s100, v7, 1
    s_lshl_b32 s100, s100, 2
    s_add_u32 s100, s100, 1
    s_min_u32 s96, s96, s100
    v_readlane_b32 s100, v7, 2
    s_lshl_b32 s100, s100, 2
    s_add_u32 s100, s100, 2
    s_min_u32 s96, s96, s100
    v_readlane_b32 s100, v7, 3
    s_lshl_b32 s100, s100, 2
    s_add_u32 s100, s100, 3
    s_min_u32 s96, s96, s100
    s_cmp_ge_u32 s96, 64
    s_cselect_b32 s96, 128, s96
    s_branch R2s_top
R2s_pe_to:
    s_mov_b32 s99, 31
    s_waitcnt vmcnt(0)
    v_max3_u32 v7, v56, v57, v58
    v_max_u32 v7, v7, v59
    v_cmp_eq_u32 vcc, -1, v7
    ds_write_b128 v0, v[56:59] offset:4096
    s_cbranch_vccz R2s_pe_go
    s_sub_u32 s19, s19, 32
    s_cbranch_scc0 R2s_pe
    s_mov_b32 s19, 0
    s_mov_b32 s99, 0
    s_branch R2s_pe_go
R2s_po:
    buffer_load_dwordx4 v[60:63], v0, s[4:7], s10 offen offset:1024 sc1
    s_sub_u32 s19, s19, 1
    s_cbranch_scc1 R2s_po_to
    s_waitcnt vmcnt(0)
    ds_write_b128 v0, v[60:63] offset:5120
    v_max3_u32 v7, v60, v61, v62
    v_max_u32 v7, v7, v63
    v_cmp_eq_u32 vcc, -1, v7
    s_cbranch_vccnz R2s_po
    s_branch R2s_po_ok
R2s_po_to:
    s_mov_b32 s19, 0
    s_waitcnt vmcnt(0)
    ds_write_b128 v0, v[60:63] offset:5120
    s_branch R2s_po_ok
R2s_rd:
    buffer_load_dword v7, v6, s[4:7], s98 offen sc1
    s_sub_u32 s19, s19, 1
    s_cbranch_scc1 R2s_rd_to
    s_waitcnt vmcnt(0)
    v_readlane_b32 s100, v7, 0
    s_lshl_b32 s100, s100, 2
    s_add_u32 s100, s100, 0
    s_mov_b32 s96, s100
    v_readlane_b32 s100, v7, 1
    s_lshl_b32 s100, s100, 2
    s_add_u32 s100, s100, 1
    s_min_u32 s96, s96, s100
    v_readlane_b32 s100, v7, 2
    s_lshl_b32 s100, s100, 2
    s_add_u32 s100, s100, 2
    s_min_u32 s96, s96, s100
    v_readlane_b32 s100, v7, 3
    s_lshl_b32 s100, s100, 2
    s_add_u32 s100, s100, 3
    s_min_u32 s96, s96, s100
    s_cmp_ge_u32 s96, 64
    s_cselect_b32 s96, 128, s96
    s_cmp_lt_u32 s20, s96
    s_cbranch_scc1 R2s_rd_ok
    s_sleep 8
    s_branch R2s_rd
R2s_rd_to:
    s_mov_b32 s19, 0
    s_mov_b32 s96, 128
    s_waitcnt vmcnt(0)
    s_branch R2s_rd_ok
R2s_p1:
    buffer_load_dwordx4 v[56:59], v0, s[4:7], s16 offen offset:0 sc1
    buffer_load_dwordx4 v[60:63], v0, s[4:7], s16 offen offset:1024 sc1
    s_waitcnt vmcnt(3)
    v_mfma_f32_16x16x32_bf16 v[48:51], v[8:11], v[40:43], 0
    s_waitcnt vmcnt(2)
    v_mfma_f32_16x16x32_bf16 v[48:51], v[8:11], v[44:47], v[48:51]
    v_and_b32 v13, 1, v40
    v_and_b32 v12, 1, v44
    v_add_u32 v12, v13, v12
    v_cmp_ne_u32 vcc, s60, v12
    s_nop 2
    v_add_f32_dpp v48, v48, v48 row_ror:4 row_mask:0xf bank_mask:0xf
    v_add_f32_dpp v49, v49, v49 row_ror:4 row_mask:0xf bank_mask:0xf
    s_cbranch_vccnz R2s_p1b
    v_add_f32_dpp v48, v48, v48 row_ror:8 row_mask:0xf bank_mask:0xf
    v_add_f32_dpp v49, v49, v49 row_ror:8 row_mask:0xf bank_mask:0xf
    v_cvt_pk_bf16_f32 v15, v48, v49
    buffer_store_dword v15, v6, s[4:7], s17 offen sc1
    s_branch R2s_p1_ok
R2s_p1b:
    buffer_load_dwordx4 v[40:43], v0, s[4:7], s16 offen offset:0 sc1
    buffer_load_dwordx4 v[44:47], v0, s[4:7], s16 offen offset:1024 sc1
    s_sub_u32 s19, s19, 1
    s_cbranch_scc1 R2s_p1_to
    s_waitcnt vmcnt(3)
    v_mfma_f32_16x16x32_bf16 v[48:51], v[8:11], v[56:59], 0
    s_waitcnt vmcnt(2)
    v_mfma_f32_16x16x32_bf16 v[48:51], v[8:11], v[60:63], v[48:51]
    v_and_b32 v13, 1, v56
    v_and_b32 v12, 1, v60
    v_add_u32 v12, v13, v12
    v_cmp_ne_u32 vcc, s60, v12
    s_nop 2
    v_add_f32_dpp v48, v48, v48 row_ror:4 row_mask:0xf bank_mask:0xf
    v_add_f32_dpp v49, v49, v49 row_ror:4 row_mask:0xf bank_mask:0xf
    s_cbranch_vccnz R2s_p1
    v_add_f32_dpp v48, v48, v48 row_ror:8 row_mask:0xf bank_mask:0xf
    v_add_f32_dpp v49, v49, v49 row_ror:8 row_mask:0xf bank_mask:0xf
    v_cvt_pk_bf16_f32 v15, v48, v49
    buffer_store_dword v15, v6, s[4:7], s17 offen sc1
    s_branch R2s_p1_ok
R2s_p1_to:
    s_mov_b32 s19, 0
    v_add_f32_dpp v48, v48, v48 row_ror:8 row_mask:0xf bank_mask:0xf
    v_add_f32_dpp v49, v49, v49 row_ror:8 row_mask:0xf bank_mask:0xf
    v_cvt_pk_bf16_f32 v15, v48, v49
    buffer_store_dword v15, v6, s[4:7], s17 offen sc1
    s_branch R2s_p1_ok
R2s_fin:
    buffer_store_dword v15, v6, s[4:7], s18 offen sc1
    s_branch L_end
RR_29_w3:
    v_mov_b32 v20, v0
    v_lshrrev_b32 v32, 4, v20
    v_lshlrev_b32 v32, 13, v32
    v_and_b32 v21, 15, v20
    v_lshrrev_b32 v22, 5, v20
    v_lshlrev_b32 v22, 1, v22
    v_xor_b32 v21, v21, v22
    v_xor_b32 v21, 12, v21
    v_lshl_add_u32 v32, v21, 4, v32
    v_and_b32 v21, 3, v20
    s_lshl_b32 s48, s8, 8
    s_mov_b32 m0, 129024
    s_add_u32 s20, s48, 393216
    buffer_load_dwordx4 v32, s[36:39], s20 offen lds
    s_mov_b32 m0, 130048
    s_add_u32 s20, s48, 425984
    buffer_load_dwordx4 v32, s[36:39], s20 offen lds
    s_mov_b32 m0, 131072
    s_add_u32 s20, s48, 458752
    buffer_load_dwordx4 v32, s[36:39], s20 offen lds
    s_mov_b32 m0, 132096
    s_add_u32 s20, s48, 491520
    buffer_load_dwordx4 v32, s[36:39], s20 offen lds
    s_mov_b32 m0, 133120
    s_add_u32 s20, s48, 393216
    buffer_load_dwordx4 v32, s[40:43], s20 offen lds
    s_mov_b32 m0, 134144
    s_add_u32 s20, s48, 425984
    buffer_load_dwordx4 v32, s[40:43], s20 offen lds
    s_mov_b32 m0, 135168
    s_add_u32 s20, s48, 458752
    buffer_load_dwordx4 v32, s[40:43], s20 offen lds
    s_mov_b32 m0, 136192
    s_add_u32 s20, s48, 491520
    buffer_load_dwordx4 v32, s[40:43], s20 offen lds
    s_mov_b32 m0, 137216
    s_add_u32 s20, s48, 917504
    buffer_load_dwordx4 v32, s[36:39], s20 offen lds
    s_mov_b32 m0, 138240
    s_add_u32 s20, s48, 950272
    buffer_load_dwordx4 v32, s[36:39], s20 offen lds
    s_mov_b32 m0, 139264
    s_add_u32 s20, s48, 983040
    buffer_load_dwordx4 v32, s[36:39], s20 offen lds
    s_mov_b32 m0, 140288
    s_add_u32 s20, s48, 1015808
    buffer_load_dwordx4 v32, s[36:39], s20 offen lds
    s_mov_b32 m0, 141312
    s_add_u32 s20, s48, 917504
    buffer_load_dwordx4 v32, s[40:43], s20 offen lds
    s_mov_b32 m0, 142336
    s_add_u32 s20, s48, 950272
    buffer_load_dwordx4 v32, s[40:43], s20 offen lds
    s_mov_b32 m0, 143360
    s_add_u32 s20, s48, 983040
    buffer_load_dwordx4 v32, s[40:43], s20 offen lds
    s_mov_b32 m0, 144384
    s_add_u32 s20, s48, 1015808
    buffer_load_dwordx4 v32, s[40:43], s20 offen lds
    v_lshlrev_b32 v34, 3, v21
    v_add_u32 v35, 129024, v34
    v_add_u32 v34, 24768, v34
    v_bfe_u32 v22, v20, 2, 2
    v_mul_u32_u24 v22, 34816, v22
    v_add_u32 v34, v34, v22
    v_lshrrev_b32 v22, 4, v20
    v_lshl_add_u32 v34, v22, 9, v34
    v_bfe_u32 v22, v20, 4, 1
    v_lshlrev_b32 v22, 5, v22
    v_xor_b32 v34, v34, v22
    v_bfe_u32 v22, v20, 2, 2
    v_lshlrev_b32 v22, 6, v22
    v_xor_b32 v34, v34, v22
    v_xor_b32 v36, 32, v34
    v_bfe_u32 v22, v20, 4, 1
    v_lshl_add_u32 v35, v22, 12, v35
    v_bfe_u32 v22, v20, 3, 1
    v_lshl_add_u32 v35, v22, 11, v35
    v_bfe_u32 v22, v20, 5, 1
    v_lshl_add_u32 v35, v22, 9, v35
    v_bfe_u32 v22, v20, 2, 1
    v_lshl_add_u32 v35, v22, 7, v35
    s_cmp_eq_u32 s59, 0
    s_cbranch_scc1 VF_33
    v_mov_b32 v1, 0
    s_barrier
    ds_read_b32 v2, v1
    s_waitcnt lgkmcnt(0)
    v_readfirstlane_b32 s56, v2
    s_bitcmp1_b32 s56, s8
    s_cbranch_scc1 L_lost
VF_33:
    v_and_b32 v16, 15, v0
    v_lshrrev_b32 v17, 4, v0
    v_lshlrev_b32 v0, 4, v0
    v_add_u32 v2, 129024, v0
    v_and_b32 v18, 2, v16
    v_mov_b32 v1, 0x4444
    v_mov_b32 v7, 0xeeee
    v_cmp_eq_u32 vcc, 2, v18
    s_nop 1
    v_cndmask_b32 v1, v1, v7, vcc
    v_mov_b32 v14, 0
    v_mov_b32 v7, 0x7f800000
    v_cndmask_b32 v14, v14, v7, vcc
    v_mul_u32_u24 v3, 1088, v17
    v_lshl_add_u32 v3, v16, 2, v3
    v_add_u32 v3, 16576, v3
    v_lshrrev_b32 v18, 2, v16
    v_mul_u32_u24 v4, 1088, v18
    v_and_b32 v18, 1, v16
    v_mul_u32_u24 v18, 544, v18
    v_add_u32 v4, v4, v18
    v_bfe_u32 v18, v16, 1, 1
    v_mul_u32_u24 v18, 128, v18
    v_add_u32 v4, v4, v18
    v_lshl_add_u32 v4, v17, 4, v4
    v_add_u32 v4, 16384, v4
    v_lshlrev_b32 v5, 14, v17
    v_lshrrev_b32 v18, 3, v16
    v_lshl_add_u32 v5, v18, 13, v5
    v_bfe_u32 v18, v16, 2, 1
    v_lshl_add_u32 v5, v18, 11, v5
    v_and_b32 v18, 3, v16
    v_lshl_add_u32 v5, v18, 4, v5
    v_lshlrev_b32 v6, 4, v17
    v_lshl_add_u32 v6, v16, 2, v6
    v_mov_b32 v7, 0x40000000
    v_cmp_gt_u32 vcc, 4, v16
    s_nop 1
    v_cndmask_b32 v6, v7, v6, vcc
    v_mov_b32 v8, 0
    v_mov_b32 v7, 0x3f80
    v_cmp_eq_u32 vcc, 0, v16
    s_nop 1
    v_cndmask_b32 v8, v8, v7, vcc
    v_mov_b32 v7, 1.0
    v_cmp_eq_u32 vcc, 1, v16
    s_nop 1
    v_cndmask_b32 v8, v8, v7, vcc
    v_mov_b32 v9, 0
    v_mov_b32 v7, 0x3f80
    v_cmp_eq_u32 vcc, 4, v16
    s_nop 1
    v_cndmask_b32 v9, v9, v7, vcc
    v_mov_b32 v7, 1.0
    v_cmp_eq_u32 vcc, 5, v16
    s_nop 1
    v_cndmask_b32 v9, v9, v7, vcc
    v_mov_b32 v10, 0
    v_mov_b32 v7, 0x3f80
    v_cmp_eq_u32 vcc, 8, v16
    s_nop 1
    v_cndmask_b32 v10, v10, v7, vcc
    v_mov_b32 v7, 1.0
    v_cmp_eq_u32 vcc, 9, v16
    s_nop 1
    v_cndmask_b32 v10, v10, v7, vcc
    v_mov_b32 v11, 0
    v_mov_b32 v7, 0x3f80
    v_cmp_eq_u32 vcc, 12, v16
    s_nop 1
    v_cndmask_b32 v11, v11, v7, vcc
    v_mov_b32 v7, 1.0
    v_cmp_eq_u32 vcc, 13, v16
    s_nop 1
    v_cndmask_b32 v11, v11, v7, vcc
    s_mov_b32 s9, 0
    s_mov_b32 s10, 51386368
    s_lshl_b32 s20, s8, 13
    s_add_u32 s11, s20, 16783360
    s_add_u32 s12, s20, 33560576
    s_add_u32 s13, s20, 33820672
    s_add_u32 s16, s20, 50337792
    s_lshr_b32 s20, s8, 4
    s_lshl_b32 s14, s20, 10
    s_and_b32 s20, s8, 3
    s_lshl_b32 s20, s20, 8
    s_add_u32 s14, s14, s20
    s_and_b32 s20, s8, 12
    s_lshl_b32 s20, s20, 4
    s_add_u32 s14, s14, s20
    s_add_u32 s14, s14, 50528256
    s_add_u32 s15, s14, 4096
    s_lshr_b32 s20, s8, 3
    s_lshl_b32 s17, s20, 11
    s_and_b32 s20, s8, 6
    s_lshl_b32 s20, s20, 5
    s_add_u32 s17, s17, s20
    s_and_b32 s20, s8, 1
    s_lshl_b32 s20, s20, 9
    s_add_u32 s17, s17, s20
    s_add_u32 s17, s17, 51381504
    s_mov_b32 s19, 4194304
    s_mov_b32 s99, 31
    s_mov_b32 s21, 0
    s_mov_b32 s60, 0
    s_add_u32 s61, s17, 16384
    s_sub_u32 s18, s17, 524288
    s_mov_b32 s96, 0
    s_mov_b32 s56, 0x3e0293ee
    s_mov_b32 s57, 0x3e0293ee
    s_mov_b32 s58, 0x3f803f80
    s_mov_b32 s59, 0x3f803f80
    s_waitcnt vmcnt(24)
    ds_read_b64_tr_b16 v[192:193], v35 offset:18432
    ds_read_b64_tr_b16 v[194:195], v35 offset:18688
    ds_read_b64_tr_b16 v[196:197], v35 offset:19456
    ds_read_b64_tr_b16 v[198:199], v35 offset:19712
    ds_read_b64_tr_b16 v[208:209], v35 offset:18464
    ds_read_b64_tr_b16 v[210:211], v35 offset:18720
    ds_read_b64_tr_b16 v[212:213], v35 offset:19488
    ds_read_b64_tr_b16 v[214:215], v35 offset:19744
    ds_read_b64_tr_b16 v[224:225], v35 offset:18496
    ds_read_b64_tr_b16 v[226:227], v35 offset:18752
    ds_read_b64_tr_b16 v[228:229], v35 offset:19520
    ds_read_b64_tr_b16 v[230:231], v35 offset:19776
    ds_read_b64_tr_b16 v[240:241], v35 offset:18528
    ds_read_b64_tr_b16 v[242:243], v35 offset:18784
    ds_read_b64_tr_b16 v[244:245], v35 offset:19552
    ds_read_b64_tr_b16 v[246:247], v35 offset:19808
    s_waitcnt lgkmcnt(0)
    s_mov_b32 m0, 147456
    s_add_u32 s20, s48, 917504
    buffer_load_dwordx4 v32, s[32:35], s20 offen lds
    s_mov_b32 m0, 148480
    s_add_u32 s20, s48, 950272
    buffer_load_dwordx4 v32, s[32:35], s20 offen lds
    s_mov_b32 m0, 149504
    s_add_u32 s20, s48, 983040
    buffer_load_dwordx4 v32, s[32:35], s20 offen lds
    s_mov_b32 m0, 150528
    s_add_u32 s20, s48, 1015808
    buffer_load_dwordx4 v32, s[32:35], s20 offen lds
    s_mov_b32 m0, 151552
    s_add_u32 s20, s48, 1441792
    buffer_load_dwordx4 v32, s[36:39], s20 offen lds
    s_mov_b32 m0, 152576
    s_add_u32 s20, s48, 1474560
    buffer_load_dwordx4 v32, s[36:39], s20 offen lds
    s_mov_b32 m0, 153600
    s_add_u32 s20, s48, 1507328
    buffer_load_dwordx4 v32, s[36:39], s20 offen lds
    s_mov_b32 m0, 154624
    s_add_u32 s20, s48, 1540096
    buffer_load_dwordx4 v32, s[36:39], s20 offen lds
    s_waitcnt vmcnt(24)
    ds_read_b64_tr_b16 v[200:201], v35 offset:26624
    ds_read_b64_tr_b16 v[202:203], v35 offset:26880
    ds_read_b64_tr_b16 v[204:205], v35 offset:27648
    ds_read_b64_tr_b16 v[206:207], v35 offset:27904
    ds_read_b64_tr_b16 v[216:217], v35 offset:26656
    ds_read_b64_tr_b16 v[218:219], v35 offset:26912
    ds_read_b64_tr_b16 v[220:221], v35 offset:27680
    ds_read_b64_tr_b16 v[222:223], v35 offset:27936
    ds_read_b64_tr_b16 v[232:233], v35 offset:26688
    ds_read_b64_tr_b16 v[234:235], v35 offset:26944
    ds_read_b64_tr_b16 v[236:237], v35 offset:27712
    ds_read_b64_tr_b16 v[238:239], v35 offset:27968
    ds_read_b64_tr_b16 v[248:249], v35 offset:26720
    ds_read_b64_tr_b16 v[250:251], v35 offset:26976
    ds_read_b64_tr_b16 v[252:253], v35 offset:27744
    ds_read_b64_tr_b16 v[254:255], v35 offset:28000
    s_waitcnt lgkmcnt(0)
    s_mov_b32 m0, 155648
    s_add_u32 s20, s48, 1441792
    buffer_load_dwordx4 v32, s[40:43], s20 offen lds
    s_mov_b32 m0, 156672
    s_add_u32 s20, s48, 1474560
    buffer_load_dwordx4 v32, s[40:43], s20 offen lds
    s_mov_b32 m0, 157696
    s_add_u32 s20, s48, 1507328
    buffer_load_dwordx4 v32, s[40:43], s20 offen lds
    s_mov_b32 m0, 158720
    s_add_u32 s20, s48, 1540096
    buffer_load_dwordx4 v32, s[40:43], s20 offen lds
    s_mov_b32 m0, 159744
    s_add_u32 s20, s48, 1966080
    buffer_load_dwordx4 v32, s[36:39], s20 offen lds
    s_mov_b32 m0, 160768
    s_add_u32 s20, s48, 1998848
    buffer_load_dwordx4 v32, s[36:39], s20 offen lds
    s_mov_b32 m0, 161792
    s_add_u32 s20, s48, 2031616
    buffer_load_dwordx4 v32, s[36:39], s20 offen lds
    s_mov_b32 m0, 162816
    s_add_u32 s20, s48, 2064384
    buffer_load_dwordx4 v32, s[36:39], s20 offen lds
    s_waitcnt vmcnt(28)
    s_barrier
    ds_read_b64_tr_b16 a[0:1], v34 offset:0
    ds_read_b64_tr_b16 a[2:3], v34 offset:256
    ds_read_b64_tr_b16 a[4:5], v34 offset:2048
    ds_read_b64_tr_b16 a[6:7], v34 offset:2304
    ds_read_b64_tr_b16 a[8:9], v36 offset:0
    ds_read_b64_tr_b16 a[10:11], v36 offset:256
    ds_read_b64_tr_b16 a[12:13], v36 offset:2048
    ds_read_b64_tr_b16 a[14:15], v36 offset:2304
    s_waitcnt lgkmcnt(0)
    s_waitcnt vmcnt(24)
    s_barrier
    ds_read_b64_tr_b16 a[128:129], v34 offset:4096
    ds_read_b64_tr_b16 a[130:131], v34 offset:4352
    ds_read_b64_tr_b16 a[132:133], v34 offset:6144
    ds_read_b64_tr_b16 a[134:135], v34 offset:6400
    ds_read_b64_tr_b16 a[136:137], v36 offset:4096
    ds_read_b64_tr_b16 a[138:139], v36 offset:4352
    ds_read_b64_tr_b16 a[140:141], v36 offset:6144
    ds_read_b64_tr_b16 a[142:143], v36 offset:6400
    s_mov_b32 m0, 129024
    s_add_u32 s20, s48, 1966080
    buffer_load_dwordx4 v32, s[40:43], s20 offen lds
    s_mov_b32 m0, 130048
    s_add_u32 s20, s48, 1998848
    buffer_load_dwordx4 v32, s[40:43], s20 offen lds
    s_mov_b32 m0, 131072
    s_add_u32 s20, s48, 2031616
    buffer_load_dwordx4 v32, s[40:43], s20 offen lds
    s_mov_b32 m0, 132096
    s_add_u32 s20, s48, 2064384
    buffer_load_dwordx4 v32, s[40:43], s20 offen lds
    s_waitcnt lgkmcnt(0)
    s_waitcnt vmcnt(24)
    s_barrier
    ds_read_b64_tr_b16 a[16:17], v34 offset:8192
    ds_read_b64_tr_b16 a[18:19], v34 offset:8448
    ds_read_b64_tr_b16 a[20:21], v34 offset:10240
    ds_read_b64_tr_b16 a[22:23], v34 offset:10496
    ds_read_b64_tr_b16 a[24:25], v36 offset:8192
    ds_read_b64_tr_b16 a[26:27], v36 offset:8448
    ds_read_b64_tr_b16 a[28:29], v36 offset:10240
    ds_read_b64_tr_b16 a[30:31], v36 offset:10496
    s_mov_b32 m0, 133120
    s_add_u32 s20, s48, 1966080
    buffer_load_dwordx4 v32, s[32:35], s20 offen lds
    s_mov_b32 m0, 134144
    s_add_u32 s20, s48, 1998848
    buffer_load_dwordx4 v32, s[32:35], s20 offen lds
    s_mov_b32 m0, 135168
    s_add_u32 s20, s48, 2031616
    buffer_load_dwordx4 v32, s[32:35], s20 offen lds
    s_mov_b32 m0, 136192
    s_add_u32 s20, s48, 2064384
    buffer_load_dwordx4 v32, s[32:35], s20 offen lds
    s_waitcnt lgkmcnt(0)
    s_waitcnt vmcnt(24)
    s_barrier
    ds_read_b64_tr_b16 a[144:145], v34 offset:12288
    ds_read_b64_tr_b16 a[146:147], v34 offset:12544
    ds_read_b64_tr_b16 a[148:149], v34 offset:14336
    ds_read_b64_tr_b16 a[150:151], v34 offset:14592
    ds_read_b64_tr_b16 a[152:153], v36 offset:12288
    ds_read_b64_tr_b16 a[154:155], v36 offset:12544
    ds_read_b64_tr_b16 a[156:157], v36 offset:14336
    ds_read_b64_tr_b16 a[158:159], v36 offset:14592
    s_mov_b32 m0, 137216
    s_add_u32 s20, s48, 2490368
    buffer_load_dwordx4 v32, s[36:39], s20 offen lds
    s_mov_b32 m0, 138240
    s_add_u32 s20, s48, 2523136
    buffer_load_dwordx4 v32, s[36:39], s20 offen lds
    s_mov_b32 m0, 139264
    s_add_u32 s20, s48, 2555904
    buffer_load_dwordx4 v32, s[36:39], s20 offen lds
    s_mov_b32 m0, 140288
    s_add_u32 s20, s48, 2588672
    buffer_load_dwordx4 v32, s[36:39], s20 offen lds
    s_waitcnt lgkmcnt(0)
    s_waitcnt vmcnt(24)
    s_barrier
    ds_read_b64_tr_b16 v[144:145], v34 offset:18432
    ds_read_b64_tr_b16 v[146:147], v34 offset:18688
    ds_read_b64_tr_b16 v[148:149], v34 offset:20480
    ds_read_b64_tr_b16 v[150:151], v34 offset:20736
    ds_read_b64_tr_b16 v[152:153], v36 offset:18432
    ds_read_b64_tr_b16 v[154:155], v36 offset:18688
    ds_read_b64_tr_b16 v[156:157], v36 offset:20480
    ds_read_b64_tr_b16 v[158:159], v36 offset:20736
    s_mov_b32 m0, 141312
    s_add_u32 s20, s48, 2490368
    buffer_load_dwordx4 v32, s[40:43], s20 offen lds
    s_mov_b32 m0, 142336
    s_add_u32 s20, s48, 2523136
    buffer_load_dwordx4 v32, s[40:43], s20 offen lds
    s_mov_b32 m0, 143360
    s_add_u32 s20, s48, 2555904
    buffer_load_dwordx4 v32, s[40:43], s20 offen lds
    s_mov_b32 m0, 144384
    s_add_u32 s20, s48, 2588672
    buffer_load_dwordx4 v32, s[40:43], s20 offen lds
    s_waitcnt lgkmcnt(0)
    s_waitcnt vmcnt(24)
    s_barrier
    ds_read_b64_tr_b16 a[32:33], v34 offset:22528
    ds_read_b64_tr_b16 a[34:35], v34 offset:22784
    ds_read_b64_tr_b16 a[36:37], v34 offset:24576
    ds_read_b64_tr_b16 a[38:39], v34 offset:24832
    ds_read_b64_tr_b16 a[40:41], v36 offset:22528
    ds_read_b64_tr_b16 a[42:43], v36 offset:22784
    ds_read_b64_tr_b16 a[44:45], v36 offset:24576
    ds_read_b64_tr_b16 a[46:47], v36 offset:24832
    s_mov_b32 m0, 147456
    s_add_u32 s20, s48, 3014656
    buffer_load_dwordx4 v32, s[36:39], s20 offen lds
    s_mov_b32 m0, 148480
    s_add_u32 s20, s48, 3047424
    buffer_load_dwordx4 v32, s[36:39], s20 offen lds
    s_mov_b32 m0, 149504
    s_add_u32 s20, s48, 3080192
    buffer_load_dwordx4 v32, s[36:39], s20 offen lds
    s_mov_b32 m0, 150528
    s_add_u32 s20, s48, 3112960
    buffer_load_dwordx4 v32, s[36:39], s20 offen lds
    s_waitcnt lgkmcnt(0)
    s_waitcnt vmcnt(24)
    s_barrier
    ds_read_b64_tr_b16 a[160:161], v34 offset:26624
    ds_read_b64_tr_b16 a[162:163], v34 offset:26880
    ds_read_b64_tr_b16 a[164:165], v34 offset:28672
    ds_read_b64_tr_b16 a[166:167], v34 offset:28928
    ds_read_b64_tr_b16 a[168:169], v36 offset:26624
    ds_read_b64_tr_b16 a[170:171], v36 offset:26880
    ds_read_b64_tr_b16 a[172:173], v36 offset:28672
    ds_read_b64_tr_b16 a[174:175], v36 offset:28928
    s_mov_b32 m0, 151552
    s_add_u32 s20, s48, 3014656
    buffer_load_dwordx4 v32, s[40:43], s20 offen lds
    s_mov_b32 m0, 152576
    s_add_u32 s20, s48, 3047424
    buffer_load_dwordx4 v32, s[40:43], s20 offen lds
    s_mov_b32 m0, 153600
    s_add_u32 s20, s48, 3080192
    buffer_load_dwordx4 v32, s[40:43], s20 offen lds
    s_mov_b32 m0, 154624
    s_add_u32 s20, s48, 3112960
    buffer_load_dwordx4 v32, s[40:43], s20 offen lds
    s_waitcnt lgkmcnt(0)
    s_waitcnt vmcnt(24)
    s_barrier
    ds_read_b64_tr_b16 a[48:49], v34 offset:30720
    ds_read_b64_tr_b16 a[50:51], v34 offset:30976
    ds_read_b64_tr_b16 a[52:53], v34 offset:32768
    ds_read_b64_tr_b16 a[54:55], v34 offset:33024
    ds_read_b64_tr_b16 a[56:57], v36 offset:30720
    ds_read_b64_tr_b16 a[58:59], v36 offset:30976
    ds_read_b64_tr_b16 a[60:61], v36 offset:32768
    ds_read_b64_tr_b16 a[62:63], v36 offset:33024
    s_mov_b32 m0, 155648
    s_add_u32 s20, s48, 3014656
    buffer_load_dwordx4 v32, s[32:35], s20 offen lds
    s_mov_b32 m0, 156672
    s_add_u32 s20, s48, 3047424
    buffer_load_dwordx4 v32, s[32:35], s20 offen lds
    s_mov_b32 m0, 157696
    s_add_u32 s20, s48, 3080192
    buffer_load_dwordx4 v32, s[32:35], s20 offen lds
    s_mov_b32 m0, 158720
    s_add_u32 s20, s48, 3112960
    buffer_load_dwordx4 v32, s[32:35], s20 offen lds
    s_waitcnt lgkmcnt(0)
    s_waitcnt vmcnt(24)
    s_barrier
    ds_read_b64_tr_b16 a[176:177], v34 offset:0
    ds_read_b64_tr_b16 a[178:179], v34 offset:256
    ds_read_b64_tr_b16 a[180:181], v34 offset:2048
    ds_read_b64_tr_b16 a[182:183], v34 offset:2304
    ds_read_b64_tr_b16 a[184:185], v36 offset:0
    ds_read_b64_tr_b16 a[186:187], v36 offset:256
    ds_read_b64_tr_b16 a[188:189], v36 offset:2048
    ds_read_b64_tr_b16 a[190:191], v36 offset:2304
    s_mov_b32 m0, 159744
    s_add_u32 s20, s48, 3538944
    buffer_load_dwordx4 v32, s[36:39], s20 offen lds
    s_mov_b32 m0, 160768
    s_add_u32 s20, s48, 3571712
    buffer_load_dwordx4 v32, s[36:39], s20 offen lds
    s_mov_b32 m0, 161792
    s_add_u32 s20, s48, 3604480
    buffer_load_dwordx4 v32, s[36:39], s20 offen lds
    s_mov_b32 m0, 162816
    s_add_u32 s20, s48, 3637248
    buffer_load_dwordx4 v32, s[36:39], s20 offen lds
    s_waitcnt lgkmcnt(0)
    s_waitcnt vmcnt(24)
    s_barrier
    ds_read_b64_tr_b16 v[160:161], v34 offset:4096
    ds_read_b64_tr_b16 v[162:163], v34 offset:4352
    ds_read_b64_tr_b16 v[164:165], v34 offset:6144
    ds_read_b64_tr_b16 v[166:167], v34 offset:6400
    ds_read_b64_tr_b16 v[168:169], v36 offset:4096
    ds_read_b64_tr_b16 v[170:171], v36 offset:4352
    ds_read_b64_tr_b16 v[172:173], v36 offset:6144
    ds_read_b64_tr_b16 v[174:175], v36 offset:6400
    v_and_b32 v21, 3, v20
    v_lshrrev_b32 v22, 4, v20
    v_and_b32 v23, 1, v22
    v_lshlrev_b32 v23, 10, v23
    v_lshrrev_b32 v22, 1, v22
    v_lshl_add_u32 v23, v22, 6, v23
    v_lshl_add_u32 v23, v21, 1, v23
    s_and_b32 s20, s8, 6
    s_lshl_b32 s20, s20, 10
    s_lshr_b32 s100, s8, 3
    s_lshl_b32 s100, s100, 8
    s_add_u32 s20, s20, s100
    s_and_b32 s100, s8, 1
    s_lshl_b32 s100, s100, 4
    s_add_u32 s20, s20, s100
    s_add_u32 s20, s20, 136
    v_add_u32 v23, s20, v23
    global_load_ushort v24, v23, s[50:51]
    global_load_ushort v25, v23, s[50:51] offset:32
    v_mov_b32 v22, 128
    global_load_dwordx4 v[40:43], v22, s[64:65] sc1
    s_mov_b32 m0, 129024
    s_add_u32 s20, s48, 3538944
    buffer_load_dwordx4 v32, s[40:43], s20 offen lds
    s_mov_b32 m0, 130048
    s_add_u32 s20, s48, 3571712
    buffer_load_dwordx4 v32, s[40:43], s20 offen lds
    s_mov_b32 m0, 131072
    s_add_u32 s20, s48, 3604480
    buffer_load_dwordx4 v32, s[40:43], s20 offen lds
    s_mov_b32 m0, 132096
    s_add_u32 s20, s48, 3637248
    buffer_load_dwordx4 v32, s[40:43], s20 offen lds
    s_waitcnt lgkmcnt(0)
    s_waitcnt vmcnt(27)
    s_barrier
    ds_read_b64_tr_b16 a[64:65], v34 offset:8192
    ds_read_b64_tr_b16 a[66:67], v34 offset:8448
    ds_read_b64_tr_b16 a[68:69], v34 offset:10240
    ds_read_b64_tr_b16 a[70:71], v34 offset:10496
    ds_read_b64_tr_b16 a[72:73], v36 offset:8192
    ds_read_b64_tr_b16 a[74:75], v36 offset:8448
    ds_read_b64_tr_b16 a[76:77], v36 offset:10240
    ds_read_b64_tr_b16 a[78:79], v36 offset:10496
    s_mov_b32 m0, 133120
    s_add_u32 s20, s48, 4063232
    buffer_load_dwordx4 v32, s[36:39], s20 offen lds
    s_mov_b32 m0, 134144
    s_add_u32 s20, s48, 4096000
    buffer_load_dwordx4 v32, s[36:39], s20 offen lds
    s_mov_b32 m0, 135168
    s_add_u32 s20, s48, 4128768
    buffer_load_dwordx4 v32, s[36:39], s20 offen lds
    s_mov_b32 m0, 136192
    s_add_u32 s20, s48, 4161536
    buffer_load_dwordx4 v32, s[36:39], s20 offen lds
    s_waitcnt lgkmcnt(0)
    s_waitcnt vmcnt(27)
    s_barrier
    ds_read_b64_tr_b16 a[192:193], v34 offset:12288
    ds_read_b64_tr_b16 a[194:195], v34 offset:12544
    ds_read_b64_tr_b16 a[196:197], v34 offset:14336
    ds_read_b64_tr_b16 a[198:199], v34 offset:14592
    ds_read_b64_tr_b16 a[200:201], v36 offset:12288
    ds_read_b64_tr_b16 a[202:203], v36 offset:12544
    ds_read_b64_tr_b16 a[204:205], v36 offset:14336
    ds_read_b64_tr_b16 a[206:207], v36 offset:14592
    s_mov_b32 m0, 137216
    s_add_u32 s20, s48, 4063232
    buffer_load_dwordx4 v32, s[40:43], s20 offen lds
    s_mov_b32 m0, 138240
    s_add_u32 s20, s48, 4096000
    buffer_load_dwordx4 v32, s[40:43], s20 offen lds
    s_mov_b32 m0, 139264
    s_add_u32 s20, s48, 4128768
    buffer_load_dwordx4 v32, s[40:43], s20 offen lds
    s_mov_b32 m0, 140288
    s_add_u32 s20, s48, 4161536
    buffer_load_dwordx4 v32, s[40:43], s20 offen lds
    s_waitcnt lgkmcnt(0)
    s_waitcnt vmcnt(27)
    s_barrier
    ds_read_b64_tr_b16 a[80:81], v34 offset:18432
    ds_read_b64_tr_b16 a[82:83], v34 offset:18688
    ds_read_b64_tr_b16 a[84:85], v34 offset:20480
    ds_read_b64_tr_b16 a[86:87], v34 offset:20736
    ds_read_b64_tr_b16 a[88:89], v36 offset:18432
    ds_read_b64_tr_b16 a[90:91], v36 offset:18688
    ds_read_b64_tr_b16 a[92:93], v36 offset:20480
    ds_read_b64_tr_b16 a[94:95], v36 offset:20736
    s_mov_b32 m0, 141312
    s_add_u32 s20, s48, 4063232
    buffer_load_dwordx4 v32, s[32:35], s20 offen lds
    s_mov_b32 m0, 142336
    s_add_u32 s20, s48, 4096000
    buffer_load_dwordx4 v32, s[32:35], s20 offen lds
    s_mov_b32 m0, 143360
    s_add_u32 s20, s48, 4128768
    buffer_load_dwordx4 v32, s[32:35], s20 offen lds
    s_mov_b32 m0, 144384
    s_add_u32 s20, s48, 4161536
    buffer_load_dwordx4 v32, s[32:35], s20 offen lds
    s_waitcnt lgkmcnt(0)
    s_waitcnt vmcnt(27)
    s_barrier
    ds_read_b64_tr_b16 a[208:209], v34 offset:22528
    ds_read_b64_tr_b16 a[210:211], v34 offset:22784
    ds_read_b64_tr_b16 a[212:213], v34 offset:24576
    ds_read_b64_tr_b16 a[214:215], v34 offset:24832
    ds_read_b64_tr_b16 a[216:217], v36 offset:22528
    ds_read_b64_tr_b16 a[218:219], v36 offset:22784
    ds_read_b64_tr_b16 a[220:221], v36 offset:24576
    ds_read_b64_tr_b16 a[222:223], v36 offset:24832
    s_mov_b32 m0, 147456
    s_add_u32 s20, s49, 128
    buffer_load_dwordx4 v33, s[44:47], s20 offen lds
    s_mov_b32 m0, 148480
    s_add_u32 s20, s49, 8320
    buffer_load_dwordx4 v33, s[44:47], s20 offen lds
    s_mov_b32 m0, 149504
    s_add_u32 s20, s49, 16512
    buffer_load_dwordx4 v33, s[44:47], s20 offen lds
    s_mov_b32 m0, 150528
    s_add_u32 s20, s49, 24704
    buffer_load_dwordx4 v33, s[44:47], s20 offen lds
    s_waitcnt lgkmcnt(0)
    s_waitcnt vmcnt(27)
    s_barrier
    ds_read_b64_tr_b16 v[176:177], v34 offset:26624
    ds_read_b64_tr_b16 v[178:179], v34 offset:26880
    ds_read_b64_tr_b16 v[180:181], v34 offset:28672
    ds_read_b64_tr_b16 v[182:183], v34 offset:28928
    ds_read_b64_tr_b16 v[184:185], v36 offset:26624
    ds_read_b64_tr_b16 v[186:187], v36 offset:26880
    ds_read_b64_tr_b16 v[188:189], v36 offset:28672
    ds_read_b64_tr_b16 v[190:191], v36 offset:28928
    s_mov_b32 m0, 151552
    s_add_u32 s20, s49, 32896
    buffer_load_dwordx4 v33, s[44:47], s20 offen lds
    s_mov_b32 m0, 152576
    s_add_u32 s20, s49, 41088
    buffer_load_dwordx4 v33, s[44:47], s20 offen lds
    s_mov_b32 m0, 153600
    s_add_u32 s20, s49, 49280
    buffer_load_dwordx4 v33, s[44:47], s20 offen lds
    s_mov_b32 m0, 154624
    s_add_u32 s20, s49, 57472
    buffer_load_dwordx4 v33, s[44:47], s20 offen lds
    s_waitcnt lgkmcnt(0)
    s_waitcnt vmcnt(27)
    s_barrier
    ds_read_b64_tr_b16 a[96:97], v34 offset:30720
    ds_read_b64_tr_b16 a[98:99], v34 offset:30976
    ds_read_b64_tr_b16 a[100:101], v34 offset:32768
    ds_read_b64_tr_b16 a[102:103], v34 offset:33024
    ds_read_b64_tr_b16 a[104:105], v36 offset:30720
    ds_read_b64_tr_b16 a[106:107], v36 offset:30976
    ds_read_b64_tr_b16 a[108:109], v36 offset:32768
    ds_read_b64_tr_b16 a[110:111], v36 offset:33024
    s_mov_b32 m0, 155648
    s_add_u32 s20, s49, 65664
    buffer_load_dwordx4 v33, s[44:47], s20 offen lds
    s_mov_b32 m0, 156672
    s_add_u32 s20, s49, 73856
    buffer_load_dwordx4 v33, s[44:47], s20 offen lds
    s_mov_b32 m0, 157696
    s_add_u32 s20, s49, 82048
    buffer_load_dwordx4 v33, s[44:47], s20 offen lds
    s_mov_b32 m0, 158720
    s_add_u32 s20, s49, 90240
    buffer_load_dwordx4 v33, s[44:47], s20 offen lds
    s_waitcnt lgkmcnt(0)
    s_waitcnt vmcnt(24)
    s_barrier
    ds_read_b64_tr_b16 a[224:225], v34 offset:0
    ds_read_b64_tr_b16 a[226:227], v34 offset:256
    ds_read_b64_tr_b16 a[228:229], v34 offset:2048
    ds_read_b64_tr_b16 a[230:231], v34 offset:2304
    ds_read_b64_tr_b16 a[232:233], v36 offset:0
    ds_read_b64_tr_b16 a[234:235], v36 offset:256
    ds_read_b64_tr_b16 a[236:237], v36 offset:2048
    ds_read_b64_tr_b16 a[238:239], v36 offset:2304
    s_mov_b32 m0, 159744
    s_add_u32 s20, s49, 98432
    buffer_load_dwordx4 v33, s[44:47], s20 offen lds
    s_mov_b32 m0, 160768
    s_add_u32 s20, s49, 106624
    buffer_load_dwordx4 v33, s[44:47], s20 offen lds
    s_mov_b32 m0, 161792
    s_add_u32 s20, s49, 114816
    buffer_load_dwordx4 v33, s[44:47], s20 offen lds
    s_mov_b32 m0, 162816
    s_add_u32 s20, s49, 123008
    buffer_load_dwordx4 v33, s[44:47], s20 offen lds
    s_waitcnt lgkmcnt(0)
    s_waitcnt vmcnt(24)
    s_barrier
    ds_read_b64_tr_b16 a[112:113], v34 offset:4096
    ds_read_b64_tr_b16 a[114:115], v34 offset:4352
    ds_read_b64_tr_b16 a[116:117], v34 offset:6144
    ds_read_b64_tr_b16 a[118:119], v34 offset:6400
    ds_read_b64_tr_b16 a[120:121], v36 offset:4096
    ds_read_b64_tr_b16 a[122:123], v36 offset:4352
    ds_read_b64_tr_b16 a[124:125], v36 offset:6144
    ds_read_b64_tr_b16 a[126:127], v36 offset:6400
    s_waitcnt vmcnt(32)
RR_29_c3:
    v_readfirstlane_b32 s100, v40
    v_readfirstlane_b32 s101, v41
    v_readfirstlane_b32 s97, v42
    s_cmp_ge_u32 s101, 8
    s_cselect_b32 s100, s100, 0
    s_cmp_eq_u32 s100, -1
    s_cbranch_scc1 RR_29_d3
    global_load_dwordx4 v[40:43], v22, s[64:65] sc1
    s_sub_u32 s19, s19, 1
    s_cbranch_scc1 L_end
    s_waitcnt vmcnt(0)
    s_branch RR_29_c3
RR_29_d3:
    v_lshl_or_b32 v15, v25, 16, v24
    buffer_store_dword v15, v6, s[4:7], s17 offen sc1
    s_add_u32 s17, s17, 8192
    s_mov_b32 m0, 129024
    s_add_u32 s20, s48, 393216
    buffer_load_dwordx4 v32, s[32:35], s20 offen lds
    s_mov_b32 m0, 130048
    s_add_u32 s20, s48, 425984
    buffer_load_dwordx4 v32, s[32:35], s20 offen lds
    s_mov_b32 m0, 131072
    s_add_u32 s20, s48, 458752
    buffer_load_dwordx4 v32, s[32:35], s20 offen lds
    s_mov_b32 m0, 132096
    s_add_u32 s20, s48, 491520
    buffer_load_dwordx4 v32, s[32:35], s20 offen lds
    s_waitcnt lgkmcnt(0)
    s_waitcnt vmcnt(25)
    s_barrier
    ds_read_b64_tr_b16 a[240:241], v34 offset:8192
    ds_read_b64_tr_b16 a[242:243], v34 offset:8448
    ds_read_b64_tr_b16 a[244:245], v34 offset:10240
    ds_read_b64_tr_b16 a[246:247], v34 offset:10496
    ds_read_b64_tr_b16 a[248:249], v36 offset:8192
    ds_read_b64_tr_b16 a[250:251], v36 offset:8448
    ds_read_b64_tr_b16 a[252:253], v36 offset:10240
    ds_read_b64_tr_b16 a[254:255], v36 offset:10496
    s_mov_b32 m0, 133120
    s_add_u32 s20, s48, 1441792
    buffer_load_dwordx4 v32, s[32:35], s20 offen lds
    s_mov_b32 m0, 134144
    s_add_u32 s20, s48, 1474560
    buffer_load_dwordx4 v32, s[32:35], s20 offen lds
    s_mov_b32 m0, 135168
    s_add_u32 s20, s48, 1507328
    buffer_load_dwordx4 v32, s[32:35], s20 offen lds
    s_mov_b32 m0, 136192
    s_add_u32 s20, s48, 1540096
    buffer_load_dwordx4 v32, s[32:35], s20 offen lds
    buffer_load_dword v28, v6, s[4:7], s98 offen sc1
    s_waitcnt lgkmcnt(0)
    s_waitcnt vmcnt(26)
    s_barrier
    ds_read_b64_tr_b16 v[128:129], v34 offset:12288
    ds_read_b64_tr_b16 v[130:131], v34 offset:12544
    ds_read_b64_tr_b16 v[132:133], v34 offset:14336
    ds_read_b64_tr_b16 v[134:135], v34 offset:14592
    ds_read_b64_tr_b16 v[136:137], v36 offset:12288
    ds_read_b64_tr_b16 v[138:139], v36 offset:12544
    ds_read_b64_tr_b16 v[140:141], v36 offset:14336
    ds_read_b64_tr_b16 v[142:143], v36 offset:14592
    s_mov_b32 m0, 137216
    s_add_u32 s20, s48, 2490368
    buffer_load_dwordx4 v32, s[32:35], s20 offen lds
    s_mov_b32 m0, 138240
    s_add_u32 s20, s48, 2523136
    buffer_load_dwordx4 v32, s[32:35], s20 offen lds
    s_mov_b32 m0, 139264
    s_add_u32 s20, s48, 2555904
    buffer_load_dwordx4 v32, s[32:35], s20 offen lds
    s_mov_b32 m0, 140288
    s_add_u32 s20, s48, 2588672
    buffer_load_dwordx4 v32, s[32:35], s20 offen lds
    s_waitcnt lgkmcnt(0)
    ds_write_b128 v2, v[128:131] offset:16384
    ds_write_b128 v2, v[132:135] offset:17408
    s_waitcnt vmcnt(22)
    s_barrier
    ds_read_b64_tr_b16 v[64:65], v35 offset:18432
    ds_read_b64_tr_b16 v[66:67], v35 offset:18688
    ds_read_b64_tr_b16 v[68:69], v35 offset:19456
    ds_read_b64_tr_b16 v[70:71], v35 offset:19712
    ds_read_b64_tr_b16 v[80:81], v35 offset:18464
    ds_read_b64_tr_b16 v[82:83], v35 offset:18720
    ds_read_b64_tr_b16 v[84:85], v35 offset:19488
    ds_read_b64_tr_b16 v[86:87], v35 offset:19744
    ds_read_b64_tr_b16 v[96:97], v35 offset:18496
    ds_read_b64_tr_b16 v[98:99], v35 offset:18752
    ds_read_b64_tr_b16 v[100:101], v35 offset:19520
    ds_read_b64_tr_b16 v[102:103], v35 offset:19776
    ds_read_b64_tr_b16 v[112:113], v35 offset:18528
    ds_read_b64_tr_b16 v[114:115], v35 offset:18784
    ds_read_b64_tr_b16 v[116:117], v35 offset:19552
    ds_read_b64_tr_b16 v[118:119], v35 offset:19808
    s_mov_b32 m0, 141312
    s_add_u32 s20, s48, 3538944
    buffer_load_dwordx4 v32, s[32:35], s20 offen lds
    s_mov_b32 m0, 142336
    s_add_u32 s20, s48, 3571712
    buffer_load_dwordx4 v32, s[32:35], s20 offen lds
    s_mov_b32 m0, 143360
    s_add_u32 s20, s48, 3604480
    buffer_load_dwordx4 v32, s[32:35], s20 offen lds
    s_mov_b32 m0, 144384
    s_add_u32 s20, s48, 3637248
    buffer_load_dwordx4 v32, s[32:35], s20 offen lds
    s_waitcnt lgkmcnt(0)
    s_waitcnt vmcnt(18)
    ds_read_b64_tr_b16 v[72:73], v35 offset:26624
    ds_read_b64_tr_b16 v[74:75], v35 offset:26880
    ds_read_b64_tr_b16 v[76:77], v35 offset:27648
    ds_read_b64_tr_b16 v[78:79], v35 offset:27904
    ds_read_b64_tr_b16 v[88:89], v35 offset:26656
    ds_read_b64_tr_b16 v[90:91], v35 offset:26912
    ds_read_b64_tr_b16 v[92:93], v35 offset:27680
    ds_read_b64_tr_b16 v[94:95], v35 offset:27936
    ds_read_b64_tr_b16 v[104:105], v35 offset:26688
    ds_read_b64_tr_b16 v[106:107], v35 offset:26944
    ds_read_b64_tr_b16 v[108:109], v35 offset:27712
    ds_read_b64_tr_b16 v[110:111], v35 offset:27968
    ds_read_b64_tr_b16 v[120:121], v35 offset:26720
    ds_read_b64_tr_b16 v[122:123], v35 offset:26976
    ds_read_b64_tr_b16 v[124:125], v35 offset:27744
    ds_read_b64_tr_b16 v[126:127], v35 offset:28000
    v_lshlrev_b32 v30, 1, v0
    s_add_u32 s20, s16, 0
    buffer_load_dword v7, v30, s[4:7], s20 offen sc1
    s_add_u32 s20, s16, 262144
    buffer_load_dword v7, v30, s[4:7], s20 offen sc1
    s_add_u32 s20, s10, 8192
    buffer_load_dword v7, v30, s[4:7], s20 offen sc1
    s_add_u32 s20, s10, 16384
    buffer_load_dword v7, v30, s[4:7], s20 offen sc1
    s_add_u32 s20, s10, 24576
    buffer_load_dword v7, v30, s[4:7], s20 offen sc1
    s_getpc_b64 s[54:55]
RR_29_pc3:
    v_lshlrev_b32 v30, 3, v0
    v_min_u32 v30, 5632, v30
    global_load_dword v7, v30, s[54:55]
    s_waitcnt lgkmcnt(0)
    ds_write_b128 v2, v[64:67] offset:18432
    ds_write_b128 v2, v[68:71] offset:19456
    ds_write_b128 v2, v[72:75] offset:20480
    ds_write_b128 v2, v[76:79] offset:21504
    ds_write_b128 v2, v[80:83] offset:22528
    ds_write_b128 v2, v[84:87] offset:23552
    ds_write_b128 v2, v[88:91] offset:24576
    ds_write_b128 v2, v[92:95] offset:25600
    ds_write_b128 v2, v[96:99] offset:26624
    ds_write_b128 v2, v[100:103] offset:27648
    ds_write_b128 v2, v[104:107] offset:28672
    ds_write_b128 v2, v[108:111] offset:29696
    ds_write_b128 v2, v[112:115] offset:30720
    ds_write_b128 v2, v[116:119] offset:31744
    ds_write_b128 v2, v[120:123] offset:32768
    ds_write_b128 v2, v[124:127] offset:33792
    s_waitcnt lgkmcnt(0)
    s_waitcnt vmcnt(19)
    s_barrier
    ds_read_b64_tr_b16 v[80:81], v34 offset:0
    ds_read_b64_tr_b16 v[82:83], v34 offset:256
    ds_read_b64_tr_b16 v[84:85], v34 offset:2048
    ds_read_b64_tr_b16 v[86:87], v34 offset:2304
    ds_read_b64_tr_b16 v[88:89], v36 offset:0
    ds_read_b64_tr_b16 v[90:91], v36 offset:256
    ds_read_b64_tr_b16 v[92:93], v36 offset:2048
    ds_read_b64_tr_b16 v[94:95], v36 offset:2304
    buffer_load_dword v13, v6, s[4:7], s98 offen sc1
    s_waitcnt lgkmcnt(0)
    s_waitcnt vmcnt(16)
    s_barrier
    ds_read_b64_tr_b16 v[96:97], v34 offset:4096
    ds_read_b64_tr_b16 v[98:99], v34 offset:4352
    ds_read_b64_tr_b16 v[100:101], v34 offset:6144
    ds_read_b64_tr_b16 v[102:103], v34 offset:6400
    ds_read_b64_tr_b16 v[104:105], v36 offset:4096
    ds_read_b64_tr_b16 v[106:107], v36 offset:4352
    ds_read_b64_tr_b16 v[108:109], v36 offset:6144
    ds_read_b64_tr_b16 v[110:111], v36 offset:6400
    s_waitcnt lgkmcnt(0)
    s_waitcnt vmcnt(11)
    s_barrier
    ds_read_b64_tr_b16 v[112:113], v34 offset:8192
    ds_read_b64_tr_b16 v[114:115], v34 offset:8448
    ds_read_b64_tr_b16 v[116:117], v34 offset:10240
    ds_read_b64_tr_b16 v[118:119], v34 offset:10496
    ds_read_b64_tr_b16 v[120:121], v36 offset:8192
    ds_read_b64_tr_b16 v[122:123], v36 offset:8448
    ds_read_b64_tr_b16 v[124:125], v36 offset:10240
    ds_read_b64_tr_b16 v[126:127], v36 offset:10496
    v_readlane_b32 s100, v28, 0
    s_lshl_b32 s100, s100, 2
    s_add_u32 s100, s100, 0
    s_mov_b32 s96, s100
    v_readlane_b32 s100, v28, 1
    s_lshl_b32 s100, s100, 2
    s_add_u32 s100, s100, 1
    s_min_u32 s96, s96, s100
    v_readlane_b32 s100, v28, 2
    s_lshl_b32 s100, s100, 2
    s_add_u32 s100, s100, 2
    s_min_u32 s96, s96, s100
    v_readlane_b32 s100, v28, 3
    s_lshl_b32 s100, s100, 2
    s_add_u32 s100, s100, 3
    s_min_u32 s96, s96, s100
    s_cmp_ge_u32 s96, 64
    s_cselect_b32 s96, 128, s96
    s_cmp_lt_u32 s96, 2
    s_cselect_b32 s100, 0x40000000, 0
    v_lshlrev_b32 v30, 1, v0
    v_add_u32 v30, s100, v30
    buffer_load_dword v7, v30, s[4:7], s11 offen
    buffer_load_dword v7, v30, s[4:7], s12 offen
    s_add_u32 s20, s11, 262144
    buffer_load_dword v7, v30, s[4:7], s20 offen
    s_waitcnt lgkmcnt(0)
    s_waitcnt vmcnt(10)
    s_barrier
    ds_read_b64_tr_b16 v[64:65], v34 offset:12288
    ds_read_b64_tr_b16 v[66:67], v34 offset:12544
    ds_read_b64_tr_b16 v[68:69], v34 offset:14336
    ds_read_b64_tr_b16 v[70:71], v34 offset:14592
    ds_read_b64_tr_b16 v[72:73], v36 offset:12288
    ds_read_b64_tr_b16 v[74:75], v36 offset:12544
    ds_read_b64_tr_b16 v[76:77], v36 offset:14336
    ds_read_b64_tr_b16 v[78:79], v36 offset:14592
    s_mov_b32 s20, 1
    s_cmp_lt_u32 s20, s96
    s_cbranch_scc1 R3s_r0_ok
    s_waitcnt vmcnt(0)
    v_readlane_b32 s100, v13, 0
    s_lshl_b32 s100, s100, 2
    s_add_u32 s100, s100, 0
    s_mov_b32 s96, s100
    v_readlane_b32 s100, v13, 1
    s_lshl_b32 s100, s100, 2
    s_add_u32 s100, s100, 1
    s_min_u32 s96, s96, s100
    v_readlane_b32 s100, v13, 2
    s_lshl_b32 s100, s100, 2
    s_add_u32 s100, s100, 2
    s_min_u32 s96, s96, s100
    v_readlane_b32 s100, v13, 3
    s_lshl_b32 s100, s100, 2
    s_add_u32 s100, s100, 3
    s_min_u32 s96, s96, s100
    s_cmp_ge_u32 s96, 64
    s_cselect_b32 s96, 128, s96
    s_cmp_lt_u32 s20, s96
    s_cbranch_scc1 R3s_r0_w
R3s_r0:
    buffer_load_dword v7, v6, s[4:7], s98 offen sc1
    s_sub_u32 s19, s19, 1
    s_cbranch_scc1 R3s_r0_to
    s_waitcnt vmcnt(0)
    v_readlane_b32 s100, v7, 0
    s_lshl_b32 s100, s100, 2
    s_add_u32 s100, s100, 0
    s_mov_b32 s96, s100
    v_readlane_b32 s100, v7, 1
    s_lshl_b32 s100, s100, 2
    s_add_u32 s100, s100, 1
    s_min_u32 s96, s96, s100
    v_readlane_b32 s100, v7, 2
    s_lshl_b32 s100, s100, 2
    s_add_u32 s100, s100, 2
    s_min_u32 s96, s96, s100
    v_readlane_b32 s100, v7, 3
    s_lshl_b32 s100, s100, 2
    s_add_u32 s100, s100, 3
    s_min_u32 s96, s96, s100
    s_cmp_ge_u32 s96, 64
    s_cselect_b32 s96, 128, s96
    s_cmp_lt_u32 s20, s96
    s_cbranch_scc1 R3s_r0_w
    s_sleep 8
    s_branch R3s_r0
R3s_r0_to:
    s_mov_b32 s19, 0
    s_mov_b32 s96, 128
    s_waitcnt vmcnt(0)
    s_branch R3s_r0_w
R3s_r0_w:
    v_lshlrev_b32 v30, 1, v0
    buffer_load_dword v7, v30, s[4:7], s11 offen
    buffer_load_dword v7, v30, s[4:7], s12 offen
    s_add_u32 s20, s11, 262144
    buffer_load_dword v7, v30, s[4:7], s20 offen
R3s_r0_ok:
    s_mov_b32 m0, 14336
    s_nop 0
    buffer_load_dwordx4 v0, s[4:7], s11 offen offset:0 nt lds
    buffer_load_dwordx4 v0, s[4:7], s11 offen offset:1024 nt lds
    s_add_u32 s11, s11, 262144
    buffer_load_dwordx4 v[56:59], v0, s[4:7], s10 offen offset:0 sc1
    buffer_load_dwordx4 v[56:59], v0, s[4:7], s10 offen offset:0 sc1
    s_waitcnt lgkmcnt(0)
    s_barrier
    ds_write_b128 v2, v[64:67] offset:0
    ds_write_b128 v2, v[68:71] offset:1024
    ds_write_b128 v2, v[72:75] offset:2048
    ds_write_b128 v2, v[76:79] offset:3072
    ds_write_b128 v2, v[80:83] offset:4096
    ds_write_b128 v2, v[84:87] offset:5120
    ds_write_b128 v2, v[88:91] offset:6144
    ds_write_b128 v2, v[92:95] offset:7168
    ds_write_b128 v2, v[96:99] offset:8192
    ds_write_b128 v2, v[100:103] offset:9216
    ds_write_b128 v2, v[104:107] offset:10240
    ds_write_b128 v2, v[108:111] offset:11264
    ds_write_b128 v2, v[112:115] offset:12288
    ds_write_b128 v2, v[116:119] offset:13312
    ds_write_b128 v2, v[120:123] offset:14336
    ds_write_b128 v2, v[124:127] offset:15360
    s_cmp_lg_u32 s97, 0
    s_cbranch_scc1 RR_29_s3
    v_mov_b64 v[16:17], 0
    v_mov_b64 v[18:19], 0
    v_mov_b64 v[20:21], 0
    v_mov_b64 v[22:23], 0
    v_mov_b64 v[24:25], 0
    v_mov_b64 v[26:27], 0
    v_mov_b64 v[28:29], 0
    v_mov_b64 v[30:31], 0
    v_mov_b64 v[32:33], 0
    v_mov_b64 v[34:35], 0
    v_mov_b64 v[36:37], 0
    v_mov_b64 v[38:39], 0
    s_branch R3f_top
.p2align 6
    s_nop 0
R3f_pe:
    buffer_load_dwordx4 v[56:59], v0, s[4:7], s10 offen offset:0 sc1
    s_sub_u32 s99, s99, 1
    s_cbranch_scc1 R3f_pe_to
R3f_top:
    s_waitcnt vmcnt(1)
    v_fma_f32 v7, v56, v57, v58
    v_cmp_u_f32 vcc, v7, v59
    ds_write_b128 v0, v[56:59] offset:6144
    s_cbranch_vccnz R3f_pe
R3f_pe_go:
    v_smfmac_f32_16x16x64_bf16 v[16:19], v[56:59], v[64:71], v1
    buffer_load_dwordx4 v[60:63], v0, s[4:7], s10 offen offset:1024 sc1
    v_smfmac_f32_16x16x64_bf16 v[20:23], v[56:59], v[72:79], v1
    v_smfmac_f32_16x16x64_bf16 v[24:27], v[56:59], a[96:103], v1
    s_waitcnt lgkmcnt(0)
    s_barrier
    ds_read_b128 v[48:51], v0 offset:0
    v_smfmac_f32_16x16x64_bf16 v[28:31], v[56:59], a[104:111], v1
    ds_read_b128 v[52:55], v0 offset:2048
    v_smfmac_f32_16x16x64_bf16 v[32:35], v[56:59], a[224:231], v1
    v_smfmac_f32_16x16x64_bf16 v[36:39], v[56:59], a[232:239], v1
    s_waitcnt lgkmcnt(1)
    v_smfmac_f32_16x16x64_bf16 v[16:19], v[48:51], v[80:87], v1
    v_smfmac_f32_16x16x64_bf16 v[20:23], v[48:51], v[88:95], v1
    ds_read_b128 v[80:83], v0 offset:8192
    v_smfmac_f32_16x16x64_bf16 v[24:27], v[48:51], a[0:7], v1
    s_waitcnt vmcnt(1)
    ds_read_b128 v[56:59], v0 offset:4096
    v_smfmac_f32_16x16x64_bf16 v[28:31], v[48:51], a[8:15], v1
    ds_read_b128 v[84:87], v0 offset:9216
    s_waitcnt lgkmcnt(3)
    v_smfmac_f32_16x16x64_bf16 v[16:19], v[52:55], v[96:103], v1
    ds_read_b128 v[88:91], v0 offset:10240
    v_mov_b32 v12, -1
    v_smfmac_f32_16x16x64_bf16 v[20:23], v[52:55], v[104:111], v1
    v_smfmac_f32_16x16x64_bf16 v[24:27], v[52:55], a[32:39], v1
    buffer_load_dwordx4 v[40:43], v0, s[4:7], s12 offen offset:0 nt
    s_waitcnt lgkmcnt(2)
    v_smfmac_f32_16x16x64_bf16 v[28:31], v[52:55], a[40:47], v1
    s_waitcnt vmcnt(1)
    ds_write_b128 v0, v[60:63] offset:7168
    v_smfmac_f32_16x16x64_bf16 v[16:19], v[56:59], v[112:119], v1
    buffer_load_dwordx4 v[44:47], v0, s[4:7], s12 offen offset:1024 nt
    v_fma_f32 v7, v60, v61, v62
    v_smfmac_f32_16x16x64_bf16 v[20:23], v[56:59], v[120:127], v1
    v_cmp_u_f32 vcc, v7, v63
    v_smfmac_f32_16x16x64_bf16 v[24:27], v[56:59], a[64:71], v1
    v_smfmac_f32_16x16x64_bf16 v[28:31], v[56:59], a[72:79], v1
    s_cbranch_vccnz R3f_po
R3f_po_ok:
    v_smfmac_f32_16x16x64_bf16 v[32:35], v[56:59], a[192:199], v1
    buffer_store_dword v12, v6, s[4:7], s61 offen
    s_waitcnt lgkmcnt(0)
    s_barrier
    ds_read_b128 v[48:51], v0 offset:1024
    v_smfmac_f32_16x16x64_bf16 v[36:39], v[56:59], a[200:207], v1
    ds_read_b128 v[56:59], v0 offset:3072
    v_smfmac_f32_16x16x64_bf16 v[16:19], v[60:63], v[128:135], v1
    ds_read_b128 v[52:55], v0 offset:5120
    v_smfmac_f32_16x16x64_bf16 v[20:23], v[60:63], v[136:143], v1
    v_smfmac_f32_16x16x64_bf16 v[24:27], v[60:63], a[112:119], v1
    buffer_store_dword v15, v6, s[4:7], s18 offen sc1
    v_smfmac_f32_16x16x64_bf16 v[28:31], v[60:63], a[120:127], v1
    s_waitcnt lgkmcnt(2)
    ds_read_b128 v[92:95], v0 offset:11264
    v_smfmac_f32_16x16x64_bf16 v[16:19], v[48:51], v[144:151], v1
    ds_read_b128 v[96:99], v0 offset:12288
    v_smfmac_f32_16x16x64_bf16 v[20:23], v[48:51], v[152:159], v1
    s_waitcnt lgkmcnt(3)
    ds_read_b128 v[100:103], v0 offset:13312
    v_smfmac_f32_16x16x64_bf16 v[16:19], v[56:59], v[160:167], v1
    ds_read_b128 v[104:107], v0 offset:14336
    v_smfmac_f32_16x16x64_bf16 v[20:23], v[56:59], v[168:175], v1
    s_waitcnt lgkmcnt(4)
    ds_read_b128 v[108:111], v0 offset:15360
    v_smfmac_f32_16x16x64_bf16 v[16:19], v[52:55], v[176:183], v1
    v_smfmac_f32_16x16x64_bf16 v[20:23], v[52:55], v[184:191], v1
    v_smfmac_f32_16x16x64_bf16 v[24:27], v[48:51], a[16:23], v1
    ds_read_b128 v[120:123], v2 offset:32768
    v_add_f32 v16, v16, v18
    v_smfmac_f32_16x16x64_bf16 v[28:31], v[48:51], a[24:31], v1
    ds_read_b128 v[124:127], v2 offset:33792
    v_add_f32 v17, v17, v19
    v_smfmac_f32_16x16x64_bf16 v[24:27], v[56:59], a[48:55], v1
    v_add_f32 v20, v20, v22
    v_smfmac_f32_16x16x64_bf16 v[28:31], v[56:59], a[56:63], v1
    v_add_f32 v21, v21, v23
    v_smfmac_f32_16x16x64_bf16 v[24:27], v[52:55], a[80:87], v1
    v_cvt_pk_bf16_f32 v18, v16, v20
    v_smfmac_f32_16x16x64_bf16 v[28:31], v[52:55], a[88:95], v1
    v_cvt_pk_bf16_f32 v19, v17, v21
    v_smfmac_f32_16x16x64_bf16 v[32:35], v[48:51], a[144:151], v1
    ds_write2_b32 v3, v18, v19 offset0:0 offset1:136
    v_add_f32 v24, v24, v26
    v_smfmac_f32_16x16x64_bf16 v[36:39], v[48:51], a[152:159], v1
    ds_read_b128 v[48:51], v0 offset:0
    v_add_f32 v25, v25, v27
    v_add_f32 v28, v28, v30
    v_add_f32 v29, v29, v31
    v_cvt_pk_bf16_f32 v128, v24, v28
    v_cvt_pk_bf16_f32 v129, v25, v29
    v_smfmac_f32_16x16x64_bf16 v[32:35], v[52:55], a[208:215], v1
    ds_write2_b32 v3, v128, v129 offset0:64 offset1:200
    v_smfmac_f32_16x16x64_bf16 v[36:39], v[52:55], a[216:223], v1
    ds_read_b128 v[52:55], v0 offset:2048
    v_smfmac_f32_16x16x64_bf16 v[32:35], v[60:63], a[240:247], v1
    v_smfmac_f32_16x16x64_bf16 v[36:39], v[60:63], a[248:255], v1
    v_smfmac_f32_16x16x64_bf16 v[32:35], v[56:59], a[176:183], v1
    s_waitcnt lgkmcnt(1)
    s_barrier
    ds_read_b128 v[64:67], v4 offset:0
    v_smfmac_f32_16x16x64_bf16 v[36:39], v[56:59], a[184:191], v1
    ds_read_b128 v[68:71], v4 offset:64
    ds_read_b128 v[112:115], v4 offset:256
    v_smfmac_f32_16x16x64_bf16 v[32:35], v[48:51], a[128:135], v1
    ds_read_b128 v[116:119], v4 offset:320
    ds_read_b128 v[72:75], v4 offset:128
    s_waitcnt lgkmcnt(5)
    ds_read_b128 v[76:79], v4 offset:192
    s_waitcnt lgkmcnt(5)
    v_mfma_f32_16x16x32_bf16 v[16:19], v[80:83], v[64:67], 0
    v_mfma_f32_16x16x32_bf16 v[20:23], v[96:99], v[64:67], 0
    s_waitcnt lgkmcnt(4)
    v_mfma_f32_16x16x32_bf16 v[16:19], v[84:87], v[68:71], v[16:19]
    v_mov_b64 v[56:57], s[58:59]
    v_mov_b64 v[58:59], s[58:59]
    v_mfma_f32_16x16x32_bf16 v[20:23], v[100:103], v[68:71], v[20:23]
    s_waitcnt lgkmcnt(2)
    v_mfma_f32_16x16x32_bf16 v[24:27], v[112:115], v[64:67], 0
    v_mfma_f32_16x16x32_bf16 v[24:27], v[116:119], v[68:71], v[24:27]
    s_waitcnt lgkmcnt(1)
    v_mfma_f32_16x16x32_bf16 v[16:19], v[88:91], v[72:75], v[16:19]
    buffer_load_dwordx4 v0, s[4:7], s11 offen offset:0 nt lds
    ds_read_b128 v[80:83], v2 offset:22528
    v_mfma_f32_16x16x32_bf16 v[20:23], v[104:107], v[72:75], v[20:23]
    buffer_load_dwordx4 v0, s[4:7], s11 offen offset:1024 nt lds
    s_waitcnt lgkmcnt(1)
    ds_read_b128 v[84:87], v2 offset:23552
    v_mfma_f32_16x16x32_bf16 v[16:19], v[92:95], v[76:79], v[16:19]
    ds_read_b128 v[64:67], v2 offset:18432
    v_add_f32_dpp v24, v26, v24 quad_perm:[2,3,0,1] row_mask:0xf bank_mask:0xf
    v_add_f32_dpp v25, v27, v25 quad_perm:[2,3,0,1] row_mask:0xf bank_mask:0xf
    v_mfma_f32_16x16x32_bf16 v[20:23], v[108:111], v[76:79], v[20:23]
    ds_read_b128 v[68:71], v2 offset:19456
    v_max_f32 v132, v24, v25
    v_smfmac_f32_16x16x64_bf16 v[36:39], v[48:51], a[136:143], v1
    ds_read_b128 v[88:91], v2 offset:24576
    ds_read_b128 v[72:75], v2 offset:20480
    v_max3_f32 v132, v132, v16, v17
    v_max3_f32 v132, v132, v18, v19
    v_max3_f32 v134, v132, v20, v21
    v_max3_f32 v132, v134, v22, v23
    v_max3_f32 v133, v134, v22, v23
    v_smfmac_f32_16x16x64_bf16 v[32:35], v[52:55], a[160:167], v1
    ds_read_b128 v[92:95], v2 offset:25600
    ds_read_b128 v[96:99], v2 offset:26624
    v_permlane16_swap_b32 v132, v133
    v_max_f32 v134, v132, v133
    v_max_f32 v135, v132, v133
    v_smfmac_f32_16x16x64_bf16 v[36:39], v[52:55], a[168:175], v1
    ds_read_b128 v[100:103], v2 offset:27648
    v_permlane32_swap_b32 v134, v135
    v_max_f32 v132, v134, v135
    v_fma_f32 v132, v132, s56, v14
    v_pk_fma_f32 v[24:25], v[24:25], s[56:57], v[132:133] op_sel_hi:[1,1,0] neg_lo:[0,0,1] neg_hi:[0,0,1]
    v_pk_fma_f32 v[16:17], v[16:17], s[56:57], v[132:133] op_sel_hi:[1,1,0] neg_lo:[0,0,1] neg_hi:[0,0,1]
    v_pk_fma_f32 v[18:19], v[18:19], s[56:57], v[132:133] op_sel_hi:[1,1,0] neg_lo:[0,0,1] neg_hi:[0,0,1]
    v_pk_fma_f32 v[20:21], v[20:21], s[56:57], v[132:133] op_sel_hi:[1,1,0] neg_lo:[0,0,1] neg_hi:[0,0,1]
    v_pk_fma_f32 v[22:23], v[22:23], s[56:57], v[132:133] op_sel_hi:[1,1,0] neg_lo:[0,0,1] neg_hi:[0,0,1]
    v_pk_add_f32 v[32:33], v[32:33], v[34:35]
    v_pk_add_f32 v[36:37], v[36:37], v[38:39]
    v_cvt_pk_bf16_f32 v130, v32, v33
    v_cvt_pk_bf16_f32 v131, v36, v37
    v_exp_f32 v24, v24
    v_exp_f32 v25, v25
    v_exp_f32 v16, v16
    v_cvt_pk_bf16_f32 v12, v24, v25
    v_exp_f32 v17, v17
    v_exp_f32 v18, v18
    v_mov_b32_dpp v13, v12 quad_perm:[2,3,0,1] row_mask:0xf bank_mask:0xf
    v_exp_f32 v19, v19
    v_cvt_pk_bf16_f32 v28, v16, v17
    v_mfma_f32_16x16x16_bf16 v[60:63], v[56:57], v[12:13], 0
    ds_read_b128 v[76:79], v2 offset:21504
    v_exp_f32 v20, v20
    v_cvt_pk_bf16_f32 v29, v18, v19
    v_mfma_f32_16x16x16_bf16 v[48:51], v[130:131], v[12:13], 0
    s_waitcnt vmcnt(4)
    v_exp_f32 v21, v21
    v_exp_f32 v22, v22
    v_exp_f32 v23, v23
    v_cvt_pk_bf16_f32 v30, v20, v21
    v_cvt_pk_bf16_f32 v31, v22, v23
    v_mov_b32_dpp v16, v28 quad_perm:[2,3,0,1] row_mask:0xf bank_mask:0xf
    v_mov_b32_dpp v17, v29 quad_perm:[2,3,0,1] row_mask:0xf bank_mask:0xf
    v_mfma_f32_16x16x32_bf16 v[60:63], v[56:59], v[28:31], v[60:63]
    v_mov_b32_dpp v18, v30 quad_perm:[2,3,0,1] row_mask:0xf bank_mask:0xf
    v_mov_b32_dpp v19, v31 quad_perm:[2,3,0,1] row_mask:0xf bank_mask:0xf
    v_mfma_f32_16x16x32_bf16 v[48:51], v[40:43], v[28:31], v[48:51]
    v_mov_b64 v[24:25], 0
    v_mov_b64 v[26:27], 0
    v_mfma_f32_16x16x32_bf16 v[48:51], v[44:47], v[16:19], v[48:51]
    v_rcp_f32_dpp v132, v60 quad_perm:[0,1,0,1] row_mask:0xf bank_mask:0xf
    v_mov_b64 v[20:21], 0
    v_mov_b64 v[22:23], 0
    v_mov_b64 v[16:17], 0
    v_mov_b64 v[18:19], 0
    v_mov_b64 v[28:29], 0
    v_pk_mul_f32 v[48:49], v[48:49], v[132:133] op_sel_hi:[1,0]
    v_pk_mul_f32 v[50:51], v[50:51], v[132:133] op_sel_hi:[1,0]
    v_cvt_pk_bf16_f32 v134, v48, v49
    v_cvt_pk_bf16_f32 v135, v50, v51
    ds_write_b64 v0, v[134:135] offset:23048
    v_mov_b64 v[30:31], 0
    v_mov_b64 v[48:49], 0
    v_mov_b64 v[50:51], 0
    v_mov_b64 v[32:33], 0
    v_mov_b64 v[34:35], 0
    v_mov_b64 v[36:37], 0
    v_mov_b64 v[38:39], 0
    v_mov_b64 v[52:53], 0
    v_mov_b64 v[54:55], 0
    s_add_u32 s11, s11, 262144
    s_add_u32 s12, s12, 262144
    s_add_u32 s9, s9, 1
    s_waitcnt lgkmcnt(0)
    s_barrier
    ds_read_b128 v[56:59], v0 offset:22016
    ds_read_b128 v[60:63], v0 offset:23040
    s_add_u32 s10, s10, 8192
    s_and_b32 s10, s10, 0xffff7fff
    s_add_u32 s13, s13, 262144
    s_add_u32 s18, s18, 8192
    s_xor_b32 s61, s17, 16384
    s_waitcnt lgkmcnt(1)
    v_smfmac_f32_16x16x64_bf16 v[16:19], v[56:59], v[192:199], v1
    v_smfmac_f32_16x16x64_bf16 v[20:23], v[56:59], v[208:215], v1
    s_waitcnt lgkmcnt(0)
    v_smfmac_f32_16x16x64_bf16 v[16:19], v[60:63], v[200:207], v1
    ds_read_b128 v[104:107], v2 offset:28672
    v_smfmac_f32_16x16x64_bf16 v[20:23], v[60:63], v[216:223], v1
    ds_read_b128 v[108:111], v2 offset:29696
    v_smfmac_f32_16x16x64_bf16 v[24:27], v[56:59], v[224:231], v1
    ds_read_b128 v[112:115], v2 offset:30720
    v_add_f32 v16, v16, v18
    v_smfmac_f32_16x16x64_bf16 v[24:27], v[60:63], v[232:239], v1
    ds_read_b128 v[116:119], v2 offset:31744
    v_add_f32 v20, v20, v22
    v_smfmac_f32_16x16x64_bf16 v[28:31], v[56:59], v[240:247], v1
    v_add_f32 v17, v17, v19
    v_smfmac_f32_16x16x64_bf16 v[28:31], v[60:63], v[248:255], v1
    v_add_f32 v21, v21, v23
    v_smfmac_f32_16x16x64_bf16 v[32:35], v[56:59], v[64:71], v1
    v_cvt_pk_bf16_f32 v16, v16, v20
    v_bfi_b32 v16, 1, s21, v16
    v_cvt_pk_bf16_f32 v17, v17, v21
    v_add_f32 v24, v24, v26
    v_add_f32 v25, v25, v27
    v_add_f32 v28, v28, v30
    v_add_f32 v29, v29, v31
    v_cvt_pk_bf16_f32 v18, v24, v28
    v_cvt_pk_bf16_f32 v19, v25, v29
    v_smfmac_f32_16x16x64_bf16 v[32:35], v[60:63], v[72:79], v1
    buffer_store_dwordx4 v[16:19], v5, s[4:7], s14 offen
    v_smfmac_f32_16x16x64_bf16 v[36:39], v[56:59], v[80:87], v1
    v_smfmac_f32_16x16x64_bf16 v[36:39], v[60:63], v[88:95], v1
    s_waitcnt lgkmcnt(0)
    v_add_f32 v32, v32, v34
    v_smfmac_f32_16x16x64_bf16 v[48:51], v[56:59], v[96:103], v1
    v_add_f32 v33, v33, v35
    v_smfmac_f32_16x16x64_bf16 v[48:51], v[60:63], v[104:111], v1
    v_add_f32 v36, v36, v38
    v_smfmac_f32_16x16x64_bf16 v[52:55], v[56:59], v[112:119], v1
    v_add_f32 v37, v37, v39
    v_smfmac_f32_16x16x64_bf16 v[52:55], v[60:63], v[120:127], v1
    v_cvt_pk_bf16_f32 v32, v32, v36
    v_bfi_b32 v32, 1, s21, v32
    v_cvt_pk_bf16_f32 v33, v33, v37
    v_add_f32 v48, v48, v50
    v_add_f32 v49, v49, v51
    s_nop 1
    v_add_f32 v52, v52, v54
    v_add_f32 v53, v53, v55
    v_cvt_pk_bf16_f32 v34, v48, v52
    v_cvt_pk_bf16_f32 v35, v49, v53
    buffer_store_dwordx4 v[32:35], v5, s[4:7], s15 offen
    v_mov_b64 v[16:17], 0
    v_mov_b64 v[18:19], 0
    v_mov_b64 v[20:21], 0
    v_mov_b64 v[22:23], 0
    v_mov_b64 v[24:25], 0
    v_mov_b64 v[26:27], 0
    v_mov_b64 v[28:29], 0
    v_mov_b64 v[30:31], 0
    v_mov_b64 v[32:33], 0
    v_mov_b64 v[34:35], 0
    v_mov_b64 v[36:37], 0
    v_mov_b64 v[38:39], 0
    ds_read_b128 v[64:67], v2 offset:0
    ds_read_b128 v[68:71], v2 offset:1024
    ds_read_b128 v[72:75], v2 offset:2048
    ds_read_b128 v[76:79], v2 offset:3072
    ds_read_b128 v[80:83], v2 offset:4096
    ds_read_b128 v[84:87], v2 offset:5120
    ds_read_b128 v[88:91], v2 offset:6144
    ds_read_b128 v[92:95], v2 offset:7168
    s_waitcnt vmcnt(0)
    buffer_load_dwordx4 v[56:59], v0, s[4:7], s16 offen offset:0 sc1
    buffer_load_dwordx4 v[60:63], v0, s[4:7], s16 offen offset:1024 sc1
    ds_read_b128 v[96:99], v2 offset:8192
    ds_read_b128 v[100:103], v2 offset:9216
    ds_read_b128 v[104:107], v2 offset:10240
    ds_read_b128 v[108:111], v2 offset:11264
    ds_read_b128 v[112:115], v2 offset:12288
    ds_read_b128 v[116:119], v2 offset:13312
    s_waitcnt lgkmcnt(0)
    buffer_load_dwordx4 v[40:43], v0, s[4:7], s16 offen offset:0 sc1
    buffer_load_dwordx4 v[44:47], v0, s[4:7], s16 offen offset:1024 sc1
    s_waitcnt vmcnt(3)
    v_mfma_f32_16x16x32_bf16 v[48:51], v[8:11], v[56:59], 0
    s_waitcnt vmcnt(2)
    v_mfma_f32_16x16x32_bf16 v[48:51], v[8:11], v[60:63], v[48:51]
    v_and_b32 v13, 1, v56
    v_and_b32 v12, 1, v60
    v_add_u32 v12, v13, v12
    v_cmp_ne_u32 vcc, s60, v12
    s_nop 2
    v_add_f32_dpp v48, v48, v48 row_ror:4 row_mask:0xf bank_mask:0xf
    v_add_f32_dpp v49, v49, v49 row_ror:4 row_mask:0xf bank_mask:0xf
    s_cbranch_vccnz R3f_p1
    v_add_f32_dpp v48, v48, v48 row_ror:8 row_mask:0xf bank_mask:0xf
    v_add_f32_dpp v49, v49, v49 row_ror:8 row_mask:0xf bank_mask:0xf
    v_cvt_pk_bf16_f32 v15, v48, v49
    buffer_store_dword v15, v6, s[4:7], s17 offen
R3f_p1_ok:
    buffer_load_dwordx4 v[56:59], v0, s[4:7], s10 offen offset:0 sc1
    s_cmp_eq_u32 s9, 63
    s_cbranch_scc1 R3f_fin
    s_xor_b32 s14, s14, 262144
    s_xor_b32 s15, s15, 262144
    s_add_u32 s17, s17, 8192
    s_and_b32 s17, s17, 0xffff7fff
    s_xor_b32 s16, s16, 262144
    s_min_u32 s99, s19, 31
    s_and_b32 s60, s9, 2
    s_lshr_b32 s21, s60, 1
    ds_read_b128 v[120:123], v2 offset:14336
    ds_read_b128 v[124:127], v2 offset:15360
    ds_read_b128 v[128:131], v2 offset:16384
    ds_read_b128 v[132:135], v2 offset:17408
    s_waitcnt lgkmcnt(0)
    buffer_load_dwordx4 v[56:59], v0, s[4:7], s10 offen offset:0 sc1
    s_branch R3f_top
R3f_pe_to:
    s_mov_b32 s99, 31
    s_waitcnt vmcnt(0)
    v_max3_u32 v7, v56, v57, v58
    v_max_u32 v7, v7, v59
    v_cmp_eq_u32 vcc, -1, v7
    ds_write_b128 v0, v[56:59] offset:6144
    s_cbranch_vccz R3f_pe_go
    s_sub_u32 s19, s19, 32
    s_cbranch_scc0 R3f_pe
    s_mov_b32 s19, 0
    s_mov_b32 s99, 0
    s_branch R3f_pe_go
R3f_po:
    buffer_load_dwordx4 v[60:63], v0, s[4:7], s10 offen offset:1024 sc1
    s_sub_u32 s19, s19, 1
    s_cbranch_scc1 R3f_po_to
    s_waitcnt vmcnt(0)
    ds_write_b128 v0, v[60:63] offset:7168
    v_max3_u32 v7, v60, v61, v62
    v_max_u32 v7, v7, v63
    v_cmp_eq_u32 vcc, -1, v7
    s_cbranch_vccnz R3f_po
    s_branch R3f_po_ok
R3f_po_to:
    s_mov_b32 s19, 0
    s_waitcnt vmcnt(0)
    ds_write_b128 v0, v[60:63] offset:7168
    s_branch R3f_po_ok
R3f_p1:
    buffer_load_dwordx4 v[56:59], v0, s[4:7], s16 offen offset:0 sc1
    buffer_load_dwordx4 v[60:63], v0, s[4:7], s16 offen offset:1024 sc1
    s_waitcnt vmcnt(3)
    v_mfma_f32_16x16x32_bf16 v[48:51], v[8:11], v[40:43], 0
    s_waitcnt vmcnt(2)
    v_mfma_f32_16x16x32_bf16 v[48:51], v[8:11], v[44:47], v[48:51]
    v_and_b32 v13, 1, v40
    v_and_b32 v12, 1, v44
    v_add_u32 v12, v13, v12
    v_cmp_ne_u32 vcc, s60, v12
    s_nop 2
    v_add_f32_dpp v48, v48, v48 row_ror:4 row_mask:0xf bank_mask:0xf
    v_add_f32_dpp v49, v49, v49 row_ror:4 row_mask:0xf bank_mask:0xf
    s_cbranch_vccnz R3f_p1b
    v_add_f32_dpp v48, v48, v48 row_ror:8 row_mask:0xf bank_mask:0xf
    v_add_f32_dpp v49, v49, v49 row_ror:8 row_mask:0xf bank_mask:0xf
    v_cvt_pk_bf16_f32 v15, v48, v49
    buffer_store_dword v15, v6, s[4:7], s17 offen
    s_branch R3f_p1_ok
R3f_p1b:
    buffer_load_dwordx4 v[40:43], v0, s[4:7], s16 offen offset:0 sc1
    buffer_load_dwordx4 v[44:47], v0, s[4:7], s16 offen offset:1024 sc1
    s_sub_u32 s19, s19, 1
    s_cbranch_scc1 R3f_p1_to
    s_waitcnt vmcnt(3)
    v_mfma_f32_16x16x32_bf16 v[48:51], v[8:11], v[56:59], 0
    s_waitcnt vmcnt(2)
    v_mfma_f32_16x16x32_bf16 v[48:51], v[8:11], v[60:63], v[48:51]
    v_and_b32 v13, 1, v56
    v_and_b32 v12, 1, v60
    v_add_u32 v12, v13, v12
    v_cmp_ne_u32 vcc, s60, v12
    s_nop 2
    v_add_f32_dpp v48, v48, v48 row_ror:4 row_mask:0xf bank_mask:0xf
    v_add_f32_dpp v49, v49, v49 row_ror:4 row_mask:0xf bank_mask:0xf
    s_cbranch_vccnz R3f_p1
    v_add_f32_dpp v48, v48, v48 row_ror:8 row_mask:0xf bank_mask:0xf
    v_add_f32_dpp v49, v49, v49 row_ror:8 row_mask:0xf bank_mask:0xf
    v_cvt_pk_bf16_f32 v15, v48, v49
    buffer_store_dword v15, v6, s[4:7], s17 offen
    s_branch R3f_p1_ok
R3f_p1_to:
    s_mov_b32 s19, 0
    v_add_f32_dpp v48, v48, v48 row_ror:8 row_mask:0xf bank_mask:0xf
    v_add_f32_dpp v49, v49, v49 row_ror:8 row_mask:0xf bank_mask:0xf
    v_cvt_pk_bf16_f32 v15, v48, v49
    buffer_store_dword v15, v6, s[4:7], s17 offen
    s_branch R3f_p1_ok
R3f_fin:
    buffer_store_dword v15, v6, s[4:7], s18 offen sc1
    s_waitcnt vmcnt(0)
    buffer_wbl2 sc1
    s_branch L_end
RR_29_s3:
    v_mov_b64 v[16:17], 0
    v_mov_b64 v[18:19], 0
    v_mov_b64 v[20:21], 0
    v_mov_b64 v[22:23], 0
    v_mov_b64 v[24:25], 0
    v_mov_b64 v[26:27], 0
    v_mov_b64 v[28:29], 0
    v_mov_b64 v[30:31], 0
    v_mov_b64 v[32:33], 0
    v_mov_b64 v[34:35], 0
    v_mov_b64 v[36:37], 0
    v_mov_b64 v[38:39], 0
    s_branch R3s_top
.p2align 6
    s_nop 0
R3s_pe:
    buffer_load_dwordx4 v[56:59], v0, s[4:7], s10 offen offset:0 sc1
    s_sub_u32 s99, s99, 1
    s_cbranch_scc1 R3s_pe_to
R3s_top:
    s_waitcnt vmcnt(1)
    v_fma_f32 v7, v56, v57, v58
    v_cmp_u_f32 vcc, v7, v59
    ds_write_b128 v0, v[56:59] offset:6144
    s_cbranch_vccnz R3s_pe
R3s_pe_go:
    v_smfmac_f32_16x16x64_bf16 v[16:19], v[56:59], v[64:71], v1
    buffer_load_dwordx4 v[60:63], v0, s[4:7], s10 offen offset:1024 sc1
    v_smfmac_f32_16x16x64_bf16 v[20:23], v[56:59], v[72:79], v1
    v_smfmac_f32_16x16x64_bf16 v[24:27], v[56:59], a[96:103], v1
    s_waitcnt lgkmcnt(0)
    s_barrier
    ds_read_b128 v[48:51], v0 offset:0
    v_smfmac_f32_16x16x64_bf16 v[28:31], v[56:59], a[104:111], v1
    ds_read_b128 v[52:55], v0 offset:2048
    v_smfmac_f32_16x16x64_bf16 v[32:35], v[56:59], a[224:231], v1
    v_smfmac_f32_16x16x64_bf16 v[36:39], v[56:59], a[232:239], v1
    s_waitcnt lgkmcnt(1)
    v_smfmac_f32_16x16x64_bf16 v[16:19], v[48:51], v[80:87], v1
    v_smfmac_f32_16x16x64_bf16 v[20:23], v[48:51], v[88:95], v1
    ds_read_b128 v[80:83], v0 offset:8192
    v_smfmac_f32_16x16x64_bf16 v[24:27], v[48:51], a[0:7], v1
    s_waitcnt vmcnt(1)
    ds_read_b128 v[56:59], v0 offset:4096
    v_smfmac_f32_16x16x64_bf16 v[28:31], v[48:51], a[8:15], v1
    ds_read_b128 v[84:87], v0 offset:9216
    s_waitcnt lgkmcnt(3)
    v_smfmac_f32_16x16x64_bf16 v[16:19], v[52:55], v[96:103], v1
    ds_read_b128 v[88:91], v0 offset:10240
    v_mov_b32 v12, -1
    v_smfmac_f32_16x16x64_bf16 v[20:23], v[52:55], v[104:111], v1
    v_smfmac_f32_16x16x64_bf16 v[24:27], v[52:55], a[32:39], v1
    buffer_load_dwordx4 v[40:43], v0, s[4:7], s12 offen offset:0 nt
    s_waitcnt lgkmcnt(2)
    v_smfmac_f32_16x16x64_bf16 v[28:31], v[52:55], a[40:47], v1
    s_waitcnt vmcnt(1)
    ds_write_b128 v0, v[60:63] offset:7168
    v_smfmac_f32_16x16x64_bf16 v[16:19], v[56:59], v[112:119], v1
    buffer_load_dwordx4 v[44:47], v0, s[4:7], s12 offen offset:1024 nt
    v_fma_f32 v7, v60, v61, v62
    v_smfmac_f32_16x16x64_bf16 v[20:23], v[56:59], v[120:127], v1
    v_cmp_u_f32 vcc, v7, v63
    v_smfmac_f32_16x16x64_bf16 v[24:27], v[56:59], a[64:71], v1
    v_smfmac_f32_16x16x64_bf16 v[28:31], v[56:59], a[72:79], v1
    s_cbranch_vccnz R3s_po
R3s_po_ok:
    v_smfmac_f32_16x16x64_bf16 v[32:35], v[56:59], a[192:199], v1
    buffer_store_dword v12, v6, s[4:7], s61 offen sc1
    s_waitcnt lgkmcnt(0)
    s_barrier
    ds_read_b128 v[48:51], v0 offset:1024
    v_smfmac_f32_16x16x64_bf16 v[36:39], v[56:59], a[200:207], v1
    ds_read_b128 v[56:59], v0 offset:3072
    v_smfmac_f32_16x16x64_bf16 v[16:19], v[60:63], v[128:135], v1
    ds_read_b128 v[52:55], v0 offset:5120
    v_smfmac_f32_16x16x64_bf16 v[20:23], v[60:63], v[136:143], v1
    v_smfmac_f32_16x16x64_bf16 v[24:27], v[60:63], a[112:119], v1
    buffer_store_dword v15, v6, s[4:7], s18 offen sc1
    v_smfmac_f32_16x16x64_bf16 v[28:31], v[60:63], a[120:127], v1
    s_waitcnt lgkmcnt(2)
    ds_read_b128 v[92:95], v0 offset:11264
    v_smfmac_f32_16x16x64_bf16 v[16:19], v[48:51], v[144:151], v1
    ds_read_b128 v[96:99], v0 offset:12288
    v_smfmac_f32_16x16x64_bf16 v[20:23], v[48:51], v[152:159], v1
    s_waitcnt lgkmcnt(3)
    ds_read_b128 v[100:103], v0 offset:13312
    v_smfmac_f32_16x16x64_bf16 v[16:19], v[56:59], v[160:167], v1
    ds_read_b128 v[104:107], v0 offset:14336
    v_smfmac_f32_16x16x64_bf16 v[20:23], v[56:59], v[168:175], v1
    s_waitcnt lgkmcnt(4)
    ds_read_b128 v[108:111], v0 offset:15360
    v_smfmac_f32_16x16x64_bf16 v[16:19], v[52:55], v[176:183], v1
    v_smfmac_f32_16x16x64_bf16 v[20:23], v[52:55], v[184:191], v1
    v_smfmac_f32_16x16x64_bf16 v[24:27], v[48:51], a[16:23], v1
    ds_read_b128 v[120:123], v2 offset:32768
    v_add_f32 v16, v16, v18
    v_smfmac_f32_16x16x64_bf16 v[28:31], v[48:51], a[24:31], v1
    ds_read_b128 v[124:127], v2 offset:33792
    v_add_f32 v17, v17, v19
    v_smfmac_f32_16x16x64_bf16 v[24:27], v[56:59], a[48:55], v1
    v_add_f32 v20, v20, v22
    v_smfmac_f32_16x16x64_bf16 v[28:31], v[56:59], a[56:63], v1
    v_add_f32 v21, v21, v23
    v_smfmac_f32_16x16x64_bf16 v[24:27], v[52:55], a[80:87], v1
    v_cvt_pk_bf16_f32 v18, v16, v20
    v_smfmac_f32_16x16x64_bf16 v[28:31], v[52:55], a[88:95], v1
    v_cvt_pk_bf16_f32 v19, v17, v21
    v_smfmac_f32_16x16x64_bf16 v[32:35], v[48:51], a[144:151], v1
    ds_write2_b32 v3, v18, v19 offset0:0 offset1:136
    v_add_f32 v24, v24, v26
    v_smfmac_f32_16x16x64_bf16 v[36:39], v[48:51], a[152:159], v1
    ds_read_b128 v[48:51], v0 offset:0
    v_add_f32 v25, v25, v27
    v_add_f32 v28, v28, v30
    v_add_f32 v29, v29, v31
    v_cvt_pk_bf16_f32 v128, v24, v28
    v_cvt_pk_bf16_f32 v129, v25, v29
    v_smfmac_f32_16x16x64_bf16 v[32:35], v[52:55], a[208:215], v1
    ds_write2_b32 v3, v128, v129 offset0:64 offset1:200
    v_smfmac_f32_16x16x64_bf16 v[36:39], v[52:55], a[216:223], v1
    ds_read_b128 v[52:55], v0 offset:2048
    v_smfmac_f32_16x16x64_bf16 v[32:35], v[60:63], a[240:247], v1
    v_smfmac_f32_16x16x64_bf16 v[36:39], v[60:63], a[248:255], v1
    v_smfmac_f32_16x16x64_bf16 v[32:35], v[56:59], a[176:183], v1
    s_waitcnt lgkmcnt(1)
    s_barrier
    ds_read_b128 v[64:67], v4 offset:0
    v_smfmac_f32_16x16x64_bf16 v[36:39], v[56:59], a[184:191], v1
    ds_read_b128 v[68:71], v4 offset:64
    ds_read_b128 v[112:115], v4 offset:256
    v_smfmac_f32_16x16x64_bf16 v[32:35], v[48:51], a[128:135], v1
    ds_read_b128 v[116:119], v4 offset:320
    ds_read_b128 v[72:75], v4 offset:128
    s_waitcnt lgkmcnt(5)
    ds_read_b128 v[76:79], v4 offset:192
    s_waitcnt lgkmcnt(5)
    v_mfma_f32_16x16x32_bf16 v[16:19], v[80:83], v[64:67], 0
    v_mfma_f32_16x16x32_bf16 v[20:23], v[96:99], v[64:67], 0
    s_waitcnt lgkmcnt(4)
    v_mfma_f32_16x16x32_bf16 v[16:19], v[84:87], v[68:71], v[16:19]
    v_mov_b64 v[56:57], s[58:59]
    v_mov_b64 v[58:59], s[58:59]
    v_mfma_f32_16x16x32_bf16 v[20:23], v[100:103], v[68:71], v[20:23]
    s_waitcnt lgkmcnt(2)
    v_mfma_f32_16x16x32_bf16 v[24:27], v[112:115], v[64:67], 0
    v_mfma_f32_16x16x32_bf16 v[24:27], v[116:119], v[68:71], v[24:27]
    s_waitcnt lgkmcnt(1)
    v_mfma_f32_16x16x32_bf16 v[16:19], v[88:91], v[72:75], v[16:19]
    buffer_load_dwordx4 v0, s[4:7], s11 offen offset:0 nt lds
    ds_read_b128 v[80:83], v2 offset:22528
    v_mfma_f32_16x16x32_bf16 v[20:23], v[104:107], v[72:75], v[20:23]
    buffer_load_dwordx4 v0, s[4:7], s11 offen offset:1024 nt lds
    s_waitcnt lgkmcnt(1)
    ds_read_b128 v[84:87], v2 offset:23552
    v_mfma_f32_16x16x32_bf16 v[16:19], v[92:95], v[76:79], v[16:19]
    ds_read_b128 v[64:67], v2 offset:18432
    v_add_f32_dpp v24, v26, v24 quad_perm:[2,3,0,1] row_mask:0xf bank_mask:0xf
    v_add_f32_dpp v25, v27, v25 quad_perm:[2,3,0,1] row_mask:0xf bank_mask:0xf
    v_mfma_f32_16x16x32_bf16 v[20:23], v[108:111], v[76:79], v[20:23]
    ds_read_b128 v[68:71], v2 offset:19456
    v_max_f32 v132, v24, v25
    v_smfmac_f32_16x16x64_bf16 v[36:39], v[48:51], a[136:143], v1
    ds_read_b128 v[88:91], v2 offset:24576
    ds_read_b128 v[72:75], v2 offset:20480
    v_max3_f32 v132, v132, v16, v17
    v_max3_f32 v132, v132, v18, v19
    v_max3_f32 v134, v132, v20, v21
    v_max3_f32 v132, v134, v22, v23
    v_max3_f32 v133, v134, v22, v23
    v_smfmac_f32_16x16x64_bf16 v[32:35], v[52:55], a[160:167], v1
    ds_read_b128 v[92:95], v2 offset:25600
    ds_read_b128 v[96:99], v2 offset:26624
    v_permlane16_swap_b32 v132, v133
    v_max_f32 v134, v132, v133
    v_max_f32 v135, v132, v133
    v_smfmac_f32_16x16x64_bf16 v[36:39], v[52:55], a[168:175], v1
    ds_read_b128 v[100:103], v2 offset:27648
    v_permlane32_swap_b32 v134, v135
    v_max_f32 v132, v134, v135
    v_fma_f32 v132, v132, s56, v14
    v_pk_fma_f32 v[24:25], v[24:25], s[56:57], v[132:133] op_sel_hi:[1,1,0] neg_lo:[0,0,1] neg_hi:[0,0,1]
    v_pk_fma_f32 v[16:17], v[16:17], s[56:57], v[132:133] op_sel_hi:[1,1,0] neg_lo:[0,0,1] neg_hi:[0,0,1]
    v_pk_fma_f32 v[18:19], v[18:19], s[56:57], v[132:133] op_sel_hi:[1,1,0] neg_lo:[0,0,1] neg_hi:[0,0,1]
    v_pk_fma_f32 v[20:21], v[20:21], s[56:57], v[132:133] op_sel_hi:[1,1,0] neg_lo:[0,0,1] neg_hi:[0,0,1]
    v_pk_fma_f32 v[22:23], v[22:23], s[56:57], v[132:133] op_sel_hi:[1,1,0] neg_lo:[0,0,1] neg_hi:[0,0,1]
    v_pk_add_f32 v[32:33], v[32:33], v[34:35]
    v_pk_add_f32 v[36:37], v[36:37], v[38:39]
    v_cvt_pk_bf16_f32 v130, v32, v33
    v_cvt_pk_bf16_f32 v131, v36, v37
    v_exp_f32 v24, v24
    v_exp_f32 v25, v25
    v_exp_f32 v16, v16
    v_cvt_pk_bf16_f32 v12, v24, v25
    v_exp_f32 v17, v17
    v_exp_f32 v18, v18
    v_mov_b32_dpp v13, v12 quad_perm:[2,3,0,1] row_mask:0xf bank_mask:0xf
    v_exp_f32 v19, v19
    v_cvt_pk_bf16_f32 v28, v16, v17
    v_mfma_f32_16x16x16_bf16 v[60:63], v[56:57], v[12:13], 0
    ds_read_b128 v[76:79], v2 offset:21504
    v_exp_f32 v20, v20
    v_cvt_pk_bf16_f32 v29, v18, v19
    v_mfma_f32_16x16x16_bf16 v[48:51], v[130:131], v[12:13], 0
    s_waitcnt vmcnt(4)
    v_exp_f32 v21, v21
    v_exp_f32 v22, v22
    v_exp_f32 v23, v23
    v_cvt_pk_bf16_f32 v30, v20, v21
    v_cvt_pk_bf16_f32 v31, v22, v23
    v_mov_b32_dpp v16, v28 quad_perm:[2,3,0,1] row_mask:0xf bank_mask:0xf
    v_mov_b32_dpp v17, v29 quad_perm:[2,3,0,1] row_mask:0xf bank_mask:0xf
    v_mfma_f32_16x16x32_bf16 v[60:63], v[56:59], v[28:31], v[60:63]
    v_mov_b32_dpp v18, v30 quad_perm:[2,3,0,1] row_mask:0xf bank_mask:0xf
    v_mov_b32_dpp v19, v31 quad_perm:[2,3,0,1] row_mask:0xf bank_mask:0xf
    v_mfma_f32_16x16x32_bf16 v[48:51], v[40:43], v[28:31], v[48:51]
    v_mov_b64 v[24:25], 0
    v_mov_b64 v[26:27], 0
    v_mfma_f32_16x16x32_bf16 v[48:51], v[44:47], v[16:19], v[48:51]
    v_rcp_f32_dpp v132, v60 quad_perm:[0,1,0,1] row_mask:0xf bank_mask:0xf
    v_mov_b64 v[20:21], 0
    v_mov_b64 v[22:23], 0
    v_mov_b64 v[16:17], 0
    v_mov_b64 v[18:19], 0
    v_mov_b64 v[28:29], 0
    v_pk_mul_f32 v[48:49], v[48:49], v[132:133] op_sel_hi:[1,0]
    v_pk_mul_f32 v[50:51], v[50:51], v[132:133] op_sel_hi:[1,0]
    v_cvt_pk_bf16_f32 v134, v48, v49
    v_cvt_pk_bf16_f32 v135, v50, v51
    ds_write_b64 v0, v[134:135] offset:23048
    v_mov_b64 v[30:31], 0
    v_mov_b64 v[48:49], 0
    v_mov_b64 v[50:51], 0
    v_mov_b64 v[32:33], 0
    v_mov_b64 v[34:35], 0
    v_mov_b64 v[36:37], 0
    v_mov_b64 v[38:39], 0
    v_mov_b64 v[52:53], 0
    v_mov_b64 v[54:55], 0
    s_add_u32 s11, s11, 262144
    s_add_u32 s12, s12, 262144
    s_add_u32 s9, s9, 1
    s_waitcnt lgkmcnt(0)
    s_barrier
    ds_read_b128 v[56:59], v0 offset:22016
    ds_read_b128 v[60:63], v0 offset:23040
    s_add_u32 s10, s10, 8192
    s_and_b32 s10, s10, 0xffff7fff
    s_add_u32 s13, s13, 262144
    s_add_u32 s18, s18, 8192
    s_xor_b32 s61, s17, 16384
    s_waitcnt lgkmcnt(1)
    v_smfmac_f32_16x16x64_bf16 v[16:19], v[56:59], v[192:199], v1
    v_smfmac_f32_16x16x64_bf16 v[20:23], v[56:59], v[208:215], v1
    s_waitcnt lgkmcnt(0)
    v_smfmac_f32_16x16x64_bf16 v[16:19], v[60:63], v[200:207], v1
    ds_read_b128 v[104:107], v2 offset:28672
    v_smfmac_f32_16x16x64_bf16 v[20:23], v[60:63], v[216:223], v1
    ds_read_b128 v[108:111], v2 offset:29696
    v_smfmac_f32_16x16x64_bf16 v[24:27], v[56:59], v[224:231], v1
    ds_read_b128 v[112:115], v2 offset:30720
    v_add_f32 v16, v16, v18
    v_smfmac_f32_16x16x64_bf16 v[24:27], v[60:63], v[232:239], v1
    ds_read_b128 v[116:119], v2 offset:31744
    v_add_f32 v20, v20, v22
    v_smfmac_f32_16x16x64_bf16 v[28:31], v[56:59], v[240:247], v1
    v_add_f32 v17, v17, v19
    v_smfmac_f32_16x16x64_bf16 v[28:31], v[60:63], v[248:255], v1
    v_add_f32 v21, v21, v23
    v_smfmac_f32_16x16x64_bf16 v[32:35], v[56:59], v[64:71], v1
    v_cvt_pk_bf16_f32 v16, v16, v20
    v_bfi_b32 v16, 1, s21, v16
    v_cvt_pk_bf16_f32 v17, v17, v21
    v_add_f32 v24, v24, v26
    v_add_f32 v25, v25, v27
    v_add_f32 v28, v28, v30
    v_add_f32 v29, v29, v31
    v_cvt_pk_bf16_f32 v18, v24, v28
    v_cvt_pk_bf16_f32 v19, v25, v29
    v_smfmac_f32_16x16x64_bf16 v[32:35], v[60:63], v[72:79], v1
    buffer_store_dwordx4 v[16:19], v5, s[4:7], s14 offen sc1
    v_smfmac_f32_16x16x64_bf16 v[36:39], v[56:59], v[80:87], v1
    v_smfmac_f32_16x16x64_bf16 v[36:39], v[60:63], v[88:95], v1
    s_waitcnt lgkmcnt(0)
    v_add_f32 v32, v32, v34
    v_smfmac_f32_16x16x64_bf16 v[48:51], v[56:59], v[96:103], v1
    v_add_f32 v33, v33, v35
    v_smfmac_f32_16x16x64_bf16 v[48:51], v[60:63], v[104:111], v1
    v_add_f32 v36, v36, v38
    v_smfmac_f32_16x16x64_bf16 v[52:55], v[56:59], v[112:119], v1
    v_add_f32 v37, v37, v39
    v_smfmac_f32_16x16x64_bf16 v[52:55], v[60:63], v[120:127], v1
    v_cvt_pk_bf16_f32 v32, v32, v36
    v_bfi_b32 v32, 1, s21, v32
    v_cvt_pk_bf16_f32 v33, v33, v37
    v_add_f32 v48, v48, v50
    v_add_f32 v49, v49, v51
    s_nop 1
    v_add_f32 v52, v52, v54
    v_add_f32 v53, v53, v55
    v_cvt_pk_bf16_f32 v34, v48, v52
    v_cvt_pk_bf16_f32 v35, v49, v53
    buffer_store_dwordx4 v[32:35], v5, s[4:7], s15 offen sc1
    v_mov_b64 v[16:17], 0
    v_mov_b64 v[18:19], 0
    v_mov_b64 v[20:21], 0
    v_mov_b64 v[22:23], 0
    v_mov_b64 v[24:25], 0
    v_mov_b64 v[26:27], 0
    v_mov_b64 v[28:29], 0
    v_mov_b64 v[30:31], 0
    v_mov_b64 v[32:33], 0
    v_mov_b64 v[34:35], 0
    v_mov_b64 v[36:37], 0
    v_mov_b64 v[38:39], 0
    ds_read_b128 v[64:67], v2 offset:0
    ds_read_b128 v[68:71], v2 offset:1024
    ds_read_b128 v[72:75], v2 offset:2048
    ds_read_b128 v[76:79], v2 offset:3072
    ds_read_b128 v[80:83], v2 offset:4096
    ds_read_b128 v[84:87], v2 offset:5120
    ds_read_b128 v[88:91], v2 offset:6144
    ds_read_b128 v[92:95], v2 offset:7168
    s_waitcnt vmcnt(0)
    buffer_load_dwordx4 v[56:59], v0, s[4:7], s16 offen offset:0 sc1
    buffer_load_dwordx4 v[60:63], v0, s[4:7], s16 offen offset:1024 sc1
    ds_read_b128 v[96:99], v2 offset:8192
    ds_read_b128 v[100:103], v2 offset:9216
    ds_read_b128 v[104:107], v2 offset:10240
    ds_read_b128 v[108:111], v2 offset:11264
    ds_read_b128 v[112:115], v2 offset:12288
    ds_read_b128 v[116:119], v2 offset:13312
    s_waitcnt lgkmcnt(0)
    buffer_load_dwordx4 v[40:43], v0, s[4:7], s16 offen offset:0 sc1
    buffer_load_dwordx4 v[44:47], v0, s[4:7], s16 offen offset:1024 sc1
    s_waitcnt vmcnt(3)
    v_mfma_f32_16x16x32_bf16 v[48:51], v[8:11], v[56:59], 0
    s_waitcnt vmcnt(2)
    v_mfma_f32_16x16x32_bf16 v[48:51], v[8:11], v[60:63], v[48:51]
    v_and_b32 v13, 1, v56
    v_and_b32 v12, 1, v60
    v_add_u32 v12, v13, v12
    v_cmp_ne_u32 vcc, s60, v12
    s_nop 2
    v_add_f32_dpp v48, v48, v48 row_ror:4 row_mask:0xf bank_mask:0xf
    v_add_f32_dpp v49, v49, v49 row_ror:4 row_mask:0xf bank_mask:0xf
    s_cbranch_vccnz R3s_p1
    v_add_f32_dpp v48, v48, v48 row_ror:8 row_mask:0xf bank_mask:0xf
    v_add_f32_dpp v49, v49, v49 row_ror:8 row_mask:0xf bank_mask:0xf
    v_cvt_pk_bf16_f32 v15, v48, v49
    buffer_store_dword v15, v6, s[4:7], s17 offen sc1
R3s_p1_ok:
    buffer_load_dwordx4 v[56:59], v0, s[4:7], s10 offen offset:0 sc1
    s_cmp_eq_u32 s9, 63
    s_cbranch_scc1 R3s_fin
    s_xor_b32 s14, s14, 262144
    s_xor_b32 s15, s15, 262144
    s_add_u32 s17, s17, 8192
    s_and_b32 s17, s17, 0xffff7fff
    s_xor_b32 s16, s16, 262144
    s_min_u32 s99, s19, 31
    s_and_b32 s60, s9, 2
    s_lshr_b32 s21, s60, 1
    ds_read_b128 v[120:123], v2 offset:14336
    ds_read_b128 v[124:127], v2 offset:15360
    ds_read_b128 v[128:131], v2 offset:16384
    ds_read_b128 v[132:135], v2 offset:17408
    s_waitcnt lgkmcnt(0)
    buffer_load_dwordx4 v[56:59], v0, s[4:7], s10 offen offset:0 sc1
    s_branch R3s_top
R3s_pe_to:
    s_mov_b32 s99, 31
    s_waitcnt vmcnt(0)
    v_max3_u32 v7, v56, v57, v58
    v_max_u32 v7, v7, v59
    v_cmp_eq_u32 vcc, -1, v7
    ds_write_b128 v0, v[56:59] offset:6144
    s_cbranch_vccz R3s_pe_go
    s_sub_u32 s19, s19, 32
    s_cbranch_scc0 R3s_pe
    s_mov_b32 s19, 0
    s_mov_b32 s99, 0
    s_branch R3s_pe_go
R3s_po:
    buffer_load_dwordx4 v[60:63], v0, s[4:7], s10 offen offset:1024 sc1
    s_sub_u32 s19, s19, 1
    s_cbranch_scc1 R3s_po_to
    s_waitcnt vmcnt(0)
    ds_write_b128 v0, v[60:63] offset:7168
    v_max3_u32 v7, v60, v61, v62
    v_max_u32 v7, v7, v63
    v_cmp_eq_u32 vcc, -1, v7
    s_cbranch_vccnz R3s_po
    s_branch R3s_po_ok
R3s_po_to:
    s_mov_b32 s19, 0
    s_waitcnt vmcnt(0)
    ds_write_b128 v0, v[60:63] offset:7168
    s_branch R3s_po_ok
R3s_p1:
    buffer_load_dwordx4 v[56:59], v0, s[4:7], s16 offen offset:0 sc1
    buffer_load_dwordx4 v[60:63], v0, s[4:7], s16 offen offset:1024 sc1
    s_waitcnt vmcnt(3)
    v_mfma_f32_16x16x32_bf16 v[48:51], v[8:11], v[40:43], 0
    s_waitcnt vmcnt(2)
    v_mfma_f32_16x16x32_bf16 v[48:51], v[8:11], v[44:47], v[48:51]
    v_and_b32 v13, 1, v40
    v_and_b32 v12, 1, v44
    v_add_u32 v12, v13, v12
    v_cmp_ne_u32 vcc, s60, v12
    s_nop 2
    v_add_f32_dpp v48, v48, v48 row_ror:4 row_mask:0xf bank_mask:0xf
    v_add_f32_dpp v49, v49, v49 row_ror:4 row_mask:0xf bank_mask:0xf
    s_cbranch_vccnz R3s_p1b
    v_add_f32_dpp v48, v48, v48 row_ror:8 row_mask:0xf bank_mask:0xf
    v_add_f32_dpp v49, v49, v49 row_ror:8 row_mask:0xf bank_mask:0xf
    v_cvt_pk_bf16_f32 v15, v48, v49
    buffer_store_dword v15, v6, s[4:7], s17 offen sc1
    s_branch R3s_p1_ok
R3s_p1b:
    buffer_load_dwordx4 v[40:43], v0, s[4:7], s16 offen offset:0 sc1
    buffer_load_dwordx4 v[44:47], v0, s[4:7], s16 offen offset:1024 sc1
    s_sub_u32 s19, s19, 1
    s_cbranch_scc1 R3s_p1_to
    s_waitcnt vmcnt(3)
    v_mfma_f32_16x16x32_bf16 v[48:51], v[8:11], v[56:59], 0
    s_waitcnt vmcnt(2)
    v_mfma_f32_16x16x32_bf16 v[48:51], v[8:11], v[60:63], v[48:51]
    v_and_b32 v13, 1, v56
    v_and_b32 v12, 1, v60
    v_add_u32 v12, v13, v12
    v_cmp_ne_u32 vcc, s60, v12
    s_nop 2
    v_add_f32_dpp v48, v48, v48 row_ror:4 row_mask:0xf bank_mask:0xf
    v_add_f32_dpp v49, v49, v49 row_ror:4 row_mask:0xf bank_mask:0xf
    s_cbranch_vccnz R3s_p1
    v_add_f32_dpp v48, v48, v48 row_ror:8 row_mask:0xf bank_mask:0xf
    v_add_f32_dpp v49, v49, v49 row_ror:8 row_mask:0xf bank_mask:0xf
    v_cvt_pk_bf16_f32 v15, v48, v49
    buffer_store_dword v15, v6, s[4:7], s17 offen sc1
    s_branch R3s_p1_ok
R3s_p1_to:
    s_mov_b32 s19, 0
    v_add_f32_dpp v48, v48, v48 row_ror:8 row_mask:0xf bank_mask:0xf
    v_add_f32_dpp v49, v49, v49 row_ror:8 row_mask:0xf bank_mask:0xf
    v_cvt_pk_bf16_f32 v15, v48, v49
    buffer_store_dword v15, v6, s[4:7], s17 offen sc1
    s_branch R3s_p1_ok
R3s_fin:
    buffer_store_dword v15, v6, s[4:7], s18 offen sc1
    s_waitcnt vmcnt(0)
    buffer_wbl2 sc1
    s_branch L_end
L_end:
    s_endpgm
.section .rodata,"a"
.p2align 6
.amdhsa_kernel gated_mix__memory_aug_recurrent_mem_tr__softmax_full_mha__prompt_kernel
  .amdhsa_next_free_vgpr 512
  .amdhsa_next_free_sgpr 102
  .amdhsa_accum_offset 256
  .amdhsa_group_segment_fixed_size 0
  .amdhsa_kernarg_size 112
  .amdhsa_user_sgpr_count 2
  .amdhsa_user_sgpr_kernarg_segment_ptr 1
  .amdhsa_system_sgpr_workgroup_id_x 1
.end_amdhsa_kernel
```
